```python
import torch

def _softmax(x, axis=-1):
    return torch.softmax(x, dim=axis)
def _gelu(x):
    return torch.nn.functional.gelu(x, approximate="tanh")
def _silu(x):
    return torch.nn.functional.silu(x)
def _sigmoid(x):
    return torch.sigmoid(x)
def _layernorm(x, axis=-1, eps=1e-5):
    m = x.mean(dim=axis, keepdim=True)
    v = x.var(dim=axis, keepdim=True, unbiased=False)
    return (x - m) / torch.sqrt(v + eps)
def _scatter_add(tgt, idx, src, axis=0):
    return tgt.clone().index_add_(axis, idx, src)
def _segment_sum(src, seg, n):
    out = torch.zeros((n,) + src.shape[1:], dtype=src.dtype)
    return out.index_add_(0, seg, src)
def _pad(x, pw):
    flat = tuple(v for pair in reversed(pw) for v in pair)
    return torch.nn.functional.pad(x, flat)

kernel_name = 'standalone__mha_block_cached__near_ridge'

def setup_inputs():

    _w = (lambda a: (lambda t: t.to(torch.bfloat16) if t.is_floating_point() else t)(torch.as_tensor(a)))
    B, Sq, D = 16, 208, 1024
    H, Sk, Dh = 32, 1024, 128
    return {
        "x": _w((lambda *s: torch.randn(*s, dtype=torch.bfloat16) * 0.8)(B, Sq, D)),
        "k_cache": _w((lambda *s: torch.randn(*s, dtype=torch.bfloat16) * 0.8)(B, H, Sk, Dh)),
        "v_cache": _w((lambda *s: torch.randn(*s, dtype=torch.bfloat16) * 0.05)(B, H, Sk, Dh)),
        "wq": _w((lambda *s: torch.randn(*s, dtype=torch.bfloat16) * 0.8)(D, H * Dh) * (D ** -0.5)),
        "wo": _w((lambda *s: torch.randn(*s, dtype=torch.bfloat16) * 0.05)(H * Dh, D) * ((H * Dh) ** -0.5)),
    }

def reference(x, k_cache, v_cache, wq, wo):
    B, Sq, D = x.shape
    H, Dh = 32, 128
    q = (lambda x, *d: x.permute(*d))((x @ wq).reshape(B, Sq, H, Dh), 0, 2, 1, 3)
    scores = torch.einsum("bhqd,bhkd->bhqk", q, k_cache) * (Dh ** -0.5)
    p = _softmax(scores, axis=-1)
    o = torch.einsum("bhqk,bhkd->bhqd", p, v_cache)
    return (lambda x, *d: x.permute(*d))(o, 0, 2, 1, 3).reshape(B, Sq, H * Dh) @ wo
```

```asm
; @launch grid=(256,1,1) block=(256,1,1) lds=163840
.amdgcn_target "amdgcn-amd-amdhsa--gfx950"
.text
.globl standalone__mha_block_cached__near_ridge_kernel
.p2align 8
.type standalone__mha_block_cached__near_ridge_kernel,@function
standalone__mha_block_cached__near_ridge_kernel:
  s_cmp_ge_u32 s2, 256
  s_cbranch_scc1 L1_end
  s_load_dwordx8 s[28:35], s[0:1], 0
  s_load_dwordx8 s[92:99], s[0:1], 32
  v_lshrrev_b32 v2, 6, v0
  v_and_b32 v1, 63, v0
  v_readfirstlane_b32 s3, v2
  s_and_b32 s46, s2, 7
  s_lshr_b32 s47, s2, 3
  s_and_b32 s6, s46, 1
  s_lshl_b32 s6, s6, 3
  s_and_b32 s48, s47, 7
  s_add_u32 s6, s6, s48
  s_lshr_b32 s7, s46, 1
  s_lshl_b32 s7, s7, 2
  s_lshr_b32 s48, s47, 3
  s_add_u32 s7, s7, s48
  s_lshr_b32 s4, s3, 1
  s_and_b32 s5, s3, 1
  s_lshl_b32 s7, s7, 1
  s_add_u32 s7, s7, s4
  s_lshl_b32 s40, s4, 15
  s_lshl_b32 s41, s4, 16
  s_lshl_b32 s42, s4, 14
  s_add_u32 s42, s42, 131072
  v_lshrrev_b32 v2, 3, v1
  v_and_b32 v3, 6, v2
  v_and_b32 v4, 7, v1
  v_xor_b32 v4, v4, v3
  v_lshlrev_b32 v4, 4, v4
  v_lshl_add_u32 v4, v2, 11, v4
  s_lshl_b32 s47, s4, 14
  v_add_u32 v4, s47, v4
  v_lshrrev_b32 v2, 4, v1
  v_lshlrev_b32 v3, 2, v2
  v_and_b32 v5, 15, v1
  v_xor_b32 v5, v5, v3
  v_lshlrev_b32 v5, 4, v5
  v_lshl_add_u32 v5, v2, 13, v5
  v_lshlrev_b32 v3, 1, v2
  v_and_b32 v6, 15, v1
  v_xor_b32 v6, v6, v3
  v_lshlrev_b32 v6, 4, v6
  v_lshl_add_u32 v6, v2, 8, v6
  v_xor_b32 v31, 4224, v6
  s_mov_b32 s43, 0
  s_mov_b32 s44, 0
  s_mov_b32 s55, 0
  s_lshr_b32 s39, s2, 3
  s_lshl_b32 s46, s2, 2
  s_add_u32 s39, s39, s46
  s_lshl_b32 s46, s4, 4
  s_add_u32 s39, s39, s46
  s_and_b32 s39, s39, 31
  s_lshl_b32 s39, s39, 13
  s_mov_b32 s45, s39
  s_waitcnt lgkmcnt(0)
  s_mul_i32 s46, s6, 425984
  s_add_u32 s8, s28, s46
  s_addc_u32 s9, s29, 0
  s_mov_b32 s10, 425984
  s_mov_b32 s11, 131072
  s_lshl_b32 s46, s7, 8
  s_add_u32 s12, s34, s46
  s_addc_u32 s13, s35, 0
  s_sub_u32 s14, 8388608, s46
  s_mov_b32 s15, 131072
  s_lshl_b32 s46, s6, 5
  s_add_u32 s46, s46, s7
  s_lshl_b32 s46, s46, 18
  s_add_u32 s16, s30, s46
  s_addc_u32 s17, s31, 0
  s_mov_b32 s18, 262144
  s_mov_b32 s19, 131072
  s_add_u32 s20, s32, s46
  s_addc_u32 s21, s33, 0
  s_mov_b32 s22, 262144
  s_mov_b32 s23, 131072
  s_lshl_b32 s46, s6, 22
  s_add_u32 s24, s98, s46
  s_addc_u32 s25, s99, 0
  s_mov_b32 s26, 4194304
  s_mov_b32 s27, 131072
  s_cmp_eq_u32 s5, 0
  s_cbranch_scc1 L1a_start
L1b_start:
  s_add_u32 m0, s41, 8192
  s_add_u32 s46, s44, 0
  buffer_load_dwordx4 v5, s[12:15], s46 offen offset:0 lds
  s_add_u32 s47, s44, 31744
  buffer_load_dwordx4 v5, s[12:15], s47 offen offset:1024 lds
  s_add_u32 s46, s44, 63488
  buffer_load_dwordx4 v5, s[12:15], s46 offen offset:2048 lds
  s_add_u32 s47, s44, 95232
  buffer_load_dwordx4 v5, s[12:15], s47 offen offset:3072 lds
  s_add_u32 m0, s41, 12288
  s_add_u32 s46, s44, 131072
  buffer_load_dwordx4 v5, s[12:15], s46 offen offset:0 lds
  s_add_u32 s47, s44, 162816
  buffer_load_dwordx4 v5, s[12:15], s47 offen offset:1024 lds
  s_add_u32 s46, s44, 194560
  buffer_load_dwordx4 v5, s[12:15], s46 offen offset:2048 lds
  s_add_u32 s47, s44, 226304
  buffer_load_dwordx4 v5, s[12:15], s47 offen offset:3072 lds
  s_add_u32 s44, s44, 262144
  s_add_u32 m0, s40, 0
  s_add_u32 s46, s43, 0
  buffer_load_dwordx4 v4, s[8:11], s46 offen offset:0 lds
  s_add_u32 m0, s40, 1024
  s_add_u32 s47, s43, 32768
  buffer_load_dwordx4 v4, s[8:11], s47 offen offset:0 lds
  s_add_u32 m0, s40, 2048
  s_add_u32 s46, s43, 65536
  buffer_load_dwordx4 v4, s[8:11], s46 offen offset:0 lds
  s_add_u32 m0, s40, 3072
  s_add_u32 s47, s43, 98304
  buffer_load_dwordx4 v4, s[8:11], s47 offen offset:0 lds
  s_add_u32 m0, s40, 4096
  s_add_u32 s46, s43, 131072
  buffer_load_dwordx4 v4, s[8:11], s46 offen offset:0 lds
  s_add_u32 m0, s40, 5120
  s_add_u32 s47, s43, 163840
  buffer_load_dwordx4 v4, s[8:11], s47 offen offset:0 lds
  s_add_u32 m0, s40, 6144
  s_add_u32 s46, s43, 196608
  buffer_load_dwordx4 v4, s[8:11], s46 offen offset:0 lds
  s_add_u32 m0, s40, 65536
  s_add_u32 s47, s43, 229376
  buffer_load_dwordx4 v4, s[8:11], s47 offen offset:0 lds
  s_add_u32 m0, s40, 66560
  s_add_u32 s46, s43, 262144
  buffer_load_dwordx4 v4, s[8:11], s46 offen offset:0 lds
  s_add_u32 m0, s40, 67584
  s_add_u32 s47, s43, 294912
  buffer_load_dwordx4 v4, s[8:11], s47 offen offset:0 lds
  s_add_u32 m0, s40, 68608
  s_add_u32 s46, s43, 327680
  buffer_load_dwordx4 v4, s[8:11], s46 offen offset:0 lds
  s_add_u32 m0, s40, 69632
  s_add_u32 s47, s43, 360448
  buffer_load_dwordx4 v4, s[8:11], s47 offen offset:0 lds
  s_add_u32 m0, s40, 70656
  s_add_u32 s46, s43, 393216
  buffer_load_dwordx4 v4, s[8:11], s46 offen offset:0 lds
  s_add_u32 s43, s43, 128
  s_add_u32 m0, s41, 40960
  s_add_u32 s46, s44, 0
  buffer_load_dwordx4 v5, s[12:15], s46 offen offset:0 lds
  s_add_u32 s47, s44, 31744
  buffer_load_dwordx4 v5, s[12:15], s47 offen offset:1024 lds
  s_add_u32 s46, s44, 63488
  buffer_load_dwordx4 v5, s[12:15], s46 offen offset:2048 lds
  s_add_u32 s47, s44, 95232
  buffer_load_dwordx4 v5, s[12:15], s47 offen offset:3072 lds
  s_add_u32 m0, s41, 45056
  s_add_u32 s46, s44, 131072
  buffer_load_dwordx4 v5, s[12:15], s46 offen offset:0 lds
  s_add_u32 s47, s44, 162816
  buffer_load_dwordx4 v5, s[12:15], s47 offen offset:1024 lds
  s_add_u32 s46, s44, 194560
  buffer_load_dwordx4 v5, s[12:15], s46 offen offset:2048 lds
  s_add_u32 s47, s44, 226304
  buffer_load_dwordx4 v5, s[12:15], s47 offen offset:3072 lds
  s_add_u32 s44, s44, 262144
  v_lshrrev_b32 v2, 4, v1
  v_and_b32 v29, 15, v1
  v_and_b32 v3, 6, v29
  v_xor_b32 v3, v3, v2
  v_lshlrev_b32 v7, 4, v3
  v_and_b32 v3, 7, v29
  v_lshl_add_u32 v7, v3, 7, v7
  v_lshrrev_b32 v3, 3, v29
  v_lshl_add_u32 v7, v3, 15, v7
  s_lshl_b32 s46, s5, 16
  v_add_u32 v7, s46, v7
  v_xor_b32 v8, 64, v7
  v_lshlrev_b32 v9, 4, v29
  v_lshrrev_b32 v3, 2, v29
  v_lshl_add_u32 v9, v3, 8, v9
  v_lshl_add_u32 v9, v2, 11, v9
  v_add_u32 v9, s41, v9
  v_xor_b32 v10, 64, v9
  v_xor_b32 v11, 128, v9
  v_xor_b32 v12, 192, v9
  v_and_b32 v13, 3, v29
  v_lshrrev_b32 v3, 3, v29
  v_lshl_add_u32 v13, v3, 2, v13
  v_and_b32 v3, 4, v29
  v_lshl_add_u32 v13, v3, 2, v13
  v_lshlrev_b32 v13, 8, v13
  v_and_b32 v3, 7, v29
  v_lshlrev_b32 v3, 1, v3
  v_xor_b32 v3, v3, v2
  v_lshl_add_u32 v13, v3, 4, v13
  v_add_u32 v13, s41, v13
  v_xor_b32 v14, 64, v13
  v_xor_b32 v15, 128, v13
  v_xor_b32 v16, 192, v13
  s_sub_u32 s48, s42, s41
  v_add_u32 v24, s48, v13
  v_add_u32 v25, s48, v14
  v_add_u32 v26, s48, v15
  v_add_u32 v27, s48, v16
  v_lshrrev_b32 v29, 2, v1
  v_and_b32 v17, 3, v29
  v_lshrrev_b32 v3, 3, v29
  v_lshl_add_u32 v17, v3, 2, v17
  v_and_b32 v3, 4, v29
  v_lshl_add_u32 v17, v3, 2, v17
  v_lshlrev_b32 v17, 8, v17
  v_and_b32 v3, 7, v29
  v_lshl_add_u32 v17, v3, 5, v17
  v_and_b32 v3, 3, v1
  v_lshl_add_u32 v17, v3, 3, v17
  s_add_u32 s47, s41, 32768
  v_add_u32 v17, s47, v17
  v_xor_b32 v18, 32, v17
  v_xor_b32 v19, 64, v17
  v_xor_b32 v20, 96, v17
  v_xor_b32 v21, 128, v17
  v_xor_b32 v22, 160, v17
  v_xor_b32 v23, 192, v17
  v_xor_b32 v28, 224, v17
  v_lshlrev_b32 v3, 3, v2
  v_mov_b32 v30, 100860416
  v_lshrrev_b32 v30, v3, v30
  v_and_b32 v30, 255, v30
  v_lshlrev_b32 v30, 8, v30
  v_and_b32 v3, 15, v1
  v_lshl_add_u32 v30, v3, 4, v30
  s_lshr_b32 s54, s7, 3
  s_lshl_b32 s54, s54, 4
  s_and_b32 s46, s7, 7
  s_add_u32 s54, s54, s46
  s_mul_i32 s54, s54, 53248
  s_mul_i32 s46, s5, 14336
  s_add_u32 s54, s54, s46
  s_mov_b32 s52, 0x3e0293ee
  s_mov_b32 s53, 0x3e0293ee
  s_mov_b32 s51, 0
  s_mov_b32 s50, 0
  v_mov_b32 v32, 0
  v_mov_b32 v33, 0
  v_mov_b32 v34, 0
  v_mov_b32 v35, 0
  v_mov_b32 v36, 0
  v_mov_b32 v37, 0
  v_mov_b32 v38, 0
  v_mov_b32 v39, 0
  v_mov_b32 v40, 0
  v_mov_b32 v41, 0
  v_mov_b32 v42, 0
  v_mov_b32 v43, 0
  v_mov_b32 v44, 0
  v_mov_b32 v45, 0
  v_mov_b32 v46, 0
  v_mov_b32 v47, 0
  v_mov_b32 v48, 0
  v_mov_b32 v49, 0
  v_mov_b32 v50, 0
  v_mov_b32 v51, 0
  v_mov_b32 v52, 0
  v_mov_b32 v53, 0
  v_mov_b32 v54, 0
  v_mov_b32 v55, 0
  v_mov_b32 v56, 0
  v_mov_b32 v57, 0
  v_mov_b32 v58, 0
  v_mov_b32 v59, 0
  v_mov_b32 v60, 0
  v_mov_b32 v61, 0
  v_mov_b32 v62, 0
  v_mov_b32 v63, 0
  v_mov_b32 v64, 0
  v_mov_b32 v65, 0
  v_mov_b32 v66, 0
  v_mov_b32 v67, 0
  v_mov_b32 v68, 0
  v_mov_b32 v69, 0
  v_mov_b32 v70, 0
  v_mov_b32 v71, 0
  v_mov_b32 v72, 0
  v_mov_b32 v73, 0
  v_mov_b32 v74, 0
  v_mov_b32 v75, 0
  v_mov_b32 v76, 0
  v_mov_b32 v77, 0
  v_mov_b32 v78, 0
  v_mov_b32 v79, 0
  v_mov_b32 v80, 0
  v_mov_b32 v81, 0
  v_mov_b32 v82, 0
  v_mov_b32 v83, 0
  v_mov_b32 v84, 0
  v_mov_b32 v85, 0
  v_mov_b32 v86, 0
  v_mov_b32 v87, 0
  v_mov_b32 v88, 0
  v_mov_b32 v89, 0
  v_mov_b32 v90, 0
  v_mov_b32 v91, 0
  v_mov_b32 v92, 0
  v_mov_b32 v93, 0
  v_mov_b32 v94, 0
  v_mov_b32 v95, 0
  v_mov_b32 v96, 0
  v_mov_b32 v97, 0
  v_mov_b32 v98, 0
  v_mov_b32 v99, 0
  v_mov_b32 v100, 0
  v_mov_b32 v101, 0
  v_mov_b32 v102, 0
  v_mov_b32 v103, 0
  v_mov_b32 v104, 0
  v_mov_b32 v105, 0
  v_mov_b32 v106, 0
  v_mov_b32 v107, 0
  v_mov_b32 v108, 0
  v_mov_b32 v109, 0
  v_mov_b32 v110, 0
  v_mov_b32 v111, 0
  v_mov_b32 v112, 0
  v_mov_b32 v113, 0
  v_mov_b32 v114, 0
  v_mov_b32 v115, 0
  v_mov_b32 v116, 0
  v_mov_b32 v117, 0
  v_mov_b32 v118, 0
  v_mov_b32 v119, 0
  v_mov_b32 v120, 0
  v_mov_b32 v121, 0
  v_mov_b32 v122, 0
  v_mov_b32 v123, 0
  v_mov_b32 v124, 0
  v_mov_b32 v125, 0
  v_mov_b32 v126, 0
  v_mov_b32 v127, 0
  v_mov_b32 v128, 0
  v_mov_b32 v129, 0
  v_mov_b32 v130, 0
  v_mov_b32 v131, 0
  v_mov_b32 v132, 0
  v_mov_b32 v133, 0
  v_mov_b32 v134, 0
  v_mov_b32 v135, 0
  v_mov_b32 v136, 0
  v_mov_b32 v137, 0
  v_mov_b32 v138, 0
  v_mov_b32 v139, 0
  v_mov_b32 v140, 0
  v_mov_b32 v141, 0
  v_mov_b32 v142, 0
  v_mov_b32 v143, 0
  v_mov_b32 v144, 0
  v_mov_b32 v145, 0
  v_mov_b32 v146, 0
  v_mov_b32 v147, 0
  v_mov_b32 v148, 0
  v_mov_b32 v149, 0
  v_mov_b32 v150, 0
  v_mov_b32 v151, 0
  v_mov_b32 v152, 0
  v_mov_b32 v153, 0
  v_mov_b32 v154, 0
  v_mov_b32 v155, 0
  v_mov_b32 v156, 0
  v_mov_b32 v157, 0
  v_mov_b32 v158, 0
  v_mov_b32 v159, 0
  v_mov_b32 v160, 0
  v_mov_b32 v161, 0
  v_mov_b32 v162, 0
  v_mov_b32 v163, 0
  v_mov_b32 v164, 0
  v_mov_b32 v165, 0
  v_mov_b32 v166, 0
  v_mov_b32 v167, 0
  v_mov_b32 v168, 0
  v_mov_b32 v169, 0
  v_mov_b32 v170, 0
  v_mov_b32 v171, 0
  v_mov_b32 v172, 0
  v_mov_b32 v173, 0
  v_mov_b32 v174, 0
  v_mov_b32 v175, 0
  v_mov_b32 v176, 0
  v_mov_b32 v177, 0
  v_mov_b32 v178, 0
  v_mov_b32 v179, 0
  v_mov_b32 v180, 0
  v_mov_b32 v181, 0
  v_mov_b32 v182, 0
  v_mov_b32 v183, 0
  v_mov_b32 v184, 0
  v_mov_b32 v185, 0
  v_mov_b32 v186, 0
  v_mov_b32 v187, 0
  v_mov_b32 v188, 0
  v_mov_b32 v189, 0
  v_mov_b32 v190, 0
  v_mov_b32 v191, 0
  v_mov_b32 v192, 0
  v_mov_b32 v193, 0
  v_mov_b32 v194, 0
  v_mov_b32 v195, 0
  v_mov_b32 v196, 0
  v_mov_b32 v197, 0
  v_mov_b32 v198, 0
  v_mov_b32 v199, 0
  v_mov_b32 v200, 0
  v_mov_b32 v201, 0
  v_mov_b32 v202, 0
  v_mov_b32 v203, 0
  v_mov_b32 v204, 0
  v_mov_b32 v205, 0
  v_mov_b32 v206, 0
  v_mov_b32 v207, 0
  v_mov_b32 v208, 0
  v_mov_b32 v209, 0
  v_mov_b32 v210, 0
  v_mov_b32 v211, 0
  v_mov_b32 v212, 0
  v_mov_b32 v213, 0
  v_mov_b32 v214, 0
  v_mov_b32 v215, 0
  v_mov_b32 v216, 0
  v_mov_b32 v217, 0
  v_mov_b32 v218, 0
  v_mov_b32 v219, 0
  v_mov_b32 v220, 0
  v_mov_b32 v221, 0
  v_mov_b32 v222, 0
  v_mov_b32 v223, 0
  s_add_u32 s43, s43, 128
  s_add_u32 s44, s44, 262144
  s_add_u32 s55, s55, 8192
  s_xor_b32 s45, s55, s39
  s_waitcnt vmcnt(8)
  s_barrier
  ds_read_b64_tr_b16 a[112:113], v9 offset:8192
  ds_read_b64_tr_b16 a[114:115], v9 offset:9216
  ds_read_b64_tr_b16 a[116:117], v9 offset:8200
  ds_read_b64_tr_b16 a[118:119], v9 offset:9224
  ds_read_b64_tr_b16 a[120:121], v10 offset:8192
  ds_read_b64_tr_b16 a[122:123], v10 offset:9216
  ds_read_b64_tr_b16 a[124:125], v10 offset:8200
  ds_read_b64_tr_b16 a[126:127], v10 offset:9224
  ds_read_b64_tr_b16 a[128:129], v11 offset:8192
  ds_read_b64_tr_b16 a[130:131], v11 offset:9216
  ds_read_b64_tr_b16 a[132:133], v11 offset:8200
  ds_read_b64_tr_b16 a[134:135], v11 offset:9224
  ds_read_b64_tr_b16 a[136:137], v12 offset:8192
  ds_read_b64_tr_b16 a[138:139], v12 offset:9216
  ds_read_b64_tr_b16 a[140:141], v12 offset:8200
  s_waitcnt lgkmcnt(8)
  ds_read_b64_tr_b16 a[142:143], v12 offset:9224
  ds_read_b128 a[0:3], v7 offset:0
  ds_read_b128 a[4:7], v7 offset:1024
  ds_read_b128 a[8:11], v7 offset:2048
  ds_read_b128 a[12:15], v7 offset:3072
  ds_read_b128 a[16:19], v7 offset:4096
  ds_read_b128 a[20:23], v7 offset:5120
  s_waitcnt lgkmcnt(8)
  ds_read_b128 a[28:31], v8 offset:0
  ds_read_b128 a[32:35], v8 offset:1024
  ds_read_b128 a[36:39], v8 offset:2048
  ds_read_b128 a[40:43], v8 offset:3072
  ds_read_b128 a[44:47], v8 offset:4096
  ds_read_b128 a[48:51], v8 offset:5120
  s_add_u32 m0, s41, 57344
  s_add_u32 s46, s44, 0
  buffer_load_dwordx4 v5, s[12:15], s46 offen offset:0 lds
  s_add_u32 s47, s44, 31744
  buffer_load_dwordx4 v5, s[12:15], s47 offen offset:1024 lds
  s_add_u32 s46, s44, 63488
  buffer_load_dwordx4 v5, s[12:15], s46 offen offset:2048 lds
  s_add_u32 s47, s44, 95232
  buffer_load_dwordx4 v5, s[12:15], s47 offen offset:3072 lds
  s_add_u32 m0, s41, 61440
  s_add_u32 s46, s44, 131072
  buffer_load_dwordx4 v5, s[12:15], s46 offen offset:0 lds
  s_add_u32 s47, s44, 162816
  buffer_load_dwordx4 v5, s[12:15], s47 offen offset:1024 lds
  s_add_u32 s46, s44, 194560
  buffer_load_dwordx4 v5, s[12:15], s46 offen offset:2048 lds
  s_add_u32 s47, s44, 226304
  buffer_load_dwordx4 v5, s[12:15], s47 offen offset:3072 lds
  s_add_u32 s44, s44, 262144
  s_waitcnt vmcnt(8)
L1b_qloop:
  s_waitcnt vmcnt(29) lgkmcnt(0)
  s_barrier
  v_mfma_f32_16x16x32_bf16 v[32:35], a[112:115], a[0:3], v[32:35]
  ds_read_b64_tr_b16 a[144:145], v9 offset:40960
  v_mfma_f32_16x16x32_bf16 v[36:39], a[116:119], a[0:3], v[36:39]
  s_add_u32 m0, s40, 0
  ds_read_b64_tr_b16 a[146:147], v9 offset:41984
  v_mfma_f32_16x16x32_bf16 v[40:43], a[120:123], a[0:3], v[40:43]
  s_add_u32 s46, s43, 0
  buffer_load_dwordx4 v4, s[8:11], s46 offen offset:0 lds
  v_mfma_f32_16x16x32_bf16 v[44:47], a[124:127], a[0:3], v[44:47]
  s_add_u32 m0, s40, 1024
  v_mfma_f32_16x16x32_bf16 v[48:51], a[128:131], a[0:3], v[48:51]
  s_add_u32 s47, s43, 32768
  buffer_load_dwordx4 v4, s[8:11], s47 offen offset:0 lds
  v_mfma_f32_16x16x32_bf16 v[52:55], a[132:135], a[0:3], v[52:55]
  ds_read_b64_tr_b16 a[148:149], v9 offset:40968
  v_mfma_f32_16x16x32_bf16 v[56:59], a[136:139], a[0:3], v[56:59]
  s_add_u32 m0, s40, 2048
  ds_read_b64_tr_b16 a[150:151], v9 offset:41992
  v_mfma_f32_16x16x32_bf16 v[60:63], a[140:143], a[0:3], v[60:63]
  s_add_u32 s46, s43, 65536
  buffer_load_dwordx4 v4, s[8:11], s46 offen offset:0 lds
  v_mfma_f32_16x16x32_bf16 v[64:67], a[112:115], a[4:7], v[64:67]
  v_mfma_f32_16x16x32_bf16 v[68:71], a[116:119], a[4:7], v[68:71]
  s_add_u32 m0, s40, 3072
  ds_read_b64_tr_b16 a[152:153], v10 offset:40960
  v_mfma_f32_16x16x32_bf16 v[72:75], a[120:123], a[4:7], v[72:75]
  s_add_u32 s47, s43, 98304
  buffer_load_dwordx4 v4, s[8:11], s47 offen offset:0 lds
  v_mfma_f32_16x16x32_bf16 v[76:79], a[124:127], a[4:7], v[76:79]
  v_mfma_f32_16x16x32_bf16 v[80:83], a[128:131], a[4:7], v[80:83]
  s_add_u32 m0, s40, 4096
  ds_read_b64_tr_b16 a[154:155], v10 offset:41984
  v_mfma_f32_16x16x32_bf16 v[84:87], a[132:135], a[4:7], v[84:87]
  s_add_u32 s46, s43, 131072
  buffer_load_dwordx4 v4, s[8:11], s46 offen offset:0 lds
  v_mfma_f32_16x16x32_bf16 v[88:91], a[136:139], a[4:7], v[88:91]
  ds_read_b64_tr_b16 a[156:157], v10 offset:40968
  v_mfma_f32_16x16x32_bf16 v[92:95], a[140:143], a[4:7], v[92:95]
  s_add_u32 m0, s40, 5120
  v_mfma_f32_16x16x32_bf16 v[96:99], a[112:115], a[8:11], v[96:99]
  s_add_u32 s47, s43, 163840
  buffer_load_dwordx4 v4, s[8:11], s47 offen offset:0 lds
  v_mfma_f32_16x16x32_bf16 v[100:103], a[116:119], a[8:11], v[100:103]
  ds_read_b64_tr_b16 a[158:159], v10 offset:41992
  v_mfma_f32_16x16x32_bf16 v[104:107], a[120:123], a[8:11], v[104:107]
  s_add_u32 m0, s40, 6144
  v_mfma_f32_16x16x32_bf16 v[108:111], a[124:127], a[8:11], v[108:111]
  s_add_u32 s46, s43, 196608
  buffer_load_dwordx4 v4, s[8:11], s46 offen offset:0 lds
  v_mfma_f32_16x16x32_bf16 v[112:115], a[128:131], a[8:11], v[112:115]
  ds_read_b64_tr_b16 a[160:161], v11 offset:40960
  v_mfma_f32_16x16x32_bf16 v[116:119], a[132:135], a[8:11], v[116:119]
  s_add_u32 m0, s41, 8192
  ds_read_b64_tr_b16 a[162:163], v11 offset:41984
  v_mfma_f32_16x16x32_bf16 v[120:123], a[136:139], a[8:11], v[120:123]
  s_add_u32 s46, s44, 0
  buffer_load_dwordx4 v5, s[12:15], s46 offen offset:0 lds
  v_mfma_f32_16x16x32_bf16 v[124:127], a[140:143], a[8:11], v[124:127]
  v_mfma_f32_16x16x32_bf16 v[128:131], a[112:115], a[12:15], v[128:131]
  s_add_u32 s47, s44, 31744
  buffer_load_dwordx4 v5, s[12:15], s47 offen offset:1024 lds
  v_mfma_f32_16x16x32_bf16 v[132:135], a[116:119], a[12:15], v[132:135]
  ds_read_b64_tr_b16 a[164:165], v11 offset:40968
  v_mfma_f32_16x16x32_bf16 v[136:139], a[120:123], a[12:15], v[136:139]
  ds_read_b64_tr_b16 a[166:167], v11 offset:41992
  v_mfma_f32_16x16x32_bf16 v[140:143], a[124:127], a[12:15], v[140:143]
  s_add_u32 s46, s44, 63488
  buffer_load_dwordx4 v5, s[12:15], s46 offen offset:2048 lds
  v_mfma_f32_16x16x32_bf16 v[144:147], a[128:131], a[12:15], v[144:147]
  v_mfma_f32_16x16x32_bf16 v[148:151], a[132:135], a[12:15], v[148:151]
  ds_read_b64_tr_b16 a[168:169], v12 offset:40960
  v_mfma_f32_16x16x32_bf16 v[152:155], a[136:139], a[12:15], v[152:155]
  s_add_u32 s47, s44, 95232
  buffer_load_dwordx4 v5, s[12:15], s47 offen offset:3072 lds
  v_mfma_f32_16x16x32_bf16 v[156:159], a[140:143], a[12:15], v[156:159]
  v_mfma_f32_16x16x32_bf16 v[160:163], a[112:115], a[16:19], v[160:163]
  s_add_u32 m0, s41, 12288
  ds_read_b64_tr_b16 a[170:171], v12 offset:41984
  v_mfma_f32_16x16x32_bf16 v[164:167], a[116:119], a[16:19], v[164:167]
  s_add_u32 s46, s44, 131072
  buffer_load_dwordx4 v5, s[12:15], s46 offen offset:0 lds
  v_mfma_f32_16x16x32_bf16 v[168:171], a[120:123], a[16:19], v[168:171]
  ds_read_b64_tr_b16 a[172:173], v12 offset:40968
  v_mfma_f32_16x16x32_bf16 v[172:175], a[124:127], a[16:19], v[172:175]
  v_mfma_f32_16x16x32_bf16 v[176:179], a[128:131], a[16:19], v[176:179]
  s_add_u32 s47, s44, 162816
  buffer_load_dwordx4 v5, s[12:15], s47 offen offset:1024 lds
  v_mfma_f32_16x16x32_bf16 v[180:183], a[132:135], a[16:19], v[180:183]
  s_waitcnt lgkmcnt(8)
  ds_read_b64_tr_b16 a[174:175], v12 offset:41992
  v_mfma_f32_16x16x32_bf16 v[184:187], a[136:139], a[16:19], v[184:187]
  v_mfma_f32_16x16x32_bf16 v[188:191], a[140:143], a[16:19], v[188:191]
  s_add_u32 s46, s44, 194560
  buffer_load_dwordx4 v5, s[12:15], s46 offen offset:2048 lds
  v_mfma_f32_16x16x32_bf16 v[192:195], a[112:115], a[20:23], v[192:195]
  v_mfma_f32_16x16x32_bf16 v[196:199], a[116:119], a[20:23], v[196:199]
  v_mfma_f32_16x16x32_bf16 v[200:203], a[120:123], a[20:23], v[200:203]
  s_add_u32 s47, s44, 226304
  buffer_load_dwordx4 v5, s[12:15], s47 offen offset:3072 lds
  v_mfma_f32_16x16x32_bf16 v[204:207], a[124:127], a[20:23], v[204:207]
  s_add_u32 s44, s44, 262144
  v_mfma_f32_16x16x32_bf16 v[208:211], a[128:131], a[20:23], v[208:211]
  v_mfma_f32_16x16x32_bf16 v[212:215], a[132:135], a[20:23], v[212:215]
  v_mfma_f32_16x16x32_bf16 v[216:219], a[136:139], a[20:23], v[216:219]
  v_mfma_f32_16x16x32_bf16 v[220:223], a[140:143], a[20:23], v[220:223]
  s_waitcnt vmcnt(23) lgkmcnt(0)
  s_barrier
  v_mfma_f32_16x16x32_bf16 v[32:35], a[144:147], a[28:31], v[32:35]
  ds_read_b64_tr_b16 a[112:113], v9 offset:24576
  ds_read_b64_tr_b16 a[114:115], v9 offset:25600
  v_mfma_f32_16x16x32_bf16 v[36:39], a[148:151], a[28:31], v[36:39]
  s_add_u32 m0, s40, 65536
  ds_read_b64_tr_b16 a[116:117], v9 offset:24584
  v_mfma_f32_16x16x32_bf16 v[40:43], a[152:155], a[28:31], v[40:43]
  s_add_u32 s47, s43, 229376
  buffer_load_dwordx4 v4, s[8:11], s47 offen offset:0 lds
  v_mfma_f32_16x16x32_bf16 v[44:47], a[156:159], a[28:31], v[44:47]
  ds_read_b64_tr_b16 a[118:119], v9 offset:25608
  v_mfma_f32_16x16x32_bf16 v[48:51], a[160:163], a[28:31], v[48:51]
  s_add_u32 m0, s40, 66560
  ds_read_b64_tr_b16 a[120:121], v10 offset:24576
  v_mfma_f32_16x16x32_bf16 v[52:55], a[164:167], a[28:31], v[52:55]
  s_add_u32 s46, s43, 262144
  buffer_load_dwordx4 v4, s[8:11], s46 offen offset:0 lds
  v_mfma_f32_16x16x32_bf16 v[56:59], a[168:171], a[28:31], v[56:59]
  ds_read_b64_tr_b16 a[122:123], v10 offset:25600
  v_mfma_f32_16x16x32_bf16 v[60:63], a[172:175], a[28:31], v[60:63]
  s_add_u32 m0, s40, 67584
  ds_read_b64_tr_b16 a[124:125], v10 offset:24584
  v_mfma_f32_16x16x32_bf16 v[64:67], a[144:147], a[32:35], v[64:67]
  s_add_u32 s47, s43, 294912
  buffer_load_dwordx4 v4, s[8:11], s47 offen offset:0 lds
  v_mfma_f32_16x16x32_bf16 v[68:71], a[148:151], a[32:35], v[68:71]
  ds_read_b64_tr_b16 a[126:127], v10 offset:25608
  v_mfma_f32_16x16x32_bf16 v[72:75], a[152:155], a[32:35], v[72:75]
  s_add_u32 m0, s40, 68608
  ds_read_b64_tr_b16 a[128:129], v11 offset:24576
  v_mfma_f32_16x16x32_bf16 v[76:79], a[156:159], a[32:35], v[76:79]
  s_add_u32 s46, s43, 327680
  buffer_load_dwordx4 v4, s[8:11], s46 offen offset:0 lds
  v_mfma_f32_16x16x32_bf16 v[80:83], a[160:163], a[32:35], v[80:83]
  ds_read_b64_tr_b16 a[130:131], v11 offset:25600
  v_mfma_f32_16x16x32_bf16 v[84:87], a[164:167], a[32:35], v[84:87]
  s_add_u32 m0, s40, 69632
  ds_read_b64_tr_b16 a[132:133], v11 offset:24584
  v_mfma_f32_16x16x32_bf16 v[88:91], a[168:171], a[32:35], v[88:91]
  s_add_u32 s47, s43, 360448
  buffer_load_dwordx4 v4, s[8:11], s47 offen offset:0 lds
  v_mfma_f32_16x16x32_bf16 v[92:95], a[172:175], a[32:35], v[92:95]
  ds_read_b64_tr_b16 a[134:135], v11 offset:25608
  v_mfma_f32_16x16x32_bf16 v[96:99], a[144:147], a[36:39], v[96:99]
  s_add_u32 m0, s40, 70656
  ds_read_b64_tr_b16 a[136:137], v12 offset:24576
  v_mfma_f32_16x16x32_bf16 v[100:103], a[148:151], a[36:39], v[100:103]
  s_add_u32 s46, s43, 393216
  buffer_load_dwordx4 v4, s[8:11], s46 offen offset:0 lds
  v_mfma_f32_16x16x32_bf16 v[104:107], a[152:155], a[36:39], v[104:107]
  s_add_u32 s43, s43, 128
  ds_read_b64_tr_b16 a[138:139], v12 offset:25600
  v_mfma_f32_16x16x32_bf16 v[108:111], a[156:159], a[36:39], v[108:111]
  s_add_u32 m0, s41, 40960
  ds_read_b64_tr_b16 a[140:141], v12 offset:24584
  v_mfma_f32_16x16x32_bf16 v[112:115], a[160:163], a[36:39], v[112:115]
  s_add_u32 s46, s44, 0
  buffer_load_dwordx4 v5, s[12:15], s46 offen offset:0 lds
  v_mfma_f32_16x16x32_bf16 v[116:119], a[164:167], a[36:39], v[116:119]
  s_waitcnt lgkmcnt(8)
  ds_read_b64_tr_b16 a[142:143], v12 offset:25608
  v_mfma_f32_16x16x32_bf16 v[120:123], a[168:171], a[36:39], v[120:123]
  ds_read_b128 a[56:59], v7 offset:16384
  v_mfma_f32_16x16x32_bf16 v[124:127], a[172:175], a[36:39], v[124:127]
  s_add_u32 s47, s44, 31744
  buffer_load_dwordx4 v5, s[12:15], s47 offen offset:1024 lds
  v_mfma_f32_16x16x32_bf16 v[128:131], a[144:147], a[40:43], v[128:131]
  ds_read_b128 a[60:63], v7 offset:17408
  v_mfma_f32_16x16x32_bf16 v[132:135], a[148:151], a[40:43], v[132:135]
  ds_read_b128 a[64:67], v7 offset:18432
  v_mfma_f32_16x16x32_bf16 v[136:139], a[152:155], a[40:43], v[136:139]
  s_add_u32 s46, s44, 63488
  buffer_load_dwordx4 v5, s[12:15], s46 offen offset:2048 lds
  v_mfma_f32_16x16x32_bf16 v[140:143], a[156:159], a[40:43], v[140:143]
  ds_read_b128 a[68:71], v7 offset:19456
  v_mfma_f32_16x16x32_bf16 v[144:147], a[160:163], a[40:43], v[144:147]
  ds_read_b128 a[72:75], v7 offset:20480
  v_mfma_f32_16x16x32_bf16 v[148:151], a[164:167], a[40:43], v[148:151]
  s_add_u32 s47, s44, 95232
  buffer_load_dwordx4 v5, s[12:15], s47 offen offset:3072 lds
  v_mfma_f32_16x16x32_bf16 v[152:155], a[168:171], a[40:43], v[152:155]
  ds_read_b128 a[76:79], v7 offset:21504
  v_mfma_f32_16x16x32_bf16 v[156:159], a[172:175], a[40:43], v[156:159]
  s_waitcnt lgkmcnt(8)
  s_add_u32 m0, s41, 45056
  ds_read_b128 a[84:87], v8 offset:16384
  v_mfma_f32_16x16x32_bf16 v[160:163], a[144:147], a[44:47], v[160:163]
  s_add_u32 s46, s44, 131072
  buffer_load_dwordx4 v5, s[12:15], s46 offen offset:0 lds
  v_mfma_f32_16x16x32_bf16 v[164:167], a[148:151], a[44:47], v[164:167]
  ds_read_b128 a[88:91], v8 offset:17408
  v_mfma_f32_16x16x32_bf16 v[168:171], a[152:155], a[44:47], v[168:171]
  ds_read_b128 a[92:95], v8 offset:18432
  v_mfma_f32_16x16x32_bf16 v[172:175], a[156:159], a[44:47], v[172:175]
  s_add_u32 s47, s44, 162816
  buffer_load_dwordx4 v5, s[12:15], s47 offen offset:1024 lds
  v_mfma_f32_16x16x32_bf16 v[176:179], a[160:163], a[44:47], v[176:179]
  ds_read_b128 a[96:99], v8 offset:19456
  v_mfma_f32_16x16x32_bf16 v[180:183], a[164:167], a[44:47], v[180:183]
  ds_read_b128 a[100:103], v8 offset:20480
  v_mfma_f32_16x16x32_bf16 v[184:187], a[168:171], a[44:47], v[184:187]
  s_add_u32 s46, s44, 194560
  buffer_load_dwordx4 v5, s[12:15], s46 offen offset:2048 lds
  v_mfma_f32_16x16x32_bf16 v[188:191], a[172:175], a[44:47], v[188:191]
  ds_read_b128 a[104:107], v8 offset:21504
  v_mfma_f32_16x16x32_bf16 v[192:195], a[144:147], a[48:51], v[192:195]
  v_mfma_f32_16x16x32_bf16 v[196:199], a[148:151], a[48:51], v[196:199]
  s_add_u32 s47, s44, 226304
  buffer_load_dwordx4 v5, s[12:15], s47 offen offset:3072 lds
  v_mfma_f32_16x16x32_bf16 v[200:203], a[152:155], a[48:51], v[200:203]
  s_add_u32 s44, s44, 262144
  v_mfma_f32_16x16x32_bf16 v[204:207], a[156:159], a[48:51], v[204:207]
  v_mfma_f32_16x16x32_bf16 v[208:211], a[160:163], a[48:51], v[208:211]
  v_mfma_f32_16x16x32_bf16 v[212:215], a[164:167], a[48:51], v[212:215]
  v_mfma_f32_16x16x32_bf16 v[216:219], a[168:171], a[48:51], v[216:219]
  v_mfma_f32_16x16x32_bf16 v[220:223], a[172:175], a[48:51], v[220:223]
  s_waitcnt vmcnt(29) lgkmcnt(0)
  s_barrier
  v_mfma_f32_16x16x32_bf16 v[32:35], a[112:115], a[56:59], v[32:35]
  ds_read_b64_tr_b16 a[144:145], v9 offset:57344
  v_mfma_f32_16x16x32_bf16 v[36:39], a[116:119], a[56:59], v[36:39]
  s_add_u32 m0, s40, 16384
  ds_read_b64_tr_b16 a[146:147], v9 offset:58368
  v_mfma_f32_16x16x32_bf16 v[40:43], a[120:123], a[56:59], v[40:43]
  s_add_u32 s46, s43, 0
  buffer_load_dwordx4 v4, s[8:11], s46 offen offset:0 lds
  v_mfma_f32_16x16x32_bf16 v[44:47], a[124:127], a[56:59], v[44:47]
  s_add_u32 m0, s40, 17408
  v_mfma_f32_16x16x32_bf16 v[48:51], a[128:131], a[56:59], v[48:51]
  s_add_u32 s47, s43, 32768
  buffer_load_dwordx4 v4, s[8:11], s47 offen offset:0 lds
  v_mfma_f32_16x16x32_bf16 v[52:55], a[132:135], a[56:59], v[52:55]
  ds_read_b64_tr_b16 a[148:149], v9 offset:57352
  v_mfma_f32_16x16x32_bf16 v[56:59], a[136:139], a[56:59], v[56:59]
  s_add_u32 m0, s40, 18432
  ds_read_b64_tr_b16 a[150:151], v9 offset:58376
  v_mfma_f32_16x16x32_bf16 v[60:63], a[140:143], a[56:59], v[60:63]
  s_add_u32 s46, s43, 65536
  buffer_load_dwordx4 v4, s[8:11], s46 offen offset:0 lds
  v_mfma_f32_16x16x32_bf16 v[64:67], a[112:115], a[60:63], v[64:67]
  v_mfma_f32_16x16x32_bf16 v[68:71], a[116:119], a[60:63], v[68:71]
  s_add_u32 m0, s40, 19456
  ds_read_b64_tr_b16 a[152:153], v10 offset:57344
  v_mfma_f32_16x16x32_bf16 v[72:75], a[120:123], a[60:63], v[72:75]
  s_add_u32 s47, s43, 98304
  buffer_load_dwordx4 v4, s[8:11], s47 offen offset:0 lds
  v_mfma_f32_16x16x32_bf16 v[76:79], a[124:127], a[60:63], v[76:79]
  v_mfma_f32_16x16x32_bf16 v[80:83], a[128:131], a[60:63], v[80:83]
  s_add_u32 m0, s40, 20480
  ds_read_b64_tr_b16 a[154:155], v10 offset:58368
  v_mfma_f32_16x16x32_bf16 v[84:87], a[132:135], a[60:63], v[84:87]
  s_add_u32 s46, s43, 131072
  buffer_load_dwordx4 v4, s[8:11], s46 offen offset:0 lds
  v_mfma_f32_16x16x32_bf16 v[88:91], a[136:139], a[60:63], v[88:91]
  ds_read_b64_tr_b16 a[156:157], v10 offset:57352
  v_mfma_f32_16x16x32_bf16 v[92:95], a[140:143], a[60:63], v[92:95]
  s_add_u32 m0, s40, 21504
  v_mfma_f32_16x16x32_bf16 v[96:99], a[112:115], a[64:67], v[96:99]
  s_add_u32 s47, s43, 163840
  buffer_load_dwordx4 v4, s[8:11], s47 offen offset:0 lds
  v_mfma_f32_16x16x32_bf16 v[100:103], a[116:119], a[64:67], v[100:103]
  ds_read_b64_tr_b16 a[158:159], v10 offset:58376
  v_mfma_f32_16x16x32_bf16 v[104:107], a[120:123], a[64:67], v[104:107]
  s_add_u32 m0, s40, 22528
  v_mfma_f32_16x16x32_bf16 v[108:111], a[124:127], a[64:67], v[108:111]
  s_add_u32 s46, s43, 196608
  buffer_load_dwordx4 v4, s[8:11], s46 offen offset:0 lds
  v_mfma_f32_16x16x32_bf16 v[112:115], a[128:131], a[64:67], v[112:115]
  ds_read_b64_tr_b16 a[160:161], v11 offset:57344
  v_mfma_f32_16x16x32_bf16 v[116:119], a[132:135], a[64:67], v[116:119]
  s_add_u32 m0, s41, 24576
  ds_read_b64_tr_b16 a[162:163], v11 offset:58368
  v_mfma_f32_16x16x32_bf16 v[120:123], a[136:139], a[64:67], v[120:123]
  s_add_u32 s46, s44, 0
  buffer_load_dwordx4 v5, s[12:15], s46 offen offset:0 lds
  v_mfma_f32_16x16x32_bf16 v[124:127], a[140:143], a[64:67], v[124:127]
  v_mfma_f32_16x16x32_bf16 v[128:131], a[112:115], a[68:71], v[128:131]
  s_add_u32 s47, s44, 31744
  buffer_load_dwordx4 v5, s[12:15], s47 offen offset:1024 lds
  v_mfma_f32_16x16x32_bf16 v[132:135], a[116:119], a[68:71], v[132:135]
  ds_read_b64_tr_b16 a[164:165], v11 offset:57352
  v_mfma_f32_16x16x32_bf16 v[136:139], a[120:123], a[68:71], v[136:139]
  ds_read_b64_tr_b16 a[166:167], v11 offset:58376
  v_mfma_f32_16x16x32_bf16 v[140:143], a[124:127], a[68:71], v[140:143]
  s_add_u32 s46, s44, 63488
  buffer_load_dwordx4 v5, s[12:15], s46 offen offset:2048 lds
  v_mfma_f32_16x16x32_bf16 v[144:147], a[128:131], a[68:71], v[144:147]
  v_mfma_f32_16x16x32_bf16 v[148:151], a[132:135], a[68:71], v[148:151]
  ds_read_b64_tr_b16 a[168:169], v12 offset:57344
  v_mfma_f32_16x16x32_bf16 v[152:155], a[136:139], a[68:71], v[152:155]
  s_add_u32 s47, s44, 95232
  buffer_load_dwordx4 v5, s[12:15], s47 offen offset:3072 lds
  v_mfma_f32_16x16x32_bf16 v[156:159], a[140:143], a[68:71], v[156:159]
  v_mfma_f32_16x16x32_bf16 v[160:163], a[112:115], a[72:75], v[160:163]
  s_add_u32 m0, s41, 28672
  ds_read_b64_tr_b16 a[170:171], v12 offset:58368
  v_mfma_f32_16x16x32_bf16 v[164:167], a[116:119], a[72:75], v[164:167]
  s_add_u32 s46, s44, 131072
  buffer_load_dwordx4 v5, s[12:15], s46 offen offset:0 lds
  v_mfma_f32_16x16x32_bf16 v[168:171], a[120:123], a[72:75], v[168:171]
  ds_read_b64_tr_b16 a[172:173], v12 offset:57352
  v_mfma_f32_16x16x32_bf16 v[172:175], a[124:127], a[72:75], v[172:175]
  v_mfma_f32_16x16x32_bf16 v[176:179], a[128:131], a[72:75], v[176:179]
  s_add_u32 s47, s44, 162816
  buffer_load_dwordx4 v5, s[12:15], s47 offen offset:1024 lds
  v_mfma_f32_16x16x32_bf16 v[180:183], a[132:135], a[72:75], v[180:183]
  s_waitcnt lgkmcnt(8)
  ds_read_b64_tr_b16 a[174:175], v12 offset:58376
  v_mfma_f32_16x16x32_bf16 v[184:187], a[136:139], a[72:75], v[184:187]
  v_mfma_f32_16x16x32_bf16 v[188:191], a[140:143], a[72:75], v[188:191]
  s_add_u32 s46, s44, 194560
  buffer_load_dwordx4 v5, s[12:15], s46 offen offset:2048 lds
  v_mfma_f32_16x16x32_bf16 v[192:195], a[112:115], a[76:79], v[192:195]
  v_mfma_f32_16x16x32_bf16 v[196:199], a[116:119], a[76:79], v[196:199]
  v_mfma_f32_16x16x32_bf16 v[200:203], a[120:123], a[76:79], v[200:203]
  s_add_u32 s47, s44, 226304
  buffer_load_dwordx4 v5, s[12:15], s47 offen offset:3072 lds
  v_mfma_f32_16x16x32_bf16 v[204:207], a[124:127], a[76:79], v[204:207]
  s_add_u32 s44, s44, 262144
  v_mfma_f32_16x16x32_bf16 v[208:211], a[128:131], a[76:79], v[208:211]
  v_mfma_f32_16x16x32_bf16 v[212:215], a[132:135], a[76:79], v[212:215]
  v_mfma_f32_16x16x32_bf16 v[216:219], a[136:139], a[76:79], v[216:219]
  v_mfma_f32_16x16x32_bf16 v[220:223], a[140:143], a[76:79], v[220:223]
  s_waitcnt vmcnt(23) lgkmcnt(0)
  s_barrier
  v_mfma_f32_16x16x32_bf16 v[32:35], a[144:147], a[84:87], v[32:35]
  ds_read_b64_tr_b16 a[112:113], v9 offset:8192
  ds_read_b64_tr_b16 a[114:115], v9 offset:9216
  v_mfma_f32_16x16x32_bf16 v[36:39], a[148:151], a[84:87], v[36:39]
  s_add_u32 m0, s40, 81920
  ds_read_b64_tr_b16 a[116:117], v9 offset:8200
  v_mfma_f32_16x16x32_bf16 v[40:43], a[152:155], a[84:87], v[40:43]
  s_add_u32 s47, s43, 229376
  buffer_load_dwordx4 v4, s[8:11], s47 offen offset:0 lds
  v_mfma_f32_16x16x32_bf16 v[44:47], a[156:159], a[84:87], v[44:47]
  ds_read_b64_tr_b16 a[118:119], v9 offset:9224
  v_mfma_f32_16x16x32_bf16 v[48:51], a[160:163], a[84:87], v[48:51]
  s_add_u32 m0, s40, 82944
  ds_read_b64_tr_b16 a[120:121], v10 offset:8192
  v_mfma_f32_16x16x32_bf16 v[52:55], a[164:167], a[84:87], v[52:55]
  s_add_u32 s46, s43, 262144
  buffer_load_dwordx4 v4, s[8:11], s46 offen offset:0 lds
  v_mfma_f32_16x16x32_bf16 v[56:59], a[168:171], a[84:87], v[56:59]
  ds_read_b64_tr_b16 a[122:123], v10 offset:9216
  v_mfma_f32_16x16x32_bf16 v[60:63], a[172:175], a[84:87], v[60:63]
  s_add_u32 m0, s40, 83968
  ds_read_b64_tr_b16 a[124:125], v10 offset:8200
  v_mfma_f32_16x16x32_bf16 v[64:67], a[144:147], a[88:91], v[64:67]
  s_add_u32 s47, s43, 294912
  buffer_load_dwordx4 v4, s[8:11], s47 offen offset:0 lds
  v_mfma_f32_16x16x32_bf16 v[68:71], a[148:151], a[88:91], v[68:71]
  ds_read_b64_tr_b16 a[126:127], v10 offset:9224
  v_mfma_f32_16x16x32_bf16 v[72:75], a[152:155], a[88:91], v[72:75]
  s_add_u32 m0, s40, 84992
  ds_read_b64_tr_b16 a[128:129], v11 offset:8192
  v_mfma_f32_16x16x32_bf16 v[76:79], a[156:159], a[88:91], v[76:79]
  s_add_u32 s46, s43, 327680
  buffer_load_dwordx4 v4, s[8:11], s46 offen offset:0 lds
  v_mfma_f32_16x16x32_bf16 v[80:83], a[160:163], a[88:91], v[80:83]
  ds_read_b64_tr_b16 a[130:131], v11 offset:9216
  v_mfma_f32_16x16x32_bf16 v[84:87], a[164:167], a[88:91], v[84:87]
  s_add_u32 m0, s40, 86016
  ds_read_b64_tr_b16 a[132:133], v11 offset:8200
  v_mfma_f32_16x16x32_bf16 v[88:91], a[168:171], a[88:91], v[88:91]
  s_add_u32 s47, s43, 360448
  buffer_load_dwordx4 v4, s[8:11], s47 offen offset:0 lds
  v_mfma_f32_16x16x32_bf16 v[92:95], a[172:175], a[88:91], v[92:95]
  ds_read_b64_tr_b16 a[134:135], v11 offset:9224
  v_mfma_f32_16x16x32_bf16 v[96:99], a[144:147], a[92:95], v[96:99]
  s_add_u32 m0, s40, 87040
  ds_read_b64_tr_b16 a[136:137], v12 offset:8192
  v_mfma_f32_16x16x32_bf16 v[100:103], a[148:151], a[92:95], v[100:103]
  s_add_u32 s46, s43, 393216
  buffer_load_dwordx4 v4, s[8:11], s46 offen offset:0 lds
  v_mfma_f32_16x16x32_bf16 v[104:107], a[152:155], a[92:95], v[104:107]
  s_add_u32 s43, s43, 128
  ds_read_b64_tr_b16 a[138:139], v12 offset:9216
  v_mfma_f32_16x16x32_bf16 v[108:111], a[156:159], a[92:95], v[108:111]
  s_add_u32 m0, s41, 57344
  ds_read_b64_tr_b16 a[140:141], v12 offset:8200
  v_mfma_f32_16x16x32_bf16 v[112:115], a[160:163], a[92:95], v[112:115]
  s_add_u32 s46, s44, 0
  buffer_load_dwordx4 v5, s[12:15], s46 offen offset:0 lds
  v_mfma_f32_16x16x32_bf16 v[116:119], a[164:167], a[92:95], v[116:119]
  s_waitcnt lgkmcnt(8)
  ds_read_b64_tr_b16 a[142:143], v12 offset:9224
  v_mfma_f32_16x16x32_bf16 v[120:123], a[168:171], a[92:95], v[120:123]
  ds_read_b128 a[0:3], v7 offset:0
  v_mfma_f32_16x16x32_bf16 v[124:127], a[172:175], a[92:95], v[124:127]
  s_add_u32 s47, s44, 31744
  buffer_load_dwordx4 v5, s[12:15], s47 offen offset:1024 lds
  v_mfma_f32_16x16x32_bf16 v[128:131], a[144:147], a[96:99], v[128:131]
  ds_read_b128 a[4:7], v7 offset:1024
  v_mfma_f32_16x16x32_bf16 v[132:135], a[148:151], a[96:99], v[132:135]
  ds_read_b128 a[8:11], v7 offset:2048
  v_mfma_f32_16x16x32_bf16 v[136:139], a[152:155], a[96:99], v[136:139]
  s_add_u32 s46, s44, 63488
  buffer_load_dwordx4 v5, s[12:15], s46 offen offset:2048 lds
  v_mfma_f32_16x16x32_bf16 v[140:143], a[156:159], a[96:99], v[140:143]
  ds_read_b128 a[12:15], v7 offset:3072
  v_mfma_f32_16x16x32_bf16 v[144:147], a[160:163], a[96:99], v[144:147]
  ds_read_b128 a[16:19], v7 offset:4096
  v_mfma_f32_16x16x32_bf16 v[148:151], a[164:167], a[96:99], v[148:151]
  s_add_u32 s47, s44, 95232
  buffer_load_dwordx4 v5, s[12:15], s47 offen offset:3072 lds
  v_mfma_f32_16x16x32_bf16 v[152:155], a[168:171], a[96:99], v[152:155]
  ds_read_b128 a[20:23], v7 offset:5120
  v_mfma_f32_16x16x32_bf16 v[156:159], a[172:175], a[96:99], v[156:159]
  s_waitcnt lgkmcnt(8)
  s_add_u32 m0, s41, 61440
  ds_read_b128 a[28:31], v8 offset:0
  v_mfma_f32_16x16x32_bf16 v[160:163], a[144:147], a[100:103], v[160:163]
  s_add_u32 s46, s44, 131072
  buffer_load_dwordx4 v5, s[12:15], s46 offen offset:0 lds
  v_mfma_f32_16x16x32_bf16 v[164:167], a[148:151], a[100:103], v[164:167]
  ds_read_b128 a[32:35], v8 offset:1024
  v_mfma_f32_16x16x32_bf16 v[168:171], a[152:155], a[100:103], v[168:171]
  ds_read_b128 a[36:39], v8 offset:2048
  v_mfma_f32_16x16x32_bf16 v[172:175], a[156:159], a[100:103], v[172:175]
  s_add_u32 s47, s44, 162816
  buffer_load_dwordx4 v5, s[12:15], s47 offen offset:1024 lds
  v_mfma_f32_16x16x32_bf16 v[176:179], a[160:163], a[100:103], v[176:179]
  ds_read_b128 a[40:43], v8 offset:3072
  v_mfma_f32_16x16x32_bf16 v[180:183], a[164:167], a[100:103], v[180:183]
  ds_read_b128 a[44:47], v8 offset:4096
  v_mfma_f32_16x16x32_bf16 v[184:187], a[168:171], a[100:103], v[184:187]
  s_add_u32 s46, s44, 194560
  buffer_load_dwordx4 v5, s[12:15], s46 offen offset:2048 lds
  v_mfma_f32_16x16x32_bf16 v[188:191], a[172:175], a[100:103], v[188:191]
  ds_read_b128 a[48:51], v8 offset:5120
  v_mfma_f32_16x16x32_bf16 v[192:195], a[144:147], a[104:107], v[192:195]
  v_mfma_f32_16x16x32_bf16 v[196:199], a[148:151], a[104:107], v[196:199]
  s_add_u32 s47, s44, 226304
  buffer_load_dwordx4 v5, s[12:15], s47 offen offset:3072 lds
  v_mfma_f32_16x16x32_bf16 v[200:203], a[152:155], a[104:107], v[200:203]
  s_add_u32 s44, s44, 262144
  v_mfma_f32_16x16x32_bf16 v[204:207], a[156:159], a[104:107], v[204:207]
  v_mfma_f32_16x16x32_bf16 v[208:211], a[160:163], a[104:107], v[208:211]
  v_mfma_f32_16x16x32_bf16 v[212:215], a[164:167], a[104:107], v[212:215]
  v_mfma_f32_16x16x32_bf16 v[216:219], a[168:171], a[104:107], v[216:219]
  s_add_u32 s50, s50, 1
  v_mfma_f32_16x16x32_bf16 v[220:223], a[172:175], a[104:107], v[220:223]
  s_cmp_lt_u32 s50, 7
  s_cbranch_scc1 L1b_qloop
  s_waitcnt vmcnt(29) lgkmcnt(0)
  s_barrier
  v_mfma_f32_16x16x32_bf16 v[32:35], a[112:115], a[0:3], v[32:35]
  ds_read_b64_tr_b16 a[144:145], v9 offset:40960
  v_mfma_f32_16x16x32_bf16 v[36:39], a[116:119], a[0:3], v[36:39]
  s_add_u32 m0, s41, 0
  v_mfma_f32_16x16x32_bf16 v[40:43], a[120:123], a[0:3], v[40:43]
  s_waitcnt vmcnt(9)
  buffer_load_dwordx4 v6, s[16:19], s45 offen offset:0 nt lds
  v_mfma_f32_16x16x32_bf16 v[44:47], a[124:127], a[0:3], v[44:47]
  ds_read_b64_tr_b16 a[146:147], v9 offset:41984
  v_mfma_f32_16x16x32_bf16 v[48:51], a[128:131], a[0:3], v[48:51]
  v_mfma_f32_16x16x32_bf16 v[52:55], a[132:135], a[0:3], v[52:55]
  ds_read_b64_tr_b16 a[148:149], v9 offset:40968
  v_mfma_f32_16x16x32_bf16 v[56:59], a[136:139], a[0:3], v[56:59]
  v_mfma_f32_16x16x32_bf16 v[60:63], a[140:143], a[0:3], v[60:63]
  s_waitcnt vmcnt(9)
  buffer_load_dwordx4 v6, s[16:19], s45 offen offset:1024 nt lds
  v_mfma_f32_16x16x32_bf16 v[64:67], a[112:115], a[4:7], v[64:67]
  ds_read_b64_tr_b16 a[150:151], v9 offset:41992
  v_mfma_f32_16x16x32_bf16 v[68:71], a[116:119], a[4:7], v[68:71]
  v_mfma_f32_16x16x32_bf16 v[72:75], a[120:123], a[4:7], v[72:75]
  ds_read_b64_tr_b16 a[152:153], v10 offset:40960
  v_mfma_f32_16x16x32_bf16 v[76:79], a[124:127], a[4:7], v[76:79]
  v_mfma_f32_16x16x32_bf16 v[80:83], a[128:131], a[4:7], v[80:83]
  s_waitcnt vmcnt(9)
  buffer_load_dwordx4 v6, s[16:19], s45 offen offset:2048 nt lds
  v_mfma_f32_16x16x32_bf16 v[84:87], a[132:135], a[4:7], v[84:87]
  ds_read_b64_tr_b16 a[154:155], v10 offset:41984
  v_mfma_f32_16x16x32_bf16 v[88:91], a[136:139], a[4:7], v[88:91]
  v_mfma_f32_16x16x32_bf16 v[92:95], a[140:143], a[4:7], v[92:95]
  ds_read_b64_tr_b16 a[156:157], v10 offset:40968
  v_mfma_f32_16x16x32_bf16 v[96:99], a[112:115], a[8:11], v[96:99]
  v_mfma_f32_16x16x32_bf16 v[100:103], a[116:119], a[8:11], v[100:103]
  ds_read_b64_tr_b16 a[158:159], v10 offset:41992
  v_mfma_f32_16x16x32_bf16 v[104:107], a[120:123], a[8:11], v[104:107]
  s_waitcnt vmcnt(9)
  buffer_load_dwordx4 v6, s[16:19], s45 offen offset:3072 nt lds
  v_mfma_f32_16x16x32_bf16 v[108:111], a[124:127], a[8:11], v[108:111]
  v_mfma_f32_16x16x32_bf16 v[112:115], a[128:131], a[8:11], v[112:115]
  ds_read_b64_tr_b16 a[160:161], v11 offset:40960
  v_mfma_f32_16x16x32_bf16 v[116:119], a[132:135], a[8:11], v[116:119]
  v_mfma_f32_16x16x32_bf16 v[120:123], a[136:139], a[8:11], v[120:123]
  s_add_u32 m0, s41, 4096
  ds_read_b64_tr_b16 a[162:163], v11 offset:41984
  v_mfma_f32_16x16x32_bf16 v[124:127], a[140:143], a[8:11], v[124:127]
  s_waitcnt vmcnt(9)
  buffer_load_dwordx4 v31, s[16:19], s45 offen offset:0 nt lds
  v_mfma_f32_16x16x32_bf16 v[128:131], a[112:115], a[12:15], v[128:131]
  v_mfma_f32_16x16x32_bf16 v[132:135], a[116:119], a[12:15], v[132:135]
  ds_read_b64_tr_b16 a[164:165], v11 offset:40968
  v_mfma_f32_16x16x32_bf16 v[136:139], a[120:123], a[12:15], v[136:139]
  v_mfma_f32_16x16x32_bf16 v[140:143], a[124:127], a[12:15], v[140:143]
  ds_read_b64_tr_b16 a[166:167], v11 offset:41992
  v_mfma_f32_16x16x32_bf16 v[144:147], a[128:131], a[12:15], v[144:147]
  s_waitcnt vmcnt(9)
  buffer_load_dwordx4 v31, s[16:19], s45 offen offset:1024 nt lds
  v_mfma_f32_16x16x32_bf16 v[148:151], a[132:135], a[12:15], v[148:151]
  v_mfma_f32_16x16x32_bf16 v[152:155], a[136:139], a[12:15], v[152:155]
  ds_read_b64_tr_b16 a[168:169], v12 offset:40960
  v_mfma_f32_16x16x32_bf16 v[156:159], a[140:143], a[12:15], v[156:159]
  v_mfma_f32_16x16x32_bf16 v[160:163], a[112:115], a[16:19], v[160:163]
  ds_read_b64_tr_b16 a[170:171], v12 offset:41984
  v_mfma_f32_16x16x32_bf16 v[164:167], a[116:119], a[16:19], v[164:167]
  v_mfma_f32_16x16x32_bf16 v[168:171], a[120:123], a[16:19], v[168:171]
  s_waitcnt vmcnt(9)
  buffer_load_dwordx4 v31, s[16:19], s45 offen offset:2048 nt lds
  v_mfma_f32_16x16x32_bf16 v[172:175], a[124:127], a[16:19], v[172:175]
  ds_read_b64_tr_b16 a[172:173], v12 offset:40968
  v_mfma_f32_16x16x32_bf16 v[176:179], a[128:131], a[16:19], v[176:179]
  v_mfma_f32_16x16x32_bf16 v[180:183], a[132:135], a[16:19], v[180:183]
  s_waitcnt lgkmcnt(8)
  ds_read_b64_tr_b16 a[174:175], v12 offset:41992
  v_mfma_f32_16x16x32_bf16 v[184:187], a[136:139], a[16:19], v[184:187]
  v_mfma_f32_16x16x32_bf16 v[188:191], a[140:143], a[16:19], v[188:191]
  s_waitcnt vmcnt(9)
  buffer_load_dwordx4 v31, s[16:19], s45 offen offset:3072 nt lds
  v_mfma_f32_16x16x32_bf16 v[192:195], a[112:115], a[20:23], v[192:195]
  v_mfma_f32_16x16x32_bf16 v[196:199], a[116:119], a[20:23], v[196:199]
  v_mfma_f32_16x16x32_bf16 v[200:203], a[120:123], a[20:23], v[200:203]
  v_mfma_f32_16x16x32_bf16 v[204:207], a[124:127], a[20:23], v[204:207]
  v_mfma_f32_16x16x32_bf16 v[208:211], a[128:131], a[20:23], v[208:211]
  v_mfma_f32_16x16x32_bf16 v[212:215], a[132:135], a[20:23], v[212:215]
  v_mfma_f32_16x16x32_bf16 v[216:219], a[136:139], a[20:23], v[216:219]
  v_mfma_f32_16x16x32_bf16 v[220:223], a[140:143], a[20:23], v[220:223]
  s_waitcnt vmcnt(16) lgkmcnt(0)
  s_barrier
  v_mfma_f32_16x16x32_bf16 v[32:35], a[144:147], a[28:31], v[32:35]
  ds_read_b64_tr_b16 a[112:113], v9 offset:24576
  v_mfma_f32_16x16x32_bf16 v[36:39], a[148:151], a[28:31], v[36:39]
  s_add_u32 m0, s41, 32768
  ds_read_b64_tr_b16 a[114:115], v9 offset:25600
  v_mfma_f32_16x16x32_bf16 v[40:43], a[152:155], a[28:31], v[40:43]
  s_waitcnt vmcnt(9)
  buffer_load_dwordx4 v6, s[20:23], s45 offen offset:0 nt lds
  v_mfma_f32_16x16x32_bf16 v[44:47], a[156:159], a[28:31], v[44:47]
  ds_read_b64_tr_b16 a[116:117], v9 offset:24584
  v_mfma_f32_16x16x32_bf16 v[48:51], a[160:163], a[28:31], v[48:51]
  ds_read_b64_tr_b16 a[118:119], v9 offset:25608
  v_mfma_f32_16x16x32_bf16 v[52:55], a[164:167], a[28:31], v[52:55]
  ds_read_b64_tr_b16 a[120:121], v10 offset:24576
  v_mfma_f32_16x16x32_bf16 v[56:59], a[168:171], a[28:31], v[56:59]
  ds_read_b64_tr_b16 a[122:123], v10 offset:25600
  v_mfma_f32_16x16x32_bf16 v[60:63], a[172:175], a[28:31], v[60:63]
  s_waitcnt vmcnt(9)
  buffer_load_dwordx4 v6, s[20:23], s45 offen offset:1024 nt lds
  v_mfma_f32_16x16x32_bf16 v[64:67], a[144:147], a[32:35], v[64:67]
  ds_read_b64_tr_b16 a[124:125], v10 offset:24584
  v_mfma_f32_16x16x32_bf16 v[68:71], a[148:151], a[32:35], v[68:71]
  v_mfma_f32_16x16x32_bf16 v[72:75], a[152:155], a[32:35], v[72:75]
  ds_read_b64_tr_b16 a[126:127], v10 offset:25608
  v_mfma_f32_16x16x32_bf16 v[76:79], a[156:159], a[32:35], v[76:79]
  ds_read_b64_tr_b16 a[128:129], v11 offset:24576
  v_mfma_f32_16x16x32_bf16 v[80:83], a[160:163], a[32:35], v[80:83]
  s_waitcnt vmcnt(9)
  buffer_load_dwordx4 v6, s[20:23], s45 offen offset:2048 nt lds
  v_mfma_f32_16x16x32_bf16 v[84:87], a[164:167], a[32:35], v[84:87]
  ds_read_b64_tr_b16 a[130:131], v11 offset:25600
  v_mfma_f32_16x16x32_bf16 v[88:91], a[168:171], a[32:35], v[88:91]
  ds_read_b64_tr_b16 a[132:133], v11 offset:24584
  v_mfma_f32_16x16x32_bf16 v[92:95], a[172:175], a[32:35], v[92:95]
  ds_read_b64_tr_b16 a[134:135], v11 offset:25608
  v_mfma_f32_16x16x32_bf16 v[96:99], a[144:147], a[36:39], v[96:99]
  ds_read_b64_tr_b16 a[136:137], v12 offset:24576
  v_mfma_f32_16x16x32_bf16 v[100:103], a[148:151], a[36:39], v[100:103]
  ds_read_b64_tr_b16 a[138:139], v12 offset:25600
  v_mfma_f32_16x16x32_bf16 v[104:107], a[152:155], a[36:39], v[104:107]
  s_waitcnt vmcnt(9)
  buffer_load_dwordx4 v6, s[20:23], s45 offen offset:3072 nt lds
  v_mfma_f32_16x16x32_bf16 v[108:111], a[156:159], a[36:39], v[108:111]
  v_mfma_f32_16x16x32_bf16 v[112:115], a[160:163], a[36:39], v[112:115]
  ds_read_b64_tr_b16 a[140:141], v12 offset:24584
  v_mfma_f32_16x16x32_bf16 v[116:119], a[164:167], a[36:39], v[116:119]
  s_waitcnt lgkmcnt(8)
  ds_read_b64_tr_b16 a[142:143], v12 offset:25608
  v_mfma_f32_16x16x32_bf16 v[120:123], a[168:171], a[36:39], v[120:123]
  s_add_u32 m0, s41, 36864
  ds_read_b128 a[56:59], v7 offset:16384
  v_mfma_f32_16x16x32_bf16 v[124:127], a[172:175], a[36:39], v[124:127]
  s_waitcnt vmcnt(9)
  buffer_load_dwordx4 v31, s[20:23], s45 offen offset:0 nt lds
  v_mfma_f32_16x16x32_bf16 v[128:131], a[144:147], a[40:43], v[128:131]
  ds_read_b128 a[60:63], v7 offset:17408
  v_mfma_f32_16x16x32_bf16 v[132:135], a[148:151], a[40:43], v[132:135]
  ds_read_b128 a[64:67], v7 offset:18432
  v_mfma_f32_16x16x32_bf16 v[136:139], a[152:155], a[40:43], v[136:139]
  ds_read_b128 a[68:71], v7 offset:19456
  v_mfma_f32_16x16x32_bf16 v[140:143], a[156:159], a[40:43], v[140:143]
  ds_read_b128 a[72:75], v7 offset:20480
  v_mfma_f32_16x16x32_bf16 v[144:147], a[160:163], a[40:43], v[144:147]
  s_waitcnt vmcnt(9)
  buffer_load_dwordx4 v31, s[20:23], s45 offen offset:1024 nt lds
  v_mfma_f32_16x16x32_bf16 v[148:151], a[164:167], a[40:43], v[148:151]
  v_mfma_f32_16x16x32_bf16 v[152:155], a[168:171], a[40:43], v[152:155]
  ds_read_b128 a[76:79], v7 offset:21504
  v_mfma_f32_16x16x32_bf16 v[156:159], a[172:175], a[40:43], v[156:159]
  s_waitcnt lgkmcnt(8)
  ds_read_b128 a[84:87], v8 offset:16384
  v_mfma_f32_16x16x32_bf16 v[160:163], a[144:147], a[44:47], v[160:163]
  ds_read_b128 a[88:91], v8 offset:17408
  v_mfma_f32_16x16x32_bf16 v[164:167], a[148:151], a[44:47], v[164:167]
  ds_read_b128 a[92:95], v8 offset:18432
  v_mfma_f32_16x16x32_bf16 v[168:171], a[152:155], a[44:47], v[168:171]
  s_waitcnt vmcnt(9)
  buffer_load_dwordx4 v31, s[20:23], s45 offen offset:2048 nt lds
  v_mfma_f32_16x16x32_bf16 v[172:175], a[156:159], a[44:47], v[172:175]
  ds_read_b128 a[96:99], v8 offset:19456
  v_mfma_f32_16x16x32_bf16 v[176:179], a[160:163], a[44:47], v[176:179]
  ds_read_b128 a[100:103], v8 offset:20480
  v_mfma_f32_16x16x32_bf16 v[180:183], a[164:167], a[44:47], v[180:183]
  ds_read_b128 a[104:107], v8 offset:21504
  v_mfma_f32_16x16x32_bf16 v[184:187], a[168:171], a[44:47], v[184:187]
  v_mfma_f32_16x16x32_bf16 v[188:191], a[172:175], a[44:47], v[188:191]
  s_waitcnt vmcnt(9)
  buffer_load_dwordx4 v31, s[20:23], s45 offen offset:3072 nt lds
  v_mfma_f32_16x16x32_bf16 v[192:195], a[144:147], a[48:51], v[192:195]
  s_add_u32 s55, s55, 8192
  s_xor_b32 s45, s55, s39
  v_mfma_f32_16x16x32_bf16 v[196:199], a[148:151], a[48:51], v[196:199]
  v_mfma_f32_16x16x32_bf16 v[200:203], a[152:155], a[48:51], v[200:203]
  v_mfma_f32_16x16x32_bf16 v[204:207], a[156:159], a[48:51], v[204:207]
  v_mfma_f32_16x16x32_bf16 v[208:211], a[160:163], a[48:51], v[208:211]
  v_mfma_f32_16x16x32_bf16 v[212:215], a[164:167], a[48:51], v[212:215]
  v_mfma_f32_16x16x32_bf16 v[216:219], a[168:171], a[48:51], v[216:219]
  v_mfma_f32_16x16x32_bf16 v[220:223], a[172:175], a[48:51], v[220:223]
  s_waitcnt vmcnt(16) lgkmcnt(0)
  s_barrier
  v_mfma_f32_16x16x32_bf16 v[32:35], a[112:115], a[56:59], v[32:35]
  ds_read_b128 a[192:195], v24 offset:0
  v_mfma_f32_16x16x32_bf16 v[36:39], a[116:119], a[56:59], v[36:39]
  s_add_u32 m0, s41, 8192
  ds_read_b128 a[196:199], v25 offset:0
  v_mfma_f32_16x16x32_bf16 v[40:43], a[120:123], a[56:59], v[40:43]
  s_waitcnt vmcnt(9)
  buffer_load_dwordx4 v6, s[16:19], s45 offen offset:0 nt lds
  v_mfma_f32_16x16x32_bf16 v[44:47], a[124:127], a[56:59], v[44:47]
  ds_read_b128 a[200:203], v26 offset:0
  v_mfma_f32_16x16x32_bf16 v[48:51], a[128:131], a[56:59], v[48:51]
  ds_read_b128 a[204:207], v27 offset:0
  v_mfma_f32_16x16x32_bf16 v[52:55], a[132:135], a[56:59], v[52:55]
  ds_read_b128 a[208:211], v24 offset:2048
  v_mfma_f32_16x16x32_bf16 v[56:59], a[136:139], a[56:59], v[56:59]
  ds_read_b128 a[212:215], v25 offset:2048
  v_mfma_f32_16x16x32_bf16 v[60:63], a[140:143], a[56:59], v[60:63]
  s_waitcnt vmcnt(9)
  buffer_load_dwordx4 v6, s[16:19], s45 offen offset:1024 nt lds
  v_mfma_f32_16x16x32_bf16 v[64:67], a[112:115], a[60:63], v[64:67]
  ds_read_b128 a[216:219], v26 offset:2048
  v_mfma_f32_16x16x32_bf16 v[68:71], a[116:119], a[60:63], v[68:71]
  ds_read_b128 a[220:223], v27 offset:2048
  v_mfma_f32_16x16x32_bf16 v[72:75], a[120:123], a[60:63], v[72:75]
  ds_read_b64_tr_b16 a[144:145], v9 offset:57344
  v_mfma_f32_16x16x32_bf16 v[76:79], a[124:127], a[60:63], v[76:79]
  ds_read_b64_tr_b16 a[146:147], v9 offset:58368
  v_mfma_f32_16x16x32_bf16 v[80:83], a[128:131], a[60:63], v[80:83]
  s_waitcnt vmcnt(9)
  buffer_load_dwordx4 v6, s[16:19], s45 offen offset:2048 nt lds
  v_mfma_f32_16x16x32_bf16 v[84:87], a[132:135], a[60:63], v[84:87]
  ds_read_b64_tr_b16 a[148:149], v9 offset:57352
  v_mfma_f32_16x16x32_bf16 v[88:91], a[136:139], a[60:63], v[88:91]
  ds_read_b64_tr_b16 a[150:151], v9 offset:58376
  v_mfma_f32_16x16x32_bf16 v[92:95], a[140:143], a[60:63], v[92:95]
  v_mfma_f32_16x16x32_bf16 v[96:99], a[112:115], a[64:67], v[96:99]
  ds_read_b64_tr_b16 a[152:153], v10 offset:57344
  v_mfma_f32_16x16x32_bf16 v[100:103], a[116:119], a[64:67], v[100:103]
  ds_read_b64_tr_b16 a[154:155], v10 offset:58368
  v_mfma_f32_16x16x32_bf16 v[104:107], a[120:123], a[64:67], v[104:107]
  s_waitcnt vmcnt(9)
  buffer_load_dwordx4 v6, s[16:19], s45 offen offset:3072 nt lds
  v_mfma_f32_16x16x32_bf16 v[108:111], a[124:127], a[64:67], v[108:111]
  ds_read_b64_tr_b16 a[156:157], v10 offset:57352
  v_mfma_f32_16x16x32_bf16 v[112:115], a[128:131], a[64:67], v[112:115]
  s_waitcnt lgkmcnt(8)
  ds_read_b64_tr_b16 a[158:159], v10 offset:58376
  v_mfma_f32_16x16x32_bf16 v[116:119], a[132:135], a[64:67], v[116:119]
  ds_read_b64_tr_b16 a[160:161], v11 offset:57344
  v_mfma_f32_16x16x32_bf16 v[120:123], a[136:139], a[64:67], v[120:123]
  s_add_u32 m0, s41, 12288
  ds_read_b64_tr_b16 a[162:163], v11 offset:58368
  v_mfma_f32_16x16x32_bf16 v[124:127], a[140:143], a[64:67], v[124:127]
  s_waitcnt vmcnt(9)
  buffer_load_dwordx4 v31, s[16:19], s45 offen offset:0 nt lds
  v_mfma_f32_16x16x32_bf16 v[128:131], a[112:115], a[68:71], v[128:131]
  ds_read_b64_tr_b16 a[164:165], v11 offset:57352
  v_mfma_f32_16x16x32_bf16 v[132:135], a[116:119], a[68:71], v[132:135]
  ds_read_b64_tr_b16 a[166:167], v11 offset:58376
  v_mfma_f32_16x16x32_bf16 v[136:139], a[120:123], a[68:71], v[136:139]
  ds_read_b64_tr_b16 a[168:169], v12 offset:57344
  v_mfma_f32_16x16x32_bf16 v[140:143], a[124:127], a[68:71], v[140:143]
  ds_read_b64_tr_b16 a[170:171], v12 offset:58368
  v_mfma_f32_16x16x32_bf16 v[144:147], a[128:131], a[68:71], v[144:147]
  s_waitcnt vmcnt(9)
  buffer_load_dwordx4 v31, s[16:19], s45 offen offset:1024 nt lds
  v_mfma_f32_16x16x32_bf16 v[148:151], a[132:135], a[68:71], v[148:151]
  s_waitcnt lgkmcnt(8)
  ds_read_b64_tr_b16 a[172:173], v12 offset:57352
  v_mfma_f32_16x16x32_bf16 v[152:155], a[136:139], a[68:71], v[152:155]
  s_sub_u32 s48, s42, s41
  s_sub_u32 s48, s48, 24576
  ds_read_b64_tr_b16 a[174:175], v12 offset:58376
  v_mfma_f32_16x16x32_bf16 v[156:159], a[140:143], a[68:71], v[156:159]
  v_mfma_f32_16x16x32_bf16 v[160:163], a[112:115], a[72:75], v[160:163]
  v_add_u32 v0, s48, v17
  v_mfma_f32_16x16x32_bf16 v[164:167], a[116:119], a[72:75], v[164:167]
  v_add_u32 v2, s48, v18
  v_mfma_f32_16x16x32_bf16 v[168:171], a[120:123], a[72:75], v[168:171]
  s_waitcnt vmcnt(9)
  buffer_load_dwordx4 v31, s[16:19], s45 offen offset:2048 nt lds
  v_add_u32 v3, s48, v19
  v_mfma_f32_16x16x32_bf16 v[172:175], a[124:127], a[72:75], v[172:175]
  v_add_u32 v29, s48, v20
  v_mfma_f32_16x16x32_bf16 v[176:179], a[128:131], a[72:75], v[176:179]
  v_add_u32 v24, s48, v21
  v_mfma_f32_16x16x32_bf16 v[180:183], a[132:135], a[72:75], v[180:183]
  v_add_u32 v25, s48, v22
  v_mfma_f32_16x16x32_bf16 v[184:187], a[136:139], a[72:75], v[184:187]
  v_add_u32 v26, s48, v23
  v_mfma_f32_16x16x32_bf16 v[188:191], a[140:143], a[72:75], v[188:191]
  s_waitcnt vmcnt(9)
  buffer_load_dwordx4 v31, s[16:19], s45 offen offset:3072 nt lds
  v_add_u32 v27, s48, v28
  v_mfma_f32_16x16x32_bf16 v[192:195], a[112:115], a[76:79], v[192:195]
  v_mfma_f32_16x16x32_bf16 v[196:199], a[116:119], a[76:79], v[196:199]
  v_mfma_f32_16x16x32_bf16 v[200:203], a[120:123], a[76:79], v[200:203]
  v_mfma_f32_16x16x32_bf16 v[204:207], a[124:127], a[76:79], v[204:207]
  v_mfma_f32_16x16x32_bf16 v[208:211], a[128:131], a[76:79], v[208:211]
  v_mfma_f32_16x16x32_bf16 v[212:215], a[132:135], a[76:79], v[212:215]
  v_mfma_f32_16x16x32_bf16 v[216:219], a[136:139], a[76:79], v[216:219]
  v_mfma_f32_16x16x32_bf16 v[220:223], a[140:143], a[76:79], v[220:223]
  s_waitcnt lgkmcnt(0)
  s_barrier
  v_mfma_f32_16x16x32_bf16 v[32:35], a[144:147], a[84:87], v[32:35]
  s_lshr_b32 s46, s7, 3
  s_lshl_b32 s47, s6, 2
  ds_read_b64_tr_b16 a[224:225], v0 offset:0
  v_mfma_f32_16x16x32_bf16 v[36:39], a[148:151], a[84:87], v[36:39]
  s_add_u32 s46, s46, s47
  s_lshl_b32 s46, s46, 7
  s_add_u32 m0, s41, 40960
  ds_read_b64_tr_b16 a[226:227], v0 offset:2048
  v_mfma_f32_16x16x32_bf16 v[40:43], a[152:155], a[84:87], v[40:43]
  s_and_b32 s47, s7, 6
  s_lshl_b32 s47, s47, 1
  s_waitcnt vmcnt(9)
  buffer_load_dwordx4 v6, s[20:23], s45 offen offset:0 nt lds
  v_mfma_f32_16x16x32_bf16 v[44:47], a[156:159], a[84:87], v[44:47]
  s_add_u32 s46, s46, s47
  s_add_u32 s46, s46, 75497472
  v_mfma_f32_16x16x32_bf16 v[48:51], a[160:163], a[84:87], v[48:51]
  v_mov_b32 v12, s46
  v_mfma_f32_16x16x32_bf16 v[52:55], a[164:167], a[84:87], v[52:55]
  s_and_b32 s46, s2, 7
  s_lshr_b32 s47, s2, 3
  ds_read_b64_tr_b16 a[228:229], v2 offset:0
  v_mfma_f32_16x16x32_bf16 v[56:59], a[168:171], a[84:87], v[56:59]
  s_lshr_b32 s32, s46, 1
  s_lshl_b32 s32, s32, 2
  ds_read_b64_tr_b16 a[230:231], v2 offset:2048
  v_mfma_f32_16x16x32_bf16 v[60:63], a[172:175], a[84:87], v[60:63]
  s_and_b32 s48, s47, 3
  s_add_u32 s32, s32, s48
  s_waitcnt vmcnt(9)
  buffer_load_dwordx4 v6, s[20:23], s45 offen offset:1024 nt lds
  v_mfma_f32_16x16x32_bf16 v[64:67], a[144:147], a[88:91], v[64:67]
  s_lshr_b32 s33, s47, 2
  s_and_b32 s33, s33, 1
  v_mfma_f32_16x16x32_bf16 v[68:71], a[148:151], a[88:91], v[68:71]
  s_and_b32 s34, s46, 1
  s_lshl_b32 s34, s34, 2
  ds_read_b64_tr_b16 a[232:233], v3 offset:0
  v_mfma_f32_16x16x32_bf16 v[72:75], a[152:155], a[88:91], v[72:75]
  s_lshr_b32 s48, s47, 3
  s_add_u32 s34, s34, s48
  ds_read_b64_tr_b16 a[234:235], v3 offset:2048
  v_mfma_f32_16x16x32_bf16 v[76:79], a[156:159], a[88:91], v[76:79]
  s_lshl_b32 s28, s3, 15
  v_lshrrev_b32 v4, 4, v1
  v_mfma_f32_16x16x32_bf16 v[80:83], a[160:163], a[88:91], v[80:83]
  s_waitcnt vmcnt(9)
  buffer_load_dwordx4 v6, s[20:23], s45 offen offset:2048 nt lds
  v_lshlrev_b32 v9, 1, v4
  v_and_b32 v10, 15, v1
  v_mfma_f32_16x16x32_bf16 v[84:87], a[164:167], a[88:91], v[84:87]
  v_xor_b32 v10, v10, v9
  v_lshlrev_b32 v10, 4, v10
  v_mfma_f32_16x16x32_bf16 v[88:91], a[168:171], a[88:91], v[88:91]
  v_lshl_add_u32 v7, v4, 11, v10
  v_lshrrev_b32 v9, 1, v1
  v_mul_f32 v32, s52, v32
  v_mul_f32 v33, s52, v33
  v_mfma_f32_16x16x32_bf16 v[92:95], a[172:175], a[88:91], v[92:95]
  v_and_b32 v10, 1, v1
  v_lshlrev_b32 v10, 7, v10
  v_mul_f32 v34, s52, v34
  v_mfma_f32_16x16x32_bf16 v[96:99], a[144:147], a[92:95], v[96:99]
  v_lshl_add_u32 v5, v9, 11, v10
  v_xor_b32 v8, 128, v7
  v_mul_f32 v35, s52, v35
  v_mul_f32 v36, s52, v36
  v_mfma_f32_16x16x32_bf16 v[100:103], a[148:151], a[92:95], v[100:103]
  v_add_u32 v8, 7168, v8
  v_add_u32 v9, 14336, v7
  v_mul_f32 v37, s52, v37
  v_mfma_f32_16x16x32_bf16 v[104:107], a[152:155], a[92:95], v[104:107]
  s_waitcnt vmcnt(9)
  buffer_load_dwordx4 v6, s[20:23], s45 offen offset:3072 nt lds
  v_add_u32 v10, 14336, v8
  v_mul_f32 v38, s52, v38
  v_mul_f32 v39, s52, v39
  v_mfma_f32_16x16x32_bf16 v[108:111], a[156:159], a[92:95], v[108:111]
  s_lshl_b32 s30, s3, 21
  s_lshl_b32 s43, s32, 1
  v_cvt_pk_bf16_f32 v32, v32, v33
  v_mfma_f32_16x16x32_bf16 v[112:115], a[160:163], a[92:95], v[112:115]
  s_add_u32 s43, s43, s33
  s_lshl_b32 s43, s43, 2
  ds_read_b64_tr_b16 a[236:237], v29 offset:0
  v_cvt_pk_bf16_f32 v33, v34, v35
  v_mfma_f32_16x16x32_bf16 v[116:119], a[164:167], a[92:95], v[116:119]
  s_add_u32 s43, s43, s3
  s_lshl_b32 s43, s43, 16
  ds_read_b64_tr_b16 a[238:239], v29 offset:2048
  v_cvt_pk_bf16_f32 v34, v36, v37
  v_cvt_pk_bf16_f32 v35, v38, v39
  v_mfma_f32_16x16x32_bf16 v[120:123], a[168:171], a[92:95], v[120:123]
  s_mul_i32 s29, s3, 851968
  s_mul_i32 s46, s33, 14336
  s_add_u32 m0, s41, 45056
  v_mul_f32 v40, s52, v40
  v_mfma_f32_16x16x32_bf16 v[124:127], a[172:175], a[92:95], v[124:127]
  s_add_u32 s29, s29, s46
  s_lshl_b32 s46, s34, 8
  s_waitcnt vmcnt(9)
  buffer_load_dwordx4 v31, s[20:23], s45 offen offset:0 nt lds
  v_mul_f32 v41, s52, v41
  v_mul_f32 v42, s52, v42
  v_mfma_f32_16x16x32_bf16 v[128:131], a[144:147], a[96:99], v[128:131]
  s_add_u32 s12, s92, s46
  s_addc_u32 s13, s93, 0
  ds_read_b64_tr_b16 a[240:241], v24 offset:0
  v_mul_f32 v43, s52, v43
  v_mfma_f32_16x16x32_bf16 v[132:135], a[148:151], a[96:99], v[132:135]
  s_sub_u32 s14, 8388608, s46
  s_mov_b32 s15, 131072
  ds_read_b64_tr_b16 a[242:243], v24 offset:2048
  v_mul_f32 v44, s52, v44
  v_mfma_f32_16x16x32_bf16 v[136:139], a[152:155], a[96:99], v[136:139]
  s_add_u32 s46, s46, 83885824
  s_add_u32 s47, s98, s46
  s_addc_u32 s48, s99, 0
  v_mul_f32 v45, s52, v45
  v_mul_f32 v46, s52, v46
  v_mfma_f32_16x16x32_bf16 v[140:143], a[156:159], a[96:99], v[140:143]
  s_and_b32 s46, s34, 3
  s_cmp_eq_u32 s46, 1
  s_cselect_b32 s12, s47, s12
  s_cselect_b32 s13, s48, s13
  s_cselect_b32 s43, 16777216, s43
  ds_read_b64_tr_b16 a[244:245], v25 offset:0
  v_mul_f32 v47, s52, v47
  v_mfma_f32_16x16x32_bf16 v[144:147], a[160:163], a[96:99], v[144:147]
  s_lshl_b32 s46, s32, 22
  s_add_u32 s8, s98, s46
  s_addc_u32 s9, s99, 0
  s_waitcnt vmcnt(9)
  buffer_load_dwordx4 v31, s[20:23], s45 offen offset:1024 nt lds
  v_cvt_pk_bf16_f32 v36, v40, v41
  v_cvt_pk_bf16_f32 v37, v42, v43
  v_mfma_f32_16x16x32_bf16 v[148:151], a[164:167], a[96:99], v[148:151]
  s_mov_b32 s10, 4194304
  s_mov_b32 s11, 131072
  ds_read_b64_tr_b16 a[246:247], v25 offset:2048
  v_cvt_pk_bf16_f32 v38, v44, v45
  v_mfma_f32_16x16x32_bf16 v[152:155], a[168:171], a[96:99], v[152:155]
  s_lshl_b32 s47, s32, 2
  s_add_u32 s46, s47, s3
  v_cvt_pk_bf16_f32 v39, v46, v47
  v_mfma_f32_16x16x32_bf16 v[156:159], a[172:175], a[96:99], v[156:159]
  s_lshl_b32 s46, s46, 7
  s_add_u32 s46, s46, 75497472
  ds_read_b64_tr_b16 a[248:249], v26 offset:0
  v_mul_f32 v48, s52, v48
  v_mul_f32 v49, s52, v49
  v_mfma_f32_16x16x32_bf16 v[160:163], a[144:147], a[100:103], v[160:163]
  v_mov_b32 v11, s46
  v_mul_f32 v50, s52, v50
  v_mfma_f32_16x16x32_bf16 v[164:167], a[148:151], a[100:103], v[164:167]
  s_mov_b32 s37, 0
  s_mov_b32 s31, 0
  ds_read_b64_tr_b16 a[250:251], v26 offset:2048
  v_mul_f32 v51, s52, v51
  v_mul_f32 v52, s52, v52
  v_mfma_f32_16x16x32_bf16 v[168:171], a[152:155], a[100:103], v[168:171]
  s_mov_b32 s35, 6
  s_add_u32 s36, s30, 786432
  s_waitcnt vmcnt(9)
  buffer_load_dwordx4 v31, s[20:23], s45 offen offset:2048 nt lds
  v_mul_f32 v53, s52, v53
  v_mfma_f32_16x16x32_bf16 v[172:175], a[156:159], a[100:103], v[172:175]
  s_mov_b32 s44, 16777216
  v_mul_f32 v54, s52, v54
  v_mul_f32 v55, s52, v55
  v_mfma_f32_16x16x32_bf16 v[176:179], a[160:163], a[100:103], v[176:179]
  ds_read_b64_tr_b16 a[252:253], v27 offset:0
  v_cvt_pk_bf16_f32 v40, v48, v49
  v_mfma_f32_16x16x32_bf16 v[180:183], a[164:167], a[100:103], v[180:183]
  s_waitcnt lgkmcnt(8)
  ds_read_b64_tr_b16 a[254:255], v27 offset:2048
  v_cvt_pk_bf16_f32 v41, v50, v51
  v_mfma_f32_16x16x32_bf16 v[184:187], a[168:171], a[100:103], v[184:187]
  v_cvt_pk_bf16_f32 v42, v52, v53
  v_cvt_pk_bf16_f32 v43, v54, v55
  v_mfma_f32_16x16x32_bf16 v[188:191], a[172:175], a[100:103], v[188:191]
  s_waitcnt vmcnt(9)
  buffer_load_dwordx4 v31, s[20:23], s45 offen offset:3072 nt lds
  v_mul_f32 v56, s52, v56
  v_mfma_f32_16x16x32_bf16 v[192:195], a[144:147], a[104:107], v[192:195]
  s_add_u32 s55, s55, 8192
  s_xor_b32 s45, s55, s39
  v_mul_f32 v57, s52, v57
  v_mul_f32 v58, s52, v58
  v_mfma_f32_16x16x32_bf16 v[196:199], a[148:151], a[104:107], v[196:199]
  v_mul_f32 v59, s52, v59
  v_mfma_f32_16x16x32_bf16 v[200:203], a[152:155], a[104:107], v[200:203]
  v_mul_f32 v60, s52, v60
  v_mfma_f32_16x16x32_bf16 v[204:207], a[156:159], a[104:107], v[204:207]
  v_mul_f32 v61, s52, v61
  v_mul_f32 v62, s52, v62
  v_mfma_f32_16x16x32_bf16 v[208:211], a[160:163], a[104:107], v[208:211]
  v_mul_f32 v63, s52, v63
  v_mfma_f32_16x16x32_bf16 v[212:215], a[164:167], a[104:107], v[212:215]
  v_cvt_pk_bf16_f32 v44, v56, v57
  v_cvt_pk_bf16_f32 v45, v58, v59
  v_mfma_f32_16x16x32_bf16 v[216:219], a[168:171], a[104:107], v[216:219]
  v_cvt_pk_bf16_f32 v46, v60, v61
  v_mfma_f32_16x16x32_bf16 v[220:223], a[172:175], a[104:107], v[220:223]
  v_cvt_pk_bf16_f32 v47, v62, v63
  s_add_u32 m0, s41, 24576
  s_waitcnt vmcnt(9)
  buffer_load_dwordx4 v6, s[16:19], s45 offen offset:0 nt lds
  s_waitcnt vmcnt(9)
  buffer_load_dwordx4 v6, s[16:19], s45 offen offset:1024 nt lds
  s_waitcnt vmcnt(9)
  buffer_load_dwordx4 v6, s[16:19], s45 offen offset:2048 nt lds
  v_pk_mul_f32 v[64:65], v[64:65], s[52:53]
  v_pk_mul_f32 v[66:67], v[66:67], s[52:53]
  v_pk_mul_f32 v[68:69], v[68:69], s[52:53]
  v_pk_mul_f32 v[70:71], v[70:71], s[52:53]
  v_mfma_f32_16x16x32_bf16 v[48:51], a[192:195], v[32:35], 0
  v_mfma_f32_16x16x32_bf16 v[48:51], a[196:199], v[36:39], v[48:51]
  v_mfma_f32_16x16x32_bf16 v[48:51], a[200:203], v[40:43], v[48:51]
  v_mfma_f32_16x16x32_bf16 v[48:51], a[204:207], v[44:47], v[48:51]
  v_cvt_pk_bf16_f32 v64, v64, v65
  v_cvt_pk_bf16_f32 v65, v66, v67
  v_cvt_pk_bf16_f32 v66, v68, v69
  v_cvt_pk_bf16_f32 v67, v70, v71
  v_pk_mul_f32 v[72:73], v[72:73], s[52:53]
  v_pk_mul_f32 v[74:75], v[74:75], s[52:53]
  v_pk_mul_f32 v[76:77], v[76:77], s[52:53]
  v_pk_mul_f32 v[78:79], v[78:79], s[52:53]
  s_waitcnt vmcnt(9)
  buffer_load_dwordx4 v6, s[16:19], s45 offen offset:3072 nt lds
  v_cvt_pk_bf16_f32 v68, v72, v73
  v_cvt_pk_bf16_f32 v69, v74, v75
  v_cvt_pk_bf16_f32 v70, v76, v77
  v_cvt_pk_bf16_f32 v71, v78, v79
  v_pk_mul_f32 v[80:81], v[80:81], s[52:53]
  v_pk_mul_f32 v[82:83], v[82:83], s[52:53]
  v_pk_mul_f32 v[84:85], v[84:85], s[52:53]
  v_pk_mul_f32 v[86:87], v[86:87], s[52:53]
  v_cvt_pk_bf16_f32 v72, v80, v81
  v_cvt_pk_bf16_f32 v73, v82, v83
  v_cvt_pk_bf16_f32 v74, v84, v85
  v_cvt_pk_bf16_f32 v75, v86, v87
  v_pk_mul_f32 v[88:89], v[88:89], s[52:53]
  v_pk_mul_f32 v[90:91], v[90:91], s[52:53]
  v_pk_mul_f32 v[92:93], v[92:93], s[52:53]
  v_pk_mul_f32 v[94:95], v[94:95], s[52:53]
  v_cvt_pk_bf16_f32 v76, v88, v89
  v_cvt_pk_bf16_f32 v77, v90, v91
  v_cvt_pk_bf16_f32 v78, v92, v93
  v_cvt_pk_bf16_f32 v79, v94, v95
  s_add_u32 m0, s41, 28672
  s_waitcnt vmcnt(9)
  buffer_load_dwordx4 v31, s[16:19], s45 offen offset:0 nt lds
  v_pk_mul_f32 v[96:97], v[96:97], s[52:53]
  v_pk_mul_f32 v[98:99], v[98:99], s[52:53]
  v_pk_mul_f32 v[100:101], v[100:101], s[52:53]
  v_pk_mul_f32 v[102:103], v[102:103], s[52:53]
  v_mfma_f32_16x16x32_bf16 v[80:83], a[192:195], v[64:67], 0
  v_mfma_f32_16x16x32_bf16 v[80:83], a[196:199], v[68:71], v[80:83]
  v_mfma_f32_16x16x32_bf16 v[80:83], a[200:203], v[72:75], v[80:83]
  v_mfma_f32_16x16x32_bf16 v[80:83], a[204:207], v[76:79], v[80:83]
  v_cvt_pk_bf16_f32 v96, v96, v97
  v_cvt_pk_bf16_f32 v97, v98, v99
  v_cvt_pk_bf16_f32 v98, v100, v101
  v_cvt_pk_bf16_f32 v99, v102, v103
  v_pk_mul_f32 v[104:105], v[104:105], s[52:53]
  v_pk_mul_f32 v[106:107], v[106:107], s[52:53]
  v_pk_mul_f32 v[108:109], v[108:109], s[52:53]
  v_pk_mul_f32 v[110:111], v[110:111], s[52:53]
  v_cvt_pk_bf16_f32 v100, v104, v105
  v_cvt_pk_bf16_f32 v101, v106, v107
  v_cvt_pk_bf16_f32 v102, v108, v109
  v_cvt_pk_bf16_f32 v103, v110, v111
  v_pk_mul_f32 v[112:113], v[112:113], s[52:53]
  v_pk_mul_f32 v[114:115], v[114:115], s[52:53]
  v_pk_mul_f32 v[116:117], v[116:117], s[52:53]
  v_pk_mul_f32 v[118:119], v[118:119], s[52:53]
  v_cvt_pk_bf16_f32 v104, v112, v113
  v_cvt_pk_bf16_f32 v105, v114, v115
  v_cvt_pk_bf16_f32 v106, v116, v117
  v_cvt_pk_bf16_f32 v107, v118, v119
  v_pk_mul_f32 v[120:121], v[120:121], s[52:53]
  v_pk_mul_f32 v[122:123], v[122:123], s[52:53]
  v_pk_mul_f32 v[124:125], v[124:125], s[52:53]
  v_pk_mul_f32 v[126:127], v[126:127], s[52:53]
  v_cvt_pk_bf16_f32 v108, v120, v121
  v_cvt_pk_bf16_f32 v109, v122, v123
  v_cvt_pk_bf16_f32 v110, v124, v125
  v_cvt_pk_bf16_f32 v111, v126, v127
  s_waitcnt vmcnt(9)
  buffer_load_dwordx4 v31, s[16:19], s45 offen offset:1024 nt lds
  v_pk_mul_f32 v[128:129], v[128:129], s[52:53]
  v_pk_mul_f32 v[130:131], v[130:131], s[52:53]
  v_pk_mul_f32 v[132:133], v[132:133], s[52:53]
  v_pk_mul_f32 v[134:135], v[134:135], s[52:53]
  v_mfma_f32_16x16x32_bf16 v[112:115], a[192:195], v[96:99], 0
  v_mfma_f32_16x16x32_bf16 v[112:115], a[196:199], v[100:103], v[112:115]
  v_mfma_f32_16x16x32_bf16 v[112:115], a[200:203], v[104:107], v[112:115]
  v_mfma_f32_16x16x32_bf16 v[112:115], a[204:207], v[108:111], v[112:115]
  v_cvt_pk_bf16_f32 v128, v128, v129
  v_cvt_pk_bf16_f32 v129, v130, v131
  v_cvt_pk_bf16_f32 v130, v132, v133
  v_cvt_pk_bf16_f32 v131, v134, v135
  v_pk_mul_f32 v[136:137], v[136:137], s[52:53]
  v_pk_mul_f32 v[138:139], v[138:139], s[52:53]
  v_pk_mul_f32 v[140:141], v[140:141], s[52:53]
  v_pk_mul_f32 v[142:143], v[142:143], s[52:53]
  v_cvt_pk_bf16_f32 v132, v136, v137
  v_cvt_pk_bf16_f32 v133, v138, v139
  v_cvt_pk_bf16_f32 v134, v140, v141
  v_cvt_pk_bf16_f32 v135, v142, v143
  v_pk_mul_f32 v[144:145], v[144:145], s[52:53]
  v_pk_mul_f32 v[146:147], v[146:147], s[52:53]
  v_pk_mul_f32 v[148:149], v[148:149], s[52:53]
  v_pk_mul_f32 v[150:151], v[150:151], s[52:53]
  v_cvt_pk_bf16_f32 v136, v144, v145
  v_cvt_pk_bf16_f32 v137, v146, v147
  v_cvt_pk_bf16_f32 v138, v148, v149
  v_cvt_pk_bf16_f32 v139, v150, v151
  v_pk_mul_f32 v[152:153], v[152:153], s[52:53]
  v_pk_mul_f32 v[154:155], v[154:155], s[52:53]
  v_pk_mul_f32 v[156:157], v[156:157], s[52:53]
  v_pk_mul_f32 v[158:159], v[158:159], s[52:53]
  v_cvt_pk_bf16_f32 v140, v152, v153
  v_cvt_pk_bf16_f32 v141, v154, v155
  v_cvt_pk_bf16_f32 v142, v156, v157
  v_cvt_pk_bf16_f32 v143, v158, v159
  s_waitcnt vmcnt(9)
  buffer_load_dwordx4 v31, s[16:19], s45 offen offset:2048 nt lds
  v_pk_mul_f32 v[160:161], v[160:161], s[52:53]
  v_pk_mul_f32 v[162:163], v[162:163], s[52:53]
  v_pk_mul_f32 v[164:165], v[164:165], s[52:53]
  v_pk_mul_f32 v[166:167], v[166:167], s[52:53]
  v_mfma_f32_16x16x32_bf16 v[144:147], a[192:195], v[128:131], 0
  v_mfma_f32_16x16x32_bf16 v[144:147], a[196:199], v[132:135], v[144:147]
  v_mfma_f32_16x16x32_bf16 v[144:147], a[200:203], v[136:139], v[144:147]
  v_mfma_f32_16x16x32_bf16 v[144:147], a[204:207], v[140:143], v[144:147]
  v_cvt_pk_bf16_f32 v160, v160, v161
  v_cvt_pk_bf16_f32 v161, v162, v163
  v_cvt_pk_bf16_f32 v162, v164, v165
  v_cvt_pk_bf16_f32 v163, v166, v167
  v_pk_mul_f32 v[168:169], v[168:169], s[52:53]
  v_pk_mul_f32 v[170:171], v[170:171], s[52:53]
  v_pk_mul_f32 v[172:173], v[172:173], s[52:53]
  v_pk_mul_f32 v[174:175], v[174:175], s[52:53]
  v_cvt_pk_bf16_f32 v164, v168, v169
  v_cvt_pk_bf16_f32 v165, v170, v171
  v_cvt_pk_bf16_f32 v166, v172, v173
  v_cvt_pk_bf16_f32 v167, v174, v175
  v_pk_mul_f32 v[176:177], v[176:177], s[52:53]
  v_pk_mul_f32 v[178:179], v[178:179], s[52:53]
  v_pk_mul_f32 v[180:181], v[180:181], s[52:53]
  v_pk_mul_f32 v[182:183], v[182:183], s[52:53]
  v_cvt_pk_bf16_f32 v168, v176, v177
  v_cvt_pk_bf16_f32 v169, v178, v179
  v_cvt_pk_bf16_f32 v170, v180, v181
  v_cvt_pk_bf16_f32 v171, v182, v183
  v_pk_mul_f32 v[184:185], v[184:185], s[52:53]
  v_pk_mul_f32 v[186:187], v[186:187], s[52:53]
  v_pk_mul_f32 v[188:189], v[188:189], s[52:53]
  v_pk_mul_f32 v[190:191], v[190:191], s[52:53]
  v_cvt_pk_bf16_f32 v172, v184, v185
  v_cvt_pk_bf16_f32 v173, v186, v187
  v_cvt_pk_bf16_f32 v174, v188, v189
  v_cvt_pk_bf16_f32 v175, v190, v191
  s_waitcnt vmcnt(9)
  buffer_load_dwordx4 v31, s[16:19], s45 offen offset:3072 nt lds
  v_pk_mul_f32 v[192:193], v[192:193], s[52:53]
  v_pk_mul_f32 v[194:195], v[194:195], s[52:53]
  v_pk_mul_f32 v[196:197], v[196:197], s[52:53]
  v_pk_mul_f32 v[198:199], v[198:199], s[52:53]
  v_mfma_f32_16x16x32_bf16 v[176:179], a[192:195], v[160:163], 0
  v_mfma_f32_16x16x32_bf16 v[176:179], a[196:199], v[164:167], v[176:179]
  v_mfma_f32_16x16x32_bf16 v[176:179], a[200:203], v[168:171], v[176:179]
  v_mfma_f32_16x16x32_bf16 v[176:179], a[204:207], v[172:175], v[176:179]
  v_cvt_pk_bf16_f32 v192, v192, v193
  v_cvt_pk_bf16_f32 v193, v194, v195
  v_cvt_pk_bf16_f32 v194, v196, v197
  v_cvt_pk_bf16_f32 v195, v198, v199
  v_pk_mul_f32 v[200:201], v[200:201], s[52:53]
  v_pk_mul_f32 v[202:203], v[202:203], s[52:53]
  v_pk_mul_f32 v[204:205], v[204:205], s[52:53]
  v_pk_mul_f32 v[206:207], v[206:207], s[52:53]
  v_cvt_pk_bf16_f32 v196, v200, v201
  v_cvt_pk_bf16_f32 v197, v202, v203
  v_cvt_pk_bf16_f32 v198, v204, v205
  v_cvt_pk_bf16_f32 v199, v206, v207
  v_pk_mul_f32 v[208:209], v[208:209], s[52:53]
  v_pk_mul_f32 v[210:211], v[210:211], s[52:53]
  v_pk_mul_f32 v[212:213], v[212:213], s[52:53]
  v_pk_mul_f32 v[214:215], v[214:215], s[52:53]
  v_cvt_pk_bf16_f32 v200, v208, v209
  v_cvt_pk_bf16_f32 v201, v210, v211
  v_cvt_pk_bf16_f32 v202, v212, v213
  v_cvt_pk_bf16_f32 v203, v214, v215
  v_pk_mul_f32 v[216:217], v[216:217], s[52:53]
  v_pk_mul_f32 v[218:219], v[218:219], s[52:53]
  v_pk_mul_f32 v[220:221], v[220:221], s[52:53]
  v_pk_mul_f32 v[222:223], v[222:223], s[52:53]
  v_cvt_pk_bf16_f32 v204, v216, v217
  v_cvt_pk_bf16_f32 v205, v218, v219
  v_cvt_pk_bf16_f32 v206, v220, v221
  v_cvt_pk_bf16_f32 v207, v222, v223
  s_nop 1
  v_mfma_f32_16x16x32_bf16 v[208:211], a[192:195], v[192:195], 0
  v_mfma_f32_16x16x32_bf16 v[208:211], a[196:199], v[196:199], v[208:211]
  v_mfma_f32_16x16x32_bf16 v[208:211], a[200:203], v[200:203], v[208:211]
  v_mfma_f32_16x16x32_bf16 v[208:211], a[204:207], v[204:207], v[208:211]
  v_mov_b32 v52, 0
  v_mov_b32 v84, 0
  v_mov_b32 v116, 0
  v_mov_b32 v148, 0
  v_mov_b32 v180, 0
  v_mov_b32 v212, 0
  s_nop 1
  v_max3_f32 v48, v48, v49, v50
  v_max3_f32 v80, v80, v81, v82
  v_max3_f32 v112, v112, v113, v114
  v_max3_f32 v144, v144, v145, v146
  v_max3_f32 v176, v176, v177, v178
  v_max3_f32 v208, v208, v209, v210
  v_max_f32 v48, v48, v51
  v_max_f32 v80, v80, v83
  v_max_f32 v112, v112, v115
  v_max_f32 v144, v144, v147
  v_max_f32 v176, v176, v179
  v_max_f32 v208, v208, v211
  v_mov_b32 v49, v48
  v_mov_b32 v81, v80
  v_mov_b32 v113, v112
  v_mov_b32 v145, v144
  v_mov_b32 v177, v176
  v_mov_b32 v209, v208
  s_nop 1
  v_permlane16_swap_b32 v48, v49
  v_permlane16_swap_b32 v80, v81
  v_permlane16_swap_b32 v112, v113
  v_permlane16_swap_b32 v144, v145
  v_permlane16_swap_b32 v176, v177
  v_permlane16_swap_b32 v208, v209
  s_nop 0
  v_max_f32 v48, v48, v49
  v_max_f32 v80, v80, v81
  v_max_f32 v112, v112, v113
  v_max_f32 v144, v144, v145
  v_max_f32 v176, v176, v177
  v_max_f32 v208, v208, v209
  v_mov_b32 v49, v48
  v_mov_b32 v81, v80
  v_mov_b32 v113, v112
  v_mov_b32 v145, v144
  v_mov_b32 v177, v176
  v_mov_b32 v209, v208
  s_nop 1
  v_permlane32_swap_b32 v48, v49
  v_permlane32_swap_b32 v80, v81
  v_permlane32_swap_b32 v112, v113
  v_permlane32_swap_b32 v144, v145
  v_permlane32_swap_b32 v176, v177
  v_permlane32_swap_b32 v208, v209
  s_nop 0
  v_max_f32 v48, v48, v49
  v_max_f32 v80, v80, v81
  v_max_f32 v112, v112, v113
  v_max_f32 v144, v144, v145
  v_max_f32 v176, v176, v177
  v_max_f32 v208, v208, v209
  v_sub_f32 v51, 0, v48
  v_sub_f32 v50, 0, v48
  v_sub_f32 v49, 0, v48
  v_sub_f32 v48, 0, v48
  s_mov_b32 s50, 0
  s_nop 0
  v_mfma_f32_16x16x32_bf16 v[56:59], a[192:195], v[32:35], v[48:51]
  v_sub_f32 v83, 0, v80
  v_sub_f32 v82, 0, v80
  v_sub_f32 v81, 0, v80
  v_mfma_f32_16x16x32_bf16 v[56:59], a[196:199], v[36:39], v[56:59]
  v_sub_f32 v80, 0, v80
  v_sub_f32 v115, 0, v112
  v_sub_f32 v114, 0, v112
  v_mfma_f32_16x16x32_bf16 v[56:59], a[200:203], v[40:43], v[56:59]
  v_sub_f32 v113, 0, v112
  v_sub_f32 v112, 0, v112
  v_sub_f32 v147, 0, v144
  v_mfma_f32_16x16x32_bf16 v[56:59], a[204:207], v[44:47], v[56:59]
  v_sub_f32 v146, 0, v144
  v_sub_f32 v145, 0, v144
  v_sub_f32 v144, 0, v144
  v_mfma_f32_16x16x32_bf16 v[60:63], a[208:211], v[32:35], v[48:51]
  v_sub_f32 v179, 0, v176
  v_sub_f32 v178, 0, v176
  v_sub_f32 v177, 0, v176
  v_mfma_f32_16x16x32_bf16 v[60:63], a[212:215], v[36:39], v[60:63]
  v_sub_f32 v176, 0, v176
  v_sub_f32 v211, 0, v208
  v_sub_f32 v210, 0, v208
  v_mfma_f32_16x16x32_bf16 v[60:63], a[216:219], v[40:43], v[60:63]
  v_sub_f32 v209, 0, v208
  v_sub_f32 v208, 0, v208
  v_mfma_f32_16x16x32_bf16 v[60:63], a[220:223], v[44:47], v[60:63]
  s_nop 3
  v_exp_f32 v56, v56
  v_exp_f32 v57, v57
  v_exp_f32 v58, v58
  v_exp_f32 v59, v59
  v_exp_f32 v60, v60
  v_add_f32 v52, v52, v56
  v_add_f32 v52, v52, v57
  v_add_f32 v52, v52, v58
  v_add_f32 v52, v52, v59
  v_cvt_pk_bf16_f32 v120, v56, v57
  v_cvt_pk_bf16_f32 v121, v58, v59
  s_add_u32 s40, s41, 16384
  s_add_u32 s42, s41, 57344
  s_mov_b32 s59, 16384
  v_mfma_f32_16x16x32_bf16 v[88:91], a[192:195], v[64:67], v[80:83]
  v_add_f32 v52, v52, v60
  v_mfma_f32_16x16x32_bf16 v[88:91], a[196:199], v[68:71], v[88:91]
  v_exp_f32 v61, v61
  v_mfma_f32_16x16x32_bf16 v[88:91], a[200:203], v[72:75], v[88:91]
  s_add_u32 m0, s42, 0
  v_add_f32 v52, v52, v61
  v_cvt_pk_bf16_f32 v122, v60, v61
  v_mfma_f32_16x16x32_bf16 v[88:91], a[204:207], v[76:79], v[88:91]
  s_waitcnt vmcnt(6)
  v_exp_f32 v62, v62
  v_mfma_f32_16x16x32_bf16 v[92:95], a[208:211], v[64:67], v[80:83]
  buffer_load_dwordx4 v6, s[20:23], s45 offen offset:0 nt lds
  v_add_f32 v52, v52, v62
  v_mfma_f32_16x16x32_bf16 v[92:95], a[212:215], v[68:71], v[92:95]
  v_exp_f32 v63, v63
  v_mfma_f32_16x16x32_bf16 v[92:95], a[216:219], v[72:75], v[92:95]
  v_add_f32 v52, v52, v63
  v_cvt_pk_bf16_f32 v123, v62, v63
  v_mfma_f32_16x16x32_bf16 v[92:95], a[220:223], v[76:79], v[92:95]
  v_exp_f32 v88, v88
  v_mfma_f32_16x16x32_bf16 a[0:3], a[224:227], v[120:123], 0
  v_add_f32 v84, v84, v88
  v_mfma_f32_16x16x32_bf16 a[4:7], a[228:231], v[120:123], 0
  s_waitcnt vmcnt(6)
  v_exp_f32 v89, v89
  v_mfma_f32_16x16x32_bf16 a[8:11], a[232:235], v[120:123], 0
  s_waitcnt lgkmcnt(8)
  buffer_load_dwordx4 v6, s[20:23], s45 offen offset:1024 nt lds
  v_add_f32 v84, v84, v89
  v_cvt_pk_bf16_f32 v124, v88, v89
  v_mfma_f32_16x16x32_bf16 a[12:15], a[236:239], v[120:123], 0
  s_waitcnt lgkmcnt(6)
  v_exp_f32 v90, v90
  v_mfma_f32_16x16x32_bf16 a[16:19], a[240:243], v[120:123], 0
  s_waitcnt lgkmcnt(4)
  v_add_f32 v84, v84, v90
  v_mfma_f32_16x16x32_bf16 a[20:23], a[244:247], v[120:123], 0
  s_waitcnt lgkmcnt(2)
  v_exp_f32 v91, v91
  v_mfma_f32_16x16x32_bf16 a[24:27], a[248:251], v[120:123], 0
  s_waitcnt lgkmcnt(0)
  v_add_f32 v84, v84, v91
  v_cvt_pk_bf16_f32 v125, v90, v91
  v_mfma_f32_16x16x32_bf16 a[28:31], a[252:255], v[120:123], 0
  s_waitcnt vmcnt(16)
  s_barrier
  s_waitcnt vmcnt(6)
  v_exp_f32 v92, v92
  v_mfma_f32_16x16x32_bf16 v[56:59], a[192:195], v[96:99], v[112:115]
  buffer_load_dwordx4 v6, s[20:23], s45 offen offset:2048 nt lds
  v_add_f32 v84, v84, v92
  v_mfma_f32_16x16x32_bf16 v[56:59], a[196:199], v[100:103], v[56:59]
  v_exp_f32 v93, v93
  v_mfma_f32_16x16x32_bf16 v[56:59], a[200:203], v[104:107], v[56:59]
  v_add_f32 v84, v84, v93
  v_cvt_pk_bf16_f32 v126, v92, v93
  v_mfma_f32_16x16x32_bf16 v[56:59], a[204:207], v[108:111], v[56:59]
  v_exp_f32 v94, v94
  v_mfma_f32_16x16x32_bf16 v[60:63], a[208:211], v[96:99], v[112:115]
  v_add_f32 v84, v84, v94
  v_mfma_f32_16x16x32_bf16 v[60:63], a[212:215], v[100:103], v[60:63]
  s_waitcnt vmcnt(6)
  v_exp_f32 v95, v95
  v_mfma_f32_16x16x32_bf16 v[60:63], a[216:219], v[104:107], v[60:63]
  buffer_load_dwordx4 v6, s[20:23], s45 offen offset:3072 nt lds
  v_add_f32 v84, v84, v95
  v_cvt_pk_bf16_f32 v127, v94, v95
  v_mfma_f32_16x16x32_bf16 v[60:63], a[220:223], v[108:111], v[60:63]
  v_exp_f32 v56, v56
  v_mfma_f32_16x16x32_bf16 a[32:35], a[224:227], v[124:127], 0
  v_add_f32 v116, v116, v56
  v_mfma_f32_16x16x32_bf16 a[36:39], a[228:231], v[124:127], 0
  v_exp_f32 v57, v57
  v_mfma_f32_16x16x32_bf16 a[40:43], a[232:235], v[124:127], 0
  s_add_u32 m0, s42, 4096
  v_add_f32 v116, v116, v57
  v_cvt_pk_bf16_f32 v120, v56, v57
  v_mfma_f32_16x16x32_bf16 a[44:47], a[236:239], v[124:127], 0
  s_waitcnt vmcnt(6)
  v_exp_f32 v58, v58
  v_mfma_f32_16x16x32_bf16 a[48:51], a[240:243], v[124:127], 0
  buffer_load_dwordx4 v31, s[20:23], s45 offen offset:0 nt lds
  v_add_f32 v116, v116, v58
  v_mfma_f32_16x16x32_bf16 a[52:55], a[244:247], v[124:127], 0
  v_exp_f32 v59, v59
  v_mfma_f32_16x16x32_bf16 a[56:59], a[248:251], v[124:127], 0
  v_add_f32 v116, v116, v59
  v_cvt_pk_bf16_f32 v121, v58, v59
  v_mfma_f32_16x16x32_bf16 a[60:63], a[252:255], v[124:127], 0
  v_exp_f32 v60, v60
  v_mfma_f32_16x16x32_bf16 v[88:91], a[192:195], v[128:131], v[144:147]
  v_add_f32 v116, v116, v60
  v_mfma_f32_16x16x32_bf16 v[88:91], a[196:199], v[132:135], v[88:91]
  s_waitcnt vmcnt(6)
  v_exp_f32 v61, v61
  v_mfma_f32_16x16x32_bf16 v[88:91], a[200:203], v[136:139], v[88:91]
  buffer_load_dwordx4 v31, s[20:23], s45 offen offset:1024 nt lds
  v_add_f32 v116, v116, v61
  v_cvt_pk_bf16_f32 v122, v60, v61
  v_mfma_f32_16x16x32_bf16 v[88:91], a[204:207], v[140:143], v[88:91]
  v_exp_f32 v62, v62
  v_mfma_f32_16x16x32_bf16 v[92:95], a[208:211], v[128:131], v[144:147]
  v_add_f32 v116, v116, v62
  v_mfma_f32_16x16x32_bf16 v[92:95], a[212:215], v[132:135], v[92:95]
  v_exp_f32 v63, v63
  v_mfma_f32_16x16x32_bf16 v[92:95], a[216:219], v[136:139], v[92:95]
  v_add_f32 v116, v116, v63
  v_cvt_pk_bf16_f32 v123, v62, v63
  v_mfma_f32_16x16x32_bf16 v[92:95], a[220:223], v[140:143], v[92:95]
  s_waitcnt vmcnt(6)
  v_exp_f32 v88, v88
  v_mfma_f32_16x16x32_bf16 a[64:67], a[224:227], v[120:123], 0
  buffer_load_dwordx4 v31, s[20:23], s45 offen offset:2048 nt lds
  v_add_f32 v148, v148, v88
  v_mfma_f32_16x16x32_bf16 a[68:71], a[228:231], v[120:123], 0
  v_exp_f32 v89, v89
  v_mfma_f32_16x16x32_bf16 a[72:75], a[232:235], v[120:123], 0
  v_add_f32 v148, v148, v89
  v_cvt_pk_bf16_f32 v124, v88, v89
  v_mfma_f32_16x16x32_bf16 a[76:79], a[236:239], v[120:123], 0
  v_exp_f32 v90, v90
  v_mfma_f32_16x16x32_bf16 a[80:83], a[240:243], v[120:123], 0
  v_add_f32 v148, v148, v90
  v_mfma_f32_16x16x32_bf16 a[84:87], a[244:247], v[120:123], 0
  s_waitcnt vmcnt(6)
  v_exp_f32 v91, v91
  v_mfma_f32_16x16x32_bf16 a[88:91], a[248:251], v[120:123], 0
  buffer_load_dwordx4 v31, s[20:23], s45 offen offset:3072 nt lds
  v_add_f32 v148, v148, v91
  v_cvt_pk_bf16_f32 v125, v90, v91
  v_mfma_f32_16x16x32_bf16 a[92:95], a[252:255], v[120:123], 0
  s_add_u32 s55, s55, 8192
  v_exp_f32 v92, v92
  v_mfma_f32_16x16x32_bf16 v[56:59], a[192:195], v[160:163], v[176:179]
  s_xor_b32 s45, s55, s39
  v_add_f32 v148, v148, v92
  v_mfma_f32_16x16x32_bf16 v[56:59], a[196:199], v[164:167], v[56:59]
  v_exp_f32 v93, v93
  v_mfma_f32_16x16x32_bf16 v[56:59], a[200:203], v[168:171], v[56:59]
  s_add_u32 m0, s40, 0
  v_add_f32 v148, v148, v93
  v_cvt_pk_bf16_f32 v126, v92, v93
  v_mfma_f32_16x16x32_bf16 v[56:59], a[204:207], v[172:175], v[56:59]
  s_waitcnt vmcnt(6)
  v_exp_f32 v94, v94
  v_mfma_f32_16x16x32_bf16 v[60:63], a[208:211], v[160:163], v[176:179]
  buffer_load_dwordx4 v6, s[16:19], s45 offen offset:0 nt lds
  v_add_f32 v148, v148, v94
  v_mfma_f32_16x16x32_bf16 v[60:63], a[212:215], v[164:167], v[60:63]
  v_exp_f32 v95, v95
  v_mfma_f32_16x16x32_bf16 v[60:63], a[216:219], v[168:171], v[60:63]
  v_add_f32 v148, v148, v95
  v_cvt_pk_bf16_f32 v127, v94, v95
  v_mfma_f32_16x16x32_bf16 v[60:63], a[220:223], v[172:175], v[60:63]
  v_exp_f32 v56, v56
  v_mfma_f32_16x16x32_bf16 a[96:99], a[224:227], v[124:127], 0
  v_add_f32 v180, v180, v56
  v_mfma_f32_16x16x32_bf16 a[100:103], a[228:231], v[124:127], 0
  s_waitcnt vmcnt(6)
  v_exp_f32 v57, v57
  v_mfma_f32_16x16x32_bf16 a[104:107], a[232:235], v[124:127], 0
  buffer_load_dwordx4 v6, s[16:19], s45 offen offset:1024 nt lds
  v_add_f32 v180, v180, v57
  v_cvt_pk_bf16_f32 v120, v56, v57
  v_mfma_f32_16x16x32_bf16 a[108:111], a[236:239], v[124:127], 0
  v_exp_f32 v58, v58
  v_mfma_f32_16x16x32_bf16 a[112:115], a[240:243], v[124:127], 0
  v_add_f32 v180, v180, v58
  v_mfma_f32_16x16x32_bf16 a[116:119], a[244:247], v[124:127], 0
  v_exp_f32 v59, v59
  v_mfma_f32_16x16x32_bf16 a[120:123], a[248:251], v[124:127], 0
  v_add_f32 v180, v180, v59
  v_cvt_pk_bf16_f32 v121, v58, v59
  v_mfma_f32_16x16x32_bf16 a[124:127], a[252:255], v[124:127], 0
  s_waitcnt vmcnt(6)
  v_exp_f32 v60, v60
  v_mfma_f32_16x16x32_bf16 v[88:91], a[192:195], v[192:195], v[208:211]
  ds_read_b128 a[192:195], v13 offset:0
  buffer_load_dwordx4 v6, s[16:19], s45 offen offset:2048 nt lds
  v_add_f32 v180, v180, v60
  v_mfma_f32_16x16x32_bf16 v[88:91], a[196:199], v[196:199], v[88:91]
  v_exp_f32 v61, v61
  v_mfma_f32_16x16x32_bf16 v[88:91], a[200:203], v[200:203], v[88:91]
  ds_read_b128 a[196:199], v14 offset:0
  v_add_f32 v180, v180, v61
  v_cvt_pk_bf16_f32 v122, v60, v61
  v_mfma_f32_16x16x32_bf16 v[88:91], a[204:207], v[204:207], v[88:91]
  v_exp_f32 v62, v62
  v_mfma_f32_16x16x32_bf16 v[92:95], a[208:211], v[192:195], v[208:211]
  ds_read_b128 a[200:203], v15 offset:0
  v_add_f32 v180, v180, v62
  v_mfma_f32_16x16x32_bf16 v[92:95], a[212:215], v[196:199], v[92:95]
  s_waitcnt vmcnt(6)
  v_exp_f32 v63, v63
  v_mfma_f32_16x16x32_bf16 v[92:95], a[216:219], v[200:203], v[92:95]
  ds_read_b128 a[204:207], v16 offset:0
  buffer_load_dwordx4 v6, s[16:19], s45 offen offset:3072 nt lds
  v_add_f32 v180, v180, v63
  v_cvt_pk_bf16_f32 v123, v62, v63
  v_mfma_f32_16x16x32_bf16 v[92:95], a[220:223], v[204:207], v[92:95]
  v_exp_f32 v88, v88
  v_mfma_f32_16x16x32_bf16 a[128:131], a[224:227], v[120:123], 0
  ds_read_b128 a[208:211], v13 offset:2048
  v_add_f32 v212, v212, v88
  v_mfma_f32_16x16x32_bf16 a[132:135], a[228:231], v[120:123], 0
  v_exp_f32 v89, v89
  v_mfma_f32_16x16x32_bf16 a[136:139], a[232:235], v[120:123], 0
  s_add_u32 m0, s40, 4096
  ds_read_b128 a[212:215], v14 offset:2048
  v_add_f32 v212, v212, v89
  v_cvt_pk_bf16_f32 v124, v88, v89
  v_mfma_f32_16x16x32_bf16 a[140:143], a[236:239], v[120:123], 0
  s_waitcnt vmcnt(6)
  v_exp_f32 v90, v90
  v_mfma_f32_16x16x32_bf16 a[144:147], a[240:243], v[120:123], 0
  ds_read_b128 a[216:219], v15 offset:2048
  buffer_load_dwordx4 v31, s[16:19], s45 offen offset:0 nt lds
  v_add_f32 v212, v212, v90
  v_mfma_f32_16x16x32_bf16 a[148:151], a[244:247], v[120:123], 0
  v_exp_f32 v91, v91
  v_mfma_f32_16x16x32_bf16 a[152:155], a[248:251], v[120:123], 0
  ds_read_b128 a[220:223], v16 offset:2048
  v_add_f32 v212, v212, v91
  v_cvt_pk_bf16_f32 v125, v90, v91
  v_mfma_f32_16x16x32_bf16 a[156:159], a[252:255], v[120:123], 0
  s_waitcnt lgkmcnt(7)
  v_exp_f32 v92, v92
  v_mfma_f32_16x16x32_bf16 v[56:59], a[192:195], v[32:35], v[48:51]
  s_waitcnt lgkmcnt(6)
  v_add_f32 v212, v212, v92
  v_mfma_f32_16x16x32_bf16 v[56:59], a[196:199], v[36:39], v[56:59]
  s_waitcnt lgkmcnt(5)
  s_waitcnt vmcnt(6)
  v_exp_f32 v93, v93
  v_mfma_f32_16x16x32_bf16 v[56:59], a[200:203], v[40:43], v[56:59]
  s_waitcnt lgkmcnt(4)
  buffer_load_dwordx4 v31, s[16:19], s45 offen offset:1024 nt lds
  v_add_f32 v212, v212, v93
  v_cvt_pk_bf16_f32 v126, v92, v93
  v_mfma_f32_16x16x32_bf16 v[56:59], a[204:207], v[44:47], v[56:59]
  s_waitcnt lgkmcnt(3)
  v_exp_f32 v94, v94
  v_mfma_f32_16x16x32_bf16 v[60:63], a[208:211], v[32:35], v[48:51]
  s_waitcnt lgkmcnt(2)
  v_add_f32 v212, v212, v94
  v_mfma_f32_16x16x32_bf16 v[60:63], a[212:215], v[36:39], v[60:63]
  s_waitcnt lgkmcnt(1)
  s_add_u32 s42, s40, 32768
  v_exp_f32 v95, v95
  v_mfma_f32_16x16x32_bf16 v[60:63], a[216:219], v[40:43], v[60:63]
  s_waitcnt lgkmcnt(0)
  s_xor_b32 s40, s40, s59
  v_add_f32 v212, v212, v95
  v_cvt_pk_bf16_f32 v127, v94, v95
  v_mfma_f32_16x16x32_bf16 v[60:63], a[220:223], v[44:47], v[60:63]
  s_waitcnt vmcnt(6)
  v_exp_f32 v56, v56
  v_mfma_f32_16x16x32_bf16 a[160:163], a[224:227], v[124:127], 0
  ds_read_b64_tr_b16 a[224:225], v17 offset:0
  buffer_load_dwordx4 v31, s[16:19], s45 offen offset:2048 nt lds
  v_add_f32 v52, v52, v56
  v_mfma_f32_16x16x32_bf16 a[164:167], a[228:231], v[124:127], 0
  s_xor_b32 s59, s59, 24576
  ds_read_b64_tr_b16 a[226:227], v17 offset:2048
  v_exp_f32 v57, v57
  v_mfma_f32_16x16x32_bf16 a[168:171], a[232:235], v[124:127], 0
  ds_read_b64_tr_b16 a[228:229], v18 offset:0
  v_add_f32 v52, v52, v57
  v_cvt_pk_bf16_f32 v120, v56, v57
  v_mfma_f32_16x16x32_bf16 a[172:175], a[236:239], v[124:127], 0
  ds_read_b64_tr_b16 a[230:231], v18 offset:2048
  v_exp_f32 v58, v58
  v_mfma_f32_16x16x32_bf16 a[176:179], a[240:243], v[124:127], 0
  ds_read_b64_tr_b16 a[232:233], v19 offset:0
  v_add_f32 v52, v52, v58
  v_mfma_f32_16x16x32_bf16 a[180:183], a[244:247], v[124:127], 0
  s_waitcnt vmcnt(6)
  ds_read_b64_tr_b16 a[234:235], v19 offset:2048
  v_exp_f32 v59, v59
  v_mfma_f32_16x16x32_bf16 a[184:187], a[248:251], v[124:127], 0
  ds_read_b64_tr_b16 a[236:237], v20 offset:0
  buffer_load_dwordx4 v31, s[16:19], s45 offen offset:3072 nt lds
  v_add_f32 v52, v52, v59
  v_cvt_pk_bf16_f32 v121, v58, v59
  v_mfma_f32_16x16x32_bf16 a[188:191], a[252:255], v[124:127], 0
  ds_read_b64_tr_b16 a[238:239], v20 offset:2048
  v_exp_f32 v60, v60
L1b_aloop0:
  v_mfma_f32_16x16x32_bf16 v[88:91], a[192:195], v[64:67], v[80:83]
  ds_read_b64_tr_b16 a[240:241], v21 offset:0
  v_add_f32 v52, v52, v60
  v_mfma_f32_16x16x32_bf16 v[88:91], a[196:199], v[68:71], v[88:91]
  ds_read_b64_tr_b16 a[242:243], v21 offset:2048
  v_exp_f32 v61, v61
  v_mfma_f32_16x16x32_bf16 v[88:91], a[200:203], v[72:75], v[88:91]
  s_add_u32 m0, s42, 0
  ds_read_b64_tr_b16 a[244:245], v22 offset:0
  v_add_f32 v52, v52, v61
  v_cvt_pk_bf16_f32 v122, v60, v61
  v_mfma_f32_16x16x32_bf16 v[88:91], a[204:207], v[76:79], v[88:91]
  s_waitcnt vmcnt(6)
  ds_read_b64_tr_b16 a[246:247], v22 offset:2048
  v_exp_f32 v62, v62
  v_mfma_f32_16x16x32_bf16 v[92:95], a[208:211], v[64:67], v[80:83]
  ds_read_b64_tr_b16 a[248:249], v23 offset:0
  buffer_load_dwordx4 v6, s[20:23], s45 offen offset:0 nt lds
  v_add_f32 v52, v52, v62
  v_mfma_f32_16x16x32_bf16 v[92:95], a[212:215], v[68:71], v[92:95]
  ds_read_b64_tr_b16 a[250:251], v23 offset:2048
  v_exp_f32 v63, v63
  v_mfma_f32_16x16x32_bf16 v[92:95], a[216:219], v[72:75], v[92:95]
  ds_read_b64_tr_b16 a[252:253], v28 offset:0
  v_add_f32 v52, v52, v63
  v_cvt_pk_bf16_f32 v123, v62, v63
  v_mfma_f32_16x16x32_bf16 v[92:95], a[220:223], v[76:79], v[92:95]
  s_waitcnt lgkmcnt(8)
  ds_read_b64_tr_b16 a[254:255], v28 offset:2048
  v_exp_f32 v88, v88
  v_mfma_f32_16x16x32_bf16 a[0:3], a[224:227], v[120:123], a[0:3]
  v_add_f32 v84, v84, v88
  v_mfma_f32_16x16x32_bf16 a[4:7], a[228:231], v[120:123], a[4:7]
  s_waitcnt vmcnt(6)
  v_exp_f32 v89, v89
  v_mfma_f32_16x16x32_bf16 a[8:11], a[232:235], v[120:123], a[8:11]
  s_waitcnt lgkmcnt(8)
  buffer_load_dwordx4 v6, s[20:23], s45 offen offset:1024 nt lds
  v_add_f32 v84, v84, v89
  v_cvt_pk_bf16_f32 v124, v88, v89
  v_mfma_f32_16x16x32_bf16 a[12:15], a[236:239], v[120:123], a[12:15]
  s_waitcnt lgkmcnt(6)
  v_exp_f32 v90, v90
  v_mfma_f32_16x16x32_bf16 a[16:19], a[240:243], v[120:123], a[16:19]
  s_waitcnt lgkmcnt(4)
  v_add_f32 v84, v84, v90
  v_mfma_f32_16x16x32_bf16 a[20:23], a[244:247], v[120:123], a[20:23]
  s_waitcnt lgkmcnt(2)
  v_exp_f32 v91, v91
  v_mfma_f32_16x16x32_bf16 a[24:27], a[248:251], v[120:123], a[24:27]
  s_waitcnt lgkmcnt(0)
  v_add_f32 v84, v84, v91
  v_cvt_pk_bf16_f32 v125, v90, v91
  v_mfma_f32_16x16x32_bf16 a[28:31], a[252:255], v[120:123], a[28:31]
  s_waitcnt vmcnt(16)
  s_barrier
  s_waitcnt vmcnt(6)
  v_exp_f32 v92, v92
  v_mfma_f32_16x16x32_bf16 v[56:59], a[192:195], v[96:99], v[112:115]
  buffer_load_dwordx4 v6, s[20:23], s45 offen offset:2048 nt lds
  v_add_f32 v84, v84, v92
  v_xor_b32 v13, s59, v13
  v_mfma_f32_16x16x32_bf16 v[56:59], a[196:199], v[100:103], v[56:59]
  v_exp_f32 v93, v93
  v_mfma_f32_16x16x32_bf16 v[56:59], a[200:203], v[104:107], v[56:59]
  v_add_f32 v84, v84, v93
  v_cvt_pk_bf16_f32 v126, v92, v93
  v_mfma_f32_16x16x32_bf16 v[56:59], a[204:207], v[108:111], v[56:59]
  v_exp_f32 v94, v94
  v_mfma_f32_16x16x32_bf16 v[60:63], a[208:211], v[96:99], v[112:115]
  v_add_f32 v84, v84, v94
  v_xor_b32 v14, s59, v14
  v_mfma_f32_16x16x32_bf16 v[60:63], a[212:215], v[100:103], v[60:63]
  s_waitcnt vmcnt(6)
  v_exp_f32 v95, v95
  v_mfma_f32_16x16x32_bf16 v[60:63], a[216:219], v[104:107], v[60:63]
  buffer_load_dwordx4 v6, s[20:23], s45 offen offset:3072 nt lds
  v_add_f32 v84, v84, v95
  v_cvt_pk_bf16_f32 v127, v94, v95
  v_mfma_f32_16x16x32_bf16 v[60:63], a[220:223], v[108:111], v[60:63]
  v_exp_f32 v56, v56
  v_mfma_f32_16x16x32_bf16 a[32:35], a[224:227], v[124:127], a[32:35]
  v_add_f32 v116, v116, v56
  v_xor_b32 v15, s59, v15
  v_mfma_f32_16x16x32_bf16 a[36:39], a[228:231], v[124:127], a[36:39]
  v_exp_f32 v57, v57
  v_mfma_f32_16x16x32_bf16 a[40:43], a[232:235], v[124:127], a[40:43]
  s_add_u32 m0, s42, 4096
  v_add_f32 v116, v116, v57
  v_cvt_pk_bf16_f32 v120, v56, v57
  v_mfma_f32_16x16x32_bf16 a[44:47], a[236:239], v[124:127], a[44:47]
  s_waitcnt vmcnt(6)
  v_exp_f32 v58, v58
  v_mfma_f32_16x16x32_bf16 a[48:51], a[240:243], v[124:127], a[48:51]
  buffer_load_dwordx4 v31, s[20:23], s45 offen offset:0 nt lds
  v_add_f32 v116, v116, v58
  v_xor_b32 v16, s59, v16
  v_mfma_f32_16x16x32_bf16 a[52:55], a[244:247], v[124:127], a[52:55]
  v_exp_f32 v59, v59
  v_mfma_f32_16x16x32_bf16 a[56:59], a[248:251], v[124:127], a[56:59]
  v_add_f32 v116, v116, v59
  v_cvt_pk_bf16_f32 v121, v58, v59
  v_mfma_f32_16x16x32_bf16 a[60:63], a[252:255], v[124:127], a[60:63]
  v_exp_f32 v60, v60
  v_mfma_f32_16x16x32_bf16 v[88:91], a[192:195], v[128:131], v[144:147]
  v_add_f32 v116, v116, v60
  v_xor_b32 v17, s59, v17
  v_mfma_f32_16x16x32_bf16 v[88:91], a[196:199], v[132:135], v[88:91]
  s_waitcnt vmcnt(6)
  v_exp_f32 v61, v61
  v_mfma_f32_16x16x32_bf16 v[88:91], a[200:203], v[136:139], v[88:91]
  buffer_load_dwordx4 v31, s[20:23], s45 offen offset:1024 nt lds
  v_add_f32 v116, v116, v61
  v_cvt_pk_bf16_f32 v122, v60, v61
  v_mfma_f32_16x16x32_bf16 v[88:91], a[204:207], v[140:143], v[88:91]
  v_exp_f32 v62, v62
  v_mfma_f32_16x16x32_bf16 v[92:95], a[208:211], v[128:131], v[144:147]
  v_add_f32 v116, v116, v62
  v_xor_b32 v18, s59, v18
  v_mfma_f32_16x16x32_bf16 v[92:95], a[212:215], v[132:135], v[92:95]
  v_exp_f32 v63, v63
  v_mfma_f32_16x16x32_bf16 v[92:95], a[216:219], v[136:139], v[92:95]
  v_add_f32 v116, v116, v63
  v_cvt_pk_bf16_f32 v123, v62, v63
  v_mfma_f32_16x16x32_bf16 v[92:95], a[220:223], v[140:143], v[92:95]
  s_waitcnt vmcnt(6)
  v_exp_f32 v88, v88
  v_mfma_f32_16x16x32_bf16 a[64:67], a[224:227], v[120:123], a[64:67]
  buffer_load_dwordx4 v31, s[20:23], s45 offen offset:2048 nt lds
  v_add_f32 v148, v148, v88
  v_xor_b32 v19, s59, v19
  v_mfma_f32_16x16x32_bf16 a[68:71], a[228:231], v[120:123], a[68:71]
  v_exp_f32 v89, v89
  v_mfma_f32_16x16x32_bf16 a[72:75], a[232:235], v[120:123], a[72:75]
  v_add_f32 v148, v148, v89
  v_cvt_pk_bf16_f32 v124, v88, v89
  v_mfma_f32_16x16x32_bf16 a[76:79], a[236:239], v[120:123], a[76:79]
  v_exp_f32 v90, v90
  v_mfma_f32_16x16x32_bf16 a[80:83], a[240:243], v[120:123], a[80:83]
  v_add_f32 v148, v148, v90
  v_xor_b32 v20, s59, v20
  v_mfma_f32_16x16x32_bf16 a[84:87], a[244:247], v[120:123], a[84:87]
  s_waitcnt vmcnt(6)
  v_exp_f32 v91, v91
  v_mfma_f32_16x16x32_bf16 a[88:91], a[248:251], v[120:123], a[88:91]
  buffer_load_dwordx4 v31, s[20:23], s45 offen offset:3072 nt lds
  v_add_f32 v148, v148, v91
  v_cvt_pk_bf16_f32 v125, v90, v91
  v_mfma_f32_16x16x32_bf16 a[92:95], a[252:255], v[120:123], a[92:95]
  s_add_u32 s55, s55, 8192
  v_exp_f32 v92, v92
  v_mfma_f32_16x16x32_bf16 v[56:59], a[192:195], v[160:163], v[176:179]
  s_xor_b32 s45, s55, s39
  v_add_f32 v148, v148, v92
  v_xor_b32 v21, s59, v21
  v_mfma_f32_16x16x32_bf16 v[56:59], a[196:199], v[164:167], v[56:59]
  v_exp_f32 v93, v93
  v_mfma_f32_16x16x32_bf16 v[56:59], a[200:203], v[168:171], v[56:59]
  s_add_u32 m0, s40, 0
  v_add_f32 v148, v148, v93
  v_cvt_pk_bf16_f32 v126, v92, v93
  v_mfma_f32_16x16x32_bf16 v[56:59], a[204:207], v[172:175], v[56:59]
  s_waitcnt vmcnt(6)
  v_exp_f32 v94, v94
  v_mfma_f32_16x16x32_bf16 v[60:63], a[208:211], v[160:163], v[176:179]
  buffer_load_dwordx4 v6, s[16:19], s45 offen offset:0 nt lds
  v_add_f32 v148, v148, v94
  v_xor_b32 v22, s59, v22
  v_mfma_f32_16x16x32_bf16 v[60:63], a[212:215], v[164:167], v[60:63]
  v_exp_f32 v95, v95
  v_mfma_f32_16x16x32_bf16 v[60:63], a[216:219], v[168:171], v[60:63]
  v_add_f32 v148, v148, v95
  v_cvt_pk_bf16_f32 v127, v94, v95
  v_mfma_f32_16x16x32_bf16 v[60:63], a[220:223], v[172:175], v[60:63]
  v_exp_f32 v56, v56
  v_mfma_f32_16x16x32_bf16 a[96:99], a[224:227], v[124:127], a[96:99]
  v_add_f32 v180, v180, v56
  v_xor_b32 v23, s59, v23
  v_mfma_f32_16x16x32_bf16 a[100:103], a[228:231], v[124:127], a[100:103]
  s_waitcnt vmcnt(6)
  v_exp_f32 v57, v57
  v_mfma_f32_16x16x32_bf16 a[104:107], a[232:235], v[124:127], a[104:107]
  buffer_load_dwordx4 v6, s[16:19], s45 offen offset:1024 nt lds
  v_add_f32 v180, v180, v57
  v_cvt_pk_bf16_f32 v120, v56, v57
  v_mfma_f32_16x16x32_bf16 a[108:111], a[236:239], v[124:127], a[108:111]
  v_exp_f32 v58, v58
  v_mfma_f32_16x16x32_bf16 a[112:115], a[240:243], v[124:127], a[112:115]
  v_add_f32 v180, v180, v58
  v_xor_b32 v28, s59, v28
  v_mfma_f32_16x16x32_bf16 a[116:119], a[244:247], v[124:127], a[116:119]
  v_exp_f32 v59, v59
  v_mfma_f32_16x16x32_bf16 a[120:123], a[248:251], v[124:127], a[120:123]
  v_add_f32 v180, v180, v59
  v_cvt_pk_bf16_f32 v121, v58, v59
  v_mfma_f32_16x16x32_bf16 a[124:127], a[252:255], v[124:127], a[124:127]
  s_waitcnt vmcnt(6)
  v_exp_f32 v60, v60
  v_mfma_f32_16x16x32_bf16 v[88:91], a[192:195], v[192:195], v[208:211]
  ds_read_b128 a[192:195], v13 offset:0
  buffer_load_dwordx4 v6, s[16:19], s45 offen offset:2048 nt lds
  v_add_f32 v180, v180, v60
  v_mfma_f32_16x16x32_bf16 v[88:91], a[196:199], v[196:199], v[88:91]
  v_exp_f32 v61, v61
  v_mfma_f32_16x16x32_bf16 v[88:91], a[200:203], v[200:203], v[88:91]
  ds_read_b128 a[196:199], v14 offset:0
  v_add_f32 v180, v180, v61
  v_cvt_pk_bf16_f32 v122, v60, v61
  v_mfma_f32_16x16x32_bf16 v[88:91], a[204:207], v[204:207], v[88:91]
  v_exp_f32 v62, v62
  v_mfma_f32_16x16x32_bf16 v[92:95], a[208:211], v[192:195], v[208:211]
  ds_read_b128 a[200:203], v15 offset:0
  v_add_f32 v180, v180, v62
  v_mfma_f32_16x16x32_bf16 v[92:95], a[212:215], v[196:199], v[92:95]
  s_waitcnt vmcnt(6)
  v_exp_f32 v63, v63
  v_mfma_f32_16x16x32_bf16 v[92:95], a[216:219], v[200:203], v[92:95]
  ds_read_b128 a[204:207], v16 offset:0
  buffer_load_dwordx4 v6, s[16:19], s45 offen offset:3072 nt lds
  v_add_f32 v180, v180, v63
  v_cvt_pk_bf16_f32 v123, v62, v63
  v_mfma_f32_16x16x32_bf16 v[92:95], a[220:223], v[204:207], v[92:95]
  v_exp_f32 v88, v88
  v_mfma_f32_16x16x32_bf16 a[128:131], a[224:227], v[120:123], a[128:131]
  ds_read_b128 a[208:211], v13 offset:2048
  v_add_f32 v212, v212, v88
  v_mfma_f32_16x16x32_bf16 a[132:135], a[228:231], v[120:123], a[132:135]
  v_exp_f32 v89, v89
  v_mfma_f32_16x16x32_bf16 a[136:139], a[232:235], v[120:123], a[136:139]
  s_add_u32 m0, s40, 4096
  ds_read_b128 a[212:215], v14 offset:2048
  v_add_f32 v212, v212, v89
  v_cvt_pk_bf16_f32 v124, v88, v89
  v_mfma_f32_16x16x32_bf16 a[140:143], a[236:239], v[120:123], a[140:143]
  s_waitcnt vmcnt(6)
  v_exp_f32 v90, v90
  v_mfma_f32_16x16x32_bf16 a[144:147], a[240:243], v[120:123], a[144:147]
  ds_read_b128 a[216:219], v15 offset:2048
  buffer_load_dwordx4 v31, s[16:19], s45 offen offset:0 nt lds
  v_add_f32 v212, v212, v90
  v_mfma_f32_16x16x32_bf16 a[148:151], a[244:247], v[120:123], a[148:151]
  v_exp_f32 v91, v91
  v_mfma_f32_16x16x32_bf16 a[152:155], a[248:251], v[120:123], a[152:155]
  ds_read_b128 a[220:223], v16 offset:2048
  v_add_f32 v212, v212, v91
  v_cvt_pk_bf16_f32 v125, v90, v91
  v_mfma_f32_16x16x32_bf16 a[156:159], a[252:255], v[120:123], a[156:159]
  s_waitcnt lgkmcnt(7)
  v_exp_f32 v92, v92
  v_mfma_f32_16x16x32_bf16 v[56:59], a[192:195], v[32:35], v[48:51]
  s_waitcnt lgkmcnt(6)
  v_add_f32 v212, v212, v92
  v_mfma_f32_16x16x32_bf16 v[56:59], a[196:199], v[36:39], v[56:59]
  s_waitcnt lgkmcnt(5)
  s_waitcnt vmcnt(6)
  v_exp_f32 v93, v93
  v_mfma_f32_16x16x32_bf16 v[56:59], a[200:203], v[40:43], v[56:59]
  s_waitcnt lgkmcnt(4)
  buffer_load_dwordx4 v31, s[16:19], s45 offen offset:1024 nt lds
  v_add_f32 v212, v212, v93
  v_cvt_pk_bf16_f32 v126, v92, v93
  v_mfma_f32_16x16x32_bf16 v[56:59], a[204:207], v[44:47], v[56:59]
  s_waitcnt lgkmcnt(3)
  v_exp_f32 v94, v94
  v_mfma_f32_16x16x32_bf16 v[60:63], a[208:211], v[32:35], v[48:51]
  s_waitcnt lgkmcnt(2)
  v_add_f32 v212, v212, v94
  v_mfma_f32_16x16x32_bf16 v[60:63], a[212:215], v[36:39], v[60:63]
  s_waitcnt lgkmcnt(1)
  s_add_u32 s42, s40, 32768
  v_exp_f32 v95, v95
  v_mfma_f32_16x16x32_bf16 v[60:63], a[216:219], v[40:43], v[60:63]
  s_waitcnt lgkmcnt(0)
  s_xor_b32 s40, s40, s59
  v_add_f32 v212, v212, v95
  v_cvt_pk_bf16_f32 v127, v94, v95
  v_mfma_f32_16x16x32_bf16 v[60:63], a[220:223], v[44:47], v[60:63]
  s_waitcnt vmcnt(6)
  v_exp_f32 v56, v56
  v_mfma_f32_16x16x32_bf16 a[160:163], a[224:227], v[124:127], a[160:163]
  ds_read_b64_tr_b16 a[224:225], v17 offset:0
  buffer_load_dwordx4 v31, s[16:19], s45 offen offset:2048 nt lds
  v_add_f32 v52, v52, v56
  v_mfma_f32_16x16x32_bf16 a[164:167], a[228:231], v[124:127], a[164:167]
  s_xor_b32 s59, s59, 24576
  ds_read_b64_tr_b16 a[226:227], v17 offset:2048
  v_exp_f32 v57, v57
  v_mfma_f32_16x16x32_bf16 a[168:171], a[232:235], v[124:127], a[168:171]
  ds_read_b64_tr_b16 a[228:229], v18 offset:0
  v_add_f32 v52, v52, v57
  v_cvt_pk_bf16_f32 v120, v56, v57
  v_mfma_f32_16x16x32_bf16 a[172:175], a[236:239], v[124:127], a[172:175]
  ds_read_b64_tr_b16 a[230:231], v18 offset:2048
  v_exp_f32 v58, v58
  v_mfma_f32_16x16x32_bf16 a[176:179], a[240:243], v[124:127], a[176:179]
  ds_read_b64_tr_b16 a[232:233], v19 offset:0
  v_add_f32 v52, v52, v58
  v_mfma_f32_16x16x32_bf16 a[180:183], a[244:247], v[124:127], a[180:183]
  s_waitcnt vmcnt(6)
  ds_read_b64_tr_b16 a[234:235], v19 offset:2048
  v_exp_f32 v59, v59
  v_mfma_f32_16x16x32_bf16 a[184:187], a[248:251], v[124:127], a[184:187]
  s_add_u32 s50, s50, 1
  ds_read_b64_tr_b16 a[236:237], v20 offset:0
  buffer_load_dwordx4 v31, s[16:19], s45 offen offset:3072 nt lds
  v_add_f32 v52, v52, v59
  v_cvt_pk_bf16_f32 v121, v58, v59
  v_mfma_f32_16x16x32_bf16 a[188:191], a[252:255], v[124:127], a[188:191]
  s_cmp_lt_u32 s50, 2
  ds_read_b64_tr_b16 a[238:239], v20 offset:2048
  v_exp_f32 v60, v60
  s_cbranch_scc1 L1b_aloop0
L1b_aloop1:
  v_mfma_f32_16x16x32_bf16 v[88:91], a[192:195], v[64:67], v[80:83]
  ds_read_b64_tr_b16 a[240:241], v21 offset:0
  v_add_f32 v52, v52, v60
  v_mfma_f32_16x16x32_bf16 v[88:91], a[196:199], v[68:71], v[88:91]
  ds_read_b64_tr_b16 a[242:243], v21 offset:2048
  v_exp_f32 v61, v61
  v_mfma_f32_16x16x32_bf16 v[88:91], a[200:203], v[72:75], v[88:91]
  s_add_u32 m0, s42, 0
  ds_read_b64_tr_b16 a[244:245], v22 offset:0
  v_add_f32 v52, v52, v61
  v_cvt_pk_bf16_f32 v122, v60, v61
  v_mfma_f32_16x16x32_bf16 v[88:91], a[204:207], v[76:79], v[88:91]
  s_waitcnt vmcnt(7)
  ds_read_b64_tr_b16 a[246:247], v22 offset:2048
  v_exp_f32 v62, v62
  v_mfma_f32_16x16x32_bf16 v[92:95], a[208:211], v[64:67], v[80:83]
  ds_read_b64_tr_b16 a[248:249], v23 offset:0
  buffer_load_dwordx4 v6, s[20:23], s45 offen offset:0 nt lds
  v_add_f32 v52, v52, v62
  v_mfma_f32_16x16x32_bf16 v[92:95], a[212:215], v[68:71], v[92:95]
  ds_read_b64_tr_b16 a[250:251], v23 offset:2048
  v_exp_f32 v63, v63
  v_mfma_f32_16x16x32_bf16 v[92:95], a[216:219], v[72:75], v[92:95]
  ds_read_b64_tr_b16 a[252:253], v28 offset:0
  v_add_f32 v52, v52, v63
  v_cvt_pk_bf16_f32 v123, v62, v63
  v_mfma_f32_16x16x32_bf16 v[92:95], a[220:223], v[76:79], v[92:95]
  s_waitcnt lgkmcnt(8)
  ds_read_b64_tr_b16 a[254:255], v28 offset:2048
  v_exp_f32 v88, v88
  v_mfma_f32_16x16x32_bf16 a[0:3], a[224:227], v[120:123], a[0:3]
  v_add_f32 v84, v84, v88
  v_mfma_f32_16x16x32_bf16 a[4:7], a[228:231], v[120:123], a[4:7]
  s_waitcnt vmcnt(7)
  v_exp_f32 v89, v89
  v_mfma_f32_16x16x32_bf16 a[8:11], a[232:235], v[120:123], a[8:11]
  s_waitcnt lgkmcnt(8)
  buffer_load_dwordx4 v6, s[20:23], s45 offen offset:1024 nt lds
  v_add_f32 v84, v84, v89
  v_cvt_pk_bf16_f32 v124, v88, v89
  v_mfma_f32_16x16x32_bf16 a[12:15], a[236:239], v[120:123], a[12:15]
  s_waitcnt lgkmcnt(6)
  v_exp_f32 v90, v90
  v_mfma_f32_16x16x32_bf16 a[16:19], a[240:243], v[120:123], a[16:19]
  s_waitcnt lgkmcnt(4)
  v_add_f32 v84, v84, v90
  v_mfma_f32_16x16x32_bf16 a[20:23], a[244:247], v[120:123], a[20:23]
  s_waitcnt lgkmcnt(2)
  v_exp_f32 v91, v91
  v_mfma_f32_16x16x32_bf16 a[24:27], a[248:251], v[120:123], a[24:27]
  s_waitcnt lgkmcnt(0)
  v_add_f32 v84, v84, v91
  v_cvt_pk_bf16_f32 v125, v90, v91
  v_mfma_f32_16x16x32_bf16 a[28:31], a[252:255], v[120:123], a[28:31]
  s_waitcnt vmcnt(16)
  s_barrier
  s_waitcnt vmcnt(7)
  v_exp_f32 v92, v92
  v_mfma_f32_16x16x32_bf16 v[56:59], a[192:195], v[96:99], v[112:115]
  buffer_load_dwordx4 v6, s[20:23], s45 offen offset:2048 nt lds
  v_add_f32 v84, v84, v92
  v_xor_b32 v13, s59, v13
  v_mfma_f32_16x16x32_bf16 v[56:59], a[196:199], v[100:103], v[56:59]
  v_exp_f32 v93, v93
  v_mfma_f32_16x16x32_bf16 v[56:59], a[200:203], v[104:107], v[56:59]
  v_add_f32 v84, v84, v93
  v_cvt_pk_bf16_f32 v126, v92, v93
  v_mfma_f32_16x16x32_bf16 v[56:59], a[204:207], v[108:111], v[56:59]
  v_exp_f32 v94, v94
  v_mfma_f32_16x16x32_bf16 v[60:63], a[208:211], v[96:99], v[112:115]
  v_add_f32 v84, v84, v94
  v_xor_b32 v14, s59, v14
  v_mfma_f32_16x16x32_bf16 v[60:63], a[212:215], v[100:103], v[60:63]
  s_waitcnt vmcnt(7)
  v_exp_f32 v95, v95
  v_mfma_f32_16x16x32_bf16 v[60:63], a[216:219], v[104:107], v[60:63]
  buffer_load_dwordx4 v6, s[20:23], s45 offen offset:3072 nt lds
  v_add_f32 v84, v84, v95
  v_cvt_pk_bf16_f32 v127, v94, v95
  v_mfma_f32_16x16x32_bf16 v[60:63], a[220:223], v[108:111], v[60:63]
  v_exp_f32 v56, v56
  v_mfma_f32_16x16x32_bf16 a[32:35], a[224:227], v[124:127], a[32:35]
  v_add_f32 v116, v116, v56
  v_xor_b32 v15, s59, v15
  v_mfma_f32_16x16x32_bf16 a[36:39], a[228:231], v[124:127], a[36:39]
  v_exp_f32 v57, v57
  v_mfma_f32_16x16x32_bf16 a[40:43], a[232:235], v[124:127], a[40:43]
  s_add_u32 m0, s42, 4096
  v_add_f32 v116, v116, v57
  v_cvt_pk_bf16_f32 v120, v56, v57
  v_mfma_f32_16x16x32_bf16 a[44:47], a[236:239], v[124:127], a[44:47]
  s_waitcnt vmcnt(7)
  v_exp_f32 v58, v58
  v_mfma_f32_16x16x32_bf16 a[48:51], a[240:243], v[124:127], a[48:51]
  buffer_load_dwordx4 v31, s[20:23], s45 offen offset:0 nt lds
  v_add_f32 v116, v116, v58
  v_xor_b32 v16, s59, v16
  v_mfma_f32_16x16x32_bf16 a[52:55], a[244:247], v[124:127], a[52:55]
  v_exp_f32 v59, v59
  v_mfma_f32_16x16x32_bf16 a[56:59], a[248:251], v[124:127], a[56:59]
  v_add_f32 v116, v116, v59
  v_cvt_pk_bf16_f32 v121, v58, v59
  v_mfma_f32_16x16x32_bf16 a[60:63], a[252:255], v[124:127], a[60:63]
  v_exp_f32 v60, v60
  v_mfma_f32_16x16x32_bf16 v[88:91], a[192:195], v[128:131], v[144:147]
  v_add_f32 v116, v116, v60
  v_xor_b32 v17, s59, v17
  v_mfma_f32_16x16x32_bf16 v[88:91], a[196:199], v[132:135], v[88:91]
  s_waitcnt vmcnt(7)
  v_exp_f32 v61, v61
  v_mfma_f32_16x16x32_bf16 v[88:91], a[200:203], v[136:139], v[88:91]
  buffer_load_dwordx4 v31, s[20:23], s45 offen offset:1024 nt lds
  v_add_f32 v116, v116, v61
  v_cvt_pk_bf16_f32 v122, v60, v61
  v_mfma_f32_16x16x32_bf16 v[88:91], a[204:207], v[140:143], v[88:91]
  v_exp_f32 v62, v62
  v_mfma_f32_16x16x32_bf16 v[92:95], a[208:211], v[128:131], v[144:147]
  v_add_f32 v116, v116, v62
  v_xor_b32 v18, s59, v18
  v_mfma_f32_16x16x32_bf16 v[92:95], a[212:215], v[132:135], v[92:95]
  v_exp_f32 v63, v63
  v_mfma_f32_16x16x32_bf16 v[92:95], a[216:219], v[136:139], v[92:95]
  v_add_f32 v116, v116, v63
  v_cvt_pk_bf16_f32 v123, v62, v63
  v_mfma_f32_16x16x32_bf16 v[92:95], a[220:223], v[140:143], v[92:95]
  s_waitcnt vmcnt(7)
  v_exp_f32 v88, v88
  v_mfma_f32_16x16x32_bf16 a[64:67], a[224:227], v[120:123], a[64:67]
  buffer_load_dwordx4 v31, s[20:23], s45 offen offset:2048 nt lds
  v_add_f32 v148, v148, v88
  v_xor_b32 v19, s59, v19
  v_mfma_f32_16x16x32_bf16 a[68:71], a[228:231], v[120:123], a[68:71]
  v_exp_f32 v89, v89
  v_mfma_f32_16x16x32_bf16 a[72:75], a[232:235], v[120:123], a[72:75]
  v_add_f32 v148, v148, v89
  v_cvt_pk_bf16_f32 v124, v88, v89
  v_mfma_f32_16x16x32_bf16 a[76:79], a[236:239], v[120:123], a[76:79]
  v_exp_f32 v90, v90
  v_mfma_f32_16x16x32_bf16 a[80:83], a[240:243], v[120:123], a[80:83]
  v_add_f32 v148, v148, v90
  v_xor_b32 v20, s59, v20
  v_mfma_f32_16x16x32_bf16 a[84:87], a[244:247], v[120:123], a[84:87]
  s_waitcnt vmcnt(7)
  v_exp_f32 v91, v91
  v_mfma_f32_16x16x32_bf16 a[88:91], a[248:251], v[120:123], a[88:91]
  buffer_load_dwordx4 v31, s[20:23], s45 offen offset:3072 nt lds
  v_add_f32 v148, v148, v91
  v_cvt_pk_bf16_f32 v125, v90, v91
  v_mfma_f32_16x16x32_bf16 a[92:95], a[252:255], v[120:123], a[92:95]
  s_add_u32 s55, s55, 8192
  v_exp_f32 v92, v92
  v_mfma_f32_16x16x32_bf16 v[56:59], a[192:195], v[160:163], v[176:179]
  s_xor_b32 s45, s55, s39
  v_add_f32 v148, v148, v92
  v_xor_b32 v21, s59, v21
  v_mfma_f32_16x16x32_bf16 v[56:59], a[196:199], v[164:167], v[56:59]
  v_exp_f32 v93, v93
  v_mfma_f32_16x16x32_bf16 v[56:59], a[200:203], v[168:171], v[56:59]
  s_add_u32 m0, s40, 0
  v_add_f32 v148, v148, v93
  v_cvt_pk_bf16_f32 v126, v92, v93
  v_mfma_f32_16x16x32_bf16 v[56:59], a[204:207], v[172:175], v[56:59]
  s_waitcnt vmcnt(7)
  v_exp_f32 v94, v94
  v_mfma_f32_16x16x32_bf16 v[60:63], a[208:211], v[160:163], v[176:179]
  buffer_load_dwordx4 v6, s[16:19], s45 offen offset:0 nt lds
  v_add_f32 v148, v148, v94
  v_xor_b32 v22, s59, v22
  v_mfma_f32_16x16x32_bf16 v[60:63], a[212:215], v[164:167], v[60:63]
  v_exp_f32 v95, v95
  v_mfma_f32_16x16x32_bf16 v[60:63], a[216:219], v[168:171], v[60:63]
  v_add_f32 v148, v148, v95
  v_cvt_pk_bf16_f32 v127, v94, v95
  v_mfma_f32_16x16x32_bf16 v[60:63], a[220:223], v[172:175], v[60:63]
  v_exp_f32 v56, v56
  v_mfma_f32_16x16x32_bf16 a[96:99], a[224:227], v[124:127], a[96:99]
  v_add_f32 v180, v180, v56
  v_xor_b32 v23, s59, v23
  v_mfma_f32_16x16x32_bf16 a[100:103], a[228:231], v[124:127], a[100:103]
  s_waitcnt vmcnt(7)
  v_exp_f32 v57, v57
  v_mfma_f32_16x16x32_bf16 a[104:107], a[232:235], v[124:127], a[104:107]
  buffer_load_dwordx4 v6, s[16:19], s45 offen offset:1024 nt lds
  v_add_f32 v180, v180, v57
  v_cvt_pk_bf16_f32 v120, v56, v57
  v_mfma_f32_16x16x32_bf16 a[108:111], a[236:239], v[124:127], a[108:111]
  v_exp_f32 v58, v58
  v_mfma_f32_16x16x32_bf16 a[112:115], a[240:243], v[124:127], a[112:115]
  v_add_f32 v180, v180, v58
  v_xor_b32 v28, s59, v28
  v_mfma_f32_16x16x32_bf16 a[116:119], a[244:247], v[124:127], a[116:119]
  v_exp_f32 v59, v59
  v_mfma_f32_16x16x32_bf16 a[120:123], a[248:251], v[124:127], a[120:123]
  v_add_f32 v180, v180, v59
  v_cvt_pk_bf16_f32 v121, v58, v59
  v_mfma_f32_16x16x32_bf16 a[124:127], a[252:255], v[124:127], a[124:127]
  s_waitcnt vmcnt(7)
  v_exp_f32 v60, v60
  v_mfma_f32_16x16x32_bf16 v[88:91], a[192:195], v[192:195], v[208:211]
  ds_read_b128 a[192:195], v13 offset:0
  buffer_load_dwordx4 v6, s[16:19], s45 offen offset:2048 nt lds
  v_add_f32 v180, v180, v60
  v_mfma_f32_16x16x32_bf16 v[88:91], a[196:199], v[196:199], v[88:91]
  v_exp_f32 v61, v61
  v_mfma_f32_16x16x32_bf16 v[88:91], a[200:203], v[200:203], v[88:91]
  ds_read_b128 a[196:199], v14 offset:0
  v_add_f32 v180, v180, v61
  v_cvt_pk_bf16_f32 v122, v60, v61
  v_mfma_f32_16x16x32_bf16 v[88:91], a[204:207], v[204:207], v[88:91]
  v_exp_f32 v62, v62
  v_mfma_f32_16x16x32_bf16 v[92:95], a[208:211], v[192:195], v[208:211]
  ds_read_b128 a[200:203], v15 offset:0
  v_add_f32 v180, v180, v62
  v_mfma_f32_16x16x32_bf16 v[92:95], a[212:215], v[196:199], v[92:95]
  s_waitcnt vmcnt(7)
  v_exp_f32 v63, v63
  v_mfma_f32_16x16x32_bf16 v[92:95], a[216:219], v[200:203], v[92:95]
  ds_read_b128 a[204:207], v16 offset:0
  buffer_load_dwordx4 v6, s[16:19], s45 offen offset:3072 nt lds
  v_add_f32 v180, v180, v63
  v_cvt_pk_bf16_f32 v123, v62, v63
  v_mfma_f32_16x16x32_bf16 v[92:95], a[220:223], v[204:207], v[92:95]
  v_exp_f32 v88, v88
  v_mfma_f32_16x16x32_bf16 a[128:131], a[224:227], v[120:123], a[128:131]
  ds_read_b128 a[208:211], v13 offset:2048
  v_add_f32 v212, v212, v88
  v_mfma_f32_16x16x32_bf16 a[132:135], a[228:231], v[120:123], a[132:135]
  v_exp_f32 v89, v89
  v_mfma_f32_16x16x32_bf16 a[136:139], a[232:235], v[120:123], a[136:139]
  s_add_u32 m0, s40, 4096
  ds_read_b128 a[212:215], v14 offset:2048
  v_add_f32 v212, v212, v89
  v_cvt_pk_bf16_f32 v124, v88, v89
  v_mfma_f32_16x16x32_bf16 a[140:143], a[236:239], v[120:123], a[140:143]
  s_waitcnt vmcnt(7)
  v_exp_f32 v90, v90
  v_mfma_f32_16x16x32_bf16 a[144:147], a[240:243], v[120:123], a[144:147]
  ds_read_b128 a[216:219], v15 offset:2048
  buffer_load_dwordx4 v31, s[16:19], s45 offen offset:0 nt lds
  v_add_f32 v212, v212, v90
  v_mfma_f32_16x16x32_bf16 a[148:151], a[244:247], v[120:123], a[148:151]
  v_exp_f32 v91, v91
  v_mfma_f32_16x16x32_bf16 a[152:155], a[248:251], v[120:123], a[152:155]
  ds_read_b128 a[220:223], v16 offset:2048
  v_add_f32 v212, v212, v91
  v_cvt_pk_bf16_f32 v125, v90, v91
  v_mfma_f32_16x16x32_bf16 a[156:159], a[252:255], v[120:123], a[156:159]
  s_waitcnt lgkmcnt(7)
  v_exp_f32 v92, v92
  v_mfma_f32_16x16x32_bf16 v[56:59], a[192:195], v[32:35], v[48:51]
  s_waitcnt lgkmcnt(6)
  v_add_f32 v212, v212, v92
  v_mfma_f32_16x16x32_bf16 v[56:59], a[196:199], v[36:39], v[56:59]
  s_waitcnt lgkmcnt(5)
  s_waitcnt vmcnt(7)
  v_exp_f32 v93, v93
  v_mfma_f32_16x16x32_bf16 v[56:59], a[200:203], v[40:43], v[56:59]
  s_waitcnt lgkmcnt(4)
  buffer_load_dwordx4 v31, s[16:19], s45 offen offset:1024 nt lds
  v_add_f32 v212, v212, v93
  v_cvt_pk_bf16_f32 v126, v92, v93
  v_mfma_f32_16x16x32_bf16 v[56:59], a[204:207], v[44:47], v[56:59]
  s_waitcnt lgkmcnt(3)
  v_exp_f32 v94, v94
  v_mfma_f32_16x16x32_bf16 v[60:63], a[208:211], v[32:35], v[48:51]
  s_waitcnt lgkmcnt(2)
  v_add_f32 v212, v212, v94
  v_mfma_f32_16x16x32_bf16 v[60:63], a[212:215], v[36:39], v[60:63]
  s_waitcnt lgkmcnt(1)
  s_add_u32 s42, s40, 32768
  v_exp_f32 v95, v95
  v_mfma_f32_16x16x32_bf16 v[60:63], a[216:219], v[40:43], v[60:63]
  s_waitcnt lgkmcnt(0)
  s_xor_b32 s40, s40, s59
  v_add_f32 v212, v212, v95
  v_cvt_pk_bf16_f32 v127, v94, v95
  v_mfma_f32_16x16x32_bf16 v[60:63], a[220:223], v[44:47], v[60:63]
  s_waitcnt vmcnt(7)
  v_exp_f32 v56, v56
  v_mfma_f32_16x16x32_bf16 a[160:163], a[224:227], v[124:127], a[160:163]
  ds_read_b64_tr_b16 a[224:225], v17 offset:0
  buffer_load_dwordx4 v31, s[16:19], s45 offen offset:2048 nt lds
  v_add_f32 v52, v52, v56
  v_mfma_f32_16x16x32_bf16 a[164:167], a[228:231], v[124:127], a[164:167]
  s_xor_b32 s59, s59, 24576
  ds_read_b64_tr_b16 a[226:227], v17 offset:2048
  v_exp_f32 v57, v57
  v_mfma_f32_16x16x32_bf16 a[168:171], a[232:235], v[124:127], a[168:171]
  ds_read_b64_tr_b16 a[228:229], v18 offset:0
  v_add_f32 v52, v52, v57
  v_cvt_pk_bf16_f32 v120, v56, v57
  v_mfma_f32_16x16x32_bf16 a[172:175], a[236:239], v[124:127], a[172:175]
  ds_read_b64_tr_b16 a[230:231], v18 offset:2048
  v_exp_f32 v58, v58
  v_mfma_f32_16x16x32_bf16 a[176:179], a[240:243], v[124:127], a[176:179]
  ds_read_b64_tr_b16 a[232:233], v19 offset:0
  v_add_f32 v52, v52, v58
  v_mfma_f32_16x16x32_bf16 a[180:183], a[244:247], v[124:127], a[180:183]
  s_waitcnt vmcnt(7)
  ds_read_b64_tr_b16 a[234:235], v19 offset:2048
  v_exp_f32 v59, v59
  v_mfma_f32_16x16x32_bf16 a[184:187], a[248:251], v[124:127], a[184:187]
  s_add_u32 s50, s50, 1
  ds_read_b64_tr_b16 a[236:237], v20 offset:0
  buffer_load_dwordx4 v31, s[16:19], s45 offen offset:3072 nt lds
  v_add_f32 v52, v52, v59
  v_cvt_pk_bf16_f32 v121, v58, v59
  v_mfma_f32_16x16x32_bf16 a[188:191], a[252:255], v[124:127], a[188:191]
  s_cmp_lt_u32 s50, 28
  ds_read_b64_tr_b16 a[238:239], v20 offset:2048
  v_exp_f32 v60, v60
  s_cbranch_scc1 L1b_aloop1
  v_lshlrev_b32 v5, 2, v1
  global_load_dword v29, v5, s[96:97] sc1
  v_mfma_f32_16x16x32_bf16 v[88:91], a[192:195], v[64:67], v[80:83]
  ds_read_b64_tr_b16 a[240:241], v21 offset:0
  v_add_f32 v52, v52, v60
  v_mfma_f32_16x16x32_bf16 v[88:91], a[196:199], v[68:71], v[88:91]
  ds_read_b64_tr_b16 a[242:243], v21 offset:2048
  v_exp_f32 v61, v61
  v_mfma_f32_16x16x32_bf16 v[88:91], a[200:203], v[72:75], v[88:91]
  ds_read_b64_tr_b16 a[244:245], v22 offset:0
  v_add_f32 v52, v52, v61
  v_cvt_pk_bf16_f32 v122, v60, v61
  v_mfma_f32_16x16x32_bf16 v[88:91], a[204:207], v[76:79], v[88:91]
  ds_read_b64_tr_b16 a[246:247], v22 offset:2048
  v_exp_f32 v62, v62
  v_mfma_f32_16x16x32_bf16 v[92:95], a[208:211], v[64:67], v[80:83]
  ds_read_b64_tr_b16 a[248:249], v23 offset:0
  v_add_f32 v52, v52, v62
  v_mfma_f32_16x16x32_bf16 v[92:95], a[212:215], v[68:71], v[92:95]
  ds_read_b64_tr_b16 a[250:251], v23 offset:2048
  v_exp_f32 v63, v63
  v_mfma_f32_16x16x32_bf16 v[92:95], a[216:219], v[72:75], v[92:95]
  ds_read_b64_tr_b16 a[252:253], v28 offset:0
  v_add_f32 v52, v52, v63
  v_cvt_pk_bf16_f32 v123, v62, v63
  v_mfma_f32_16x16x32_bf16 v[92:95], a[220:223], v[76:79], v[92:95]
  s_waitcnt lgkmcnt(8)
  ds_read_b64_tr_b16 a[254:255], v28 offset:2048
  v_exp_f32 v88, v88
  v_mfma_f32_16x16x32_bf16 a[0:3], a[224:227], v[120:123], a[0:3]
  v_add_f32 v84, v84, v88
  v_mfma_f32_16x16x32_bf16 a[4:7], a[228:231], v[120:123], a[4:7]
  v_exp_f32 v89, v89
  v_mfma_f32_16x16x32_bf16 a[8:11], a[232:235], v[120:123], a[8:11]
  s_waitcnt lgkmcnt(8)
  v_add_f32 v84, v84, v89
  v_cvt_pk_bf16_f32 v124, v88, v89
  v_mfma_f32_16x16x32_bf16 a[12:15], a[236:239], v[120:123], a[12:15]
  s_waitcnt lgkmcnt(6)
  v_exp_f32 v90, v90
  v_mfma_f32_16x16x32_bf16 a[16:19], a[240:243], v[120:123], a[16:19]
  s_waitcnt lgkmcnt(4)
  v_add_f32 v84, v84, v90
  v_mfma_f32_16x16x32_bf16 a[20:23], a[244:247], v[120:123], a[20:23]
  s_waitcnt lgkmcnt(2)
  v_exp_f32 v91, v91
  v_mfma_f32_16x16x32_bf16 a[24:27], a[248:251], v[120:123], a[24:27]
  s_waitcnt lgkmcnt(0)
  v_add_f32 v84, v84, v91
  v_cvt_pk_bf16_f32 v125, v90, v91
  v_mfma_f32_16x16x32_bf16 a[28:31], a[252:255], v[120:123], a[28:31]
  s_waitcnt vmcnt(0)
  s_barrier
  s_mov_b32 s49, 524288
L1b_val0_c:
  v_cmp_gt_u32 vcc, 4, v29
  s_sub_u32 s49, s49, 1
  s_cbranch_scc1 L1b_val0_go
  s_nop 3
  s_cbranch_vccz L1b_val0_go
  s_sleep 8
  global_load_dword v29, v5, s[96:97] sc1
  s_waitcnt vmcnt(0)
  s_branch L1b_val0_c
L1b_val0_go:
  v_exp_f32 v92, v92
  v_mfma_f32_16x16x32_bf16 v[56:59], a[192:195], v[96:99], v[112:115]
  v_add_f32 v84, v84, v92
  v_xor_b32 v13, s59, v13
  v_mfma_f32_16x16x32_bf16 v[56:59], a[196:199], v[100:103], v[56:59]
  v_exp_f32 v93, v93
  v_mfma_f32_16x16x32_bf16 v[56:59], a[200:203], v[104:107], v[56:59]
  s_add_u32 m0, s28, 16384
  s_add_u32 s38, s30, 0
  buffer_load_dwordx4 v7, s[12:15], s38 offen offset:0 sc1 lds
  v_add_f32 v84, v84, v93
  v_cvt_pk_bf16_f32 v126, v92, v93
  v_mfma_f32_16x16x32_bf16 v[56:59], a[204:207], v[108:111], v[56:59]
  v_exp_f32 v94, v94
  v_mfma_f32_16x16x32_bf16 v[60:63], a[208:211], v[96:99], v[112:115]
  v_add_f32 v84, v84, v94
  v_xor_b32 v14, s59, v14
  v_mfma_f32_16x16x32_bf16 v[60:63], a[212:215], v[100:103], v[60:63]
  s_add_u32 m0, s28, 16384
  s_add_u32 s38, s30, 0
  buffer_load_dwordx4 v8, s[12:15], s38 offen offset:1024 sc1 lds
  v_exp_f32 v95, v95
  v_mfma_f32_16x16x32_bf16 v[60:63], a[216:219], v[104:107], v[60:63]
  v_add_f32 v84, v84, v95
  v_cvt_pk_bf16_f32 v127, v94, v95
  v_mfma_f32_16x16x32_bf16 v[60:63], a[220:223], v[108:111], v[60:63]
  v_exp_f32 v56, v56
  v_mfma_f32_16x16x32_bf16 a[32:35], a[224:227], v[124:127], a[32:35]
  s_add_u32 m0, s28, 16384
  s_add_u32 s38, s30, 0
  buffer_load_dwordx4 v9, s[12:15], s38 offen offset:2048 sc1 lds
  v_add_f32 v116, v116, v56
  v_xor_b32 v15, s59, v15
  v_mfma_f32_16x16x32_bf16 a[36:39], a[228:231], v[124:127], a[36:39]
  v_exp_f32 v57, v57
  v_mfma_f32_16x16x32_bf16 a[40:43], a[232:235], v[124:127], a[40:43]
  v_add_f32 v116, v116, v57
  v_cvt_pk_bf16_f32 v120, v56, v57
  v_mfma_f32_16x16x32_bf16 a[44:47], a[236:239], v[124:127], a[44:47]
  s_add_u32 m0, s28, 16384
  s_add_u32 s38, s30, 0
  buffer_load_dwordx4 v10, s[12:15], s38 offen offset:3072 sc1 lds
  v_exp_f32 v58, v58
  v_mfma_f32_16x16x32_bf16 a[48:51], a[240:243], v[124:127], a[48:51]
  v_add_f32 v116, v116, v58
  v_xor_b32 v16, s59, v16
  v_mfma_f32_16x16x32_bf16 a[52:55], a[244:247], v[124:127], a[52:55]
  v_exp_f32 v59, v59
  v_mfma_f32_16x16x32_bf16 a[56:59], a[248:251], v[124:127], a[56:59]
  s_add_u32 m0, s28, 20480
  s_add_u32 s38, s30, 32768
  buffer_load_dwordx4 v7, s[12:15], s38 offen offset:0 sc1 lds
  v_add_f32 v116, v116, v59
  v_cvt_pk_bf16_f32 v121, v58, v59
  v_mfma_f32_16x16x32_bf16 a[60:63], a[252:255], v[124:127], a[60:63]
  v_exp_f32 v60, v60
  v_mfma_f32_16x16x32_bf16 v[88:91], a[192:195], v[128:131], v[144:147]
  v_add_f32 v116, v116, v60
  v_xor_b32 v17, s59, v17
  v_mfma_f32_16x16x32_bf16 v[88:91], a[196:199], v[132:135], v[88:91]
  s_add_u32 m0, s28, 20480
  s_add_u32 s38, s30, 32768
  buffer_load_dwordx4 v8, s[12:15], s38 offen offset:1024 sc1 lds
  v_exp_f32 v61, v61
  v_mfma_f32_16x16x32_bf16 v[88:91], a[200:203], v[136:139], v[88:91]
  v_add_f32 v116, v116, v61
  v_cvt_pk_bf16_f32 v122, v60, v61
  v_mfma_f32_16x16x32_bf16 v[88:91], a[204:207], v[140:143], v[88:91]
  v_exp_f32 v62, v62
  v_mfma_f32_16x16x32_bf16 v[92:95], a[208:211], v[128:131], v[144:147]
  v_add_f32 v116, v116, v62
  v_xor_b32 v18, s59, v18
  v_mfma_f32_16x16x32_bf16 v[92:95], a[212:215], v[132:135], v[92:95]
  s_add_u32 m0, s28, 20480
  s_add_u32 s38, s30, 32768
  buffer_load_dwordx4 v9, s[12:15], s38 offen offset:2048 sc1 lds
  v_exp_f32 v63, v63
  v_mfma_f32_16x16x32_bf16 v[92:95], a[216:219], v[136:139], v[92:95]
  v_add_f32 v116, v116, v63
  v_cvt_pk_bf16_f32 v123, v62, v63
  v_mfma_f32_16x16x32_bf16 v[92:95], a[220:223], v[140:143], v[92:95]
  v_exp_f32 v88, v88
  v_mfma_f32_16x16x32_bf16 a[64:67], a[224:227], v[120:123], a[64:67]
  s_add_u32 m0, s28, 20480
  s_add_u32 s38, s30, 32768
  buffer_load_dwordx4 v10, s[12:15], s38 offen offset:3072 sc1 lds
  v_add_f32 v148, v148, v88
  v_xor_b32 v19, s59, v19
  v_mfma_f32_16x16x32_bf16 a[68:71], a[228:231], v[120:123], a[68:71]
  v_exp_f32 v89, v89
  v_mfma_f32_16x16x32_bf16 a[72:75], a[232:235], v[120:123], a[72:75]
  v_add_f32 v148, v148, v89
  v_cvt_pk_bf16_f32 v124, v88, v89
  v_mfma_f32_16x16x32_bf16 a[76:79], a[236:239], v[120:123], a[76:79]
  s_add_u32 m0, s28, 4294950912
  s_add_u32 s38, s30, 4292870144
  buffer_load_dwordx4 v7, s[12:15], s38 offen offset:0 sc1 lds
  v_exp_f32 v90, v90
  v_mfma_f32_16x16x32_bf16 a[80:83], a[240:243], v[120:123], a[80:83]
  v_add_f32 v148, v148, v90
  v_xor_b32 v20, s59, v20
  v_mfma_f32_16x16x32_bf16 a[84:87], a[244:247], v[120:123], a[84:87]
  v_exp_f32 v91, v91
  v_mfma_f32_16x16x32_bf16 a[88:91], a[248:251], v[120:123], a[88:91]
  s_add_u32 m0, s28, 4294950912
  s_add_u32 s38, s30, 4292870144
  buffer_load_dwordx4 v8, s[12:15], s38 offen offset:1024 sc1 lds
  v_add_f32 v148, v148, v91
  v_cvt_pk_bf16_f32 v125, v90, v91
  v_mfma_f32_16x16x32_bf16 a[92:95], a[252:255], v[120:123], a[92:95]
  v_exp_f32 v92, v92
  v_mfma_f32_16x16x32_bf16 v[56:59], a[192:195], v[160:163], v[176:179]
  v_add_f32 v148, v148, v92
  v_xor_b32 v21, s59, v21
  v_mfma_f32_16x16x32_bf16 v[56:59], a[196:199], v[164:167], v[56:59]
  s_add_u32 m0, s28, 4294950912
  s_add_u32 s38, s30, 4292870144
  buffer_load_dwordx4 v9, s[12:15], s38 offen offset:2048 sc1 lds
  v_exp_f32 v93, v93
  v_mfma_f32_16x16x32_bf16 v[56:59], a[200:203], v[168:171], v[56:59]
  v_add_f32 v148, v148, v93
  v_cvt_pk_bf16_f32 v126, v92, v93
  v_mfma_f32_16x16x32_bf16 v[56:59], a[204:207], v[172:175], v[56:59]
  v_exp_f32 v94, v94
  v_mfma_f32_16x16x32_bf16 v[60:63], a[208:211], v[160:163], v[176:179]
  s_add_u32 m0, s28, 4294950912
  s_add_u32 s38, s30, 4292870144
  buffer_load_dwordx4 v10, s[12:15], s38 offen offset:3072 sc1 lds
  v_add_f32 v148, v148, v94
  v_xor_b32 v22, s59, v22
  v_mfma_f32_16x16x32_bf16 v[60:63], a[212:215], v[164:167], v[60:63]
  v_exp_f32 v95, v95
  v_mfma_f32_16x16x32_bf16 v[60:63], a[216:219], v[168:171], v[60:63]
  v_add_f32 v148, v148, v95
  v_cvt_pk_bf16_f32 v127, v94, v95
  v_mfma_f32_16x16x32_bf16 v[60:63], a[220:223], v[172:175], v[60:63]
  v_exp_f32 v56, v56
  v_mfma_f32_16x16x32_bf16 a[96:99], a[224:227], v[124:127], a[96:99]
  s_add_u32 m0, s28, 4294955008
  s_add_u32 s38, s30, 4292902912
  buffer_load_dwordx4 v7, s[12:15], s38 offen offset:0 sc1 lds
  v_add_f32 v180, v180, v56
  v_xor_b32 v23, s59, v23
  v_mfma_f32_16x16x32_bf16 a[100:103], a[228:231], v[124:127], a[100:103]
  v_exp_f32 v57, v57
  v_mfma_f32_16x16x32_bf16 a[104:107], a[232:235], v[124:127], a[104:107]
  v_add_f32 v180, v180, v57
  v_cvt_pk_bf16_f32 v120, v56, v57
  v_mfma_f32_16x16x32_bf16 a[108:111], a[236:239], v[124:127], a[108:111]
  s_add_u32 m0, s28, 4294955008
  s_add_u32 s38, s30, 4292902912
  buffer_load_dwordx4 v8, s[12:15], s38 offen offset:1024 sc1 lds
  v_exp_f32 v58, v58
  v_mfma_f32_16x16x32_bf16 a[112:115], a[240:243], v[124:127], a[112:115]
  v_add_f32 v180, v180, v58
  v_xor_b32 v28, s59, v28
  v_mfma_f32_16x16x32_bf16 a[116:119], a[244:247], v[124:127], a[116:119]
  v_exp_f32 v59, v59
  v_mfma_f32_16x16x32_bf16 a[120:123], a[248:251], v[124:127], a[120:123]
  s_add_u32 m0, s28, 4294955008
  s_add_u32 s38, s30, 4292902912
  buffer_load_dwordx4 v9, s[12:15], s38 offen offset:2048 sc1 lds
  v_add_f32 v180, v180, v59
  v_cvt_pk_bf16_f32 v121, v58, v59
  v_mfma_f32_16x16x32_bf16 a[124:127], a[252:255], v[124:127], a[124:127]
  v_exp_f32 v60, v60
  v_mfma_f32_16x16x32_bf16 v[88:91], a[192:195], v[192:195], v[208:211]
  ds_read_b128 a[192:195], v13 offset:0
  v_add_f32 v180, v180, v60
  v_mfma_f32_16x16x32_bf16 v[88:91], a[196:199], v[196:199], v[88:91]
  s_add_u32 m0, s28, 4294955008
  s_add_u32 s38, s30, 4292902912
  buffer_load_dwordx4 v10, s[12:15], s38 offen offset:3072 sc1 lds
  v_exp_f32 v61, v61
  v_mfma_f32_16x16x32_bf16 v[88:91], a[200:203], v[200:203], v[88:91]
  ds_read_b128 a[196:199], v14 offset:0
  v_add_f32 v180, v180, v61
  v_cvt_pk_bf16_f32 v122, v60, v61
  v_mfma_f32_16x16x32_bf16 v[88:91], a[204:207], v[204:207], v[88:91]
  v_exp_f32 v62, v62
  v_mfma_f32_16x16x32_bf16 v[92:95], a[208:211], v[192:195], v[208:211]
  s_add_u32 m0, s28, 0
  s_add_u32 s38, s30, 65536
  ds_read_b128 a[200:203], v15 offset:0
  buffer_load_dwordx4 v7, s[12:15], s38 offen offset:0 sc1 lds
  v_add_f32 v180, v180, v62
  v_mfma_f32_16x16x32_bf16 v[92:95], a[212:215], v[196:199], v[92:95]
  v_exp_f32 v63, v63
  v_mfma_f32_16x16x32_bf16 v[92:95], a[216:219], v[200:203], v[92:95]
  ds_read_b128 a[204:207], v16 offset:0
  v_add_f32 v180, v180, v63
  v_cvt_pk_bf16_f32 v123, v62, v63
  v_mfma_f32_16x16x32_bf16 v[92:95], a[220:223], v[204:207], v[92:95]
  s_add_u32 m0, s28, 0
  s_add_u32 s38, s30, 65536
  buffer_load_dwordx4 v8, s[12:15], s38 offen offset:1024 sc1 lds
  v_exp_f32 v88, v88
  v_mfma_f32_16x16x32_bf16 a[128:131], a[224:227], v[120:123], a[128:131]
  ds_read_b128 a[208:211], v13 offset:2048
  v_add_f32 v212, v212, v88
  v_mfma_f32_16x16x32_bf16 a[132:135], a[228:231], v[120:123], a[132:135]
  v_exp_f32 v89, v89
  v_mfma_f32_16x16x32_bf16 a[136:139], a[232:235], v[120:123], a[136:139]
  ds_read_b128 a[212:215], v14 offset:2048
  v_add_f32 v212, v212, v89
  v_cvt_pk_bf16_f32 v124, v88, v89
  v_mfma_f32_16x16x32_bf16 a[140:143], a[236:239], v[120:123], a[140:143]
  s_add_u32 m0, s28, 0
  s_add_u32 s38, s30, 65536
  buffer_load_dwordx4 v9, s[12:15], s38 offen offset:2048 sc1 lds
  v_exp_f32 v90, v90
  v_mfma_f32_16x16x32_bf16 a[144:147], a[240:243], v[120:123], a[144:147]
  ds_read_b128 a[216:219], v15 offset:2048
  v_add_f32 v212, v212, v90
  v_mfma_f32_16x16x32_bf16 a[148:151], a[244:247], v[120:123], a[148:151]
  v_exp_f32 v91, v91
  v_mfma_f32_16x16x32_bf16 a[152:155], a[248:251], v[120:123], a[152:155]
  s_add_u32 m0, s28, 0
  s_add_u32 s38, s30, 65536
  ds_read_b128 a[220:223], v16 offset:2048
  buffer_load_dwordx4 v10, s[12:15], s38 offen offset:3072 sc1 lds
  v_add_f32 v212, v212, v91
  v_cvt_pk_bf16_f32 v125, v90, v91
  v_mfma_f32_16x16x32_bf16 a[156:159], a[252:255], v[120:123], a[156:159]
  s_waitcnt lgkmcnt(7)
  v_exp_f32 v92, v92
  v_mfma_f32_16x16x32_bf16 v[56:59], a[192:195], v[32:35], v[48:51]
  s_waitcnt lgkmcnt(6)
  v_add_f32 v212, v212, v92
  v_mfma_f32_16x16x32_bf16 v[56:59], a[196:199], v[36:39], v[56:59]
  s_waitcnt lgkmcnt(5)
  s_add_u32 m0, s28, 4096
  s_add_u32 s38, s30, 98304
  buffer_load_dwordx4 v7, s[12:15], s38 offen offset:0 sc1 lds
  v_exp_f32 v93, v93
  v_mfma_f32_16x16x32_bf16 v[56:59], a[200:203], v[40:43], v[56:59]
  s_waitcnt lgkmcnt(4)
  v_add_f32 v212, v212, v93
  v_cvt_pk_bf16_f32 v126, v92, v93
  v_mfma_f32_16x16x32_bf16 v[56:59], a[204:207], v[44:47], v[56:59]
  s_waitcnt lgkmcnt(3)
  v_exp_f32 v94, v94
  v_mfma_f32_16x16x32_bf16 v[60:63], a[208:211], v[32:35], v[48:51]
  s_waitcnt lgkmcnt(2)
  s_add_u32 m0, s28, 4096
  s_add_u32 s38, s30, 98304
  buffer_load_dwordx4 v8, s[12:15], s38 offen offset:1024 sc1 lds
  v_add_f32 v212, v212, v94
  v_mfma_f32_16x16x32_bf16 v[60:63], a[212:215], v[36:39], v[60:63]
  s_waitcnt lgkmcnt(1)
  v_exp_f32 v95, v95
  v_mfma_f32_16x16x32_bf16 v[60:63], a[216:219], v[40:43], v[60:63]
  s_waitcnt lgkmcnt(0)
  v_add_f32 v212, v212, v95
  v_cvt_pk_bf16_f32 v127, v94, v95
  v_mfma_f32_16x16x32_bf16 v[60:63], a[220:223], v[44:47], v[60:63]
  s_add_u32 m0, s28, 4096
  s_add_u32 s38, s30, 98304
  buffer_load_dwordx4 v9, s[12:15], s38 offen offset:2048 sc1 lds
  v_exp_f32 v56, v56
  v_mfma_f32_16x16x32_bf16 a[160:163], a[224:227], v[124:127], a[160:163]
  ds_read_b64_tr_b16 a[224:225], v17 offset:0
  v_add_f32 v52, v52, v56
  v_mfma_f32_16x16x32_bf16 a[164:167], a[228:231], v[124:127], a[164:167]
  s_xor_b32 s59, s59, 24576
  ds_read_b64_tr_b16 a[226:227], v17 offset:2048
  v_exp_f32 v57, v57
  v_mfma_f32_16x16x32_bf16 a[168:171], a[232:235], v[124:127], a[168:171]
  s_add_u32 m0, s28, 4096
  s_add_u32 s38, s30, 98304
  ds_read_b64_tr_b16 a[228:229], v18 offset:0
  buffer_load_dwordx4 v10, s[12:15], s38 offen offset:3072 sc1 lds
  v_add_f32 v52, v52, v57
  v_cvt_pk_bf16_f32 v120, v56, v57
  v_mfma_f32_16x16x32_bf16 a[172:175], a[236:239], v[124:127], a[172:175]
  ds_read_b64_tr_b16 a[230:231], v18 offset:2048
  v_exp_f32 v58, v58
  v_mfma_f32_16x16x32_bf16 a[176:179], a[240:243], v[124:127], a[176:179]
  ds_read_b64_tr_b16 a[232:233], v19 offset:0
  v_add_f32 v52, v52, v58
  v_mfma_f32_16x16x32_bf16 a[180:183], a[244:247], v[124:127], a[180:183]
  ds_read_b64_tr_b16 a[234:235], v19 offset:2048
  v_exp_f32 v59, v59
  v_mfma_f32_16x16x32_bf16 a[184:187], a[248:251], v[124:127], a[184:187]
  ds_read_b64_tr_b16 a[236:237], v20 offset:0
  v_add_f32 v52, v52, v59
  v_cvt_pk_bf16_f32 v121, v58, v59
  v_mfma_f32_16x16x32_bf16 a[188:191], a[252:255], v[124:127], a[188:191]
  ds_read_b64_tr_b16 a[238:239], v20 offset:2048
  v_exp_f32 v60, v60
  v_mfma_f32_16x16x32_bf16 v[88:91], a[192:195], v[64:67], v[80:83]
  ds_read_b64_tr_b16 a[240:241], v21 offset:0
  v_add_f32 v52, v52, v60
  v_mfma_f32_16x16x32_bf16 v[88:91], a[196:199], v[68:71], v[88:91]
  ds_read_b64_tr_b16 a[242:243], v21 offset:2048
  v_exp_f32 v61, v61
  v_mfma_f32_16x16x32_bf16 v[88:91], a[200:203], v[72:75], v[88:91]
  ds_read_b64_tr_b16 a[244:245], v22 offset:0
  v_add_f32 v52, v52, v61
  v_cvt_pk_bf16_f32 v122, v60, v61
  v_mfma_f32_16x16x32_bf16 v[88:91], a[204:207], v[76:79], v[88:91]
  ds_read_b64_tr_b16 a[246:247], v22 offset:2048
  v_exp_f32 v62, v62
  v_mfma_f32_16x16x32_bf16 v[92:95], a[208:211], v[64:67], v[80:83]
  ds_read_b64_tr_b16 a[248:249], v23 offset:0
  v_add_f32 v52, v52, v62
  v_mfma_f32_16x16x32_bf16 v[92:95], a[212:215], v[68:71], v[92:95]
  ds_read_b64_tr_b16 a[250:251], v23 offset:2048
  v_exp_f32 v63, v63
  v_mfma_f32_16x16x32_bf16 v[92:95], a[216:219], v[72:75], v[92:95]
  ds_read_b64_tr_b16 a[252:253], v28 offset:0
  v_add_f32 v52, v52, v63
  v_cvt_pk_bf16_f32 v123, v62, v63
  v_mfma_f32_16x16x32_bf16 v[92:95], a[220:223], v[76:79], v[92:95]
  s_waitcnt lgkmcnt(8)
  ds_read_b64_tr_b16 a[254:255], v28 offset:2048
  v_exp_f32 v88, v88
  v_mfma_f32_16x16x32_bf16 a[0:3], a[224:227], v[120:123], a[0:3]
  v_add_f32 v84, v84, v88
  v_mfma_f32_16x16x32_bf16 a[4:7], a[228:231], v[120:123], a[4:7]
  v_exp_f32 v89, v89
  v_mfma_f32_16x16x32_bf16 a[8:11], a[232:235], v[120:123], a[8:11]
  s_waitcnt lgkmcnt(8)
  v_add_f32 v84, v84, v89
  v_cvt_pk_bf16_f32 v124, v88, v89
  v_mfma_f32_16x16x32_bf16 a[12:15], a[236:239], v[120:123], a[12:15]
  s_waitcnt lgkmcnt(6)
  v_exp_f32 v90, v90
  v_mfma_f32_16x16x32_bf16 a[16:19], a[240:243], v[120:123], a[16:19]
  s_waitcnt lgkmcnt(4)
  v_add_f32 v84, v84, v90
  v_mfma_f32_16x16x32_bf16 a[20:23], a[244:247], v[120:123], a[20:23]
  s_waitcnt lgkmcnt(2)
  v_exp_f32 v91, v91
  v_mfma_f32_16x16x32_bf16 a[24:27], a[248:251], v[120:123], a[24:27]
  s_waitcnt lgkmcnt(0)
  v_add_f32 v84, v84, v91
  v_cvt_pk_bf16_f32 v125, v90, v91
  v_mfma_f32_16x16x32_bf16 a[28:31], a[252:255], v[120:123], a[28:31]
  s_barrier
  v_exp_f32 v92, v92
  v_mfma_f32_16x16x32_bf16 v[56:59], a[192:195], v[96:99], v[112:115]
  v_add_f32 v84, v84, v92
  v_xor_b32 v13, s59, v13
  v_mfma_f32_16x16x32_bf16 v[56:59], a[196:199], v[100:103], v[56:59]
  v_exp_f32 v93, v93
  v_mfma_f32_16x16x32_bf16 v[56:59], a[200:203], v[104:107], v[56:59]
  s_add_u32 m0, s28, 4294934528
  s_add_u32 s38, s30, 4292935680
  buffer_load_dwordx4 v7, s[12:15], s38 offen offset:0 sc1 lds
  v_add_f32 v84, v84, v93
  v_cvt_pk_bf16_f32 v126, v92, v93
  v_mfma_f32_16x16x32_bf16 v[56:59], a[204:207], v[108:111], v[56:59]
  v_exp_f32 v94, v94
  v_mfma_f32_16x16x32_bf16 v[60:63], a[208:211], v[96:99], v[112:115]
  v_add_f32 v84, v84, v94
  v_xor_b32 v14, s59, v14
  v_mfma_f32_16x16x32_bf16 v[60:63], a[212:215], v[100:103], v[60:63]
  s_add_u32 m0, s28, 4294934528
  s_add_u32 s38, s30, 4292935680
  buffer_load_dwordx4 v8, s[12:15], s38 offen offset:1024 sc1 lds
  v_exp_f32 v95, v95
  v_mfma_f32_16x16x32_bf16 v[60:63], a[216:219], v[104:107], v[60:63]
  v_add_f32 v84, v84, v95
  v_cvt_pk_bf16_f32 v127, v94, v95
  v_mfma_f32_16x16x32_bf16 v[60:63], a[220:223], v[108:111], v[60:63]
  v_exp_f32 v56, v56
  v_mfma_f32_16x16x32_bf16 a[32:35], a[224:227], v[124:127], a[32:35]
  s_add_u32 m0, s28, 4294934528
  s_add_u32 s38, s30, 4292935680
  buffer_load_dwordx4 v9, s[12:15], s38 offen offset:2048 sc1 lds
  v_add_f32 v116, v116, v56
  v_xor_b32 v15, s59, v15
  v_mfma_f32_16x16x32_bf16 a[36:39], a[228:231], v[124:127], a[36:39]
  v_exp_f32 v57, v57
  v_mfma_f32_16x16x32_bf16 a[40:43], a[232:235], v[124:127], a[40:43]
  v_add_f32 v116, v116, v57
  v_cvt_pk_bf16_f32 v120, v56, v57
  v_mfma_f32_16x16x32_bf16 a[44:47], a[236:239], v[124:127], a[44:47]
  s_add_u32 m0, s28, 4294934528
  s_add_u32 s38, s30, 4292935680
  buffer_load_dwordx4 v10, s[12:15], s38 offen offset:3072 sc1 lds
  v_exp_f32 v58, v58
  v_mfma_f32_16x16x32_bf16 a[48:51], a[240:243], v[124:127], a[48:51]
  v_add_f32 v116, v116, v58
  v_xor_b32 v16, s59, v16
  v_mfma_f32_16x16x32_bf16 a[52:55], a[244:247], v[124:127], a[52:55]
  v_exp_f32 v59, v59
  v_mfma_f32_16x16x32_bf16 a[56:59], a[248:251], v[124:127], a[56:59]
  s_add_u32 m0, s28, 4294938624
  s_add_u32 s38, s30, 4292968448
  buffer_load_dwordx4 v7, s[12:15], s38 offen offset:0 sc1 lds
  v_add_f32 v116, v116, v59
  v_cvt_pk_bf16_f32 v121, v58, v59
  v_mfma_f32_16x16x32_bf16 a[60:63], a[252:255], v[124:127], a[60:63]
  v_exp_f32 v60, v60
  v_mfma_f32_16x16x32_bf16 v[88:91], a[192:195], v[128:131], v[144:147]
  v_add_f32 v116, v116, v60
  v_xor_b32 v17, s59, v17
  v_mfma_f32_16x16x32_bf16 v[88:91], a[196:199], v[132:135], v[88:91]
  s_add_u32 m0, s28, 4294938624
  s_add_u32 s38, s30, 4292968448
  buffer_load_dwordx4 v8, s[12:15], s38 offen offset:1024 sc1 lds
  v_exp_f32 v61, v61
  v_mfma_f32_16x16x32_bf16 v[88:91], a[200:203], v[136:139], v[88:91]
  v_add_f32 v116, v116, v61
  v_cvt_pk_bf16_f32 v122, v60, v61
  v_mfma_f32_16x16x32_bf16 v[88:91], a[204:207], v[140:143], v[88:91]
  v_exp_f32 v62, v62
  v_mfma_f32_16x16x32_bf16 v[92:95], a[208:211], v[128:131], v[144:147]
  v_add_f32 v116, v116, v62
  v_xor_b32 v18, s59, v18
  v_mfma_f32_16x16x32_bf16 v[92:95], a[212:215], v[132:135], v[92:95]
  s_add_u32 m0, s28, 4294938624
  s_add_u32 s38, s30, 4292968448
  buffer_load_dwordx4 v9, s[12:15], s38 offen offset:2048 sc1 lds
  v_exp_f32 v63, v63
  v_mfma_f32_16x16x32_bf16 v[92:95], a[216:219], v[136:139], v[92:95]
  v_add_f32 v116, v116, v63
  v_cvt_pk_bf16_f32 v123, v62, v63
  v_mfma_f32_16x16x32_bf16 v[92:95], a[220:223], v[140:143], v[92:95]
  v_exp_f32 v88, v88
  v_mfma_f32_16x16x32_bf16 a[64:67], a[224:227], v[120:123], a[64:67]
  s_add_u32 m0, s28, 4294938624
  s_add_u32 s38, s30, 4292968448
  buffer_load_dwordx4 v10, s[12:15], s38 offen offset:3072 sc1 lds
  v_add_f32 v148, v148, v88
  v_xor_b32 v19, s59, v19
  v_mfma_f32_16x16x32_bf16 a[68:71], a[228:231], v[120:123], a[68:71]
  v_exp_f32 v89, v89
  v_mfma_f32_16x16x32_bf16 a[72:75], a[232:235], v[120:123], a[72:75]
  v_add_f32 v148, v148, v89
  v_cvt_pk_bf16_f32 v124, v88, v89
  v_mfma_f32_16x16x32_bf16 a[76:79], a[236:239], v[120:123], a[76:79]
  s_add_u32 m0, s28, 8192
  s_add_u32 s38, s30, 262144
  buffer_load_dwordx4 v7, s[12:15], s38 offen offset:0 sc1 lds
  v_exp_f32 v90, v90
  v_mfma_f32_16x16x32_bf16 a[80:83], a[240:243], v[120:123], a[80:83]
  v_add_f32 v148, v148, v90
  v_xor_b32 v20, s59, v20
  v_mfma_f32_16x16x32_bf16 a[84:87], a[244:247], v[120:123], a[84:87]
  v_exp_f32 v91, v91
  v_mfma_f32_16x16x32_bf16 a[88:91], a[248:251], v[120:123], a[88:91]
  s_add_u32 m0, s28, 8192
  s_add_u32 s38, s30, 262144
  buffer_load_dwordx4 v8, s[12:15], s38 offen offset:1024 sc1 lds
  v_add_f32 v148, v148, v91
  v_cvt_pk_bf16_f32 v125, v90, v91
  v_mfma_f32_16x16x32_bf16 a[92:95], a[252:255], v[120:123], a[92:95]
  v_exp_f32 v92, v92
  v_mfma_f32_16x16x32_bf16 v[56:59], a[192:195], v[160:163], v[176:179]
  v_add_f32 v148, v148, v92
  v_xor_b32 v21, s59, v21
  v_mfma_f32_16x16x32_bf16 v[56:59], a[196:199], v[164:167], v[56:59]
  s_add_u32 m0, s28, 8192
  s_add_u32 s38, s30, 262144
  buffer_load_dwordx4 v9, s[12:15], s38 offen offset:2048 sc1 lds
  v_exp_f32 v93, v93
  v_mfma_f32_16x16x32_bf16 v[56:59], a[200:203], v[168:171], v[56:59]
  v_add_f32 v148, v148, v93
  v_cvt_pk_bf16_f32 v126, v92, v93
  v_mfma_f32_16x16x32_bf16 v[56:59], a[204:207], v[172:175], v[56:59]
  v_exp_f32 v94, v94
  v_mfma_f32_16x16x32_bf16 v[60:63], a[208:211], v[160:163], v[176:179]
  s_add_u32 m0, s28, 8192
  s_add_u32 s38, s30, 262144
  buffer_load_dwordx4 v10, s[12:15], s38 offen offset:3072 sc1 lds
  v_add_f32 v148, v148, v94
  v_xor_b32 v22, s59, v22
  v_mfma_f32_16x16x32_bf16 v[60:63], a[212:215], v[164:167], v[60:63]
  v_exp_f32 v95, v95
  v_mfma_f32_16x16x32_bf16 v[60:63], a[216:219], v[168:171], v[60:63]
  v_add_f32 v148, v148, v95
  v_cvt_pk_bf16_f32 v127, v94, v95
  v_mfma_f32_16x16x32_bf16 v[60:63], a[220:223], v[172:175], v[60:63]
  v_exp_f32 v56, v56
  v_mfma_f32_16x16x32_bf16 a[96:99], a[224:227], v[124:127], a[96:99]
  s_add_u32 m0, s28, 12288
  s_add_u32 s38, s30, 294912
  buffer_load_dwordx4 v7, s[12:15], s38 offen offset:0 sc1 lds
  v_add_f32 v180, v180, v56
  v_xor_b32 v23, s59, v23
  v_mfma_f32_16x16x32_bf16 a[100:103], a[228:231], v[124:127], a[100:103]
  v_exp_f32 v57, v57
  v_mfma_f32_16x16x32_bf16 a[104:107], a[232:235], v[124:127], a[104:107]
  v_add_f32 v180, v180, v57
  v_cvt_pk_bf16_f32 v120, v56, v57
  v_mfma_f32_16x16x32_bf16 a[108:111], a[236:239], v[124:127], a[108:111]
  s_add_u32 m0, s28, 12288
  s_add_u32 s38, s30, 294912
  buffer_load_dwordx4 v8, s[12:15], s38 offen offset:1024 sc1 lds
  v_exp_f32 v58, v58
  v_mfma_f32_16x16x32_bf16 a[112:115], a[240:243], v[124:127], a[112:115]
  v_add_f32 v180, v180, v58
  v_xor_b32 v28, s59, v28
  v_mfma_f32_16x16x32_bf16 a[116:119], a[244:247], v[124:127], a[116:119]
  v_exp_f32 v59, v59
  v_mfma_f32_16x16x32_bf16 a[120:123], a[248:251], v[124:127], a[120:123]
  s_add_u32 m0, s28, 12288
  s_add_u32 s38, s30, 294912
  buffer_load_dwordx4 v9, s[12:15], s38 offen offset:2048 sc1 lds
  v_add_f32 v180, v180, v59
  v_cvt_pk_bf16_f32 v121, v58, v59
  v_mfma_f32_16x16x32_bf16 a[124:127], a[252:255], v[124:127], a[124:127]
  v_exp_f32 v60, v60
  v_mfma_f32_16x16x32_bf16 v[88:91], a[192:195], v[192:195], v[208:211]
  ds_read_b128 a[192:195], v13 offset:0
  v_add_f32 v180, v180, v60
  v_mfma_f32_16x16x32_bf16 v[88:91], a[196:199], v[196:199], v[88:91]
  s_add_u32 m0, s28, 12288
  s_add_u32 s38, s30, 294912
  buffer_load_dwordx4 v10, s[12:15], s38 offen offset:3072 sc1 lds
  v_exp_f32 v61, v61
  v_mfma_f32_16x16x32_bf16 v[88:91], a[200:203], v[200:203], v[88:91]
  ds_read_b128 a[196:199], v14 offset:0
  v_add_f32 v180, v180, v61
  v_cvt_pk_bf16_f32 v122, v60, v61
  v_mfma_f32_16x16x32_bf16 v[88:91], a[204:207], v[204:207], v[88:91]
  v_exp_f32 v62, v62
  v_mfma_f32_16x16x32_bf16 v[92:95], a[208:211], v[192:195], v[208:211]
  s_add_u32 m0, s28, 4294942720
  s_add_u32 s38, s30, 4293132288
  ds_read_b128 a[200:203], v15 offset:0
  buffer_load_dwordx4 v7, s[12:15], s38 offen offset:0 sc1 lds
  v_add_f32 v180, v180, v62
  v_mfma_f32_16x16x32_bf16 v[92:95], a[212:215], v[196:199], v[92:95]
  v_exp_f32 v63, v63
  v_mfma_f32_16x16x32_bf16 v[92:95], a[216:219], v[200:203], v[92:95]
  ds_read_b128 a[204:207], v16 offset:0
  v_add_f32 v180, v180, v63
  v_cvt_pk_bf16_f32 v123, v62, v63
  v_mfma_f32_16x16x32_bf16 v[92:95], a[220:223], v[204:207], v[92:95]
  s_add_u32 m0, s28, 4294942720
  s_add_u32 s38, s30, 4293132288
  buffer_load_dwordx4 v8, s[12:15], s38 offen offset:1024 sc1 lds
  v_exp_f32 v88, v88
  v_mfma_f32_16x16x32_bf16 a[128:131], a[224:227], v[120:123], a[128:131]
  ds_read_b128 a[208:211], v13 offset:2048
  v_add_f32 v212, v212, v88
  v_mfma_f32_16x16x32_bf16 a[132:135], a[228:231], v[120:123], a[132:135]
  v_exp_f32 v89, v89
  v_mfma_f32_16x16x32_bf16 a[136:139], a[232:235], v[120:123], a[136:139]
  ds_read_b128 a[212:215], v14 offset:2048
  v_add_f32 v212, v212, v89
  v_cvt_pk_bf16_f32 v124, v88, v89
  v_mfma_f32_16x16x32_bf16 a[140:143], a[236:239], v[120:123], a[140:143]
  s_add_u32 m0, s28, 4294942720
  s_add_u32 s38, s30, 4293132288
  buffer_load_dwordx4 v9, s[12:15], s38 offen offset:2048 sc1 lds
  v_exp_f32 v90, v90
  v_mfma_f32_16x16x32_bf16 a[144:147], a[240:243], v[120:123], a[144:147]
  ds_read_b128 a[216:219], v15 offset:2048
  v_add_f32 v212, v212, v90
  v_mfma_f32_16x16x32_bf16 a[148:151], a[244:247], v[120:123], a[148:151]
  v_exp_f32 v91, v91
  v_mfma_f32_16x16x32_bf16 a[152:155], a[248:251], v[120:123], a[152:155]
  s_add_u32 m0, s28, 4294942720
  s_add_u32 s38, s30, 4293132288
  ds_read_b128 a[220:223], v16 offset:2048
  buffer_load_dwordx4 v10, s[12:15], s38 offen offset:3072 sc1 lds
  v_add_f32 v212, v212, v91
  v_cvt_pk_bf16_f32 v125, v90, v91
  v_mfma_f32_16x16x32_bf16 a[156:159], a[252:255], v[120:123], a[156:159]
  s_waitcnt lgkmcnt(7)
  v_exp_f32 v92, v92
  v_mfma_f32_16x16x32_bf16 v[56:59], a[192:195], v[32:35], v[48:51]
  s_waitcnt lgkmcnt(6)
  v_add_f32 v212, v212, v92
  v_mfma_f32_16x16x32_bf16 v[56:59], a[196:199], v[36:39], v[56:59]
  s_waitcnt lgkmcnt(5)
  s_add_u32 m0, s28, 4294946816
  s_add_u32 s38, s30, 4293165056
  buffer_load_dwordx4 v7, s[12:15], s38 offen offset:0 sc1 lds
  v_exp_f32 v93, v93
  v_mfma_f32_16x16x32_bf16 v[56:59], a[200:203], v[40:43], v[56:59]
  s_waitcnt lgkmcnt(4)
  v_add_f32 v212, v212, v93
  v_cvt_pk_bf16_f32 v126, v92, v93
  v_mfma_f32_16x16x32_bf16 v[56:59], a[204:207], v[44:47], v[56:59]
  s_waitcnt lgkmcnt(3)
  v_exp_f32 v94, v94
  v_mfma_f32_16x16x32_bf16 v[60:63], a[208:211], v[32:35], v[48:51]
  s_waitcnt lgkmcnt(2)
  s_add_u32 m0, s28, 4294946816
  s_add_u32 s38, s30, 4293165056
  buffer_load_dwordx4 v8, s[12:15], s38 offen offset:1024 sc1 lds
  v_add_f32 v212, v212, v94
  v_mfma_f32_16x16x32_bf16 v[60:63], a[212:215], v[36:39], v[60:63]
  s_waitcnt lgkmcnt(1)
  v_exp_f32 v95, v95
  v_mfma_f32_16x16x32_bf16 v[60:63], a[216:219], v[40:43], v[60:63]
  s_waitcnt lgkmcnt(0)
  v_add_f32 v212, v212, v95
  v_cvt_pk_bf16_f32 v127, v94, v95
  v_mfma_f32_16x16x32_bf16 v[60:63], a[220:223], v[44:47], v[60:63]
  s_add_u32 m0, s28, 4294946816
  s_add_u32 s38, s30, 4293165056
  buffer_load_dwordx4 v9, s[12:15], s38 offen offset:2048 sc1 lds
  v_exp_f32 v56, v56
  v_mfma_f32_16x16x32_bf16 a[160:163], a[224:227], v[124:127], a[160:163]
  ds_read_b64_tr_b16 a[224:225], v17 offset:0
  v_add_f32 v52, v52, v56
  v_mfma_f32_16x16x32_bf16 a[164:167], a[228:231], v[124:127], a[164:167]
  s_xor_b32 s59, s59, 24576
  ds_read_b64_tr_b16 a[226:227], v17 offset:2048
  v_exp_f32 v57, v57
  v_mfma_f32_16x16x32_bf16 a[168:171], a[232:235], v[124:127], a[168:171]
  s_add_u32 m0, s28, 4294946816
  s_add_u32 s38, s30, 4293165056
  ds_read_b64_tr_b16 a[228:229], v18 offset:0
  buffer_load_dwordx4 v10, s[12:15], s38 offen offset:3072 sc1 lds
  v_add_f32 v52, v52, v57
  v_cvt_pk_bf16_f32 v120, v56, v57
  v_mfma_f32_16x16x32_bf16 a[172:175], a[236:239], v[124:127], a[172:175]
  ds_read_b64_tr_b16 a[230:231], v18 offset:2048
  v_exp_f32 v58, v58
  v_mfma_f32_16x16x32_bf16 a[176:179], a[240:243], v[124:127], a[176:179]
  ds_read_b64_tr_b16 a[232:233], v19 offset:0
  v_add_f32 v52, v52, v58
  v_mfma_f32_16x16x32_bf16 a[180:183], a[244:247], v[124:127], a[180:183]
  ds_read_b64_tr_b16 a[234:235], v19 offset:2048
  v_exp_f32 v59, v59
  v_mfma_f32_16x16x32_bf16 a[184:187], a[248:251], v[124:127], a[184:187]
  ds_read_b64_tr_b16 a[236:237], v20 offset:0
  v_add_f32 v52, v52, v59
  v_cvt_pk_bf16_f32 v121, v58, v59
  v_mfma_f32_16x16x32_bf16 a[188:191], a[252:255], v[124:127], a[188:191]
  ds_read_b64_tr_b16 a[238:239], v20 offset:2048
  v_exp_f32 v60, v60
  v_mfma_f32_16x16x32_bf16 v[88:91], a[192:195], v[64:67], v[80:83]
  ds_read_b64_tr_b16 a[240:241], v21 offset:0
  v_add_f32 v52, v52, v60
  v_mfma_f32_16x16x32_bf16 v[88:91], a[196:199], v[68:71], v[88:91]
  ds_read_b64_tr_b16 a[242:243], v21 offset:2048
  v_exp_f32 v61, v61
  v_mfma_f32_16x16x32_bf16 v[88:91], a[200:203], v[72:75], v[88:91]
  ds_read_b64_tr_b16 a[244:245], v22 offset:0
  v_add_f32 v52, v52, v61
  v_cvt_pk_bf16_f32 v122, v60, v61
  v_mfma_f32_16x16x32_bf16 v[88:91], a[204:207], v[76:79], v[88:91]
  ds_read_b64_tr_b16 a[246:247], v22 offset:2048
  v_exp_f32 v62, v62
  v_mfma_f32_16x16x32_bf16 v[92:95], a[208:211], v[64:67], v[80:83]
  ds_read_b64_tr_b16 a[248:249], v23 offset:0
  v_add_f32 v52, v52, v62
  v_mfma_f32_16x16x32_bf16 v[92:95], a[212:215], v[68:71], v[92:95]
  ds_read_b64_tr_b16 a[250:251], v23 offset:2048
  v_exp_f32 v63, v63
  v_mfma_f32_16x16x32_bf16 v[92:95], a[216:219], v[72:75], v[92:95]
  ds_read_b64_tr_b16 a[252:253], v28 offset:0
  v_add_f32 v52, v52, v63
  v_cvt_pk_bf16_f32 v123, v62, v63
  v_mfma_f32_16x16x32_bf16 v[92:95], a[220:223], v[76:79], v[92:95]
  s_waitcnt lgkmcnt(8)
  ds_read_b64_tr_b16 a[254:255], v28 offset:2048
  v_exp_f32 v88, v88
  v_mfma_f32_16x16x32_bf16 a[0:3], a[224:227], v[120:123], a[0:3]
  v_add_f32 v84, v84, v88
  v_mfma_f32_16x16x32_bf16 a[4:7], a[228:231], v[120:123], a[4:7]
  v_exp_f32 v89, v89
  v_mfma_f32_16x16x32_bf16 a[8:11], a[232:235], v[120:123], a[8:11]
  s_waitcnt lgkmcnt(8)
  v_add_f32 v84, v84, v89
  v_cvt_pk_bf16_f32 v124, v88, v89
  v_mfma_f32_16x16x32_bf16 a[12:15], a[236:239], v[120:123], a[12:15]
  s_waitcnt lgkmcnt(6)
  v_exp_f32 v90, v90
  v_mfma_f32_16x16x32_bf16 a[16:19], a[240:243], v[120:123], a[16:19]
  s_waitcnt lgkmcnt(4)
  v_add_f32 v84, v84, v90
  v_mfma_f32_16x16x32_bf16 a[20:23], a[244:247], v[120:123], a[20:23]
  s_waitcnt lgkmcnt(2)
  v_exp_f32 v91, v91
  v_mfma_f32_16x16x32_bf16 a[24:27], a[248:251], v[120:123], a[24:27]
  s_waitcnt lgkmcnt(0)
  v_add_f32 v84, v84, v91
  v_cvt_pk_bf16_f32 v125, v90, v91
  v_mfma_f32_16x16x32_bf16 a[28:31], a[252:255], v[120:123], a[28:31]
  s_barrier
  v_exp_f32 v92, v92
  v_mfma_f32_16x16x32_bf16 v[56:59], a[192:195], v[96:99], v[112:115]
  v_add_f32 v84, v84, v92
  v_mfma_f32_16x16x32_bf16 v[56:59], a[196:199], v[100:103], v[56:59]
  v_exp_f32 v93, v93
  v_mfma_f32_16x16x32_bf16 v[56:59], a[200:203], v[104:107], v[56:59]
  s_add_u32 m0, s28, 24576
  s_add_u32 s38, s30, 327680
  buffer_load_dwordx4 v7, s[12:15], s38 offen offset:0 sc1 lds
  v_add_f32 v84, v84, v93
  v_cvt_pk_bf16_f32 v126, v92, v93
  v_mfma_f32_16x16x32_bf16 v[56:59], a[204:207], v[108:111], v[56:59]
  v_exp_f32 v94, v94
  v_mfma_f32_16x16x32_bf16 v[60:63], a[208:211], v[96:99], v[112:115]
  v_add_f32 v84, v84, v94
  v_mfma_f32_16x16x32_bf16 v[60:63], a[212:215], v[100:103], v[60:63]
  s_add_u32 m0, s28, 24576
  s_add_u32 s38, s30, 327680
  buffer_load_dwordx4 v8, s[12:15], s38 offen offset:1024 sc1 lds
  v_exp_f32 v95, v95
  v_mfma_f32_16x16x32_bf16 v[60:63], a[216:219], v[104:107], v[60:63]
  v_add_f32 v84, v84, v95
  v_cvt_pk_bf16_f32 v127, v94, v95
  v_mfma_f32_16x16x32_bf16 v[60:63], a[220:223], v[108:111], v[60:63]
  v_exp_f32 v56, v56
  v_mfma_f32_16x16x32_bf16 a[32:35], a[224:227], v[124:127], a[32:35]
  v_add_f32 v116, v116, v56
  v_mfma_f32_16x16x32_bf16 a[36:39], a[228:231], v[124:127], a[36:39]
  s_add_u32 m0, s28, 24576
  s_add_u32 s38, s30, 327680
  buffer_load_dwordx4 v9, s[12:15], s38 offen offset:2048 sc1 lds
  v_exp_f32 v57, v57
  v_mfma_f32_16x16x32_bf16 a[40:43], a[232:235], v[124:127], a[40:43]
  v_add_f32 v116, v116, v57
  v_cvt_pk_bf16_f32 v120, v56, v57
  v_mfma_f32_16x16x32_bf16 a[44:47], a[236:239], v[124:127], a[44:47]
  v_exp_f32 v58, v58
  v_mfma_f32_16x16x32_bf16 a[48:51], a[240:243], v[124:127], a[48:51]
  v_add_f32 v116, v116, v58
  v_mfma_f32_16x16x32_bf16 a[52:55], a[244:247], v[124:127], a[52:55]
  s_add_u32 m0, s28, 24576
  s_add_u32 s38, s30, 327680
  buffer_load_dwordx4 v10, s[12:15], s38 offen offset:3072 sc1 lds
  v_exp_f32 v59, v59
  v_mfma_f32_16x16x32_bf16 a[56:59], a[248:251], v[124:127], a[56:59]
  v_add_f32 v116, v116, v59
  v_cvt_pk_bf16_f32 v121, v58, v59
  v_mfma_f32_16x16x32_bf16 a[60:63], a[252:255], v[124:127], a[60:63]
  v_exp_f32 v60, v60
  v_mfma_f32_16x16x32_bf16 v[88:91], a[192:195], v[128:131], v[144:147]
  v_add_f32 v116, v116, v60
  v_mfma_f32_16x16x32_bf16 v[88:91], a[196:199], v[132:135], v[88:91]
  s_add_u32 m0, s28, 28672
  s_add_u32 s38, s30, 360448
  buffer_load_dwordx4 v7, s[12:15], s38 offen offset:0 sc1 lds
  v_exp_f32 v61, v61
  v_mfma_f32_16x16x32_bf16 v[88:91], a[200:203], v[136:139], v[88:91]
  v_add_f32 v116, v116, v61
  v_cvt_pk_bf16_f32 v122, v60, v61
  v_mfma_f32_16x16x32_bf16 v[88:91], a[204:207], v[140:143], v[88:91]
  v_exp_f32 v62, v62
  v_mfma_f32_16x16x32_bf16 v[92:95], a[208:211], v[128:131], v[144:147]
  s_add_u32 m0, s28, 28672
  s_add_u32 s38, s30, 360448
  buffer_load_dwordx4 v8, s[12:15], s38 offen offset:1024 sc1 lds
  v_add_f32 v116, v116, v62
  v_mfma_f32_16x16x32_bf16 v[92:95], a[212:215], v[132:135], v[92:95]
  v_exp_f32 v63, v63
  v_mfma_f32_16x16x32_bf16 v[92:95], a[216:219], v[136:139], v[92:95]
  v_add_f32 v116, v116, v63
  v_cvt_pk_bf16_f32 v123, v62, v63
  v_mfma_f32_16x16x32_bf16 v[92:95], a[220:223], v[140:143], v[92:95]
  v_exp_f32 v88, v88
  v_mfma_f32_16x16x32_bf16 a[64:67], a[224:227], v[120:123], a[64:67]
  s_add_u32 m0, s28, 28672
  s_add_u32 s38, s30, 360448
  buffer_load_dwordx4 v9, s[12:15], s38 offen offset:2048 sc1 lds
  v_add_f32 v148, v148, v88
  v_mfma_f32_16x16x32_bf16 a[68:71], a[228:231], v[120:123], a[68:71]
  v_exp_f32 v89, v89
  v_mfma_f32_16x16x32_bf16 a[72:75], a[232:235], v[120:123], a[72:75]
  v_add_f32 v148, v148, v89
  v_cvt_pk_bf16_f32 v124, v88, v89
  v_mfma_f32_16x16x32_bf16 a[76:79], a[236:239], v[120:123], a[76:79]
  v_exp_f32 v90, v90
  v_mfma_f32_16x16x32_bf16 a[80:83], a[240:243], v[120:123], a[80:83]
  s_add_u32 m0, s28, 28672
  s_add_u32 s38, s30, 360448
  buffer_load_dwordx4 v10, s[12:15], s38 offen offset:3072 sc1 lds
  v_add_f32 v148, v148, v90
  v_mfma_f32_16x16x32_bf16 a[84:87], a[244:247], v[120:123], a[84:87]
  v_exp_f32 v91, v91
  v_mfma_f32_16x16x32_bf16 a[88:91], a[248:251], v[120:123], a[88:91]
  v_add_f32 v148, v148, v91
  v_cvt_pk_bf16_f32 v125, v90, v91
  v_mfma_f32_16x16x32_bf16 a[92:95], a[252:255], v[120:123], a[92:95]
  v_exp_f32 v92, v92
  v_mfma_f32_16x16x32_bf16 v[56:59], a[192:195], v[160:163], v[176:179]
  s_add_u32 m0, s28, 4294959104
  s_add_u32 s38, s30, 4293197824
  buffer_load_dwordx4 v7, s[12:15], s38 offen offset:0 sc1 lds
  v_add_f32 v148, v148, v92
  v_mfma_f32_16x16x32_bf16 v[56:59], a[196:199], v[164:167], v[56:59]
  v_exp_f32 v93, v93
  v_mfma_f32_16x16x32_bf16 v[56:59], a[200:203], v[168:171], v[56:59]
  v_add_f32 v148, v148, v93
  v_cvt_pk_bf16_f32 v126, v92, v93
  v_mfma_f32_16x16x32_bf16 v[56:59], a[204:207], v[172:175], v[56:59]
  s_add_u32 m0, s28, 4294959104
  s_add_u32 s38, s30, 4293197824
  buffer_load_dwordx4 v8, s[12:15], s38 offen offset:1024 sc1 lds
  v_exp_f32 v94, v94
  v_mfma_f32_16x16x32_bf16 v[60:63], a[208:211], v[160:163], v[176:179]
  v_add_f32 v148, v148, v94
  v_mfma_f32_16x16x32_bf16 v[60:63], a[212:215], v[164:167], v[60:63]
  v_exp_f32 v95, v95
  v_mfma_f32_16x16x32_bf16 v[60:63], a[216:219], v[168:171], v[60:63]
  v_add_f32 v148, v148, v95
  v_cvt_pk_bf16_f32 v127, v94, v95
  v_mfma_f32_16x16x32_bf16 v[60:63], a[220:223], v[172:175], v[60:63]
  s_add_u32 m0, s28, 4294959104
  s_add_u32 s38, s30, 4293197824
  buffer_load_dwordx4 v9, s[12:15], s38 offen offset:2048 sc1 lds
  v_exp_f32 v56, v56
  v_mfma_f32_16x16x32_bf16 a[96:99], a[224:227], v[124:127], a[96:99]
  v_add_f32 v180, v180, v56
  v_mfma_f32_16x16x32_bf16 a[100:103], a[228:231], v[124:127], a[100:103]
  v_exp_f32 v57, v57
  v_mfma_f32_16x16x32_bf16 a[104:107], a[232:235], v[124:127], a[104:107]
  v_add_f32 v180, v180, v57
  v_cvt_pk_bf16_f32 v120, v56, v57
  v_mfma_f32_16x16x32_bf16 a[108:111], a[236:239], v[124:127], a[108:111]
  s_add_u32 m0, s28, 4294959104
  s_add_u32 s38, s30, 4293197824
  buffer_load_dwordx4 v10, s[12:15], s38 offen offset:3072 sc1 lds
  v_exp_f32 v58, v58
  v_mfma_f32_16x16x32_bf16 a[112:115], a[240:243], v[124:127], a[112:115]
  v_add_f32 v180, v180, v58
  v_mfma_f32_16x16x32_bf16 a[116:119], a[244:247], v[124:127], a[116:119]
  v_exp_f32 v59, v59
  v_mfma_f32_16x16x32_bf16 a[120:123], a[248:251], v[124:127], a[120:123]
  v_add_f32 v180, v180, v59
  v_cvt_pk_bf16_f32 v121, v58, v59
  v_mfma_f32_16x16x32_bf16 a[124:127], a[252:255], v[124:127], a[124:127]
  s_add_u32 m0, s28, 4294963200
  s_add_u32 s38, s30, 4293230592
  buffer_load_dwordx4 v7, s[12:15], s38 offen offset:0 sc1 lds
  v_exp_f32 v60, v60
  v_mfma_f32_16x16x32_bf16 v[88:91], a[192:195], v[192:195], v[208:211]
  v_add_f32 v180, v180, v60
  v_mfma_f32_16x16x32_bf16 v[88:91], a[196:199], v[196:199], v[88:91]
  v_exp_f32 v61, v61
  v_mfma_f32_16x16x32_bf16 v[88:91], a[200:203], v[200:203], v[88:91]
  s_add_u32 m0, s28, 4294963200
  s_add_u32 s38, s30, 4293230592
  buffer_load_dwordx4 v8, s[12:15], s38 offen offset:1024 sc1 lds
  v_add_f32 v180, v180, v61
  v_cvt_pk_bf16_f32 v122, v60, v61
  v_mfma_f32_16x16x32_bf16 v[88:91], a[204:207], v[204:207], v[88:91]
  v_exp_f32 v62, v62
  v_mfma_f32_16x16x32_bf16 v[92:95], a[208:211], v[192:195], v[208:211]
  v_add_f32 v180, v180, v62
  v_mfma_f32_16x16x32_bf16 v[92:95], a[212:215], v[196:199], v[92:95]
  v_exp_f32 v63, v63
  v_mfma_f32_16x16x32_bf16 v[92:95], a[216:219], v[200:203], v[92:95]
  s_add_u32 m0, s28, 4294963200
  s_add_u32 s38, s30, 4293230592
  buffer_load_dwordx4 v9, s[12:15], s38 offen offset:2048 sc1 lds
  v_add_f32 v180, v180, v63
  v_cvt_pk_bf16_f32 v123, v62, v63
  v_mfma_f32_16x16x32_bf16 v[92:95], a[220:223], v[204:207], v[92:95]
  v_exp_f32 v88, v88
  v_mfma_f32_16x16x32_bf16 a[128:131], a[224:227], v[120:123], a[128:131]
  v_add_f32 v212, v212, v88
  v_mfma_f32_16x16x32_bf16 a[132:135], a[228:231], v[120:123], a[132:135]
  v_exp_f32 v89, v89
  v_mfma_f32_16x16x32_bf16 a[136:139], a[232:235], v[120:123], a[136:139]
  s_add_u32 m0, s28, 4294963200
  s_add_u32 s38, s30, 4293230592
  buffer_load_dwordx4 v10, s[12:15], s38 offen offset:3072 sc1 lds
  v_add_f32 v212, v212, v89
  v_cvt_pk_bf16_f32 v124, v88, v89
  v_mfma_f32_16x16x32_bf16 a[140:143], a[236:239], v[120:123], a[140:143]
  v_exp_f32 v90, v90
  v_mfma_f32_16x16x32_bf16 a[144:147], a[240:243], v[120:123], a[144:147]
  v_add_f32 v212, v212, v90
  v_mfma_f32_16x16x32_bf16 a[148:151], a[244:247], v[120:123], a[148:151]
  v_exp_f32 v91, v91
  v_mfma_f32_16x16x32_bf16 a[152:155], a[248:251], v[120:123], a[152:155]
  v_add_f32 v212, v212, v91
  v_cvt_pk_bf16_f32 v125, v90, v91
  v_mfma_f32_16x16x32_bf16 a[156:159], a[252:255], v[120:123], a[156:159]
  v_exp_f32 v92, v92
L1b_tail:
  v_exp_f32 v93, v93
  v_exp_f32 v94, v94
  v_exp_f32 v95, v95
  s_nop 0
  v_add_f32 v212, v212, v92
  v_add_f32 v212, v212, v93
  v_cvt_pk_bf16_f32 v126, v92, v93
  v_add_f32 v212, v212, v94
  v_add_f32 v212, v212, v95
  v_cvt_pk_bf16_f32 v127, v94, v95
  s_nop 1
  v_mfma_f32_16x16x32_bf16 a[160:163], a[224:227], v[124:127], a[160:163]
  v_mfma_f32_16x16x32_bf16 a[164:167], a[228:231], v[124:127], a[164:167]
  v_mfma_f32_16x16x32_bf16 a[168:171], a[232:235], v[124:127], a[168:171]
  v_mfma_f32_16x16x32_bf16 a[172:175], a[236:239], v[124:127], a[172:175]
  v_mfma_f32_16x16x32_bf16 a[176:179], a[240:243], v[124:127], a[176:179]
  v_mfma_f32_16x16x32_bf16 a[180:183], a[244:247], v[124:127], a[180:183]
  v_mfma_f32_16x16x32_bf16 a[184:187], a[248:251], v[124:127], a[184:187]
  v_mfma_f32_16x16x32_bf16 a[188:191], a[252:255], v[124:127], a[188:191]
  v_lshlrev_b32 v5, 2, v1
  global_load_dword v29, v5, s[96:97] sc1
  s_waitcnt vmcnt(0)
  s_barrier
  s_mov_b32 s49, 524288
L1b_val_c:
  v_cmp_gt_u32 vcc, 4, v29
  s_sub_u32 s49, s49, 1
  s_cbranch_scc1 L1b_val_go
  s_nop 3
  s_cbranch_vccz L1b_val_go
  s_sleep 8
  global_load_dword v29, v5, s[96:97] sc1
  s_waitcnt vmcnt(0)
  s_branch L1b_val_c
L1b_val_go:
L1b_epi:
  v_mov_b32 v53, v52
  v_mov_b32 v85, v84
  v_mov_b32 v117, v116
  v_mov_b32 v149, v148
  v_mov_b32 v181, v180
  v_mov_b32 v213, v212
  s_nop 1
  v_permlane16_swap_b32 v52, v53
  v_permlane16_swap_b32 v84, v85
  v_permlane16_swap_b32 v116, v117
  v_permlane16_swap_b32 v148, v149
  v_permlane16_swap_b32 v180, v181
  v_permlane16_swap_b32 v212, v213
  s_nop 0
  v_add_f32 v52, v52, v53
  v_add_f32 v84, v84, v85
  v_add_f32 v116, v116, v117
  v_add_f32 v148, v148, v149
  v_add_f32 v180, v180, v181
  v_add_f32 v212, v212, v213
  v_mov_b32 v53, v52
  v_mov_b32 v85, v84
  v_mov_b32 v117, v116
  v_mov_b32 v149, v148
  v_mov_b32 v181, v180
  v_mov_b32 v213, v212
  s_nop 1
  v_permlane32_swap_b32 v52, v53
  v_permlane32_swap_b32 v84, v85
  v_permlane32_swap_b32 v116, v117
  v_permlane32_swap_b32 v148, v149
  v_permlane32_swap_b32 v180, v181
  v_permlane32_swap_b32 v212, v213
  s_nop 0
  v_add_f32 v52, v52, v53
  v_add_f32 v84, v84, v85
  v_add_f32 v116, v116, v117
  v_add_f32 v148, v148, v149
  v_add_f32 v180, v180, v181
  v_add_f32 v212, v212, v213
  v_mov_b32 v2, 0
  v_mov_b32 v3, 0
  v_maximum3_f32 v3, v52, v84, v3
  v_maximum3_f32 v3, v116, v148, v3
  v_maximum3_f32 v3, v180, v212, v3
  v_rcp_f32 v54, v52
  v_rcp_f32 v86, v84
  v_rcp_f32 v118, v116
  v_rcp_f32 v150, v148
  v_rcp_f32 v182, v180
  v_rcp_f32 v214, v212
  s_mov_b32 s47, 0x4d800000
  v_mul_f32 v2, s47, v3
  s_cmp_lg_u32 s37, 0
  s_cbranch_scc1 L1b_epi2
  v_accvgpr_read_b32 v56, a0
  v_accvgpr_read_b32 v57, a1
  v_accvgpr_read_b32 v58, a2
  v_accvgpr_read_b32 v59, a3
  v_accvgpr_read_b32 v60, a4
  v_accvgpr_read_b32 v61, a5
  v_accvgpr_read_b32 v62, a6
  v_accvgpr_read_b32 v63, a7
  v_maximum3_f32 v2, |v56|, |v57|, v2
  v_maximum3_f32 v2, |v58|, |v59|, v2
  v_maximum3_f32 v2, |v60|, |v61|, v2
  v_maximum3_f32 v2, |v62|, |v63|, v2
  v_pk_mul_f32 v[56:57], v[56:57], v[54:55] op_sel_hi:[1,0]
  v_pk_mul_f32 v[58:59], v[58:59], v[54:55] op_sel_hi:[1,0]
  v_pk_mul_f32 v[60:61], v[60:61], v[54:55] op_sel_hi:[1,0]
  v_pk_mul_f32 v[62:63], v[62:63], v[54:55] op_sel_hi:[1,0]
  v_cvt_pk_bf16_f32 v120, v56, v57
  v_cvt_pk_bf16_f32 v121, v58, v59
  v_cvt_pk_bf16_f32 v122, v60, v61
  v_cvt_pk_bf16_f32 v123, v62, v63
  s_add_u32 s46, s54, 0
  buffer_store_dwordx4 v[120:123], v30, s[24:27], s46 offen offset:0 sc1
  v_accvgpr_read_b32 v88, a32
  v_accvgpr_read_b32 v89, a33
  v_accvgpr_read_b32 v90, a34
  v_accvgpr_read_b32 v91, a35
  v_accvgpr_read_b32 v92, a36
  v_accvgpr_read_b32 v93, a37
  v_accvgpr_read_b32 v94, a38
  v_accvgpr_read_b32 v95, a39
  v_maximum3_f32 v2, |v88|, |v89|, v2
  v_maximum3_f32 v2, |v90|, |v91|, v2
  v_maximum3_f32 v2, |v92|, |v93|, v2
  v_maximum3_f32 v2, |v94|, |v95|, v2
  v_pk_mul_f32 v[88:89], v[88:89], v[86:87] op_sel_hi:[1,0]
  v_pk_mul_f32 v[90:91], v[90:91], v[86:87] op_sel_hi:[1,0]
  v_pk_mul_f32 v[92:93], v[92:93], v[86:87] op_sel_hi:[1,0]
  v_pk_mul_f32 v[94:95], v[94:95], v[86:87] op_sel_hi:[1,0]
  v_cvt_pk_bf16_f32 v124, v88, v89
  v_cvt_pk_bf16_f32 v125, v90, v91
  v_cvt_pk_bf16_f32 v126, v92, v93
  v_cvt_pk_bf16_f32 v127, v94, v95
  s_add_u32 s46, s54, 2048
  buffer_store_dwordx4 v[124:127], v30, s[24:27], s46 offen offset:0 sc1
  v_accvgpr_read_b32 v56, a64
  v_accvgpr_read_b32 v57, a65
  v_accvgpr_read_b32 v58, a66
  v_accvgpr_read_b32 v59, a67
  v_accvgpr_read_b32 v60, a68
  v_accvgpr_read_b32 v61, a69
  v_accvgpr_read_b32 v62, a70
  v_accvgpr_read_b32 v63, a71
  v_maximum3_f32 v2, |v56|, |v57|, v2
  v_maximum3_f32 v2, |v58|, |v59|, v2
  v_maximum3_f32 v2, |v60|, |v61|, v2
  v_maximum3_f32 v2, |v62|, |v63|, v2
  v_pk_mul_f32 v[56:57], v[56:57], v[118:119] op_sel_hi:[1,0]
  v_pk_mul_f32 v[58:59], v[58:59], v[118:119] op_sel_hi:[1,0]
  v_pk_mul_f32 v[60:61], v[60:61], v[118:119] op_sel_hi:[1,0]
  v_pk_mul_f32 v[62:63], v[62:63], v[118:119] op_sel_hi:[1,0]
  v_cvt_pk_bf16_f32 v120, v56, v57
  v_cvt_pk_bf16_f32 v121, v58, v59
  v_cvt_pk_bf16_f32 v122, v60, v61
  v_cvt_pk_bf16_f32 v123, v62, v63
  s_add_u32 s46, s54, 4096
  buffer_store_dwordx4 v[120:123], v30, s[24:27], s46 offen offset:0 sc1
  v_accvgpr_read_b32 v88, a96
  v_accvgpr_read_b32 v89, a97
  v_accvgpr_read_b32 v90, a98
  v_accvgpr_read_b32 v91, a99
  v_accvgpr_read_b32 v92, a100
  v_accvgpr_read_b32 v93, a101
  v_accvgpr_read_b32 v94, a102
  v_accvgpr_read_b32 v95, a103
  v_maximum3_f32 v2, |v88|, |v89|, v2
  v_maximum3_f32 v2, |v90|, |v91|, v2
  v_maximum3_f32 v2, |v92|, |v93|, v2
  v_maximum3_f32 v2, |v94|, |v95|, v2
  v_pk_mul_f32 v[88:89], v[88:89], v[150:151] op_sel_hi:[1,0]
  v_pk_mul_f32 v[90:91], v[90:91], v[150:151] op_sel_hi:[1,0]
  v_pk_mul_f32 v[92:93], v[92:93], v[150:151] op_sel_hi:[1,0]
  v_pk_mul_f32 v[94:95], v[94:95], v[150:151] op_sel_hi:[1,0]
  v_cvt_pk_bf16_f32 v124, v88, v89
  v_cvt_pk_bf16_f32 v125, v90, v91
  v_cvt_pk_bf16_f32 v126, v92, v93
  v_cvt_pk_bf16_f32 v127, v94, v95
  s_add_u32 s46, s54, 6144
  buffer_store_dwordx4 v[124:127], v30, s[24:27], s46 offen offset:0 sc1
  v_accvgpr_read_b32 v56, a128
  v_accvgpr_read_b32 v57, a129
  v_accvgpr_read_b32 v58, a130
  v_accvgpr_read_b32 v59, a131
  v_accvgpr_read_b32 v60, a132
  v_accvgpr_read_b32 v61, a133
  v_accvgpr_read_b32 v62, a134
  v_accvgpr_read_b32 v63, a135
  v_maximum3_f32 v2, |v56|, |v57|, v2
  v_maximum3_f32 v2, |v58|, |v59|, v2
  v_maximum3_f32 v2, |v60|, |v61|, v2
  v_maximum3_f32 v2, |v62|, |v63|, v2
  v_pk_mul_f32 v[56:57], v[56:57], v[182:183] op_sel_hi:[1,0]
  v_pk_mul_f32 v[58:59], v[58:59], v[182:183] op_sel_hi:[1,0]
  v_pk_mul_f32 v[60:61], v[60:61], v[182:183] op_sel_hi:[1,0]
  v_pk_mul_f32 v[62:63], v[62:63], v[182:183] op_sel_hi:[1,0]
  v_cvt_pk_bf16_f32 v120, v56, v57
  v_cvt_pk_bf16_f32 v121, v58, v59
  v_cvt_pk_bf16_f32 v122, v60, v61
  v_cvt_pk_bf16_f32 v123, v62, v63
  s_add_u32 s46, s54, 8192
  buffer_store_dwordx4 v[120:123], v30, s[24:27], s46 offen offset:0 sc1
  v_accvgpr_read_b32 v88, a160
  v_accvgpr_read_b32 v89, a161
  v_accvgpr_read_b32 v90, a162
  v_accvgpr_read_b32 v91, a163
  v_accvgpr_read_b32 v92, a164
  v_accvgpr_read_b32 v93, a165
  v_accvgpr_read_b32 v94, a166
  v_accvgpr_read_b32 v95, a167
  v_maximum3_f32 v2, |v88|, |v89|, v2
  v_maximum3_f32 v2, |v90|, |v91|, v2
  v_maximum3_f32 v2, |v92|, |v93|, v2
  v_maximum3_f32 v2, |v94|, |v95|, v2
  v_pk_mul_f32 v[88:89], v[88:89], v[214:215] op_sel_hi:[1,0]
  v_pk_mul_f32 v[90:91], v[90:91], v[214:215] op_sel_hi:[1,0]
  v_pk_mul_f32 v[92:93], v[92:93], v[214:215] op_sel_hi:[1,0]
  v_pk_mul_f32 v[94:95], v[94:95], v[214:215] op_sel_hi:[1,0]
  v_cvt_pk_bf16_f32 v124, v88, v89
  v_cvt_pk_bf16_f32 v125, v90, v91
  v_cvt_pk_bf16_f32 v126, v92, v93
  v_cvt_pk_bf16_f32 v127, v94, v95
  s_add_u32 s46, s54, 10240
  buffer_store_dwordx4 v[124:127], v30, s[24:27], s46 offen offset:0 sc1
  v_accvgpr_read_b32 v56, a8
  v_accvgpr_read_b32 v57, a9
  v_accvgpr_read_b32 v58, a10
  v_accvgpr_read_b32 v59, a11
  v_accvgpr_read_b32 v60, a12
  v_accvgpr_read_b32 v61, a13
  v_accvgpr_read_b32 v62, a14
  v_accvgpr_read_b32 v63, a15
  v_maximum3_f32 v2, |v56|, |v57|, v2
  v_maximum3_f32 v2, |v58|, |v59|, v2
  v_maximum3_f32 v2, |v60|, |v61|, v2
  v_maximum3_f32 v2, |v62|, |v63|, v2
  v_pk_mul_f32 v[56:57], v[56:57], v[54:55] op_sel_hi:[1,0]
  v_pk_mul_f32 v[58:59], v[58:59], v[54:55] op_sel_hi:[1,0]
  v_pk_mul_f32 v[60:61], v[60:61], v[54:55] op_sel_hi:[1,0]
  v_pk_mul_f32 v[62:63], v[62:63], v[54:55] op_sel_hi:[1,0]
  v_cvt_pk_bf16_f32 v120, v56, v57
  v_cvt_pk_bf16_f32 v121, v58, v59
  v_cvt_pk_bf16_f32 v122, v60, v61
  v_cvt_pk_bf16_f32 v123, v62, v63
  s_add_u32 s46, s54, 26624
  buffer_store_dwordx4 v[120:123], v30, s[24:27], s46 offen offset:0 sc1
  v_accvgpr_read_b32 v88, a40
  v_accvgpr_read_b32 v89, a41
  v_accvgpr_read_b32 v90, a42
  v_accvgpr_read_b32 v91, a43
  v_accvgpr_read_b32 v92, a44
  v_accvgpr_read_b32 v93, a45
  v_accvgpr_read_b32 v94, a46
  v_accvgpr_read_b32 v95, a47
  v_maximum3_f32 v2, |v88|, |v89|, v2
  v_maximum3_f32 v2, |v90|, |v91|, v2
  v_maximum3_f32 v2, |v92|, |v93|, v2
  v_maximum3_f32 v2, |v94|, |v95|, v2
  v_pk_mul_f32 v[88:89], v[88:89], v[86:87] op_sel_hi:[1,0]
  v_pk_mul_f32 v[90:91], v[90:91], v[86:87] op_sel_hi:[1,0]
  v_pk_mul_f32 v[92:93], v[92:93], v[86:87] op_sel_hi:[1,0]
  v_pk_mul_f32 v[94:95], v[94:95], v[86:87] op_sel_hi:[1,0]
  v_cvt_pk_bf16_f32 v124, v88, v89
  v_cvt_pk_bf16_f32 v125, v90, v91
  v_cvt_pk_bf16_f32 v126, v92, v93
  v_cvt_pk_bf16_f32 v127, v94, v95
  s_add_u32 s46, s54, 28672
  buffer_store_dwordx4 v[124:127], v30, s[24:27], s46 offen offset:0 sc1
  v_accvgpr_read_b32 v56, a72
  v_accvgpr_read_b32 v57, a73
  v_accvgpr_read_b32 v58, a74
  v_accvgpr_read_b32 v59, a75
  v_accvgpr_read_b32 v60, a76
  v_accvgpr_read_b32 v61, a77
  v_accvgpr_read_b32 v62, a78
  v_accvgpr_read_b32 v63, a79
  v_maximum3_f32 v2, |v56|, |v57|, v2
  v_maximum3_f32 v2, |v58|, |v59|, v2
  v_maximum3_f32 v2, |v60|, |v61|, v2
  v_maximum3_f32 v2, |v62|, |v63|, v2
  v_pk_mul_f32 v[56:57], v[56:57], v[118:119] op_sel_hi:[1,0]
  v_pk_mul_f32 v[58:59], v[58:59], v[118:119] op_sel_hi:[1,0]
  v_pk_mul_f32 v[60:61], v[60:61], v[118:119] op_sel_hi:[1,0]
  v_pk_mul_f32 v[62:63], v[62:63], v[118:119] op_sel_hi:[1,0]
  v_cvt_pk_bf16_f32 v120, v56, v57
  v_cvt_pk_bf16_f32 v121, v58, v59
  v_cvt_pk_bf16_f32 v122, v60, v61
  v_cvt_pk_bf16_f32 v123, v62, v63
  s_add_u32 s46, s54, 30720
  buffer_store_dwordx4 v[120:123], v30, s[24:27], s46 offen offset:0 sc1
  v_accvgpr_read_b32 v88, a104
  v_accvgpr_read_b32 v89, a105
  v_accvgpr_read_b32 v90, a106
  v_accvgpr_read_b32 v91, a107
  v_accvgpr_read_b32 v92, a108
  v_accvgpr_read_b32 v93, a109
  v_accvgpr_read_b32 v94, a110
  v_accvgpr_read_b32 v95, a111
  v_maximum3_f32 v2, |v88|, |v89|, v2
  v_maximum3_f32 v2, |v90|, |v91|, v2
  v_maximum3_f32 v2, |v92|, |v93|, v2
  v_maximum3_f32 v2, |v94|, |v95|, v2
  v_pk_mul_f32 v[88:89], v[88:89], v[150:151] op_sel_hi:[1,0]
  v_pk_mul_f32 v[90:91], v[90:91], v[150:151] op_sel_hi:[1,0]
  v_pk_mul_f32 v[92:93], v[92:93], v[150:151] op_sel_hi:[1,0]
  v_pk_mul_f32 v[94:95], v[94:95], v[150:151] op_sel_hi:[1,0]
  v_cvt_pk_bf16_f32 v124, v88, v89
  v_cvt_pk_bf16_f32 v125, v90, v91
  v_cvt_pk_bf16_f32 v126, v92, v93
  v_cvt_pk_bf16_f32 v127, v94, v95
  s_add_u32 s46, s54, 32768
  buffer_store_dwordx4 v[124:127], v30, s[24:27], s46 offen offset:0 sc1
  v_accvgpr_read_b32 v56, a136
  v_accvgpr_read_b32 v57, a137
  v_accvgpr_read_b32 v58, a138
  v_accvgpr_read_b32 v59, a139
  v_accvgpr_read_b32 v60, a140
  v_accvgpr_read_b32 v61, a141
  v_accvgpr_read_b32 v62, a142
  v_accvgpr_read_b32 v63, a143
  v_maximum3_f32 v2, |v56|, |v57|, v2
  v_maximum3_f32 v2, |v58|, |v59|, v2
  v_maximum3_f32 v2, |v60|, |v61|, v2
  v_maximum3_f32 v2, |v62|, |v63|, v2
  v_pk_mul_f32 v[56:57], v[56:57], v[182:183] op_sel_hi:[1,0]
  v_pk_mul_f32 v[58:59], v[58:59], v[182:183] op_sel_hi:[1,0]
  v_pk_mul_f32 v[60:61], v[60:61], v[182:183] op_sel_hi:[1,0]
  v_pk_mul_f32 v[62:63], v[62:63], v[182:183] op_sel_hi:[1,0]
  v_cvt_pk_bf16_f32 v120, v56, v57
  v_cvt_pk_bf16_f32 v121, v58, v59
  v_cvt_pk_bf16_f32 v122, v60, v61
  v_cvt_pk_bf16_f32 v123, v62, v63
  s_add_u32 s46, s54, 34816
  buffer_store_dwordx4 v[120:123], v30, s[24:27], s46 offen offset:0 sc1
  v_accvgpr_read_b32 v88, a168
  v_accvgpr_read_b32 v89, a169
  v_accvgpr_read_b32 v90, a170
  v_accvgpr_read_b32 v91, a171
  v_accvgpr_read_b32 v92, a172
  v_accvgpr_read_b32 v93, a173
  v_accvgpr_read_b32 v94, a174
  v_accvgpr_read_b32 v95, a175
  v_maximum3_f32 v2, |v88|, |v89|, v2
  v_maximum3_f32 v2, |v90|, |v91|, v2
  v_maximum3_f32 v2, |v92|, |v93|, v2
  v_maximum3_f32 v2, |v94|, |v95|, v2
  v_pk_mul_f32 v[88:89], v[88:89], v[214:215] op_sel_hi:[1,0]
  v_pk_mul_f32 v[90:91], v[90:91], v[214:215] op_sel_hi:[1,0]
  v_pk_mul_f32 v[92:93], v[92:93], v[214:215] op_sel_hi:[1,0]
  v_pk_mul_f32 v[94:95], v[94:95], v[214:215] op_sel_hi:[1,0]
  v_cvt_pk_bf16_f32 v124, v88, v89
  v_cvt_pk_bf16_f32 v125, v90, v91
  v_cvt_pk_bf16_f32 v126, v92, v93
  v_cvt_pk_bf16_f32 v127, v94, v95
  s_add_u32 s46, s54, 36864
  buffer_store_dwordx4 v[124:127], v30, s[24:27], s46 offen offset:0 sc1
  s_mov_b32 s46, 2139095040
  v_cmp_ngt_f32 vcc, s46, v2
  s_cmp_lg_u32 s51, 0
  s_cbranch_scc1 L1b_ck1
  s_nop 3
  s_cbranch_vccnz L1b_fb
L1b_ck1:
L1b_epi2:
  v_lshrrev_b32 v112, 2, v1
  v_lshlrev_b32 v48, 8, v112
  v_and_b32 v112, 7, v112
  v_lshl_add_u32 v48, v112, 5, v48
  v_and_b32 v112, 3, v1
  v_lshl_add_u32 v48, v112, 3, v48
  s_lshl_b32 s46, s3, 6
  v_xor_b32 v48, s46, v48
  v_add_u32 v48, s28, v48
  v_xor_b32 v49, 32, v48
  v_xor_b32 v50, 64, v48
  v_xor_b32 v51, 96, v48
  v_xor_b32 v80, 128, v48
  v_xor_b32 v81, 160, v48
  v_xor_b32 v82, 192, v48
  v_xor_b32 v83, 224, v48
  ds_read_b64_tr_b16 a[192:193], v48 offset:16384
  ds_read_b64_tr_b16 a[194:195], v48 offset:20480
  ds_read_b64_tr_b16 a[196:197], v49 offset:16384
  ds_read_b64_tr_b16 a[198:199], v49 offset:20480
  ds_read_b64_tr_b16 a[200:201], v50 offset:16384
  ds_read_b64_tr_b16 a[202:203], v50 offset:20480
  ds_read_b64_tr_b16 a[204:205], v51 offset:16384
  ds_read_b64_tr_b16 a[206:207], v51 offset:20480
  v_accvgpr_read_b32 v56, a16
  v_accvgpr_read_b32 v57, a17
  v_accvgpr_read_b32 v58, a18
  v_accvgpr_read_b32 v59, a19
  v_accvgpr_read_b32 v60, a20
  v_accvgpr_read_b32 v61, a21
  v_accvgpr_read_b32 v62, a22
  v_accvgpr_read_b32 v63, a23
  v_maximum3_f32 v2, |v56|, |v57|, v2
  v_maximum3_f32 v2, |v58|, |v59|, v2
  v_maximum3_f32 v2, |v60|, |v61|, v2
  v_maximum3_f32 v2, |v62|, |v63|, v2
  v_pk_mul_f32 v[56:57], v[56:57], v[54:55] op_sel_hi:[1,0]
  v_pk_mul_f32 v[58:59], v[58:59], v[54:55] op_sel_hi:[1,0]
  v_pk_mul_f32 v[60:61], v[60:61], v[54:55] op_sel_hi:[1,0]
  v_pk_mul_f32 v[62:63], v[62:63], v[54:55] op_sel_hi:[1,0]
  v_cvt_pk_bf16_f32 v120, v56, v57
  v_cvt_pk_bf16_f32 v121, v58, v59
  v_cvt_pk_bf16_f32 v122, v60, v61
  v_cvt_pk_bf16_f32 v123, v62, v63
  v_accvgpr_write_b32 a0, v120
  v_accvgpr_write_b32 a1, v121
  v_accvgpr_write_b32 a2, v122
  v_accvgpr_write_b32 a3, v123
  ds_read_b64_tr_b16 a[208:209], v80 offset:16384
  ds_read_b64_tr_b16 a[210:211], v80 offset:20480
  ds_read_b64_tr_b16 a[212:213], v81 offset:16384
  ds_read_b64_tr_b16 a[214:215], v81 offset:20480
  ds_read_b64_tr_b16 a[216:217], v82 offset:16384
  ds_read_b64_tr_b16 a[218:219], v82 offset:20480
  ds_read_b64_tr_b16 a[220:221], v83 offset:16384
  s_waitcnt lgkmcnt(8)
  ds_read_b64_tr_b16 a[222:223], v83 offset:20480
  v_accvgpr_read_b32 v88, a48
  v_accvgpr_read_b32 v89, a49
  v_accvgpr_read_b32 v90, a50
  v_accvgpr_read_b32 v91, a51
  v_accvgpr_read_b32 v92, a52
  v_accvgpr_read_b32 v93, a53
  v_accvgpr_read_b32 v94, a54
  v_accvgpr_read_b32 v95, a55
  v_maximum3_f32 v2, |v88|, |v89|, v2
  v_maximum3_f32 v2, |v90|, |v91|, v2
  v_maximum3_f32 v2, |v92|, |v93|, v2
  v_maximum3_f32 v2, |v94|, |v95|, v2
  v_pk_mul_f32 v[88:89], v[88:89], v[86:87] op_sel_hi:[1,0]
  v_pk_mul_f32 v[90:91], v[90:91], v[86:87] op_sel_hi:[1,0]
  v_pk_mul_f32 v[92:93], v[92:93], v[86:87] op_sel_hi:[1,0]
  v_pk_mul_f32 v[94:95], v[94:95], v[86:87] op_sel_hi:[1,0]
  v_cvt_pk_bf16_f32 v124, v88, v89
  v_cvt_pk_bf16_f32 v125, v90, v91
  v_cvt_pk_bf16_f32 v126, v92, v93
  v_cvt_pk_bf16_f32 v127, v94, v95
  v_accvgpr_write_b32 a4, v124
  v_accvgpr_write_b32 a5, v125
  v_accvgpr_write_b32 a6, v126
  v_accvgpr_write_b32 a7, v127
  ds_read_b64_tr_b16 a[224:225], v48 offset:0
  ds_read_b64_tr_b16 a[226:227], v48 offset:4096
  ds_read_b64_tr_b16 a[228:229], v49 offset:0
  ds_read_b64_tr_b16 a[230:231], v49 offset:4096
  ds_read_b64_tr_b16 a[232:233], v50 offset:0
  ds_read_b64_tr_b16 a[234:235], v50 offset:4096
  s_waitcnt lgkmcnt(8)
  ds_read_b64_tr_b16 a[236:237], v51 offset:0
  ds_read_b64_tr_b16 a[238:239], v51 offset:4096
  v_accvgpr_read_b32 v56, a80
  v_accvgpr_read_b32 v57, a81
  v_accvgpr_read_b32 v58, a82
  v_accvgpr_read_b32 v59, a83
  v_accvgpr_read_b32 v60, a84
  v_accvgpr_read_b32 v61, a85
  v_accvgpr_read_b32 v62, a86
  v_accvgpr_read_b32 v63, a87
  v_maximum3_f32 v2, |v56|, |v57|, v2
  v_maximum3_f32 v2, |v58|, |v59|, v2
  v_maximum3_f32 v2, |v60|, |v61|, v2
  v_maximum3_f32 v2, |v62|, |v63|, v2
  v_pk_mul_f32 v[56:57], v[56:57], v[118:119] op_sel_hi:[1,0]
  v_pk_mul_f32 v[58:59], v[58:59], v[118:119] op_sel_hi:[1,0]
  v_pk_mul_f32 v[60:61], v[60:61], v[118:119] op_sel_hi:[1,0]
  v_pk_mul_f32 v[62:63], v[62:63], v[118:119] op_sel_hi:[1,0]
  v_cvt_pk_bf16_f32 v120, v56, v57
  v_cvt_pk_bf16_f32 v121, v58, v59
  v_cvt_pk_bf16_f32 v122, v60, v61
  v_cvt_pk_bf16_f32 v123, v62, v63
  v_accvgpr_write_b32 a8, v120
  v_accvgpr_write_b32 a9, v121
  v_accvgpr_write_b32 a10, v122
  v_accvgpr_write_b32 a11, v123
  ds_read_b64_tr_b16 a[240:241], v80 offset:0
  ds_read_b64_tr_b16 a[242:243], v80 offset:4096
  ds_read_b64_tr_b16 a[244:245], v81 offset:0
  ds_read_b64_tr_b16 a[246:247], v81 offset:4096
  ds_read_b64_tr_b16 a[248:249], v82 offset:0
  s_waitcnt lgkmcnt(8)
  ds_read_b64_tr_b16 a[250:251], v82 offset:4096
  ds_read_b64_tr_b16 a[252:253], v83 offset:0
  ds_read_b64_tr_b16 a[254:255], v83 offset:4096
  v_accvgpr_read_b32 v88, a112
  v_accvgpr_read_b32 v89, a113
  v_accvgpr_read_b32 v90, a114
  v_accvgpr_read_b32 v91, a115
  v_accvgpr_read_b32 v92, a116
  v_accvgpr_read_b32 v93, a117
  v_accvgpr_read_b32 v94, a118
  v_accvgpr_read_b32 v95, a119
  v_maximum3_f32 v2, |v88|, |v89|, v2
  v_maximum3_f32 v2, |v90|, |v91|, v2
  v_maximum3_f32 v2, |v92|, |v93|, v2
  v_maximum3_f32 v2, |v94|, |v95|, v2
  v_pk_mul_f32 v[88:89], v[88:89], v[150:151] op_sel_hi:[1,0]
  v_pk_mul_f32 v[90:91], v[90:91], v[150:151] op_sel_hi:[1,0]
  v_pk_mul_f32 v[92:93], v[92:93], v[150:151] op_sel_hi:[1,0]
  v_pk_mul_f32 v[94:95], v[94:95], v[150:151] op_sel_hi:[1,0]
  v_cvt_pk_bf16_f32 v124, v88, v89
  v_cvt_pk_bf16_f32 v125, v90, v91
  v_cvt_pk_bf16_f32 v126, v92, v93
  v_cvt_pk_bf16_f32 v127, v94, v95
  v_accvgpr_write_b32 a12, v124
  v_accvgpr_write_b32 a13, v125
  v_accvgpr_write_b32 a14, v126
  v_accvgpr_write_b32 a15, v127
  v_accvgpr_read_b32 v56, a144
  v_accvgpr_read_b32 v57, a145
  v_accvgpr_read_b32 v58, a146
  v_accvgpr_read_b32 v59, a147
  v_accvgpr_read_b32 v60, a148
  v_accvgpr_read_b32 v61, a149
  v_accvgpr_read_b32 v62, a150
  v_accvgpr_read_b32 v63, a151
  v_maximum3_f32 v2, |v56|, |v57|, v2
  v_maximum3_f32 v2, |v58|, |v59|, v2
  v_maximum3_f32 v2, |v60|, |v61|, v2
  v_maximum3_f32 v2, |v62|, |v63|, v2
  v_pk_mul_f32 v[56:57], v[56:57], v[182:183] op_sel_hi:[1,0]
  v_pk_mul_f32 v[58:59], v[58:59], v[182:183] op_sel_hi:[1,0]
  v_pk_mul_f32 v[60:61], v[60:61], v[182:183] op_sel_hi:[1,0]
  v_pk_mul_f32 v[62:63], v[62:63], v[182:183] op_sel_hi:[1,0]
  v_cvt_pk_bf16_f32 v120, v56, v57
  v_cvt_pk_bf16_f32 v121, v58, v59
  v_cvt_pk_bf16_f32 v122, v60, v61
  v_cvt_pk_bf16_f32 v123, v62, v63
  v_accvgpr_write_b32 a32, v120
  v_accvgpr_write_b32 a33, v121
  v_accvgpr_write_b32 a34, v122
  v_accvgpr_write_b32 a35, v123
  v_accvgpr_read_b32 v88, a176
  v_accvgpr_read_b32 v89, a177
  v_accvgpr_read_b32 v90, a178
  v_accvgpr_read_b32 v91, a179
  v_accvgpr_read_b32 v92, a180
  v_accvgpr_read_b32 v93, a181
  v_accvgpr_read_b32 v94, a182
  v_accvgpr_read_b32 v95, a183
  v_maximum3_f32 v2, |v88|, |v89|, v2
  v_maximum3_f32 v2, |v90|, |v91|, v2
  v_maximum3_f32 v2, |v92|, |v93|, v2
  v_maximum3_f32 v2, |v94|, |v95|, v2
  v_pk_mul_f32 v[88:89], v[88:89], v[214:215] op_sel_hi:[1,0]
  v_pk_mul_f32 v[90:91], v[90:91], v[214:215] op_sel_hi:[1,0]
  v_pk_mul_f32 v[92:93], v[92:93], v[214:215] op_sel_hi:[1,0]
  v_pk_mul_f32 v[94:95], v[94:95], v[214:215] op_sel_hi:[1,0]
  v_cvt_pk_bf16_f32 v124, v88, v89
  v_cvt_pk_bf16_f32 v125, v90, v91
  v_cvt_pk_bf16_f32 v126, v92, v93
  v_cvt_pk_bf16_f32 v127, v94, v95
  v_accvgpr_write_b32 a36, v124
  v_accvgpr_write_b32 a37, v125
  v_accvgpr_write_b32 a38, v126
  v_accvgpr_write_b32 a39, v127
  s_cmp_lg_u32 s37, 0
  s_cbranch_scc1 L1b_epi3
  s_waitcnt vmcnt(0)
  s_barrier
  s_mov_b32 s37, 1
L1b_epi3:
  s_waitcnt lgkmcnt(0)
  s_add_u32 m0, s28, 16384
  s_add_u32 s38, s30, 524288
  buffer_load_dwordx4 v7, s[12:15], s38 offen offset:0 sc1 lds
  s_add_u32 m0, s28, 16384
  s_add_u32 s38, s30, 524288
  buffer_load_dwordx4 v8, s[12:15], s38 offen offset:1024 sc1 lds
  s_add_u32 m0, s28, 16384
  s_add_u32 s38, s30, 524288
  buffer_load_dwordx4 v9, s[12:15], s38 offen offset:2048 sc1 lds
  s_add_u32 m0, s28, 16384
  s_add_u32 s38, s30, 524288
  buffer_load_dwordx4 v10, s[12:15], s38 offen offset:3072 sc1 lds
  v_accvgpr_read_b32 v56, a24
  v_accvgpr_read_b32 v57, a25
  v_accvgpr_read_b32 v58, a26
  v_accvgpr_read_b32 v59, a27
  v_accvgpr_read_b32 v60, a28
  v_accvgpr_read_b32 v61, a29
  v_accvgpr_read_b32 v62, a30
  v_accvgpr_read_b32 v63, a31
  v_maximum3_f32 v2, |v56|, |v57|, v2
  v_maximum3_f32 v2, |v58|, |v59|, v2
  v_maximum3_f32 v2, |v60|, |v61|, v2
  v_maximum3_f32 v2, |v62|, |v63|, v2
  v_pk_mul_f32 v[56:57], v[56:57], v[54:55] op_sel_hi:[1,0]
  v_pk_mul_f32 v[58:59], v[58:59], v[54:55] op_sel_hi:[1,0]
  v_pk_mul_f32 v[60:61], v[60:61], v[54:55] op_sel_hi:[1,0]
  v_pk_mul_f32 v[62:63], v[62:63], v[54:55] op_sel_hi:[1,0]
  v_cvt_pk_bf16_f32 v120, v56, v57
  v_cvt_pk_bf16_f32 v121, v58, v59
  v_cvt_pk_bf16_f32 v122, v60, v61
  v_cvt_pk_bf16_f32 v123, v62, v63
  v_accvgpr_write_b32 a44, v120
  v_accvgpr_write_b32 a45, v121
  v_accvgpr_write_b32 a46, v122
  v_accvgpr_write_b32 a47, v123
  s_add_u32 m0, s28, 20480
  s_add_u32 s38, s30, 557056
  buffer_load_dwordx4 v7, s[12:15], s38 offen offset:0 sc1 lds
  s_add_u32 m0, s28, 20480
  s_add_u32 s38, s30, 557056
  buffer_load_dwordx4 v8, s[12:15], s38 offen offset:1024 sc1 lds
  s_add_u32 m0, s28, 20480
  s_add_u32 s38, s30, 557056
  buffer_load_dwordx4 v9, s[12:15], s38 offen offset:2048 sc1 lds
  s_add_u32 m0, s28, 20480
  s_add_u32 s38, s30, 557056
  buffer_load_dwordx4 v10, s[12:15], s38 offen offset:3072 sc1 lds
  v_accvgpr_read_b32 v88, a56
  v_accvgpr_read_b32 v89, a57
  v_accvgpr_read_b32 v90, a58
  v_accvgpr_read_b32 v91, a59
  v_accvgpr_read_b32 v92, a60
  v_accvgpr_read_b32 v93, a61
  v_accvgpr_read_b32 v94, a62
  v_accvgpr_read_b32 v95, a63
  v_maximum3_f32 v2, |v88|, |v89|, v2
  v_maximum3_f32 v2, |v90|, |v91|, v2
  v_maximum3_f32 v2, |v92|, |v93|, v2
  v_maximum3_f32 v2, |v94|, |v95|, v2
  v_pk_mul_f32 v[88:89], v[88:89], v[86:87] op_sel_hi:[1,0]
  v_pk_mul_f32 v[90:91], v[90:91], v[86:87] op_sel_hi:[1,0]
  v_pk_mul_f32 v[92:93], v[92:93], v[86:87] op_sel_hi:[1,0]
  v_pk_mul_f32 v[94:95], v[94:95], v[86:87] op_sel_hi:[1,0]
  v_cvt_pk_bf16_f32 v124, v88, v89
  v_cvt_pk_bf16_f32 v125, v90, v91
  v_cvt_pk_bf16_f32 v126, v92, v93
  v_cvt_pk_bf16_f32 v127, v94, v95
  v_accvgpr_write_b32 a64, v124
  v_accvgpr_write_b32 a65, v125
  v_accvgpr_write_b32 a66, v126
  v_accvgpr_write_b32 a67, v127
  s_add_u32 m0, s28, 0
  s_add_u32 s38, s30, 589824
  buffer_load_dwordx4 v7, s[12:15], s38 offen offset:0 sc1 lds
  s_add_u32 m0, s28, 0
  s_add_u32 s38, s30, 589824
  buffer_load_dwordx4 v8, s[12:15], s38 offen offset:1024 sc1 lds
  s_add_u32 m0, s28, 0
  s_add_u32 s38, s30, 589824
  buffer_load_dwordx4 v9, s[12:15], s38 offen offset:2048 sc1 lds
  s_add_u32 m0, s28, 0
  s_add_u32 s38, s30, 589824
  buffer_load_dwordx4 v10, s[12:15], s38 offen offset:3072 sc1 lds
  v_accvgpr_read_b32 v56, a88
  v_accvgpr_read_b32 v57, a89
  v_accvgpr_read_b32 v58, a90
  v_accvgpr_read_b32 v59, a91
  v_accvgpr_read_b32 v60, a92
  v_accvgpr_read_b32 v61, a93
  v_accvgpr_read_b32 v62, a94
  v_accvgpr_read_b32 v63, a95
  v_maximum3_f32 v2, |v56|, |v57|, v2
  v_maximum3_f32 v2, |v58|, |v59|, v2
  v_maximum3_f32 v2, |v60|, |v61|, v2
  v_maximum3_f32 v2, |v62|, |v63|, v2
  v_pk_mul_f32 v[56:57], v[56:57], v[118:119] op_sel_hi:[1,0]
  v_pk_mul_f32 v[58:59], v[58:59], v[118:119] op_sel_hi:[1,0]
  v_pk_mul_f32 v[60:61], v[60:61], v[118:119] op_sel_hi:[1,0]
  v_pk_mul_f32 v[62:63], v[62:63], v[118:119] op_sel_hi:[1,0]
  v_cvt_pk_bf16_f32 v120, v56, v57
  v_cvt_pk_bf16_f32 v121, v58, v59
  v_cvt_pk_bf16_f32 v122, v60, v61
  v_cvt_pk_bf16_f32 v123, v62, v63
  v_accvgpr_write_b32 a68, v120
  v_accvgpr_write_b32 a69, v121
  v_accvgpr_write_b32 a70, v122
  v_accvgpr_write_b32 a71, v123
  s_add_u32 m0, s28, 4096
  s_add_u32 s38, s30, 622592
  buffer_load_dwordx4 v7, s[12:15], s38 offen offset:0 sc1 lds
  s_add_u32 m0, s28, 4096
  s_add_u32 s38, s30, 622592
  buffer_load_dwordx4 v8, s[12:15], s38 offen offset:1024 sc1 lds
  s_add_u32 m0, s28, 4096
  s_add_u32 s38, s30, 622592
  buffer_load_dwordx4 v9, s[12:15], s38 offen offset:2048 sc1 lds
  s_add_u32 m0, s28, 4096
  s_add_u32 s38, s30, 622592
  buffer_load_dwordx4 v10, s[12:15], s38 offen offset:3072 sc1 lds
  v_accvgpr_read_b32 v88, a120
  v_accvgpr_read_b32 v89, a121
  v_accvgpr_read_b32 v90, a122
  v_accvgpr_read_b32 v91, a123
  v_accvgpr_read_b32 v92, a124
  v_accvgpr_read_b32 v93, a125
  v_accvgpr_read_b32 v94, a126
  v_accvgpr_read_b32 v95, a127
  v_maximum3_f32 v2, |v88|, |v89|, v2
  v_maximum3_f32 v2, |v90|, |v91|, v2
  v_maximum3_f32 v2, |v92|, |v93|, v2
  v_maximum3_f32 v2, |v94|, |v95|, v2
  v_pk_mul_f32 v[88:89], v[88:89], v[150:151] op_sel_hi:[1,0]
  v_pk_mul_f32 v[90:91], v[90:91], v[150:151] op_sel_hi:[1,0]
  v_pk_mul_f32 v[92:93], v[92:93], v[150:151] op_sel_hi:[1,0]
  v_pk_mul_f32 v[94:95], v[94:95], v[150:151] op_sel_hi:[1,0]
  v_cvt_pk_bf16_f32 v124, v88, v89
  v_cvt_pk_bf16_f32 v125, v90, v91
  v_cvt_pk_bf16_f32 v126, v92, v93
  v_cvt_pk_bf16_f32 v127, v94, v95
  v_accvgpr_write_b32 a72, v124
  v_accvgpr_write_b32 a73, v125
  v_accvgpr_write_b32 a74, v126
  v_accvgpr_write_b32 a75, v127
  v_accvgpr_read_b32 v56, a152
  v_accvgpr_read_b32 v57, a153
  v_accvgpr_read_b32 v58, a154
  v_accvgpr_read_b32 v59, a155
  v_accvgpr_read_b32 v60, a156
  v_accvgpr_read_b32 v61, a157
  v_accvgpr_read_b32 v62, a158
  v_accvgpr_read_b32 v63, a159
  v_maximum3_f32 v2, |v56|, |v57|, v2
  v_maximum3_f32 v2, |v58|, |v59|, v2
  v_maximum3_f32 v2, |v60|, |v61|, v2
  v_maximum3_f32 v2, |v62|, |v63|, v2
  v_pk_mul_f32 v[56:57], v[56:57], v[182:183] op_sel_hi:[1,0]
  v_pk_mul_f32 v[58:59], v[58:59], v[182:183] op_sel_hi:[1,0]
  v_pk_mul_f32 v[60:61], v[60:61], v[182:183] op_sel_hi:[1,0]
  v_pk_mul_f32 v[62:63], v[62:63], v[182:183] op_sel_hi:[1,0]
  v_cvt_pk_bf16_f32 v120, v56, v57
  v_cvt_pk_bf16_f32 v121, v58, v59
  v_cvt_pk_bf16_f32 v122, v60, v61
  v_cvt_pk_bf16_f32 v123, v62, v63
  v_accvgpr_write_b32 a76, v120
  v_accvgpr_write_b32 a77, v121
  v_accvgpr_write_b32 a78, v122
  v_accvgpr_write_b32 a79, v123
  global_load_dwordx4 v[24:27], v11, s[98:99] sc1
  v_accvgpr_read_b32 v88, a184
  v_accvgpr_read_b32 v89, a185
  v_accvgpr_read_b32 v90, a186
  v_accvgpr_read_b32 v91, a187
  v_accvgpr_read_b32 v92, a188
  v_accvgpr_read_b32 v93, a189
  v_accvgpr_read_b32 v94, a190
  v_accvgpr_read_b32 v95, a191
  v_maximum3_f32 v2, |v88|, |v89|, v2
  v_maximum3_f32 v2, |v90|, |v91|, v2
  v_maximum3_f32 v2, |v92|, |v93|, v2
  v_maximum3_f32 v2, |v94|, |v95|, v2
  v_pk_mul_f32 v[88:89], v[88:89], v[214:215] op_sel_hi:[1,0]
  v_pk_mul_f32 v[90:91], v[90:91], v[214:215] op_sel_hi:[1,0]
  v_pk_mul_f32 v[92:93], v[92:93], v[214:215] op_sel_hi:[1,0]
  v_pk_mul_f32 v[94:95], v[94:95], v[214:215] op_sel_hi:[1,0]
  v_cvt_pk_bf16_f32 v124, v88, v89
  v_cvt_pk_bf16_f32 v125, v90, v91
  v_cvt_pk_bf16_f32 v126, v92, v93
  v_cvt_pk_bf16_f32 v127, v94, v95
  v_accvgpr_write_b32 a96, v124
  v_accvgpr_write_b32 a97, v125
  v_accvgpr_write_b32 a98, v126
  v_accvgpr_write_b32 a99, v127
  s_mov_b32 s46, 2139095040
  v_cmp_ngt_f32 vcc, s46, v2
  s_cmp_lg_u32 s51, 0
  s_cbranch_scc1 L1b_ck2
  s_nop 3
  s_cbranch_vccnz L1b_fb
L1b_ck2:
  s_waitcnt vmcnt(0)
  s_branch L1_done
L1b_fb:
  s_waitcnt vmcnt(0) lgkmcnt(0)
  s_mov_b32 s51, 1
  v_xor_b32 v31, 4224, v6
  v_and_b32 v13, 0xffff9fff, v13
  v_and_b32 v14, 0xffff9fff, v14
  v_and_b32 v15, 0xffff9fff, v15
  v_and_b32 v16, 0xffff9fff, v16
  v_and_b32 v17, 0xffff9fff, v17
  v_and_b32 v18, 0xffff9fff, v18
  v_and_b32 v19, 0xffff9fff, v19
  v_and_b32 v20, 0xffff9fff, v20
  v_and_b32 v21, 0xffff9fff, v21
  v_and_b32 v22, 0xffff9fff, v22
  v_and_b32 v23, 0xffff9fff, v23
  v_and_b32 v28, 0xffff9fff, v28
  s_lshl_b32 s40, s3, 13
  s_add_u32 s40, s40, 131072
  s_sub_u32 s46, s40, s41
  v_add_u32 v13, s46, v13
  v_add_u32 v14, s46, v14
  v_add_u32 v15, s46, v15
  v_add_u32 v16, s46, v16
  s_sub_u32 s46, s46, 32768
  v_add_u32 v17, s46, v17
  v_add_u32 v18, s46, v18
  v_add_u32 v19, s46, v19
  v_add_u32 v20, s46, v20
  v_add_u32 v21, s46, v21
  v_add_u32 v22, s46, v22
  v_add_u32 v23, s46, v23
  v_add_u32 v28, s46, v28
  v_mov_b32 v52, 0xff800000
  v_mov_b32 v84, 0xff800000
  v_mov_b32 v116, 0xff800000
  v_mov_b32 v148, 0xff800000
  v_mov_b32 v180, 0xff800000
  v_mov_b32 v212, 0xff800000
  s_mov_b32 s45, 0
L1b_fb1:
  s_add_u32 m0, s40, 0
  s_nop 0
  buffer_load_dwordx4 v6, s[16:19], s45 offen offset:0 nt lds
  buffer_load_dwordx4 v6, s[16:19], s45 offen offset:1024 nt lds
  buffer_load_dwordx4 v6, s[16:19], s45 offen offset:2048 nt lds
  buffer_load_dwordx4 v6, s[16:19], s45 offen offset:3072 nt lds
  s_add_u32 m0, s40, 4096
  s_nop 0
  buffer_load_dwordx4 v31, s[16:19], s45 offen offset:0 nt lds
  buffer_load_dwordx4 v31, s[16:19], s45 offen offset:1024 nt lds
  buffer_load_dwordx4 v31, s[16:19], s45 offen offset:2048 nt lds
  buffer_load_dwordx4 v31, s[16:19], s45 offen offset:3072 nt lds
  s_waitcnt vmcnt(0)
  ds_read_b128 a[192:195], v13 offset:0
  ds_read_b128 a[196:199], v14 offset:0
  ds_read_b128 a[200:203], v15 offset:0
  ds_read_b128 a[204:207], v16 offset:0
  ds_read_b128 a[208:211], v13 offset:2048
  ds_read_b128 a[212:215], v14 offset:2048
  ds_read_b128 a[216:219], v15 offset:2048
  ds_read_b128 a[220:223], v16 offset:2048
  s_waitcnt lgkmcnt(0)
  v_mfma_f32_16x16x32_bf16 v[56:59], a[192:195], v[32:35], 0
  v_mfma_f32_16x16x32_bf16 v[56:59], a[196:199], v[36:39], v[56:59]
  v_mfma_f32_16x16x32_bf16 v[56:59], a[200:203], v[40:43], v[56:59]
  v_mfma_f32_16x16x32_bf16 v[56:59], a[204:207], v[44:47], v[56:59]
  v_mfma_f32_16x16x32_bf16 v[60:63], a[208:211], v[32:35], 0
  v_mfma_f32_16x16x32_bf16 v[60:63], a[212:215], v[36:39], v[60:63]
  v_mfma_f32_16x16x32_bf16 v[60:63], a[216:219], v[40:43], v[60:63]
  v_mfma_f32_16x16x32_bf16 v[60:63], a[220:223], v[44:47], v[60:63]
  s_nop 7
  v_max3_f32 v52, v52, v56, v57
  v_max3_f32 v52, v52, v58, v59
  v_max3_f32 v52, v52, v60, v61
  v_max3_f32 v52, v52, v62, v63
  v_mfma_f32_16x16x32_bf16 v[88:91], a[192:195], v[64:67], 0
  v_mfma_f32_16x16x32_bf16 v[88:91], a[196:199], v[68:71], v[88:91]
  v_mfma_f32_16x16x32_bf16 v[88:91], a[200:203], v[72:75], v[88:91]
  v_mfma_f32_16x16x32_bf16 v[88:91], a[204:207], v[76:79], v[88:91]
  v_mfma_f32_16x16x32_bf16 v[92:95], a[208:211], v[64:67], 0
  v_mfma_f32_16x16x32_bf16 v[92:95], a[212:215], v[68:71], v[92:95]
  v_mfma_f32_16x16x32_bf16 v[92:95], a[216:219], v[72:75], v[92:95]
  v_mfma_f32_16x16x32_bf16 v[92:95], a[220:223], v[76:79], v[92:95]
  s_nop 7
  v_max3_f32 v84, v84, v88, v89
  v_max3_f32 v84, v84, v90, v91
  v_max3_f32 v84, v84, v92, v93
  v_max3_f32 v84, v84, v94, v95
  v_mfma_f32_16x16x32_bf16 v[56:59], a[192:195], v[96:99], 0
  v_mfma_f32_16x16x32_bf16 v[56:59], a[196:199], v[100:103], v[56:59]
  v_mfma_f32_16x16x32_bf16 v[56:59], a[200:203], v[104:107], v[56:59]
  v_mfma_f32_16x16x32_bf16 v[56:59], a[204:207], v[108:111], v[56:59]
  v_mfma_f32_16x16x32_bf16 v[60:63], a[208:211], v[96:99], 0
  v_mfma_f32_16x16x32_bf16 v[60:63], a[212:215], v[100:103], v[60:63]
  v_mfma_f32_16x16x32_bf16 v[60:63], a[216:219], v[104:107], v[60:63]
  v_mfma_f32_16x16x32_bf16 v[60:63], a[220:223], v[108:111], v[60:63]
  s_nop 7
  v_max3_f32 v116, v116, v56, v57
  v_max3_f32 v116, v116, v58, v59
  v_max3_f32 v116, v116, v60, v61
  v_max3_f32 v116, v116, v62, v63
  v_mfma_f32_16x16x32_bf16 v[88:91], a[192:195], v[128:131], 0
  v_mfma_f32_16x16x32_bf16 v[88:91], a[196:199], v[132:135], v[88:91]
  v_mfma_f32_16x16x32_bf16 v[88:91], a[200:203], v[136:139], v[88:91]
  v_mfma_f32_16x16x32_bf16 v[88:91], a[204:207], v[140:143], v[88:91]
  v_mfma_f32_16x16x32_bf16 v[92:95], a[208:211], v[128:131], 0
  v_mfma_f32_16x16x32_bf16 v[92:95], a[212:215], v[132:135], v[92:95]
  v_mfma_f32_16x16x32_bf16 v[92:95], a[216:219], v[136:139], v[92:95]
  v_mfma_f32_16x16x32_bf16 v[92:95], a[220:223], v[140:143], v[92:95]
  s_nop 7
  v_max3_f32 v148, v148, v88, v89
  v_max3_f32 v148, v148, v90, v91
  v_max3_f32 v148, v148, v92, v93
  v_max3_f32 v148, v148, v94, v95
  v_mfma_f32_16x16x32_bf16 v[56:59], a[192:195], v[160:163], 0
  v_mfma_f32_16x16x32_bf16 v[56:59], a[196:199], v[164:167], v[56:59]
  v_mfma_f32_16x16x32_bf16 v[56:59], a[200:203], v[168:171], v[56:59]
  v_mfma_f32_16x16x32_bf16 v[56:59], a[204:207], v[172:175], v[56:59]
  v_mfma_f32_16x16x32_bf16 v[60:63], a[208:211], v[160:163], 0
  v_mfma_f32_16x16x32_bf16 v[60:63], a[212:215], v[164:167], v[60:63]
  v_mfma_f32_16x16x32_bf16 v[60:63], a[216:219], v[168:171], v[60:63]
  v_mfma_f32_16x16x32_bf16 v[60:63], a[220:223], v[172:175], v[60:63]
  s_nop 7
  v_max3_f32 v180, v180, v56, v57
  v_max3_f32 v180, v180, v58, v59
  v_max3_f32 v180, v180, v60, v61
  v_max3_f32 v180, v180, v62, v63
  v_mfma_f32_16x16x32_bf16 v[88:91], a[192:195], v[192:195], 0
  v_mfma_f32_16x16x32_bf16 v[88:91], a[196:199], v[196:199], v[88:91]
  v_mfma_f32_16x16x32_bf16 v[88:91], a[200:203], v[200:203], v[88:91]
  v_mfma_f32_16x16x32_bf16 v[88:91], a[204:207], v[204:207], v[88:91]
  v_mfma_f32_16x16x32_bf16 v[92:95], a[208:211], v[192:195], 0
  v_mfma_f32_16x16x32_bf16 v[92:95], a[212:215], v[196:199], v[92:95]
  v_mfma_f32_16x16x32_bf16 v[92:95], a[216:219], v[200:203], v[92:95]
  v_mfma_f32_16x16x32_bf16 v[92:95], a[220:223], v[204:207], v[92:95]
  s_nop 7
  v_max3_f32 v212, v212, v88, v89
  v_max3_f32 v212, v212, v90, v91
  v_max3_f32 v212, v212, v92, v93
  v_max3_f32 v212, v212, v94, v95
  s_add_u32 s45, s45, 8192
  s_cmp_lt_u32 s45, 262144
  s_cbranch_scc1 L1b_fb1
  v_mov_b32 v53, v52
  v_mov_b32 v85, v84
  v_mov_b32 v117, v116
  v_mov_b32 v149, v148
  v_mov_b32 v181, v180
  v_mov_b32 v213, v212
  s_nop 1
  v_permlane16_swap_b32 v52, v53
  v_permlane16_swap_b32 v84, v85
  v_permlane16_swap_b32 v116, v117
  v_permlane16_swap_b32 v148, v149
  v_permlane16_swap_b32 v180, v181
  v_permlane16_swap_b32 v212, v213
  s_nop 0
  v_max_f32 v52, v52, v53
  v_max_f32 v84, v84, v85
  v_max_f32 v116, v116, v117
  v_max_f32 v148, v148, v149
  v_max_f32 v180, v180, v181
  v_max_f32 v212, v212, v213
  v_mov_b32 v53, v52
  v_mov_b32 v85, v84
  v_mov_b32 v117, v116
  v_mov_b32 v149, v148
  v_mov_b32 v181, v180
  v_mov_b32 v213, v212
  s_nop 1
  v_permlane32_swap_b32 v52, v53
  v_permlane32_swap_b32 v84, v85
  v_permlane32_swap_b32 v116, v117
  v_permlane32_swap_b32 v148, v149
  v_permlane32_swap_b32 v180, v181
  v_permlane32_swap_b32 v212, v213
  s_nop 0
  v_max_f32 v52, v52, v53
  v_max_f32 v84, v84, v85
  v_max_f32 v116, v116, v117
  v_max_f32 v148, v148, v149
  v_max_f32 v180, v180, v181
  v_max_f32 v212, v212, v213
  v_sub_f32 v48, 0, v52
  v_sub_f32 v49, 0, v52
  v_sub_f32 v50, 0, v52
  v_sub_f32 v51, 0, v52
  v_sub_f32 v80, 0, v84
  v_sub_f32 v81, 0, v84
  v_sub_f32 v82, 0, v84
  v_sub_f32 v83, 0, v84
  v_sub_f32 v112, 0, v116
  v_sub_f32 v113, 0, v116
  v_sub_f32 v114, 0, v116
  v_sub_f32 v115, 0, v116
  v_sub_f32 v144, 0, v148
  v_sub_f32 v145, 0, v148
  v_sub_f32 v146, 0, v148
  v_sub_f32 v147, 0, v148
  v_sub_f32 v176, 0, v180
  v_sub_f32 v177, 0, v180
  v_sub_f32 v178, 0, v180
  v_sub_f32 v179, 0, v180
  v_sub_f32 v208, 0, v212
  v_sub_f32 v209, 0, v212
  v_sub_f32 v210, 0, v212
  v_sub_f32 v211, 0, v212
  v_mov_b32 v52, 0
  v_mov_b32 v84, 0
  v_mov_b32 v116, 0
  v_mov_b32 v148, 0
  v_mov_b32 v180, 0
  v_mov_b32 v212, 0
  v_accvgpr_write_b32 a0, 0
  v_accvgpr_write_b32 a1, 0
  v_accvgpr_write_b32 a2, 0
  v_accvgpr_write_b32 a3, 0
  v_accvgpr_write_b32 a4, 0
  v_accvgpr_write_b32 a5, 0
  v_accvgpr_write_b32 a6, 0
  v_accvgpr_write_b32 a7, 0
  v_accvgpr_write_b32 a8, 0
  v_accvgpr_write_b32 a9, 0
  v_accvgpr_write_b32 a10, 0
  v_accvgpr_write_b32 a11, 0
  v_accvgpr_write_b32 a12, 0
  v_accvgpr_write_b32 a13, 0
  v_accvgpr_write_b32 a14, 0
  v_accvgpr_write_b32 a15, 0
  v_accvgpr_write_b32 a16, 0
  v_accvgpr_write_b32 a17, 0
  v_accvgpr_write_b32 a18, 0
  v_accvgpr_write_b32 a19, 0
  v_accvgpr_write_b32 a20, 0
  v_accvgpr_write_b32 a21, 0
  v_accvgpr_write_b32 a22, 0
  v_accvgpr_write_b32 a23, 0
  v_accvgpr_write_b32 a24, 0
  v_accvgpr_write_b32 a25, 0
  v_accvgpr_write_b32 a26, 0
  v_accvgpr_write_b32 a27, 0
  v_accvgpr_write_b32 a28, 0
  v_accvgpr_write_b32 a29, 0
  v_accvgpr_write_b32 a30, 0
  v_accvgpr_write_b32 a31, 0
  v_accvgpr_write_b32 a32, 0
  v_accvgpr_write_b32 a33, 0
  v_accvgpr_write_b32 a34, 0
  v_accvgpr_write_b32 a35, 0
  v_accvgpr_write_b32 a36, 0
  v_accvgpr_write_b32 a37, 0
  v_accvgpr_write_b32 a38, 0
  v_accvgpr_write_b32 a39, 0
  v_accvgpr_write_b32 a40, 0
  v_accvgpr_write_b32 a41, 0
  v_accvgpr_write_b32 a42, 0
  v_accvgpr_write_b32 a43, 0
  v_accvgpr_write_b32 a44, 0
  v_accvgpr_write_b32 a45, 0
  v_accvgpr_write_b32 a46, 0
  v_accvgpr_write_b32 a47, 0
  v_accvgpr_write_b32 a48, 0
  v_accvgpr_write_b32 a49, 0
  v_accvgpr_write_b32 a50, 0
  v_accvgpr_write_b32 a51, 0
  v_accvgpr_write_b32 a52, 0
  v_accvgpr_write_b32 a53, 0
  v_accvgpr_write_b32 a54, 0
  v_accvgpr_write_b32 a55, 0
  v_accvgpr_write_b32 a56, 0
  v_accvgpr_write_b32 a57, 0
  v_accvgpr_write_b32 a58, 0
  v_accvgpr_write_b32 a59, 0
  v_accvgpr_write_b32 a60, 0
  v_accvgpr_write_b32 a61, 0
  v_accvgpr_write_b32 a62, 0
  v_accvgpr_write_b32 a63, 0
  v_accvgpr_write_b32 a64, 0
  v_accvgpr_write_b32 a65, 0
  v_accvgpr_write_b32 a66, 0
  v_accvgpr_write_b32 a67, 0
  v_accvgpr_write_b32 a68, 0
  v_accvgpr_write_b32 a69, 0
  v_accvgpr_write_b32 a70, 0
  v_accvgpr_write_b32 a71, 0
  v_accvgpr_write_b32 a72, 0
  v_accvgpr_write_b32 a73, 0
  v_accvgpr_write_b32 a74, 0
  v_accvgpr_write_b32 a75, 0
  v_accvgpr_write_b32 a76, 0
  v_accvgpr_write_b32 a77, 0
  v_accvgpr_write_b32 a78, 0
  v_accvgpr_write_b32 a79, 0
  v_accvgpr_write_b32 a80, 0
  v_accvgpr_write_b32 a81, 0
  v_accvgpr_write_b32 a82, 0
  v_accvgpr_write_b32 a83, 0
  v_accvgpr_write_b32 a84, 0
  v_accvgpr_write_b32 a85, 0
  v_accvgpr_write_b32 a86, 0
  v_accvgpr_write_b32 a87, 0
  v_accvgpr_write_b32 a88, 0
  v_accvgpr_write_b32 a89, 0
  v_accvgpr_write_b32 a90, 0
  v_accvgpr_write_b32 a91, 0
  v_accvgpr_write_b32 a92, 0
  v_accvgpr_write_b32 a93, 0
  v_accvgpr_write_b32 a94, 0
  v_accvgpr_write_b32 a95, 0
  v_accvgpr_write_b32 a96, 0
  v_accvgpr_write_b32 a97, 0
  v_accvgpr_write_b32 a98, 0
  v_accvgpr_write_b32 a99, 0
  v_accvgpr_write_b32 a100, 0
  v_accvgpr_write_b32 a101, 0
  v_accvgpr_write_b32 a102, 0
  v_accvgpr_write_b32 a103, 0
  v_accvgpr_write_b32 a104, 0
  v_accvgpr_write_b32 a105, 0
  v_accvgpr_write_b32 a106, 0
  v_accvgpr_write_b32 a107, 0
  v_accvgpr_write_b32 a108, 0
  v_accvgpr_write_b32 a109, 0
  v_accvgpr_write_b32 a110, 0
  v_accvgpr_write_b32 a111, 0
  v_accvgpr_write_b32 a112, 0
  v_accvgpr_write_b32 a113, 0
  v_accvgpr_write_b32 a114, 0
  v_accvgpr_write_b32 a115, 0
  v_accvgpr_write_b32 a116, 0
  v_accvgpr_write_b32 a117, 0
  v_accvgpr_write_b32 a118, 0
  v_accvgpr_write_b32 a119, 0
  v_accvgpr_write_b32 a120, 0
  v_accvgpr_write_b32 a121, 0
  v_accvgpr_write_b32 a122, 0
  v_accvgpr_write_b32 a123, 0
  v_accvgpr_write_b32 a124, 0
  v_accvgpr_write_b32 a125, 0
  v_accvgpr_write_b32 a126, 0
  v_accvgpr_write_b32 a127, 0
  v_accvgpr_write_b32 a128, 0
  v_accvgpr_write_b32 a129, 0
  v_accvgpr_write_b32 a130, 0
  v_accvgpr_write_b32 a131, 0
  v_accvgpr_write_b32 a132, 0
  v_accvgpr_write_b32 a133, 0
  v_accvgpr_write_b32 a134, 0
  v_accvgpr_write_b32 a135, 0
  v_accvgpr_write_b32 a136, 0
  v_accvgpr_write_b32 a137, 0
  v_accvgpr_write_b32 a138, 0
  v_accvgpr_write_b32 a139, 0
  v_accvgpr_write_b32 a140, 0
  v_accvgpr_write_b32 a141, 0
  v_accvgpr_write_b32 a142, 0
  v_accvgpr_write_b32 a143, 0
  v_accvgpr_write_b32 a144, 0
  v_accvgpr_write_b32 a145, 0
  v_accvgpr_write_b32 a146, 0
  v_accvgpr_write_b32 a147, 0
  v_accvgpr_write_b32 a148, 0
  v_accvgpr_write_b32 a149, 0
  v_accvgpr_write_b32 a150, 0
  v_accvgpr_write_b32 a151, 0
  v_accvgpr_write_b32 a152, 0
  v_accvgpr_write_b32 a153, 0
  v_accvgpr_write_b32 a154, 0
  v_accvgpr_write_b32 a155, 0
  v_accvgpr_write_b32 a156, 0
  v_accvgpr_write_b32 a157, 0
  v_accvgpr_write_b32 a158, 0
  v_accvgpr_write_b32 a159, 0
  v_accvgpr_write_b32 a160, 0
  v_accvgpr_write_b32 a161, 0
  v_accvgpr_write_b32 a162, 0
  v_accvgpr_write_b32 a163, 0
  v_accvgpr_write_b32 a164, 0
  v_accvgpr_write_b32 a165, 0
  v_accvgpr_write_b32 a166, 0
  v_accvgpr_write_b32 a167, 0
  v_accvgpr_write_b32 a168, 0
  v_accvgpr_write_b32 a169, 0
  v_accvgpr_write_b32 a170, 0
  v_accvgpr_write_b32 a171, 0
  v_accvgpr_write_b32 a172, 0
  v_accvgpr_write_b32 a173, 0
  v_accvgpr_write_b32 a174, 0
  v_accvgpr_write_b32 a175, 0
  v_accvgpr_write_b32 a176, 0
  v_accvgpr_write_b32 a177, 0
  v_accvgpr_write_b32 a178, 0
  v_accvgpr_write_b32 a179, 0
  v_accvgpr_write_b32 a180, 0
  v_accvgpr_write_b32 a181, 0
  v_accvgpr_write_b32 a182, 0
  v_accvgpr_write_b32 a183, 0
  v_accvgpr_write_b32 a184, 0
  v_accvgpr_write_b32 a185, 0
  v_accvgpr_write_b32 a186, 0
  v_accvgpr_write_b32 a187, 0
  v_accvgpr_write_b32 a188, 0
  v_accvgpr_write_b32 a189, 0
  v_accvgpr_write_b32 a190, 0
  v_accvgpr_write_b32 a191, 0
  s_mov_b32 s45, 0
L1b_fb2:
  s_add_u32 m0, s40, 0
  s_nop 0
  buffer_load_dwordx4 v6, s[16:19], s45 offen offset:0 nt lds
  buffer_load_dwordx4 v6, s[16:19], s45 offen offset:1024 nt lds
  buffer_load_dwordx4 v6, s[16:19], s45 offen offset:2048 nt lds
  buffer_load_dwordx4 v6, s[16:19], s45 offen offset:3072 nt lds
  s_add_u32 m0, s40, 4096
  s_nop 0
  buffer_load_dwordx4 v31, s[16:19], s45 offen offset:0 nt lds
  buffer_load_dwordx4 v31, s[16:19], s45 offen offset:1024 nt lds
  buffer_load_dwordx4 v31, s[16:19], s45 offen offset:2048 nt lds
  buffer_load_dwordx4 v31, s[16:19], s45 offen offset:3072 nt lds
  s_waitcnt vmcnt(0)
  ds_read_b128 a[192:195], v13 offset:0
  ds_read_b128 a[196:199], v14 offset:0
  ds_read_b128 a[200:203], v15 offset:0
  ds_read_b128 a[204:207], v16 offset:0
  ds_read_b128 a[208:211], v13 offset:2048
  ds_read_b128 a[212:215], v14 offset:2048
  ds_read_b128 a[216:219], v15 offset:2048
  ds_read_b128 a[220:223], v16 offset:2048
  s_waitcnt lgkmcnt(0)
  s_add_u32 m0, s40, 0
  s_nop 0
  buffer_load_dwordx4 v6, s[20:23], s45 offen offset:0 nt lds
  buffer_load_dwordx4 v6, s[20:23], s45 offen offset:1024 nt lds
  buffer_load_dwordx4 v6, s[20:23], s45 offen offset:2048 nt lds
  buffer_load_dwordx4 v6, s[20:23], s45 offen offset:3072 nt lds
  s_add_u32 m0, s40, 4096
  s_nop 0
  buffer_load_dwordx4 v31, s[20:23], s45 offen offset:0 nt lds
  buffer_load_dwordx4 v31, s[20:23], s45 offen offset:1024 nt lds
  buffer_load_dwordx4 v31, s[20:23], s45 offen offset:2048 nt lds
  buffer_load_dwordx4 v31, s[20:23], s45 offen offset:3072 nt lds
  s_waitcnt vmcnt(0)
  ds_read_b64_tr_b16 a[224:225], v17 offset:0
  ds_read_b64_tr_b16 a[226:227], v17 offset:2048
  ds_read_b64_tr_b16 a[228:229], v18 offset:0
  ds_read_b64_tr_b16 a[230:231], v18 offset:2048
  ds_read_b64_tr_b16 a[232:233], v19 offset:0
  ds_read_b64_tr_b16 a[234:235], v19 offset:2048
  ds_read_b64_tr_b16 a[236:237], v20 offset:0
  ds_read_b64_tr_b16 a[238:239], v20 offset:2048
  ds_read_b64_tr_b16 a[240:241], v21 offset:0
  ds_read_b64_tr_b16 a[242:243], v21 offset:2048
  ds_read_b64_tr_b16 a[244:245], v22 offset:0
  ds_read_b64_tr_b16 a[246:247], v22 offset:2048
  ds_read_b64_tr_b16 a[248:249], v23 offset:0
  ds_read_b64_tr_b16 a[250:251], v23 offset:2048
  ds_read_b64_tr_b16 a[252:253], v28 offset:0
  s_waitcnt lgkmcnt(8)
  ds_read_b64_tr_b16 a[254:255], v28 offset:2048
  s_waitcnt lgkmcnt(0)
  v_mfma_f32_16x16x32_bf16 v[56:59], a[192:195], v[32:35], v[48:51]
  v_mfma_f32_16x16x32_bf16 v[56:59], a[196:199], v[36:39], v[56:59]
  v_mfma_f32_16x16x32_bf16 v[56:59], a[200:203], v[40:43], v[56:59]
  v_mfma_f32_16x16x32_bf16 v[56:59], a[204:207], v[44:47], v[56:59]
  v_mfma_f32_16x16x32_bf16 v[60:63], a[208:211], v[32:35], v[48:51]
  v_mfma_f32_16x16x32_bf16 v[60:63], a[212:215], v[36:39], v[60:63]
  v_mfma_f32_16x16x32_bf16 v[60:63], a[216:219], v[40:43], v[60:63]
  v_mfma_f32_16x16x32_bf16 v[60:63], a[220:223], v[44:47], v[60:63]
  s_nop 7
  v_exp_f32 v56, v56
  v_exp_f32 v57, v57
  v_exp_f32 v58, v58
  v_exp_f32 v59, v59
  v_exp_f32 v60, v60
  v_exp_f32 v61, v61
  v_exp_f32 v62, v62
  v_exp_f32 v63, v63
  s_nop 0
  v_add_f32 v52, v52, v56
  v_add_f32 v52, v52, v57
  v_add_f32 v52, v52, v58
  v_add_f32 v52, v52, v59
  v_add_f32 v52, v52, v60
  v_add_f32 v52, v52, v61
  v_add_f32 v52, v52, v62
  v_add_f32 v52, v52, v63
  v_cvt_pk_bf16_f32 v120, v56, v57
  v_cvt_pk_bf16_f32 v121, v58, v59
  v_cvt_pk_bf16_f32 v122, v60, v61
  v_cvt_pk_bf16_f32 v123, v62, v63
  s_nop 1
  v_mfma_f32_16x16x32_bf16 a[0:3], a[224:227], v[120:123], a[0:3]
  v_mfma_f32_16x16x32_bf16 a[4:7], a[228:231], v[120:123], a[4:7]
  v_mfma_f32_16x16x32_bf16 a[8:11], a[232:235], v[120:123], a[8:11]
  v_mfma_f32_16x16x32_bf16 a[12:15], a[236:239], v[120:123], a[12:15]
  v_mfma_f32_16x16x32_bf16 a[16:19], a[240:243], v[120:123], a[16:19]
  v_mfma_f32_16x16x32_bf16 a[20:23], a[244:247], v[120:123], a[20:23]
  v_mfma_f32_16x16x32_bf16 a[24:27], a[248:251], v[120:123], a[24:27]
  v_mfma_f32_16x16x32_bf16 a[28:31], a[252:255], v[120:123], a[28:31]
  v_mfma_f32_16x16x32_bf16 v[88:91], a[192:195], v[64:67], v[80:83]
  v_mfma_f32_16x16x32_bf16 v[88:91], a[196:199], v[68:71], v[88:91]
  v_mfma_f32_16x16x32_bf16 v[88:91], a[200:203], v[72:75], v[88:91]
  v_mfma_f32_16x16x32_bf16 v[88:91], a[204:207], v[76:79], v[88:91]
  v_mfma_f32_16x16x32_bf16 v[92:95], a[208:211], v[64:67], v[80:83]
  v_mfma_f32_16x16x32_bf16 v[92:95], a[212:215], v[68:71], v[92:95]
  v_mfma_f32_16x16x32_bf16 v[92:95], a[216:219], v[72:75], v[92:95]
  v_mfma_f32_16x16x32_bf16 v[92:95], a[220:223], v[76:79], v[92:95]
  s_nop 7
  v_exp_f32 v88, v88
  v_exp_f32 v89, v89
  v_exp_f32 v90, v90
  v_exp_f32 v91, v91
  v_exp_f32 v92, v92
  v_exp_f32 v93, v93
  v_exp_f32 v94, v94
  v_exp_f32 v95, v95
  s_nop 0
  v_add_f32 v84, v84, v88
  v_add_f32 v84, v84, v89
  v_add_f32 v84, v84, v90
  v_add_f32 v84, v84, v91
  v_add_f32 v84, v84, v92
  v_add_f32 v84, v84, v93
  v_add_f32 v84, v84, v94
  v_add_f32 v84, v84, v95
  v_cvt_pk_bf16_f32 v124, v88, v89
  v_cvt_pk_bf16_f32 v125, v90, v91
  v_cvt_pk_bf16_f32 v126, v92, v93
  v_cvt_pk_bf16_f32 v127, v94, v95
  s_nop 1
  v_mfma_f32_16x16x32_bf16 a[32:35], a[224:227], v[124:127], a[32:35]
  v_mfma_f32_16x16x32_bf16 a[36:39], a[228:231], v[124:127], a[36:39]
  v_mfma_f32_16x16x32_bf16 a[40:43], a[232:235], v[124:127], a[40:43]
  v_mfma_f32_16x16x32_bf16 a[44:47], a[236:239], v[124:127], a[44:47]
  v_mfma_f32_16x16x32_bf16 a[48:51], a[240:243], v[124:127], a[48:51]
  v_mfma_f32_16x16x32_bf16 a[52:55], a[244:247], v[124:127], a[52:55]
  v_mfma_f32_16x16x32_bf16 a[56:59], a[248:251], v[124:127], a[56:59]
  v_mfma_f32_16x16x32_bf16 a[60:63], a[252:255], v[124:127], a[60:63]
  v_mfma_f32_16x16x32_bf16 v[56:59], a[192:195], v[96:99], v[112:115]
  v_mfma_f32_16x16x32_bf16 v[56:59], a[196:199], v[100:103], v[56:59]
  v_mfma_f32_16x16x32_bf16 v[56:59], a[200:203], v[104:107], v[56:59]
  v_mfma_f32_16x16x32_bf16 v[56:59], a[204:207], v[108:111], v[56:59]
  v_mfma_f32_16x16x32_bf16 v[60:63], a[208:211], v[96:99], v[112:115]
  v_mfma_f32_16x16x32_bf16 v[60:63], a[212:215], v[100:103], v[60:63]
  v_mfma_f32_16x16x32_bf16 v[60:63], a[216:219], v[104:107], v[60:63]
  v_mfma_f32_16x16x32_bf16 v[60:63], a[220:223], v[108:111], v[60:63]
  s_nop 7
  v_exp_f32 v56, v56
  v_exp_f32 v57, v57
  v_exp_f32 v58, v58
  v_exp_f32 v59, v59
  v_exp_f32 v60, v60
  v_exp_f32 v61, v61
  v_exp_f32 v62, v62
  v_exp_f32 v63, v63
  s_nop 0
  v_add_f32 v116, v116, v56
  v_add_f32 v116, v116, v57
  v_add_f32 v116, v116, v58
  v_add_f32 v116, v116, v59
  v_add_f32 v116, v116, v60
  v_add_f32 v116, v116, v61
  v_add_f32 v116, v116, v62
  v_add_f32 v116, v116, v63
  v_cvt_pk_bf16_f32 v120, v56, v57
  v_cvt_pk_bf16_f32 v121, v58, v59
  v_cvt_pk_bf16_f32 v122, v60, v61
  v_cvt_pk_bf16_f32 v123, v62, v63
  s_nop 1
  v_mfma_f32_16x16x32_bf16 a[64:67], a[224:227], v[120:123], a[64:67]
  v_mfma_f32_16x16x32_bf16 a[68:71], a[228:231], v[120:123], a[68:71]
  v_mfma_f32_16x16x32_bf16 a[72:75], a[232:235], v[120:123], a[72:75]
  v_mfma_f32_16x16x32_bf16 a[76:79], a[236:239], v[120:123], a[76:79]
  v_mfma_f32_16x16x32_bf16 a[80:83], a[240:243], v[120:123], a[80:83]
  v_mfma_f32_16x16x32_bf16 a[84:87], a[244:247], v[120:123], a[84:87]
  v_mfma_f32_16x16x32_bf16 a[88:91], a[248:251], v[120:123], a[88:91]
  v_mfma_f32_16x16x32_bf16 a[92:95], a[252:255], v[120:123], a[92:95]
  v_mfma_f32_16x16x32_bf16 v[88:91], a[192:195], v[128:131], v[144:147]
  v_mfma_f32_16x16x32_bf16 v[88:91], a[196:199], v[132:135], v[88:91]
  v_mfma_f32_16x16x32_bf16 v[88:91], a[200:203], v[136:139], v[88:91]
  v_mfma_f32_16x16x32_bf16 v[88:91], a[204:207], v[140:143], v[88:91]
  v_mfma_f32_16x16x32_bf16 v[92:95], a[208:211], v[128:131], v[144:147]
  v_mfma_f32_16x16x32_bf16 v[92:95], a[212:215], v[132:135], v[92:95]
  v_mfma_f32_16x16x32_bf16 v[92:95], a[216:219], v[136:139], v[92:95]
  v_mfma_f32_16x16x32_bf16 v[92:95], a[220:223], v[140:143], v[92:95]
  s_nop 7
  v_exp_f32 v88, v88
  v_exp_f32 v89, v89
  v_exp_f32 v90, v90
  v_exp_f32 v91, v91
  v_exp_f32 v92, v92
  v_exp_f32 v93, v93
  v_exp_f32 v94, v94
  v_exp_f32 v95, v95
  s_nop 0
  v_add_f32 v148, v148, v88
  v_add_f32 v148, v148, v89
  v_add_f32 v148, v148, v90
  v_add_f32 v148, v148, v91
  v_add_f32 v148, v148, v92
  v_add_f32 v148, v148, v93
  v_add_f32 v148, v148, v94
  v_add_f32 v148, v148, v95
  v_cvt_pk_bf16_f32 v124, v88, v89
  v_cvt_pk_bf16_f32 v125, v90, v91
  v_cvt_pk_bf16_f32 v126, v92, v93
  v_cvt_pk_bf16_f32 v127, v94, v95
  s_nop 1
  v_mfma_f32_16x16x32_bf16 a[96:99], a[224:227], v[124:127], a[96:99]
  v_mfma_f32_16x16x32_bf16 a[100:103], a[228:231], v[124:127], a[100:103]
  v_mfma_f32_16x16x32_bf16 a[104:107], a[232:235], v[124:127], a[104:107]
  v_mfma_f32_16x16x32_bf16 a[108:111], a[236:239], v[124:127], a[108:111]
  v_mfma_f32_16x16x32_bf16 a[112:115], a[240:243], v[124:127], a[112:115]
  v_mfma_f32_16x16x32_bf16 a[116:119], a[244:247], v[124:127], a[116:119]
  v_mfma_f32_16x16x32_bf16 a[120:123], a[248:251], v[124:127], a[120:123]
  v_mfma_f32_16x16x32_bf16 a[124:127], a[252:255], v[124:127], a[124:127]
  v_mfma_f32_16x16x32_bf16 v[56:59], a[192:195], v[160:163], v[176:179]
  v_mfma_f32_16x16x32_bf16 v[56:59], a[196:199], v[164:167], v[56:59]
  v_mfma_f32_16x16x32_bf16 v[56:59], a[200:203], v[168:171], v[56:59]
  v_mfma_f32_16x16x32_bf16 v[56:59], a[204:207], v[172:175], v[56:59]
  v_mfma_f32_16x16x32_bf16 v[60:63], a[208:211], v[160:163], v[176:179]
  v_mfma_f32_16x16x32_bf16 v[60:63], a[212:215], v[164:167], v[60:63]
  v_mfma_f32_16x16x32_bf16 v[60:63], a[216:219], v[168:171], v[60:63]
  v_mfma_f32_16x16x32_bf16 v[60:63], a[220:223], v[172:175], v[60:63]
  s_nop 7
  v_exp_f32 v56, v56
  v_exp_f32 v57, v57
  v_exp_f32 v58, v58
  v_exp_f32 v59, v59
  v_exp_f32 v60, v60
  v_exp_f32 v61, v61
  v_exp_f32 v62, v62
  v_exp_f32 v63, v63
  s_nop 0
  v_add_f32 v180, v180, v56
  v_add_f32 v180, v180, v57
  v_add_f32 v180, v180, v58
  v_add_f32 v180, v180, v59
  v_add_f32 v180, v180, v60
  v_add_f32 v180, v180, v61
  v_add_f32 v180, v180, v62
  v_add_f32 v180, v180, v63
  v_cvt_pk_bf16_f32 v120, v56, v57
  v_cvt_pk_bf16_f32 v121, v58, v59
  v_cvt_pk_bf16_f32 v122, v60, v61
  v_cvt_pk_bf16_f32 v123, v62, v63
  s_nop 1
  v_mfma_f32_16x16x32_bf16 a[128:131], a[224:227], v[120:123], a[128:131]
  v_mfma_f32_16x16x32_bf16 a[132:135], a[228:231], v[120:123], a[132:135]
  v_mfma_f32_16x16x32_bf16 a[136:139], a[232:235], v[120:123], a[136:139]
  v_mfma_f32_16x16x32_bf16 a[140:143], a[236:239], v[120:123], a[140:143]
  v_mfma_f32_16x16x32_bf16 a[144:147], a[240:243], v[120:123], a[144:147]
  v_mfma_f32_16x16x32_bf16 a[148:151], a[244:247], v[120:123], a[148:151]
  v_mfma_f32_16x16x32_bf16 a[152:155], a[248:251], v[120:123], a[152:155]
  v_mfma_f32_16x16x32_bf16 a[156:159], a[252:255], v[120:123], a[156:159]
  v_mfma_f32_16x16x32_bf16 v[88:91], a[192:195], v[192:195], v[208:211]
  v_mfma_f32_16x16x32_bf16 v[88:91], a[196:199], v[196:199], v[88:91]
  v_mfma_f32_16x16x32_bf16 v[88:91], a[200:203], v[200:203], v[88:91]
  v_mfma_f32_16x16x32_bf16 v[88:91], a[204:207], v[204:207], v[88:91]
  v_mfma_f32_16x16x32_bf16 v[92:95], a[208:211], v[192:195], v[208:211]
  v_mfma_f32_16x16x32_bf16 v[92:95], a[212:215], v[196:199], v[92:95]
  v_mfma_f32_16x16x32_bf16 v[92:95], a[216:219], v[200:203], v[92:95]
  v_mfma_f32_16x16x32_bf16 v[92:95], a[220:223], v[204:207], v[92:95]
  s_nop 7
  v_exp_f32 v88, v88
  v_exp_f32 v89, v89
  v_exp_f32 v90, v90
  v_exp_f32 v91, v91
  v_exp_f32 v92, v92
  v_exp_f32 v93, v93
  v_exp_f32 v94, v94
  v_exp_f32 v95, v95
  s_nop 0
  v_add_f32 v212, v212, v88
  v_add_f32 v212, v212, v89
  v_add_f32 v212, v212, v90
  v_add_f32 v212, v212, v91
  v_add_f32 v212, v212, v92
  v_add_f32 v212, v212, v93
  v_add_f32 v212, v212, v94
  v_add_f32 v212, v212, v95
  v_cvt_pk_bf16_f32 v124, v88, v89
  v_cvt_pk_bf16_f32 v125, v90, v91
  v_cvt_pk_bf16_f32 v126, v92, v93
  v_cvt_pk_bf16_f32 v127, v94, v95
  s_nop 1
  v_mfma_f32_16x16x32_bf16 a[160:163], a[224:227], v[124:127], a[160:163]
  v_mfma_f32_16x16x32_bf16 a[164:167], a[228:231], v[124:127], a[164:167]
  v_mfma_f32_16x16x32_bf16 a[168:171], a[232:235], v[124:127], a[168:171]
  v_mfma_f32_16x16x32_bf16 a[172:175], a[236:239], v[124:127], a[172:175]
  v_mfma_f32_16x16x32_bf16 a[176:179], a[240:243], v[124:127], a[176:179]
  v_mfma_f32_16x16x32_bf16 a[180:183], a[244:247], v[124:127], a[180:183]
  v_mfma_f32_16x16x32_bf16 a[184:187], a[248:251], v[124:127], a[184:187]
  v_mfma_f32_16x16x32_bf16 a[188:191], a[252:255], v[124:127], a[188:191]
  s_add_u32 s45, s45, 8192
  s_cmp_lt_u32 s45, 262144
  s_cbranch_scc1 L1b_fb2
  s_add_u32 m0, s28, 16384
  s_add_u32 s38, s30, 0
  buffer_load_dwordx4 v7, s[12:15], s38 offen offset:0 sc1 lds
  s_add_u32 m0, s28, 16384
  s_add_u32 s38, s30, 0
  buffer_load_dwordx4 v8, s[12:15], s38 offen offset:1024 sc1 lds
  s_add_u32 m0, s28, 16384
  s_add_u32 s38, s30, 0
  buffer_load_dwordx4 v9, s[12:15], s38 offen offset:2048 sc1 lds
  s_add_u32 m0, s28, 16384
  s_add_u32 s38, s30, 0
  buffer_load_dwordx4 v10, s[12:15], s38 offen offset:3072 sc1 lds
  s_add_u32 m0, s28, 20480
  s_add_u32 s38, s30, 32768
  buffer_load_dwordx4 v7, s[12:15], s38 offen offset:0 sc1 lds
  s_add_u32 m0, s28, 20480
  s_add_u32 s38, s30, 32768
  buffer_load_dwordx4 v8, s[12:15], s38 offen offset:1024 sc1 lds
  s_add_u32 m0, s28, 20480
  s_add_u32 s38, s30, 32768
  buffer_load_dwordx4 v9, s[12:15], s38 offen offset:2048 sc1 lds
  s_add_u32 m0, s28, 20480
  s_add_u32 s38, s30, 32768
  buffer_load_dwordx4 v10, s[12:15], s38 offen offset:3072 sc1 lds
  s_add_u32 m0, s28, 0
  s_add_u32 s38, s30, 65536
  buffer_load_dwordx4 v7, s[12:15], s38 offen offset:0 sc1 lds
  s_add_u32 m0, s28, 0
  s_add_u32 s38, s30, 65536
  buffer_load_dwordx4 v8, s[12:15], s38 offen offset:1024 sc1 lds
  s_add_u32 m0, s28, 0
  s_add_u32 s38, s30, 65536
  buffer_load_dwordx4 v9, s[12:15], s38 offen offset:2048 sc1 lds
  s_add_u32 m0, s28, 0
  s_add_u32 s38, s30, 65536
  buffer_load_dwordx4 v10, s[12:15], s38 offen offset:3072 sc1 lds
  s_add_u32 m0, s28, 4096
  s_add_u32 s38, s30, 98304
  buffer_load_dwordx4 v7, s[12:15], s38 offen offset:0 sc1 lds
  s_add_u32 m0, s28, 4096
  s_add_u32 s38, s30, 98304
  buffer_load_dwordx4 v8, s[12:15], s38 offen offset:1024 sc1 lds
  s_add_u32 m0, s28, 4096
  s_add_u32 s38, s30, 98304
  buffer_load_dwordx4 v9, s[12:15], s38 offen offset:2048 sc1 lds
  s_add_u32 m0, s28, 4096
  s_add_u32 s38, s30, 98304
  buffer_load_dwordx4 v10, s[12:15], s38 offen offset:3072 sc1 lds
  s_waitcnt vmcnt(0)
  s_nop 7
  s_branch L1b_epi
L1a_start:
  v_lshrrev_b32 v2, 4, v1
  v_and_b32 v29, 15, v1
  v_and_b32 v3, 6, v29
  v_xor_b32 v3, v3, v2
  v_lshlrev_b32 v7, 4, v3
  v_and_b32 v3, 7, v29
  v_lshl_add_u32 v7, v3, 7, v7
  v_lshrrev_b32 v3, 3, v29
  v_lshl_add_u32 v7, v3, 15, v7
  s_lshl_b32 s46, s5, 16
  v_add_u32 v7, s46, v7
  v_xor_b32 v8, 64, v7
  v_lshlrev_b32 v9, 4, v29
  v_lshrrev_b32 v3, 2, v29
  v_lshl_add_u32 v9, v3, 8, v9
  v_lshl_add_u32 v9, v2, 11, v9
  v_add_u32 v9, s41, v9
  v_xor_b32 v10, 64, v9
  v_xor_b32 v11, 128, v9
  v_xor_b32 v12, 192, v9
  v_and_b32 v13, 3, v29
  v_lshrrev_b32 v3, 3, v29
  v_lshl_add_u32 v13, v3, 2, v13
  v_and_b32 v3, 4, v29
  v_lshl_add_u32 v13, v3, 2, v13
  v_lshlrev_b32 v13, 8, v13
  v_and_b32 v3, 7, v29
  v_lshlrev_b32 v3, 1, v3
  v_xor_b32 v3, v3, v2
  v_lshl_add_u32 v13, v3, 4, v13
  v_add_u32 v13, s41, v13
  v_xor_b32 v14, 64, v13
  v_xor_b32 v15, 128, v13
  v_xor_b32 v16, 192, v13
  s_sub_u32 s48, s42, s41
  v_add_u32 v24, s48, v13
  v_add_u32 v25, s48, v14
  v_add_u32 v26, s48, v15
  v_add_u32 v27, s48, v16
  v_lshrrev_b32 v29, 2, v1
  v_and_b32 v17, 3, v29
  v_lshrrev_b32 v3, 3, v29
  v_lshl_add_u32 v17, v3, 2, v17
  v_and_b32 v3, 4, v29
  v_lshl_add_u32 v17, v3, 2, v17
  v_lshlrev_b32 v17, 8, v17
  v_and_b32 v3, 7, v29
  v_lshl_add_u32 v17, v3, 5, v17
  v_and_b32 v3, 3, v1
  v_lshl_add_u32 v17, v3, 3, v17
  s_add_u32 s47, s41, 32768
  v_add_u32 v17, s47, v17
  v_xor_b32 v18, 32, v17
  v_xor_b32 v19, 64, v17
  v_xor_b32 v20, 96, v17
  v_xor_b32 v21, 128, v17
  v_xor_b32 v22, 160, v17
  v_xor_b32 v23, 192, v17
  v_xor_b32 v28, 224, v17
  v_lshlrev_b32 v3, 3, v2
  v_mov_b32 v30, 100860416
  v_lshrrev_b32 v30, v3, v30
  v_and_b32 v30, 255, v30
  v_lshlrev_b32 v30, 8, v30
  v_and_b32 v3, 15, v1
  v_lshl_add_u32 v30, v3, 4, v30
  s_lshr_b32 s54, s7, 3
  s_lshl_b32 s54, s54, 4
  s_and_b32 s46, s7, 7
  s_add_u32 s54, s54, s46
  s_mul_i32 s54, s54, 53248
  s_mul_i32 s46, s5, 14336
  s_add_u32 s54, s54, s46
  s_mov_b32 s52, 0x3e0293ee
  s_mov_b32 s53, 0x3e0293ee
  s_mov_b32 s51, 0
  s_mov_b32 s50, 0
  v_mov_b32 v32, 0
  v_mov_b32 v33, 0
  v_mov_b32 v34, 0
  v_mov_b32 v35, 0
  v_mov_b32 v36, 0
  v_mov_b32 v37, 0
  v_mov_b32 v38, 0
  v_mov_b32 v39, 0
  v_mov_b32 v40, 0
  v_mov_b32 v41, 0
  v_mov_b32 v42, 0
  v_mov_b32 v43, 0
  v_mov_b32 v44, 0
  v_mov_b32 v45, 0
  v_mov_b32 v46, 0
  v_mov_b32 v47, 0
  v_mov_b32 v48, 0
  v_mov_b32 v49, 0
  v_mov_b32 v50, 0
  v_mov_b32 v51, 0
  v_mov_b32 v52, 0
  v_mov_b32 v53, 0
  v_mov_b32 v54, 0
  v_mov_b32 v55, 0
  v_mov_b32 v56, 0
  v_mov_b32 v57, 0
  v_mov_b32 v58, 0
  v_mov_b32 v59, 0
  v_mov_b32 v60, 0
  v_mov_b32 v61, 0
  v_mov_b32 v62, 0
  v_mov_b32 v63, 0
  v_mov_b32 v64, 0
  v_mov_b32 v65, 0
  v_mov_b32 v66, 0
  v_mov_b32 v67, 0
  v_mov_b32 v68, 0
  v_mov_b32 v69, 0
  v_mov_b32 v70, 0
  v_mov_b32 v71, 0
  v_mov_b32 v72, 0
  v_mov_b32 v73, 0
  v_mov_b32 v74, 0
  v_mov_b32 v75, 0
  v_mov_b32 v76, 0
  v_mov_b32 v77, 0
  v_mov_b32 v78, 0
  v_mov_b32 v79, 0
  v_mov_b32 v80, 0
  v_mov_b32 v81, 0
  v_mov_b32 v82, 0
  v_mov_b32 v83, 0
  v_mov_b32 v84, 0
  v_mov_b32 v85, 0
  v_mov_b32 v86, 0
  v_mov_b32 v87, 0
  v_mov_b32 v88, 0
  v_mov_b32 v89, 0
  v_mov_b32 v90, 0
  v_mov_b32 v91, 0
  v_mov_b32 v92, 0
  v_mov_b32 v93, 0
  v_mov_b32 v94, 0
  v_mov_b32 v95, 0
  v_mov_b32 v96, 0
  v_mov_b32 v97, 0
  v_mov_b32 v98, 0
  v_mov_b32 v99, 0
  v_mov_b32 v100, 0
  v_mov_b32 v101, 0
  v_mov_b32 v102, 0
  v_mov_b32 v103, 0
  v_mov_b32 v104, 0
  v_mov_b32 v105, 0
  v_mov_b32 v106, 0
  v_mov_b32 v107, 0
  v_mov_b32 v108, 0
  v_mov_b32 v109, 0
  v_mov_b32 v110, 0
  v_mov_b32 v111, 0
  v_mov_b32 v112, 0
  v_mov_b32 v113, 0
  v_mov_b32 v114, 0
  v_mov_b32 v115, 0
  v_mov_b32 v116, 0
  v_mov_b32 v117, 0
  v_mov_b32 v118, 0
  v_mov_b32 v119, 0
  v_mov_b32 v120, 0
  v_mov_b32 v121, 0
  v_mov_b32 v122, 0
  v_mov_b32 v123, 0
  v_mov_b32 v124, 0
  v_mov_b32 v125, 0
  v_mov_b32 v126, 0
  v_mov_b32 v127, 0
  v_mov_b32 v128, 0
  v_mov_b32 v129, 0
  v_mov_b32 v130, 0
  v_mov_b32 v131, 0
  v_mov_b32 v132, 0
  v_mov_b32 v133, 0
  v_mov_b32 v134, 0
  v_mov_b32 v135, 0
  v_mov_b32 v136, 0
  v_mov_b32 v137, 0
  v_mov_b32 v138, 0
  v_mov_b32 v139, 0
  v_mov_b32 v140, 0
  v_mov_b32 v141, 0
  v_mov_b32 v142, 0
  v_mov_b32 v143, 0
  v_mov_b32 v144, 0
  v_mov_b32 v145, 0
  v_mov_b32 v146, 0
  v_mov_b32 v147, 0
  v_mov_b32 v148, 0
  v_mov_b32 v149, 0
  v_mov_b32 v150, 0
  v_mov_b32 v151, 0
  v_mov_b32 v152, 0
  v_mov_b32 v153, 0
  v_mov_b32 v154, 0
  v_mov_b32 v155, 0
  v_mov_b32 v156, 0
  v_mov_b32 v157, 0
  v_mov_b32 v158, 0
  v_mov_b32 v159, 0
  v_mov_b32 v160, 0
  v_mov_b32 v161, 0
  v_mov_b32 v162, 0
  v_mov_b32 v163, 0
  v_mov_b32 v164, 0
  v_mov_b32 v165, 0
  v_mov_b32 v166, 0
  v_mov_b32 v167, 0
  v_mov_b32 v168, 0
  v_mov_b32 v169, 0
  v_mov_b32 v170, 0
  v_mov_b32 v171, 0
  v_mov_b32 v172, 0
  v_mov_b32 v173, 0
  v_mov_b32 v174, 0
  v_mov_b32 v175, 0
  v_mov_b32 v176, 0
  v_mov_b32 v177, 0
  v_mov_b32 v178, 0
  v_mov_b32 v179, 0
  v_mov_b32 v180, 0
  v_mov_b32 v181, 0
  v_mov_b32 v182, 0
  v_mov_b32 v183, 0
  v_mov_b32 v184, 0
  v_mov_b32 v185, 0
  v_mov_b32 v186, 0
  v_mov_b32 v187, 0
  v_mov_b32 v188, 0
  v_mov_b32 v189, 0
  v_mov_b32 v190, 0
  v_mov_b32 v191, 0
  v_mov_b32 v192, 0
  v_mov_b32 v193, 0
  v_mov_b32 v194, 0
  v_mov_b32 v195, 0
  v_mov_b32 v196, 0
  v_mov_b32 v197, 0
  v_mov_b32 v198, 0
  v_mov_b32 v199, 0
  v_mov_b32 v200, 0
  v_mov_b32 v201, 0
  v_mov_b32 v202, 0
  v_mov_b32 v203, 0
  v_mov_b32 v204, 0
  v_mov_b32 v205, 0
  v_mov_b32 v206, 0
  v_mov_b32 v207, 0
  v_mov_b32 v208, 0
  v_mov_b32 v209, 0
  v_mov_b32 v210, 0
  v_mov_b32 v211, 0
  v_mov_b32 v212, 0
  v_mov_b32 v213, 0
  v_mov_b32 v214, 0
  v_mov_b32 v215, 0
  v_mov_b32 v216, 0
  v_mov_b32 v217, 0
  v_mov_b32 v218, 0
  v_mov_b32 v219, 0
  v_mov_b32 v220, 0
  v_mov_b32 v221, 0
  v_mov_b32 v222, 0
  v_mov_b32 v223, 0
  v_mov_b32 v224, 0
  v_mov_b32 v225, 0
  v_mov_b32 v226, 0
  v_mov_b32 v227, 0
  v_mov_b32 v228, 0
  v_mov_b32 v229, 0
  v_mov_b32 v230, 0
  v_mov_b32 v231, 0
  v_mov_b32 v232, 0
  v_mov_b32 v233, 0
  v_mov_b32 v234, 0
  v_mov_b32 v235, 0
  v_mov_b32 v236, 0
  v_mov_b32 v237, 0
  v_mov_b32 v238, 0
  v_mov_b32 v239, 0
  v_mov_b32 v240, 0
  v_mov_b32 v241, 0
  v_mov_b32 v242, 0
  v_mov_b32 v243, 0
  v_mov_b32 v244, 0
  v_mov_b32 v245, 0
  v_mov_b32 v246, 0
  v_mov_b32 v247, 0
  v_mov_b32 v248, 0
  v_mov_b32 v249, 0
  v_mov_b32 v250, 0
  v_mov_b32 v251, 0
  v_mov_b32 v252, 0
  v_mov_b32 v253, 0
  v_mov_b32 v254, 0
  v_mov_b32 v255, 0
  s_mov_b32 s43, 128
  s_mov_b32 s44, 524288
  s_add_u32 m0, s40, 16384
  s_add_u32 s46, s43, 0
  buffer_load_dwordx4 v4, s[8:11], s46 offen offset:0 lds
  s_add_u32 m0, s40, 17408
  s_add_u32 s47, s43, 32768
  buffer_load_dwordx4 v4, s[8:11], s47 offen offset:0 lds
  s_add_u32 m0, s40, 18432
  s_add_u32 s46, s43, 65536
  buffer_load_dwordx4 v4, s[8:11], s46 offen offset:0 lds
  s_add_u32 m0, s40, 19456
  s_add_u32 s47, s43, 98304
  buffer_load_dwordx4 v4, s[8:11], s47 offen offset:0 lds
  s_add_u32 m0, s40, 20480
  s_add_u32 s46, s43, 131072
  buffer_load_dwordx4 v4, s[8:11], s46 offen offset:0 lds
  s_add_u32 m0, s40, 21504
  s_add_u32 s47, s43, 163840
  buffer_load_dwordx4 v4, s[8:11], s47 offen offset:0 lds
  s_add_u32 m0, s40, 22528
  s_add_u32 s46, s43, 196608
  buffer_load_dwordx4 v4, s[8:11], s46 offen offset:0 lds
  s_add_u32 m0, s40, 81920
  s_add_u32 s47, s43, 229376
  buffer_load_dwordx4 v4, s[8:11], s47 offen offset:0 lds
  s_add_u32 m0, s40, 82944
  s_add_u32 s46, s43, 262144
  buffer_load_dwordx4 v4, s[8:11], s46 offen offset:0 lds
  s_add_u32 m0, s40, 83968
  s_add_u32 s47, s43, 294912
  buffer_load_dwordx4 v4, s[8:11], s47 offen offset:0 lds
  s_add_u32 m0, s40, 84992
  s_add_u32 s46, s43, 327680
  buffer_load_dwordx4 v4, s[8:11], s46 offen offset:0 lds
  s_add_u32 m0, s40, 86016
  s_add_u32 s47, s43, 360448
  buffer_load_dwordx4 v4, s[8:11], s47 offen offset:0 lds
  s_add_u32 m0, s40, 87040
  s_add_u32 s46, s43, 393216
  buffer_load_dwordx4 v4, s[8:11], s46 offen offset:0 lds
  s_add_u32 s43, s43, 128
  s_add_u32 m0, s41, 24576
  s_add_u32 s46, s44, 0
  buffer_load_dwordx4 v5, s[12:15], s46 offen offset:0 lds
  s_add_u32 s47, s44, 31744
  buffer_load_dwordx4 v5, s[12:15], s47 offen offset:1024 lds
  s_add_u32 s46, s44, 63488
  buffer_load_dwordx4 v5, s[12:15], s46 offen offset:2048 lds
  s_add_u32 s47, s44, 95232
  buffer_load_dwordx4 v5, s[12:15], s47 offen offset:3072 lds
  s_add_u32 m0, s41, 28672
  s_add_u32 s46, s44, 131072
  buffer_load_dwordx4 v5, s[12:15], s46 offen offset:0 lds
  s_add_u32 s47, s44, 162816
  buffer_load_dwordx4 v5, s[12:15], s47 offen offset:1024 lds
  s_add_u32 s46, s44, 194560
  buffer_load_dwordx4 v5, s[12:15], s46 offen offset:2048 lds
  s_add_u32 s47, s44, 226304
  buffer_load_dwordx4 v5, s[12:15], s47 offen offset:3072 lds
  s_add_u32 s44, s44, 262144
  s_barrier
  ds_read_b64_tr_b16 a[112:113], v9 offset:8192
  ds_read_b64_tr_b16 a[114:115], v9 offset:9216
  ds_read_b64_tr_b16 a[116:117], v9 offset:8200
  ds_read_b64_tr_b16 a[118:119], v9 offset:9224
  ds_read_b64_tr_b16 a[120:121], v10 offset:8192
  ds_read_b64_tr_b16 a[122:123], v10 offset:9216
  ds_read_b64_tr_b16 a[124:125], v10 offset:8200
  ds_read_b64_tr_b16 a[126:127], v10 offset:9224
  ds_read_b64_tr_b16 a[128:129], v11 offset:8192
  ds_read_b64_tr_b16 a[130:131], v11 offset:9216
  ds_read_b64_tr_b16 a[132:133], v11 offset:8200
  ds_read_b64_tr_b16 a[134:135], v11 offset:9224
  ds_read_b64_tr_b16 a[136:137], v12 offset:8192
  ds_read_b64_tr_b16 a[138:139], v12 offset:9216
  ds_read_b64_tr_b16 a[140:141], v12 offset:8200
  s_waitcnt lgkmcnt(8)
  ds_read_b64_tr_b16 a[142:143], v12 offset:9224
  ds_read_b128 a[0:3], v7 offset:0
  ds_read_b128 a[4:7], v7 offset:1024
  ds_read_b128 a[8:11], v7 offset:2048
  ds_read_b128 a[12:15], v7 offset:3072
  ds_read_b128 a[16:19], v7 offset:4096
  ds_read_b128 a[20:23], v7 offset:5120
  s_waitcnt lgkmcnt(8)
  ds_read_b128 a[24:27], v7 offset:6144
  ds_read_b128 a[28:31], v8 offset:0
  ds_read_b128 a[32:35], v8 offset:1024
  ds_read_b128 a[36:39], v8 offset:2048
  ds_read_b128 a[40:43], v8 offset:3072
  ds_read_b128 a[44:47], v8 offset:4096
  ds_read_b128 a[48:51], v8 offset:5120
  s_waitcnt lgkmcnt(8)
  ds_read_b128 a[52:55], v8 offset:6144
  s_mov_b32 s8, s16
  s_mov_b32 s9, s17
  s_mov_b32 s10, s18
  s_mov_b32 s11, 131072
  s_mov_b32 s40, s42
  v_mov_b32 v4, v6
  v_lshlrev_b32 v5, 7, v1
  s_getpc_b64 s[56:57]
L1_pc:
  s_sub_u32 s56, s56, L1_pc-standalone__mha_block_cached__near_ridge_kernel
  s_subb_u32 s57, s57, 0
  s_lshr_b32 s46, s2, 3
  s_lshl_b32 s46, s46, 1
  s_add_u32 s46, s46, s4
  s_lshl_b32 s46, s46, 11
  v_add_u32 v2, s46, v5
  v_min_u32 v2, L_code_end-standalone__mha_block_cached__near_ridge_kernel-4, v2
  v_mov_b32 v3, s57
  v_add_co_u32 v2, vcc, s56, v2
  s_nop 1
  v_addc_co_u32 v3, vcc, 0, v3, vcc
  s_mov_b64 exec, 0xffff
  global_load_dword v31, v[2:3], off
  s_mov_b64 exec, -1
  s_lshr_b32 s46, s7, 3
  s_lshl_b32 s47, s6, 2
  s_add_u32 s46, s46, s47
  s_lshl_b32 s46, s46, 7
  s_and_b32 s47, s7, 6
  s_lshl_b32 s47, s47, 1
  s_add_u32 s46, s46, s47
  s_add_u32 s46, s46, 75497472
  s_cmp_lg_u32 s3, 0
  s_cbranch_scc1 L1a_norst
  v_mov_b32 v2, s46
  v_mov_b32 v3, 0
  s_mov_b64 exec, 1
  global_store_dword v2, v3, s[98:99] sc1
  s_mov_b64 exec, -1
L1a_norst:
L1a_qloopA:
  s_waitcnt lgkmcnt(0)
  s_barrier
  v_mfma_f32_16x16x32_bf16 v[32:35], a[112:115], a[0:3], v[32:35]
  ds_read_b64_tr_b16 a[144:145], v9 offset:40960
  v_mfma_f32_16x16x32_bf16 v[36:39], a[116:119], a[0:3], v[36:39]
  s_mov_b32 m0, s40
  v_mfma_f32_16x16x32_bf16 v[40:43], a[120:123], a[0:3], v[40:43]
  ds_read_b64_tr_b16 a[146:147], v9 offset:41984
  v_mfma_f32_16x16x32_bf16 v[44:47], a[124:127], a[0:3], v[44:47]
  buffer_load_dwordx4 v4, s[8:11], s45 offen offset:0 nt lds
  v_mfma_f32_16x16x32_bf16 v[48:51], a[128:131], a[0:3], v[48:51]
  v_mfma_f32_16x16x32_bf16 v[52:55], a[132:135], a[0:3], v[52:55]
  v_mfma_f32_16x16x32_bf16 v[56:59], a[136:139], a[0:3], v[56:59]
  ds_read_b64_tr_b16 a[148:149], v9 offset:40968
  v_mfma_f32_16x16x32_bf16 v[60:63], a[140:143], a[0:3], v[60:63]
  v_mfma_f32_16x16x32_bf16 v[64:67], a[112:115], a[4:7], v[64:67]
  v_mfma_f32_16x16x32_bf16 v[68:71], a[116:119], a[4:7], v[68:71]
  ds_read_b64_tr_b16 a[150:151], v9 offset:41992
  v_mfma_f32_16x16x32_bf16 v[72:75], a[120:123], a[4:7], v[72:75]
  v_mfma_f32_16x16x32_bf16 v[76:79], a[124:127], a[4:7], v[76:79]
  v_mfma_f32_16x16x32_bf16 v[80:83], a[128:131], a[4:7], v[80:83]
  ds_read_b64_tr_b16 a[152:153], v10 offset:40960
  v_mfma_f32_16x16x32_bf16 v[84:87], a[132:135], a[4:7], v[84:87]
  v_mfma_f32_16x16x32_bf16 v[88:91], a[136:139], a[4:7], v[88:91]
  v_mfma_f32_16x16x32_bf16 v[92:95], a[140:143], a[4:7], v[92:95]
  ds_read_b64_tr_b16 a[154:155], v10 offset:41984
  v_mfma_f32_16x16x32_bf16 v[96:99], a[112:115], a[8:11], v[96:99]
  v_mfma_f32_16x16x32_bf16 v[100:103], a[116:119], a[8:11], v[100:103]
  v_mfma_f32_16x16x32_bf16 v[104:107], a[120:123], a[8:11], v[104:107]
  ds_read_b64_tr_b16 a[156:157], v10 offset:40968
  v_mfma_f32_16x16x32_bf16 v[108:111], a[124:127], a[8:11], v[108:111]
  v_mfma_f32_16x16x32_bf16 v[112:115], a[128:131], a[8:11], v[112:115]
  v_mfma_f32_16x16x32_bf16 v[116:119], a[132:135], a[8:11], v[116:119]
  ds_read_b64_tr_b16 a[158:159], v10 offset:41992
  v_mfma_f32_16x16x32_bf16 v[120:123], a[136:139], a[8:11], v[120:123]
  v_mfma_f32_16x16x32_bf16 v[124:127], a[140:143], a[8:11], v[124:127]
  v_mfma_f32_16x16x32_bf16 v[128:131], a[112:115], a[12:15], v[128:131]
  ds_read_b64_tr_b16 a[160:161], v11 offset:40960
  v_mfma_f32_16x16x32_bf16 v[132:135], a[116:119], a[12:15], v[132:135]
  v_mfma_f32_16x16x32_bf16 v[136:139], a[120:123], a[12:15], v[136:139]
  v_mfma_f32_16x16x32_bf16 v[140:143], a[124:127], a[12:15], v[140:143]
  ds_read_b64_tr_b16 a[162:163], v11 offset:41984
  v_mfma_f32_16x16x32_bf16 v[144:147], a[128:131], a[12:15], v[144:147]
  v_mfma_f32_16x16x32_bf16 v[148:151], a[132:135], a[12:15], v[148:151]
  v_mfma_f32_16x16x32_bf16 v[152:155], a[136:139], a[12:15], v[152:155]
  ds_read_b64_tr_b16 a[164:165], v11 offset:40968
  v_mfma_f32_16x16x32_bf16 v[156:159], a[140:143], a[12:15], v[156:159]
  v_mfma_f32_16x16x32_bf16 v[160:163], a[112:115], a[16:19], v[160:163]
  v_mfma_f32_16x16x32_bf16 v[164:167], a[116:119], a[16:19], v[164:167]
  ds_read_b64_tr_b16 a[166:167], v11 offset:41992
  v_mfma_f32_16x16x32_bf16 v[168:171], a[120:123], a[16:19], v[168:171]
  v_mfma_f32_16x16x32_bf16 v[172:175], a[124:127], a[16:19], v[172:175]
  v_mfma_f32_16x16x32_bf16 v[176:179], a[128:131], a[16:19], v[176:179]
  ds_read_b64_tr_b16 a[168:169], v12 offset:40960
  v_mfma_f32_16x16x32_bf16 v[180:183], a[132:135], a[16:19], v[180:183]
  v_mfma_f32_16x16x32_bf16 v[184:187], a[136:139], a[16:19], v[184:187]
  v_mfma_f32_16x16x32_bf16 v[188:191], a[140:143], a[16:19], v[188:191]
  ds_read_b64_tr_b16 a[170:171], v12 offset:41984
  v_mfma_f32_16x16x32_bf16 v[192:195], a[112:115], a[20:23], v[192:195]
  v_mfma_f32_16x16x32_bf16 v[196:199], a[116:119], a[20:23], v[196:199]
  v_mfma_f32_16x16x32_bf16 v[200:203], a[120:123], a[20:23], v[200:203]
  ds_read_b64_tr_b16 a[172:173], v12 offset:40968
  v_mfma_f32_16x16x32_bf16 v[204:207], a[124:127], a[20:23], v[204:207]
  v_mfma_f32_16x16x32_bf16 v[208:211], a[128:131], a[20:23], v[208:211]
  v_mfma_f32_16x16x32_bf16 v[212:215], a[132:135], a[20:23], v[212:215]
  s_waitcnt lgkmcnt(8)
  ds_read_b64_tr_b16 a[174:175], v12 offset:41992
  v_mfma_f32_16x16x32_bf16 v[216:219], a[136:139], a[20:23], v[216:219]
  v_mfma_f32_16x16x32_bf16 v[220:223], a[140:143], a[20:23], v[220:223]
  v_mfma_f32_16x16x32_bf16 v[224:227], a[112:115], a[24:27], v[224:227]
  v_mfma_f32_16x16x32_bf16 v[228:231], a[116:119], a[24:27], v[228:231]
  v_mfma_f32_16x16x32_bf16 v[232:235], a[120:123], a[24:27], v[232:235]
  v_mfma_f32_16x16x32_bf16 v[236:239], a[124:127], a[24:27], v[236:239]
  v_mfma_f32_16x16x32_bf16 v[240:243], a[128:131], a[24:27], v[240:243]
  v_mfma_f32_16x16x32_bf16 v[244:247], a[132:135], a[24:27], v[244:247]
  v_mfma_f32_16x16x32_bf16 v[248:251], a[136:139], a[24:27], v[248:251]
  v_mfma_f32_16x16x32_bf16 v[252:255], a[140:143], a[24:27], v[252:255]
  s_waitcnt vmcnt(1) lgkmcnt(0)
  s_barrier
  v_mfma_f32_16x16x32_bf16 v[32:35], a[144:147], a[28:31], v[32:35]
  ds_read_b64_tr_b16 a[112:113], v9 offset:24576
  v_mfma_f32_16x16x32_bf16 v[36:39], a[148:151], a[28:31], v[36:39]
  ds_read_b64_tr_b16 a[114:115], v9 offset:25600
  v_mfma_f32_16x16x32_bf16 v[40:43], a[152:155], a[28:31], v[40:43]
  v_mfma_f32_16x16x32_bf16 v[44:47], a[156:159], a[28:31], v[44:47]
  buffer_load_dwordx4 v4, s[8:11], s45 offen offset:1024 nt lds
  v_mfma_f32_16x16x32_bf16 v[48:51], a[160:163], a[28:31], v[48:51]
  ds_read_b64_tr_b16 a[116:117], v9 offset:24584
  v_mfma_f32_16x16x32_bf16 v[52:55], a[164:167], a[28:31], v[52:55]
  ds_read_b64_tr_b16 a[118:119], v9 offset:25608
  v_mfma_f32_16x16x32_bf16 v[56:59], a[168:171], a[28:31], v[56:59]
  v_mfma_f32_16x16x32_bf16 v[60:63], a[172:175], a[28:31], v[60:63]
  ds_read_b64_tr_b16 a[120:121], v10 offset:24576
  v_mfma_f32_16x16x32_bf16 v[64:67], a[144:147], a[32:35], v[64:67]
  ds_read_b64_tr_b16 a[122:123], v10 offset:25600
  v_mfma_f32_16x16x32_bf16 v[68:71], a[148:151], a[32:35], v[68:71]
  v_mfma_f32_16x16x32_bf16 v[72:75], a[152:155], a[32:35], v[72:75]
  ds_read_b64_tr_b16 a[124:125], v10 offset:24584
  v_mfma_f32_16x16x32_bf16 v[76:79], a[156:159], a[32:35], v[76:79]
  ds_read_b64_tr_b16 a[126:127], v10 offset:25608
  v_mfma_f32_16x16x32_bf16 v[80:83], a[160:163], a[32:35], v[80:83]
  v_mfma_f32_16x16x32_bf16 v[84:87], a[164:167], a[32:35], v[84:87]
  ds_read_b64_tr_b16 a[128:129], v11 offset:24576
  v_mfma_f32_16x16x32_bf16 v[88:91], a[168:171], a[32:35], v[88:91]
  v_mfma_f32_16x16x32_bf16 v[92:95], a[172:175], a[32:35], v[92:95]
  ds_read_b64_tr_b16 a[130:131], v11 offset:25600
  v_mfma_f32_16x16x32_bf16 v[96:99], a[144:147], a[36:39], v[96:99]
  ds_read_b64_tr_b16 a[132:133], v11 offset:24584
  v_mfma_f32_16x16x32_bf16 v[100:103], a[148:151], a[36:39], v[100:103]
  v_mfma_f32_16x16x32_bf16 v[104:107], a[152:155], a[36:39], v[104:107]
  ds_read_b64_tr_b16 a[134:135], v11 offset:25608
  v_mfma_f32_16x16x32_bf16 v[108:111], a[156:159], a[36:39], v[108:111]
  ds_read_b64_tr_b16 a[136:137], v12 offset:24576
  v_mfma_f32_16x16x32_bf16 v[112:115], a[160:163], a[36:39], v[112:115]
  v_mfma_f32_16x16x32_bf16 v[116:119], a[164:167], a[36:39], v[116:119]
  ds_read_b64_tr_b16 a[138:139], v12 offset:25600
  v_mfma_f32_16x16x32_bf16 v[120:123], a[168:171], a[36:39], v[120:123]
  ds_read_b64_tr_b16 a[140:141], v12 offset:24584
  v_mfma_f32_16x16x32_bf16 v[124:127], a[172:175], a[36:39], v[124:127]
  v_mfma_f32_16x16x32_bf16 v[128:131], a[144:147], a[40:43], v[128:131]
  s_waitcnt lgkmcnt(8)
  ds_read_b64_tr_b16 a[142:143], v12 offset:25608
  v_mfma_f32_16x16x32_bf16 v[132:135], a[148:151], a[40:43], v[132:135]
  v_mfma_f32_16x16x32_bf16 v[136:139], a[152:155], a[40:43], v[136:139]
  ds_read_b128 a[56:59], v7 offset:16384
  v_mfma_f32_16x16x32_bf16 v[140:143], a[156:159], a[40:43], v[140:143]
  ds_read_b128 a[60:63], v7 offset:17408
  v_mfma_f32_16x16x32_bf16 v[144:147], a[160:163], a[40:43], v[144:147]
  v_mfma_f32_16x16x32_bf16 v[148:151], a[164:167], a[40:43], v[148:151]
  ds_read_b128 a[64:67], v7 offset:18432
  v_mfma_f32_16x16x32_bf16 v[152:155], a[168:171], a[40:43], v[152:155]
  ds_read_b128 a[68:71], v7 offset:19456
  v_mfma_f32_16x16x32_bf16 v[156:159], a[172:175], a[40:43], v[156:159]
  v_mfma_f32_16x16x32_bf16 v[160:163], a[144:147], a[44:47], v[160:163]
  ds_read_b128 a[72:75], v7 offset:20480
  v_mfma_f32_16x16x32_bf16 v[164:167], a[148:151], a[44:47], v[164:167]
  ds_read_b128 a[76:79], v7 offset:21504
  v_mfma_f32_16x16x32_bf16 v[168:171], a[152:155], a[44:47], v[168:171]
  v_mfma_f32_16x16x32_bf16 v[172:175], a[156:159], a[44:47], v[172:175]
  s_waitcnt lgkmcnt(8)
  ds_read_b128 a[80:83], v7 offset:22528
  v_mfma_f32_16x16x32_bf16 v[176:179], a[160:163], a[44:47], v[176:179]
  v_mfma_f32_16x16x32_bf16 v[180:183], a[164:167], a[44:47], v[180:183]
  ds_read_b128 a[84:87], v8 offset:16384
  v_mfma_f32_16x16x32_bf16 v[184:187], a[168:171], a[44:47], v[184:187]
  ds_read_b128 a[88:91], v8 offset:17408
  v_mfma_f32_16x16x32_bf16 v[188:191], a[172:175], a[44:47], v[188:191]
  v_mfma_f32_16x16x32_bf16 v[192:195], a[144:147], a[48:51], v[192:195]
  ds_read_b128 a[92:95], v8 offset:18432
  v_mfma_f32_16x16x32_bf16 v[196:199], a[148:151], a[48:51], v[196:199]
  ds_read_b128 a[96:99], v8 offset:19456
  v_mfma_f32_16x16x32_bf16 v[200:203], a[152:155], a[48:51], v[200:203]
  v_mfma_f32_16x16x32_bf16 v[204:207], a[156:159], a[48:51], v[204:207]
  ds_read_b128 a[100:103], v8 offset:20480
  v_mfma_f32_16x16x32_bf16 v[208:211], a[160:163], a[48:51], v[208:211]
  ds_read_b128 a[104:107], v8 offset:21504
  v_mfma_f32_16x16x32_bf16 v[212:215], a[164:167], a[48:51], v[212:215]
  v_mfma_f32_16x16x32_bf16 v[216:219], a[168:171], a[48:51], v[216:219]
  s_waitcnt lgkmcnt(8)
  ds_read_b128 a[108:111], v8 offset:22528
  v_mfma_f32_16x16x32_bf16 v[220:223], a[172:175], a[48:51], v[220:223]
  v_mfma_f32_16x16x32_bf16 v[224:227], a[144:147], a[52:55], v[224:227]
  v_mfma_f32_16x16x32_bf16 v[228:231], a[148:151], a[52:55], v[228:231]
  v_mfma_f32_16x16x32_bf16 v[232:235], a[152:155], a[52:55], v[232:235]
  v_mfma_f32_16x16x32_bf16 v[236:239], a[156:159], a[52:55], v[236:239]
  v_mfma_f32_16x16x32_bf16 v[240:243], a[160:163], a[52:55], v[240:243]
  v_mfma_f32_16x16x32_bf16 v[244:247], a[164:167], a[52:55], v[244:247]
  v_mfma_f32_16x16x32_bf16 v[248:251], a[168:171], a[52:55], v[248:251]
  v_mfma_f32_16x16x32_bf16 v[252:255], a[172:175], a[52:55], v[252:255]
  s_waitcnt lgkmcnt(0)
  s_barrier
  v_mfma_f32_16x16x32_bf16 v[32:35], a[112:115], a[56:59], v[32:35]
  ds_read_b64_tr_b16 a[144:145], v9 offset:57344
  v_mfma_f32_16x16x32_bf16 v[36:39], a[116:119], a[56:59], v[36:39]
  v_mfma_f32_16x16x32_bf16 v[40:43], a[120:123], a[56:59], v[40:43]
  ds_read_b64_tr_b16 a[146:147], v9 offset:58368
  v_mfma_f32_16x16x32_bf16 v[44:47], a[124:127], a[56:59], v[44:47]
  buffer_load_dwordx4 v4, s[8:11], s45 offen offset:2048 nt lds
  v_mfma_f32_16x16x32_bf16 v[48:51], a[128:131], a[56:59], v[48:51]
  v_mfma_f32_16x16x32_bf16 v[52:55], a[132:135], a[56:59], v[52:55]
  v_mfma_f32_16x16x32_bf16 v[56:59], a[136:139], a[56:59], v[56:59]
  ds_read_b64_tr_b16 a[148:149], v9 offset:57352
  v_mfma_f32_16x16x32_bf16 v[60:63], a[140:143], a[56:59], v[60:63]
  v_mfma_f32_16x16x32_bf16 v[64:67], a[112:115], a[60:63], v[64:67]
  v_mfma_f32_16x16x32_bf16 v[68:71], a[116:119], a[60:63], v[68:71]
  ds_read_b64_tr_b16 a[150:151], v9 offset:58376
  v_mfma_f32_16x16x32_bf16 v[72:75], a[120:123], a[60:63], v[72:75]
  v_mfma_f32_16x16x32_bf16 v[76:79], a[124:127], a[60:63], v[76:79]
  v_mfma_f32_16x16x32_bf16 v[80:83], a[128:131], a[60:63], v[80:83]
  ds_read_b64_tr_b16 a[152:153], v10 offset:57344
  v_mfma_f32_16x16x32_bf16 v[84:87], a[132:135], a[60:63], v[84:87]
  v_mfma_f32_16x16x32_bf16 v[88:91], a[136:139], a[60:63], v[88:91]
  v_mfma_f32_16x16x32_bf16 v[92:95], a[140:143], a[60:63], v[92:95]
  ds_read_b64_tr_b16 a[154:155], v10 offset:58368
  v_mfma_f32_16x16x32_bf16 v[96:99], a[112:115], a[64:67], v[96:99]
  v_mfma_f32_16x16x32_bf16 v[100:103], a[116:119], a[64:67], v[100:103]
  v_mfma_f32_16x16x32_bf16 v[104:107], a[120:123], a[64:67], v[104:107]
  ds_read_b64_tr_b16 a[156:157], v10 offset:57352
  v_mfma_f32_16x16x32_bf16 v[108:111], a[124:127], a[64:67], v[108:111]
  v_mfma_f32_16x16x32_bf16 v[112:115], a[128:131], a[64:67], v[112:115]
  v_mfma_f32_16x16x32_bf16 v[116:119], a[132:135], a[64:67], v[116:119]
  ds_read_b64_tr_b16 a[158:159], v10 offset:58376
  v_mfma_f32_16x16x32_bf16 v[120:123], a[136:139], a[64:67], v[120:123]
  v_mfma_f32_16x16x32_bf16 v[124:127], a[140:143], a[64:67], v[124:127]
  v_mfma_f32_16x16x32_bf16 v[128:131], a[112:115], a[68:71], v[128:131]
  ds_read_b64_tr_b16 a[160:161], v11 offset:57344
  v_mfma_f32_16x16x32_bf16 v[132:135], a[116:119], a[68:71], v[132:135]
  v_mfma_f32_16x16x32_bf16 v[136:139], a[120:123], a[68:71], v[136:139]
  v_mfma_f32_16x16x32_bf16 v[140:143], a[124:127], a[68:71], v[140:143]
  ds_read_b64_tr_b16 a[162:163], v11 offset:58368
  v_mfma_f32_16x16x32_bf16 v[144:147], a[128:131], a[68:71], v[144:147]
  v_mfma_f32_16x16x32_bf16 v[148:151], a[132:135], a[68:71], v[148:151]
  v_mfma_f32_16x16x32_bf16 v[152:155], a[136:139], a[68:71], v[152:155]
  ds_read_b64_tr_b16 a[164:165], v11 offset:57352
  v_mfma_f32_16x16x32_bf16 v[156:159], a[140:143], a[68:71], v[156:159]
  v_mfma_f32_16x16x32_bf16 v[160:163], a[112:115], a[72:75], v[160:163]
  v_mfma_f32_16x16x32_bf16 v[164:167], a[116:119], a[72:75], v[164:167]
  ds_read_b64_tr_b16 a[166:167], v11 offset:58376
  v_mfma_f32_16x16x32_bf16 v[168:171], a[120:123], a[72:75], v[168:171]
  v_mfma_f32_16x16x32_bf16 v[172:175], a[124:127], a[72:75], v[172:175]
  v_mfma_f32_16x16x32_bf16 v[176:179], a[128:131], a[72:75], v[176:179]
  ds_read_b64_tr_b16 a[168:169], v12 offset:57344
  v_mfma_f32_16x16x32_bf16 v[180:183], a[132:135], a[72:75], v[180:183]
  v_mfma_f32_16x16x32_bf16 v[184:187], a[136:139], a[72:75], v[184:187]
  v_mfma_f32_16x16x32_bf16 v[188:191], a[140:143], a[72:75], v[188:191]
  ds_read_b64_tr_b16 a[170:171], v12 offset:58368
  v_mfma_f32_16x16x32_bf16 v[192:195], a[112:115], a[76:79], v[192:195]
  v_mfma_f32_16x16x32_bf16 v[196:199], a[116:119], a[76:79], v[196:199]
  v_mfma_f32_16x16x32_bf16 v[200:203], a[120:123], a[76:79], v[200:203]
  ds_read_b64_tr_b16 a[172:173], v12 offset:57352
  v_mfma_f32_16x16x32_bf16 v[204:207], a[124:127], a[76:79], v[204:207]
  v_mfma_f32_16x16x32_bf16 v[208:211], a[128:131], a[76:79], v[208:211]
  v_mfma_f32_16x16x32_bf16 v[212:215], a[132:135], a[76:79], v[212:215]
  s_waitcnt lgkmcnt(8)
  ds_read_b64_tr_b16 a[174:175], v12 offset:58376
  v_mfma_f32_16x16x32_bf16 v[216:219], a[136:139], a[76:79], v[216:219]
  v_mfma_f32_16x16x32_bf16 v[220:223], a[140:143], a[76:79], v[220:223]
  v_mfma_f32_16x16x32_bf16 v[224:227], a[112:115], a[80:83], v[224:227]
  v_mfma_f32_16x16x32_bf16 v[228:231], a[116:119], a[80:83], v[228:231]
  v_mfma_f32_16x16x32_bf16 v[232:235], a[120:123], a[80:83], v[232:235]
  v_mfma_f32_16x16x32_bf16 v[236:239], a[124:127], a[80:83], v[236:239]
  v_mfma_f32_16x16x32_bf16 v[240:243], a[128:131], a[80:83], v[240:243]
  v_mfma_f32_16x16x32_bf16 v[244:247], a[132:135], a[80:83], v[244:247]
  v_mfma_f32_16x16x32_bf16 v[248:251], a[136:139], a[80:83], v[248:251]
  v_mfma_f32_16x16x32_bf16 v[252:255], a[140:143], a[80:83], v[252:255]
  s_waitcnt lgkmcnt(0)
  s_barrier
  v_mfma_f32_16x16x32_bf16 v[32:35], a[144:147], a[84:87], v[32:35]
  ds_read_b64_tr_b16 a[112:113], v9 offset:8192
  v_mfma_f32_16x16x32_bf16 v[36:39], a[148:151], a[84:87], v[36:39]
  ds_read_b64_tr_b16 a[114:115], v9 offset:9216
  v_mfma_f32_16x16x32_bf16 v[40:43], a[152:155], a[84:87], v[40:43]
  v_mfma_f32_16x16x32_bf16 v[44:47], a[156:159], a[84:87], v[44:47]
  buffer_load_dwordx4 v4, s[8:11], s45 offen offset:3072 nt lds
  v_mfma_f32_16x16x32_bf16 v[48:51], a[160:163], a[84:87], v[48:51]
  ds_read_b64_tr_b16 a[116:117], v9 offset:8200
  v_mfma_f32_16x16x32_bf16 v[52:55], a[164:167], a[84:87], v[52:55]
  s_add_u32 s40, s40, 4096
  v_xor_b32 v4, 4224, v4
  v_mfma_f32_16x16x32_bf16 v[56:59], a[168:171], a[84:87], v[56:59]
  ds_read_b64_tr_b16 a[118:119], v9 offset:9224
  v_mfma_f32_16x16x32_bf16 v[60:63], a[172:175], a[84:87], v[60:63]
  s_cmp_eq_u32 s50, 1
  v_mfma_f32_16x16x32_bf16 v[64:67], a[144:147], a[88:91], v[64:67]
  s_cselect_b32 s8, s20, s8
  ds_read_b64_tr_b16 a[120:121], v10 offset:8192
  v_mfma_f32_16x16x32_bf16 v[68:71], a[148:151], a[88:91], v[68:71]
  s_cselect_b32 s9, s21, s9
  ds_read_b64_tr_b16 a[122:123], v10 offset:9216
  v_mfma_f32_16x16x32_bf16 v[72:75], a[152:155], a[88:91], v[72:75]
  v_mfma_f32_16x16x32_bf16 v[76:79], a[156:159], a[88:91], v[76:79]
  ds_read_b64_tr_b16 a[124:125], v10 offset:8200
  v_mfma_f32_16x16x32_bf16 v[80:83], a[160:163], a[88:91], v[80:83]
  ds_read_b64_tr_b16 a[126:127], v10 offset:9224
  v_mfma_f32_16x16x32_bf16 v[84:87], a[164:167], a[88:91], v[84:87]
  v_mfma_f32_16x16x32_bf16 v[88:91], a[168:171], a[88:91], v[88:91]
  ds_read_b64_tr_b16 a[128:129], v11 offset:8192
  v_mfma_f32_16x16x32_bf16 v[92:95], a[172:175], a[88:91], v[92:95]
  ds_read_b64_tr_b16 a[130:131], v11 offset:9216
  v_mfma_f32_16x16x32_bf16 v[96:99], a[144:147], a[92:95], v[96:99]
  v_mfma_f32_16x16x32_bf16 v[100:103], a[148:151], a[92:95], v[100:103]
  ds_read_b64_tr_b16 a[132:133], v11 offset:8200
  v_mfma_f32_16x16x32_bf16 v[104:107], a[152:155], a[92:95], v[104:107]
  ds_read_b64_tr_b16 a[134:135], v11 offset:9224
  v_mfma_f32_16x16x32_bf16 v[108:111], a[156:159], a[92:95], v[108:111]
  v_mfma_f32_16x16x32_bf16 v[112:115], a[160:163], a[92:95], v[112:115]
  ds_read_b64_tr_b16 a[136:137], v12 offset:8192
  v_mfma_f32_16x16x32_bf16 v[116:119], a[164:167], a[92:95], v[116:119]
  ds_read_b64_tr_b16 a[138:139], v12 offset:9216
  v_mfma_f32_16x16x32_bf16 v[120:123], a[168:171], a[92:95], v[120:123]
  v_mfma_f32_16x16x32_bf16 v[124:127], a[172:175], a[92:95], v[124:127]
  ds_read_b64_tr_b16 a[140:141], v12 offset:8200
  v_mfma_f32_16x16x32_bf16 v[128:131], a[144:147], a[96:99], v[128:131]
  v_mfma_f32_16x16x32_bf16 v[132:135], a[148:151], a[96:99], v[132:135]
  s_waitcnt lgkmcnt(8)
  ds_read_b64_tr_b16 a[142:143], v12 offset:9224
  v_mfma_f32_16x16x32_bf16 v[136:139], a[152:155], a[96:99], v[136:139]
  ds_read_b128 a[0:3], v7 offset:0
  v_mfma_f32_16x16x32_bf16 v[140:143], a[156:159], a[96:99], v[140:143]
  v_mfma_f32_16x16x32_bf16 v[144:147], a[160:163], a[96:99], v[144:147]
  ds_read_b128 a[4:7], v7 offset:1024
  v_mfma_f32_16x16x32_bf16 v[148:151], a[164:167], a[96:99], v[148:151]
  ds_read_b128 a[8:11], v7 offset:2048
  v_mfma_f32_16x16x32_bf16 v[152:155], a[168:171], a[96:99], v[152:155]
  v_mfma_f32_16x16x32_bf16 v[156:159], a[172:175], a[96:99], v[156:159]
  ds_read_b128 a[12:15], v7 offset:3072
  v_mfma_f32_16x16x32_bf16 v[160:163], a[144:147], a[100:103], v[160:163]
  ds_read_b128 a[16:19], v7 offset:4096
  v_mfma_f32_16x16x32_bf16 v[164:167], a[148:151], a[100:103], v[164:167]
  v_mfma_f32_16x16x32_bf16 v[168:171], a[152:155], a[100:103], v[168:171]
  ds_read_b128 a[20:23], v7 offset:5120
  v_mfma_f32_16x16x32_bf16 v[172:175], a[156:159], a[100:103], v[172:175]
  s_waitcnt lgkmcnt(8)
  ds_read_b128 a[24:27], v7 offset:6144
  v_mfma_f32_16x16x32_bf16 v[176:179], a[160:163], a[100:103], v[176:179]
  v_mfma_f32_16x16x32_bf16 v[180:183], a[164:167], a[100:103], v[180:183]
  ds_read_b128 a[28:31], v8 offset:0
  v_mfma_f32_16x16x32_bf16 v[184:187], a[168:171], a[100:103], v[184:187]
  ds_read_b128 a[32:35], v8 offset:1024
  v_mfma_f32_16x16x32_bf16 v[188:191], a[172:175], a[100:103], v[188:191]
  v_mfma_f32_16x16x32_bf16 v[192:195], a[144:147], a[104:107], v[192:195]
  ds_read_b128 a[36:39], v8 offset:2048
  v_mfma_f32_16x16x32_bf16 v[196:199], a[148:151], a[104:107], v[196:199]
  ds_read_b128 a[40:43], v8 offset:3072
  v_mfma_f32_16x16x32_bf16 v[200:203], a[152:155], a[104:107], v[200:203]
  v_mfma_f32_16x16x32_bf16 v[204:207], a[156:159], a[104:107], v[204:207]
  ds_read_b128 a[44:47], v8 offset:4096
  v_mfma_f32_16x16x32_bf16 v[208:211], a[160:163], a[104:107], v[208:211]
  ds_read_b128 a[48:51], v8 offset:5120
  v_mfma_f32_16x16x32_bf16 v[212:215], a[164:167], a[104:107], v[212:215]
  v_mfma_f32_16x16x32_bf16 v[216:219], a[168:171], a[104:107], v[216:219]
  s_waitcnt lgkmcnt(8)
  ds_read_b128 a[52:55], v8 offset:6144
  v_mfma_f32_16x16x32_bf16 v[220:223], a[172:175], a[104:107], v[220:223]
  v_mfma_f32_16x16x32_bf16 v[224:227], a[144:147], a[108:111], v[224:227]
  v_mfma_f32_16x16x32_bf16 v[228:231], a[148:151], a[108:111], v[228:231]
  v_mfma_f32_16x16x32_bf16 v[232:235], a[152:155], a[108:111], v[232:235]
  v_mfma_f32_16x16x32_bf16 v[236:239], a[156:159], a[108:111], v[236:239]
  v_mfma_f32_16x16x32_bf16 v[240:243], a[160:163], a[108:111], v[240:243]
  v_mfma_f32_16x16x32_bf16 v[244:247], a[164:167], a[108:111], v[244:247]
  v_mfma_f32_16x16x32_bf16 v[248:251], a[168:171], a[108:111], v[248:251]
  s_add_u32 s50, s50, 1
  v_mfma_f32_16x16x32_bf16 v[252:255], a[172:175], a[108:111], v[252:255]
  s_cmp_lt_u32 s50, 4
  s_cbranch_scc1 L1a_qloopA
  s_mov_b32 s12, s92
  s_mov_b32 s13, s93
  s_mov_b32 s14, 8388608
  s_mov_b32 s15, 131072
  s_add_u32 s8, s98, 83886080
  s_addc_u32 s9, s99, 0
  s_mov_b32 s10, 8388608
  s_mov_b32 s11, 131072
  s_lshl_b32 s43, s2, 15
  s_lshl_b32 s46, s4, 10
  s_add_u32 s43, s43, s46
  s_mov_b32 s44, 16777216
  v_lshrrev_b32 v2, 4, v1
  v_and_b32 v3, 15, v1
  v_lshlrev_b32 v3, 4, v3
  v_lshl_add_u32 v4, v2, 11, v3
L1a_qloopB:
  s_waitcnt lgkmcnt(0)
  s_barrier
  v_mfma_f32_16x16x32_bf16 v[32:35], a[112:115], a[0:3], v[32:35]
  ds_read_b64_tr_b16 a[144:145], v9 offset:40960
  v_mfma_f32_16x16x32_bf16 v[36:39], a[116:119], a[0:3], v[36:39]
  v_mfma_f32_16x16x32_bf16 v[40:43], a[120:123], a[0:3], v[40:43]
  s_waitcnt vmcnt(2)
  ds_read_b64_tr_b16 a[146:147], v9 offset:41984
  v_mfma_f32_16x16x32_bf16 v[44:47], a[124:127], a[0:3], v[44:47]
  s_add_u32 s46, s44, 0
  buffer_store_dwordx4 a[192:195], v4, s[8:11], s46 offen offset:0 sc1
  v_mfma_f32_16x16x32_bf16 v[48:51], a[128:131], a[0:3], v[48:51]
  v_mfma_f32_16x16x32_bf16 v[52:55], a[132:135], a[0:3], v[52:55]
  v_mfma_f32_16x16x32_bf16 v[56:59], a[136:139], a[0:3], v[56:59]
  ds_read_b64_tr_b16 a[148:149], v9 offset:40968
  v_mfma_f32_16x16x32_bf16 v[60:63], a[140:143], a[0:3], v[60:63]
  s_add_u32 s46, s43, 0
  buffer_load_dwordx4 a[192:195], v4, s[12:15], s46 offen offset:256
  v_mfma_f32_16x16x32_bf16 v[64:67], a[112:115], a[4:7], v[64:67]
  v_mfma_f32_16x16x32_bf16 v[68:71], a[116:119], a[4:7], v[68:71]
  v_mfma_f32_16x16x32_bf16 v[72:75], a[120:123], a[4:7], v[72:75]
  ds_read_b64_tr_b16 a[150:151], v9 offset:41992
  v_mfma_f32_16x16x32_bf16 v[76:79], a[124:127], a[4:7], v[76:79]
  v_mfma_f32_16x16x32_bf16 v[80:83], a[128:131], a[4:7], v[80:83]
  v_mfma_f32_16x16x32_bf16 v[84:87], a[132:135], a[4:7], v[84:87]
  ds_read_b64_tr_b16 a[152:153], v10 offset:40960
  v_mfma_f32_16x16x32_bf16 v[88:91], a[136:139], a[4:7], v[88:91]
  v_mfma_f32_16x16x32_bf16 v[92:95], a[140:143], a[4:7], v[92:95]
  v_mfma_f32_16x16x32_bf16 v[96:99], a[112:115], a[8:11], v[96:99]
  ds_read_b64_tr_b16 a[154:155], v10 offset:41984
  v_mfma_f32_16x16x32_bf16 v[100:103], a[116:119], a[8:11], v[100:103]
  v_mfma_f32_16x16x32_bf16 v[104:107], a[120:123], a[8:11], v[104:107]
  v_mfma_f32_16x16x32_bf16 v[108:111], a[124:127], a[8:11], v[108:111]
  ds_read_b64_tr_b16 a[156:157], v10 offset:40968
  v_mfma_f32_16x16x32_bf16 v[112:115], a[128:131], a[8:11], v[112:115]
  v_mfma_f32_16x16x32_bf16 v[116:119], a[132:135], a[8:11], v[116:119]
  v_mfma_f32_16x16x32_bf16 v[120:123], a[136:139], a[8:11], v[120:123]
  ds_read_b64_tr_b16 a[158:159], v10 offset:41992
  v_mfma_f32_16x16x32_bf16 v[124:127], a[140:143], a[8:11], v[124:127]
  v_mfma_f32_16x16x32_bf16 v[128:131], a[112:115], a[12:15], v[128:131]
  v_mfma_f32_16x16x32_bf16 v[132:135], a[116:119], a[12:15], v[132:135]
  ds_read_b64_tr_b16 a[160:161], v11 offset:40960
  v_mfma_f32_16x16x32_bf16 v[136:139], a[120:123], a[12:15], v[136:139]
  v_mfma_f32_16x16x32_bf16 v[140:143], a[124:127], a[12:15], v[140:143]
  ds_read_b64_tr_b16 a[162:163], v11 offset:41984
  v_mfma_f32_16x16x32_bf16 v[144:147], a[128:131], a[12:15], v[144:147]
  v_mfma_f32_16x16x32_bf16 v[148:151], a[132:135], a[12:15], v[148:151]
  v_mfma_f32_16x16x32_bf16 v[152:155], a[136:139], a[12:15], v[152:155]
  ds_read_b64_tr_b16 a[164:165], v11 offset:40968
  v_mfma_f32_16x16x32_bf16 v[156:159], a[140:143], a[12:15], v[156:159]
  v_mfma_f32_16x16x32_bf16 v[160:163], a[112:115], a[16:19], v[160:163]
  v_mfma_f32_16x16x32_bf16 v[164:167], a[116:119], a[16:19], v[164:167]
  ds_read_b64_tr_b16 a[166:167], v11 offset:41992
  v_mfma_f32_16x16x32_bf16 v[168:171], a[120:123], a[16:19], v[168:171]
  v_mfma_f32_16x16x32_bf16 v[172:175], a[124:127], a[16:19], v[172:175]
  v_mfma_f32_16x16x32_bf16 v[176:179], a[128:131], a[16:19], v[176:179]
  ds_read_b64_tr_b16 a[168:169], v12 offset:40960
  v_mfma_f32_16x16x32_bf16 v[180:183], a[132:135], a[16:19], v[180:183]
  v_mfma_f32_16x16x32_bf16 v[184:187], a[136:139], a[16:19], v[184:187]
  v_mfma_f32_16x16x32_bf16 v[188:191], a[140:143], a[16:19], v[188:191]
  ds_read_b64_tr_b16 a[170:171], v12 offset:41984
  v_mfma_f32_16x16x32_bf16 v[192:195], a[112:115], a[20:23], v[192:195]
  v_mfma_f32_16x16x32_bf16 v[196:199], a[116:119], a[20:23], v[196:199]
  v_mfma_f32_16x16x32_bf16 v[200:203], a[120:123], a[20:23], v[200:203]
  ds_read_b64_tr_b16 a[172:173], v12 offset:40968
  v_mfma_f32_16x16x32_bf16 v[204:207], a[124:127], a[20:23], v[204:207]
  v_mfma_f32_16x16x32_bf16 v[208:211], a[128:131], a[20:23], v[208:211]
  v_mfma_f32_16x16x32_bf16 v[212:215], a[132:135], a[20:23], v[212:215]
  s_waitcnt lgkmcnt(8)
  ds_read_b64_tr_b16 a[174:175], v12 offset:41992
  v_mfma_f32_16x16x32_bf16 v[216:219], a[136:139], a[20:23], v[216:219]
  v_mfma_f32_16x16x32_bf16 v[220:223], a[140:143], a[20:23], v[220:223]
  v_mfma_f32_16x16x32_bf16 v[224:227], a[112:115], a[24:27], v[224:227]
  v_mfma_f32_16x16x32_bf16 v[228:231], a[116:119], a[24:27], v[228:231]
  v_mfma_f32_16x16x32_bf16 v[232:235], a[120:123], a[24:27], v[232:235]
  v_mfma_f32_16x16x32_bf16 v[236:239], a[124:127], a[24:27], v[236:239]
  v_mfma_f32_16x16x32_bf16 v[240:243], a[128:131], a[24:27], v[240:243]
  v_mfma_f32_16x16x32_bf16 v[244:247], a[132:135], a[24:27], v[244:247]
  v_mfma_f32_16x16x32_bf16 v[248:251], a[136:139], a[24:27], v[248:251]
  v_mfma_f32_16x16x32_bf16 v[252:255], a[140:143], a[24:27], v[252:255]
  s_waitcnt lgkmcnt(0)
  s_barrier
  v_mfma_f32_16x16x32_bf16 v[32:35], a[144:147], a[28:31], v[32:35]
  ds_read_b64_tr_b16 a[112:113], v9 offset:24576
  v_mfma_f32_16x16x32_bf16 v[36:39], a[148:151], a[28:31], v[36:39]
  ds_read_b64_tr_b16 a[114:115], v9 offset:25600
  v_mfma_f32_16x16x32_bf16 v[40:43], a[152:155], a[28:31], v[40:43]
  v_mfma_f32_16x16x32_bf16 v[44:47], a[156:159], a[28:31], v[44:47]
  ds_read_b64_tr_b16 a[116:117], v9 offset:24584
  v_mfma_f32_16x16x32_bf16 v[48:51], a[160:163], a[28:31], v[48:51]
  ds_read_b64_tr_b16 a[118:119], v9 offset:25608
  v_mfma_f32_16x16x32_bf16 v[52:55], a[164:167], a[28:31], v[52:55]
  v_mfma_f32_16x16x32_bf16 v[56:59], a[168:171], a[28:31], v[56:59]
  ds_read_b64_tr_b16 a[120:121], v10 offset:24576
  v_mfma_f32_16x16x32_bf16 v[60:63], a[172:175], a[28:31], v[60:63]
  v_mfma_f32_16x16x32_bf16 v[64:67], a[144:147], a[32:35], v[64:67]
  ds_read_b64_tr_b16 a[122:123], v10 offset:25600
  v_mfma_f32_16x16x32_bf16 v[68:71], a[148:151], a[32:35], v[68:71]
  ds_read_b64_tr_b16 a[124:125], v10 offset:24584
  v_mfma_f32_16x16x32_bf16 v[72:75], a[152:155], a[32:35], v[72:75]
  v_mfma_f32_16x16x32_bf16 v[76:79], a[156:159], a[32:35], v[76:79]
  ds_read_b64_tr_b16 a[126:127], v10 offset:25608
  v_mfma_f32_16x16x32_bf16 v[80:83], a[160:163], a[32:35], v[80:83]
  ds_read_b64_tr_b16 a[128:129], v11 offset:24576
  v_mfma_f32_16x16x32_bf16 v[84:87], a[164:167], a[32:35], v[84:87]
  v_mfma_f32_16x16x32_bf16 v[88:91], a[168:171], a[32:35], v[88:91]
  ds_read_b64_tr_b16 a[130:131], v11 offset:25600
  v_mfma_f32_16x16x32_bf16 v[92:95], a[172:175], a[32:35], v[92:95]
  v_mfma_f32_16x16x32_bf16 v[96:99], a[144:147], a[36:39], v[96:99]
  ds_read_b64_tr_b16 a[132:133], v11 offset:24584
  v_mfma_f32_16x16x32_bf16 v[100:103], a[148:151], a[36:39], v[100:103]
  ds_read_b64_tr_b16 a[134:135], v11 offset:25608
  v_mfma_f32_16x16x32_bf16 v[104:107], a[152:155], a[36:39], v[104:107]
  v_mfma_f32_16x16x32_bf16 v[108:111], a[156:159], a[36:39], v[108:111]
  ds_read_b64_tr_b16 a[136:137], v12 offset:24576
  v_mfma_f32_16x16x32_bf16 v[112:115], a[160:163], a[36:39], v[112:115]
  ds_read_b64_tr_b16 a[138:139], v12 offset:25600
  v_mfma_f32_16x16x32_bf16 v[116:119], a[164:167], a[36:39], v[116:119]
  v_mfma_f32_16x16x32_bf16 v[120:123], a[168:171], a[36:39], v[120:123]
  ds_read_b64_tr_b16 a[140:141], v12 offset:24584
  v_mfma_f32_16x16x32_bf16 v[124:127], a[172:175], a[36:39], v[124:127]
  v_mfma_f32_16x16x32_bf16 v[128:131], a[144:147], a[40:43], v[128:131]
  s_waitcnt lgkmcnt(8)
  ds_read_b64_tr_b16 a[142:143], v12 offset:25608
  v_mfma_f32_16x16x32_bf16 v[132:135], a[148:151], a[40:43], v[132:135]
  ds_read_b128 a[56:59], v7 offset:16384
  v_mfma_f32_16x16x32_bf16 v[136:139], a[152:155], a[40:43], v[136:139]
  v_mfma_f32_16x16x32_bf16 v[140:143], a[156:159], a[40:43], v[140:143]
  ds_read_b128 a[60:63], v7 offset:17408
  v_mfma_f32_16x16x32_bf16 v[144:147], a[160:163], a[40:43], v[144:147]
  ds_read_b128 a[64:67], v7 offset:18432
  v_mfma_f32_16x16x32_bf16 v[148:151], a[164:167], a[40:43], v[148:151]
  v_mfma_f32_16x16x32_bf16 v[152:155], a[168:171], a[40:43], v[152:155]
  ds_read_b128 a[68:71], v7 offset:19456
  v_mfma_f32_16x16x32_bf16 v[156:159], a[172:175], a[40:43], v[156:159]
  v_mfma_f32_16x16x32_bf16 v[160:163], a[144:147], a[44:47], v[160:163]
  ds_read_b128 a[72:75], v7 offset:20480
  v_mfma_f32_16x16x32_bf16 v[164:167], a[148:151], a[44:47], v[164:167]
  ds_read_b128 a[76:79], v7 offset:21504
  v_mfma_f32_16x16x32_bf16 v[168:171], a[152:155], a[44:47], v[168:171]
  v_mfma_f32_16x16x32_bf16 v[172:175], a[156:159], a[44:47], v[172:175]
  s_waitcnt lgkmcnt(8)
  ds_read_b128 a[80:83], v7 offset:22528
  v_mfma_f32_16x16x32_bf16 v[176:179], a[160:163], a[44:47], v[176:179]
  ds_read_b128 a[84:87], v8 offset:16384
  v_mfma_f32_16x16x32_bf16 v[180:183], a[164:167], a[44:47], v[180:183]
  v_mfma_f32_16x16x32_bf16 v[184:187], a[168:171], a[44:47], v[184:187]
  ds_read_b128 a[88:91], v8 offset:17408
  v_mfma_f32_16x16x32_bf16 v[188:191], a[172:175], a[44:47], v[188:191]
  v_mfma_f32_16x16x32_bf16 v[192:195], a[144:147], a[48:51], v[192:195]
  ds_read_b128 a[92:95], v8 offset:18432
  v_mfma_f32_16x16x32_bf16 v[196:199], a[148:151], a[48:51], v[196:199]
  ds_read_b128 a[96:99], v8 offset:19456
  v_mfma_f32_16x16x32_bf16 v[200:203], a[152:155], a[48:51], v[200:203]
  v_mfma_f32_16x16x32_bf16 v[204:207], a[156:159], a[48:51], v[204:207]
  ds_read_b128 a[100:103], v8 offset:20480
  v_mfma_f32_16x16x32_bf16 v[208:211], a[160:163], a[48:51], v[208:211]
  ds_read_b128 a[104:107], v8 offset:21504
  v_mfma_f32_16x16x32_bf16 v[212:215], a[164:167], a[48:51], v[212:215]
  v_mfma_f32_16x16x32_bf16 v[216:219], a[168:171], a[48:51], v[216:219]
  s_waitcnt lgkmcnt(8)
  ds_read_b128 a[108:111], v8 offset:22528
  v_mfma_f32_16x16x32_bf16 v[220:223], a[172:175], a[48:51], v[220:223]
  v_mfma_f32_16x16x32_bf16 v[224:227], a[144:147], a[52:55], v[224:227]
  v_mfma_f32_16x16x32_bf16 v[228:231], a[148:151], a[52:55], v[228:231]
  v_mfma_f32_16x16x32_bf16 v[232:235], a[152:155], a[52:55], v[232:235]
  v_mfma_f32_16x16x32_bf16 v[236:239], a[156:159], a[52:55], v[236:239]
  v_mfma_f32_16x16x32_bf16 v[240:243], a[160:163], a[52:55], v[240:243]
  v_mfma_f32_16x16x32_bf16 v[244:247], a[164:167], a[52:55], v[244:247]
  v_mfma_f32_16x16x32_bf16 v[248:251], a[168:171], a[52:55], v[248:251]
  v_mfma_f32_16x16x32_bf16 v[252:255], a[172:175], a[52:55], v[252:255]
  s_waitcnt lgkmcnt(0)
  s_barrier
  v_mfma_f32_16x16x32_bf16 v[32:35], a[112:115], a[56:59], v[32:35]
  ds_read_b64_tr_b16 a[144:145], v9 offset:57344
  v_mfma_f32_16x16x32_bf16 v[36:39], a[116:119], a[56:59], v[36:39]
  v_mfma_f32_16x16x32_bf16 v[40:43], a[120:123], a[56:59], v[40:43]
  s_waitcnt vmcnt(2)
  ds_read_b64_tr_b16 a[146:147], v9 offset:58368
  v_mfma_f32_16x16x32_bf16 v[44:47], a[124:127], a[56:59], v[44:47]
  s_add_u32 s46, s44, 8192
  buffer_store_dwordx4 a[196:199], v4, s[8:11], s46 offen offset:0 sc1
  v_mfma_f32_16x16x32_bf16 v[48:51], a[128:131], a[56:59], v[48:51]
  v_mfma_f32_16x16x32_bf16 v[52:55], a[132:135], a[56:59], v[52:55]
  v_mfma_f32_16x16x32_bf16 v[56:59], a[136:139], a[56:59], v[56:59]
  ds_read_b64_tr_b16 a[148:149], v9 offset:57352
  v_mfma_f32_16x16x32_bf16 v[60:63], a[140:143], a[56:59], v[60:63]
  s_add_u32 s46, s43, 8192
  buffer_load_dwordx4 a[196:199], v4, s[12:15], s46 offen offset:256
  v_mfma_f32_16x16x32_bf16 v[64:67], a[112:115], a[60:63], v[64:67]
  v_mfma_f32_16x16x32_bf16 v[68:71], a[116:119], a[60:63], v[68:71]
  s_mov_b32 s44, s43
  v_mfma_f32_16x16x32_bf16 v[72:75], a[120:123], a[60:63], v[72:75]
  s_add_u32 s43, s43, 16384
  ds_read_b64_tr_b16 a[150:151], v9 offset:58376
  v_mfma_f32_16x16x32_bf16 v[76:79], a[124:127], a[60:63], v[76:79]
  s_cmp_eq_u32 s50, 5
  s_cselect_b32 s43, 16777216, s43
  v_mfma_f32_16x16x32_bf16 v[80:83], a[128:131], a[60:63], v[80:83]
  v_mfma_f32_16x16x32_bf16 v[84:87], a[132:135], a[60:63], v[84:87]
  ds_read_b64_tr_b16 a[152:153], v10 offset:57344
  v_mfma_f32_16x16x32_bf16 v[88:91], a[136:139], a[60:63], v[88:91]
  v_mfma_f32_16x16x32_bf16 v[92:95], a[140:143], a[60:63], v[92:95]
  v_mfma_f32_16x16x32_bf16 v[96:99], a[112:115], a[64:67], v[96:99]
  ds_read_b64_tr_b16 a[154:155], v10 offset:58368
  v_mfma_f32_16x16x32_bf16 v[100:103], a[116:119], a[64:67], v[100:103]
  v_mfma_f32_16x16x32_bf16 v[104:107], a[120:123], a[64:67], v[104:107]
  v_mfma_f32_16x16x32_bf16 v[108:111], a[124:127], a[64:67], v[108:111]
  ds_read_b64_tr_b16 a[156:157], v10 offset:57352
  v_mfma_f32_16x16x32_bf16 v[112:115], a[128:131], a[64:67], v[112:115]
  v_mfma_f32_16x16x32_bf16 v[116:119], a[132:135], a[64:67], v[116:119]
  v_mfma_f32_16x16x32_bf16 v[120:123], a[136:139], a[64:67], v[120:123]
  ds_read_b64_tr_b16 a[158:159], v10 offset:58376
  v_mfma_f32_16x16x32_bf16 v[124:127], a[140:143], a[64:67], v[124:127]
  v_mfma_f32_16x16x32_bf16 v[128:131], a[112:115], a[68:71], v[128:131]
  v_mfma_f32_16x16x32_bf16 v[132:135], a[116:119], a[68:71], v[132:135]
  ds_read_b64_tr_b16 a[160:161], v11 offset:57344
  v_mfma_f32_16x16x32_bf16 v[136:139], a[120:123], a[68:71], v[136:139]
  v_mfma_f32_16x16x32_bf16 v[140:143], a[124:127], a[68:71], v[140:143]
  ds_read_b64_tr_b16 a[162:163], v11 offset:58368
  v_mfma_f32_16x16x32_bf16 v[144:147], a[128:131], a[68:71], v[144:147]
  v_mfma_f32_16x16x32_bf16 v[148:151], a[132:135], a[68:71], v[148:151]
  v_mfma_f32_16x16x32_bf16 v[152:155], a[136:139], a[68:71], v[152:155]
  ds_read_b64_tr_b16 a[164:165], v11 offset:57352
  v_mfma_f32_16x16x32_bf16 v[156:159], a[140:143], a[68:71], v[156:159]
  v_mfma_f32_16x16x32_bf16 v[160:163], a[112:115], a[72:75], v[160:163]
  v_mfma_f32_16x16x32_bf16 v[164:167], a[116:119], a[72:75], v[164:167]
  ds_read_b64_tr_b16 a[166:167], v11 offset:58376
  v_mfma_f32_16x16x32_bf16 v[168:171], a[120:123], a[72:75], v[168:171]
  v_mfma_f32_16x16x32_bf16 v[172:175], a[124:127], a[72:75], v[172:175]
  v_mfma_f32_16x16x32_bf16 v[176:179], a[128:131], a[72:75], v[176:179]
  ds_read_b64_tr_b16 a[168:169], v12 offset:57344
  v_mfma_f32_16x16x32_bf16 v[180:183], a[132:135], a[72:75], v[180:183]
  v_mfma_f32_16x16x32_bf16 v[184:187], a[136:139], a[72:75], v[184:187]
  v_mfma_f32_16x16x32_bf16 v[188:191], a[140:143], a[72:75], v[188:191]
  ds_read_b64_tr_b16 a[170:171], v12 offset:58368
  v_mfma_f32_16x16x32_bf16 v[192:195], a[112:115], a[76:79], v[192:195]
  v_mfma_f32_16x16x32_bf16 v[196:199], a[116:119], a[76:79], v[196:199]
  v_mfma_f32_16x16x32_bf16 v[200:203], a[120:123], a[76:79], v[200:203]
  ds_read_b64_tr_b16 a[172:173], v12 offset:57352
  v_mfma_f32_16x16x32_bf16 v[204:207], a[124:127], a[76:79], v[204:207]
  v_mfma_f32_16x16x32_bf16 v[208:211], a[128:131], a[76:79], v[208:211]
  v_mfma_f32_16x16x32_bf16 v[212:215], a[132:135], a[76:79], v[212:215]
  s_waitcnt lgkmcnt(8)
  ds_read_b64_tr_b16 a[174:175], v12 offset:58376
  v_mfma_f32_16x16x32_bf16 v[216:219], a[136:139], a[76:79], v[216:219]
  v_mfma_f32_16x16x32_bf16 v[220:223], a[140:143], a[76:79], v[220:223]
  v_mfma_f32_16x16x32_bf16 v[224:227], a[112:115], a[80:83], v[224:227]
  v_mfma_f32_16x16x32_bf16 v[228:231], a[116:119], a[80:83], v[228:231]
  v_mfma_f32_16x16x32_bf16 v[232:235], a[120:123], a[80:83], v[232:235]
  v_mfma_f32_16x16x32_bf16 v[236:239], a[124:127], a[80:83], v[236:239]
  v_mfma_f32_16x16x32_bf16 v[240:243], a[128:131], a[80:83], v[240:243]
  v_mfma_f32_16x16x32_bf16 v[244:247], a[132:135], a[80:83], v[244:247]
  v_mfma_f32_16x16x32_bf16 v[248:251], a[136:139], a[80:83], v[248:251]
  v_mfma_f32_16x16x32_bf16 v[252:255], a[140:143], a[80:83], v[252:255]
  s_waitcnt lgkmcnt(0)
  s_barrier
  v_mfma_f32_16x16x32_bf16 v[32:35], a[144:147], a[84:87], v[32:35]
  ds_read_b64_tr_b16 a[112:113], v9 offset:8192
  v_mfma_f32_16x16x32_bf16 v[36:39], a[148:151], a[84:87], v[36:39]
  ds_read_b64_tr_b16 a[114:115], v9 offset:9216
  v_mfma_f32_16x16x32_bf16 v[40:43], a[152:155], a[84:87], v[40:43]
  v_mfma_f32_16x16x32_bf16 v[44:47], a[156:159], a[84:87], v[44:47]
  ds_read_b64_tr_b16 a[116:117], v9 offset:8200
  v_mfma_f32_16x16x32_bf16 v[48:51], a[160:163], a[84:87], v[48:51]
  ds_read_b64_tr_b16 a[118:119], v9 offset:9224
  v_mfma_f32_16x16x32_bf16 v[52:55], a[164:167], a[84:87], v[52:55]
  v_mfma_f32_16x16x32_bf16 v[56:59], a[168:171], a[84:87], v[56:59]
  ds_read_b64_tr_b16 a[120:121], v10 offset:8192
  v_mfma_f32_16x16x32_bf16 v[60:63], a[172:175], a[84:87], v[60:63]
  v_mfma_f32_16x16x32_bf16 v[64:67], a[144:147], a[88:91], v[64:67]
  ds_read_b64_tr_b16 a[122:123], v10 offset:9216
  v_mfma_f32_16x16x32_bf16 v[68:71], a[148:151], a[88:91], v[68:71]
  ds_read_b64_tr_b16 a[124:125], v10 offset:8200
  v_mfma_f32_16x16x32_bf16 v[72:75], a[152:155], a[88:91], v[72:75]
  v_mfma_f32_16x16x32_bf16 v[76:79], a[156:159], a[88:91], v[76:79]
  ds_read_b64_tr_b16 a[126:127], v10 offset:9224
  v_mfma_f32_16x16x32_bf16 v[80:83], a[160:163], a[88:91], v[80:83]
  ds_read_b64_tr_b16 a[128:129], v11 offset:8192
  v_mfma_f32_16x16x32_bf16 v[84:87], a[164:167], a[88:91], v[84:87]
  v_mfma_f32_16x16x32_bf16 v[88:91], a[168:171], a[88:91], v[88:91]
  ds_read_b64_tr_b16 a[130:131], v11 offset:9216
  v_mfma_f32_16x16x32_bf16 v[92:95], a[172:175], a[88:91], v[92:95]
  v_mfma_f32_16x16x32_bf16 v[96:99], a[144:147], a[92:95], v[96:99]
  ds_read_b64_tr_b16 a[132:133], v11 offset:8200
  v_mfma_f32_16x16x32_bf16 v[100:103], a[148:151], a[92:95], v[100:103]
  ds_read_b64_tr_b16 a[134:135], v11 offset:9224
  v_mfma_f32_16x16x32_bf16 v[104:107], a[152:155], a[92:95], v[104:107]
  v_mfma_f32_16x16x32_bf16 v[108:111], a[156:159], a[92:95], v[108:111]
  ds_read_b64_tr_b16 a[136:137], v12 offset:8192
  v_mfma_f32_16x16x32_bf16 v[112:115], a[160:163], a[92:95], v[112:115]
  ds_read_b64_tr_b16 a[138:139], v12 offset:9216
  v_mfma_f32_16x16x32_bf16 v[116:119], a[164:167], a[92:95], v[116:119]
  v_mfma_f32_16x16x32_bf16 v[120:123], a[168:171], a[92:95], v[120:123]
  ds_read_b64_tr_b16 a[140:141], v12 offset:8200
  v_mfma_f32_16x16x32_bf16 v[124:127], a[172:175], a[92:95], v[124:127]
  v_mfma_f32_16x16x32_bf16 v[128:131], a[144:147], a[96:99], v[128:131]
  s_waitcnt lgkmcnt(8)
  ds_read_b64_tr_b16 a[142:143], v12 offset:9224
  v_mfma_f32_16x16x32_bf16 v[132:135], a[148:151], a[96:99], v[132:135]
  ds_read_b128 a[0:3], v7 offset:0
  v_mfma_f32_16x16x32_bf16 v[136:139], a[152:155], a[96:99], v[136:139]
  v_mfma_f32_16x16x32_bf16 v[140:143], a[156:159], a[96:99], v[140:143]
  ds_read_b128 a[4:7], v7 offset:1024
  v_mfma_f32_16x16x32_bf16 v[144:147], a[160:163], a[96:99], v[144:147]
  ds_read_b128 a[8:11], v7 offset:2048
  v_mfma_f32_16x16x32_bf16 v[148:151], a[164:167], a[96:99], v[148:151]
  v_mfma_f32_16x16x32_bf16 v[152:155], a[168:171], a[96:99], v[152:155]
  ds_read_b128 a[12:15], v7 offset:3072
  v_mfma_f32_16x16x32_bf16 v[156:159], a[172:175], a[96:99], v[156:159]
  v_mfma_f32_16x16x32_bf16 v[160:163], a[144:147], a[100:103], v[160:163]
  ds_read_b128 a[16:19], v7 offset:4096
  v_mfma_f32_16x16x32_bf16 v[164:167], a[148:151], a[100:103], v[164:167]
  ds_read_b128 a[20:23], v7 offset:5120
  v_mfma_f32_16x16x32_bf16 v[168:171], a[152:155], a[100:103], v[168:171]
  v_mfma_f32_16x16x32_bf16 v[172:175], a[156:159], a[100:103], v[172:175]
  s_waitcnt lgkmcnt(8)
  ds_read_b128 a[24:27], v7 offset:6144
  v_mfma_f32_16x16x32_bf16 v[176:179], a[160:163], a[100:103], v[176:179]
  ds_read_b128 a[28:31], v8 offset:0
  v_mfma_f32_16x16x32_bf16 v[180:183], a[164:167], a[100:103], v[180:183]
  v_mfma_f32_16x16x32_bf16 v[184:187], a[168:171], a[100:103], v[184:187]
  ds_read_b128 a[32:35], v8 offset:1024
  v_mfma_f32_16x16x32_bf16 v[188:191], a[172:175], a[100:103], v[188:191]
  v_mfma_f32_16x16x32_bf16 v[192:195], a[144:147], a[104:107], v[192:195]
  ds_read_b128 a[36:39], v8 offset:2048
  v_mfma_f32_16x16x32_bf16 v[196:199], a[148:151], a[104:107], v[196:199]
  ds_read_b128 a[40:43], v8 offset:3072
  v_mfma_f32_16x16x32_bf16 v[200:203], a[152:155], a[104:107], v[200:203]
  v_mfma_f32_16x16x32_bf16 v[204:207], a[156:159], a[104:107], v[204:207]
  ds_read_b128 a[44:47], v8 offset:4096
  v_mfma_f32_16x16x32_bf16 v[208:211], a[160:163], a[104:107], v[208:211]
  ds_read_b128 a[48:51], v8 offset:5120
  v_mfma_f32_16x16x32_bf16 v[212:215], a[164:167], a[104:107], v[212:215]
  v_mfma_f32_16x16x32_bf16 v[216:219], a[168:171], a[104:107], v[216:219]
  s_waitcnt lgkmcnt(8)
  ds_read_b128 a[52:55], v8 offset:6144
  v_mfma_f32_16x16x32_bf16 v[220:223], a[172:175], a[104:107], v[220:223]
  v_mfma_f32_16x16x32_bf16 v[224:227], a[144:147], a[108:111], v[224:227]
  v_mfma_f32_16x16x32_bf16 v[228:231], a[148:151], a[108:111], v[228:231]
  v_mfma_f32_16x16x32_bf16 v[232:235], a[152:155], a[108:111], v[232:235]
  v_mfma_f32_16x16x32_bf16 v[236:239], a[156:159], a[108:111], v[236:239]
  v_mfma_f32_16x16x32_bf16 v[240:243], a[160:163], a[108:111], v[240:243]
  v_mfma_f32_16x16x32_bf16 v[244:247], a[164:167], a[108:111], v[244:247]
  v_mfma_f32_16x16x32_bf16 v[248:251], a[168:171], a[108:111], v[248:251]
  s_add_u32 s50, s50, 1
  v_mfma_f32_16x16x32_bf16 v[252:255], a[172:175], a[108:111], v[252:255]
  s_cmp_lt_u32 s50, 7
  s_cbranch_scc1 L1a_qloopB
  s_waitcnt vmcnt(4) lgkmcnt(0)
  s_barrier
  v_mfma_f32_16x16x32_bf16 v[32:35], a[112:115], a[0:3], v[32:35]
  ds_read_b64_tr_b16 a[144:145], v9 offset:40960
  v_mfma_f32_16x16x32_bf16 v[36:39], a[116:119], a[0:3], v[36:39]
  v_mfma_f32_16x16x32_bf16 v[40:43], a[120:123], a[0:3], v[40:43]
  v_mfma_f32_16x16x32_bf16 v[44:47], a[124:127], a[0:3], v[44:47]
  ds_read_b64_tr_b16 a[146:147], v9 offset:41984
  v_mfma_f32_16x16x32_bf16 v[48:51], a[128:131], a[0:3], v[48:51]
  v_mfma_f32_16x16x32_bf16 v[52:55], a[132:135], a[0:3], v[52:55]
  v_mfma_f32_16x16x32_bf16 v[56:59], a[136:139], a[0:3], v[56:59]
  ds_read_b64_tr_b16 a[148:149], v9 offset:40968
  v_mfma_f32_16x16x32_bf16 v[60:63], a[140:143], a[0:3], v[60:63]
  v_mfma_f32_16x16x32_bf16 v[64:67], a[112:115], a[4:7], v[64:67]
  v_mfma_f32_16x16x32_bf16 v[68:71], a[116:119], a[4:7], v[68:71]
  ds_read_b64_tr_b16 a[150:151], v9 offset:41992
  v_mfma_f32_16x16x32_bf16 v[72:75], a[120:123], a[4:7], v[72:75]
  v_mfma_f32_16x16x32_bf16 v[76:79], a[124:127], a[4:7], v[76:79]
  v_mfma_f32_16x16x32_bf16 v[80:83], a[128:131], a[4:7], v[80:83]
  ds_read_b64_tr_b16 a[152:153], v10 offset:40960
  v_mfma_f32_16x16x32_bf16 v[84:87], a[132:135], a[4:7], v[84:87]
  v_mfma_f32_16x16x32_bf16 v[88:91], a[136:139], a[4:7], v[88:91]
  v_mfma_f32_16x16x32_bf16 v[92:95], a[140:143], a[4:7], v[92:95]
  ds_read_b64_tr_b16 a[154:155], v10 offset:41984
  v_mfma_f32_16x16x32_bf16 v[96:99], a[112:115], a[8:11], v[96:99]
  v_mfma_f32_16x16x32_bf16 v[100:103], a[116:119], a[8:11], v[100:103]
  v_mfma_f32_16x16x32_bf16 v[104:107], a[120:123], a[8:11], v[104:107]
  ds_read_b64_tr_b16 a[156:157], v10 offset:40968
  v_mfma_f32_16x16x32_bf16 v[108:111], a[124:127], a[8:11], v[108:111]
  v_mfma_f32_16x16x32_bf16 v[112:115], a[128:131], a[8:11], v[112:115]
  v_mfma_f32_16x16x32_bf16 v[116:119], a[132:135], a[8:11], v[116:119]
  ds_read_b64_tr_b16 a[158:159], v10 offset:41992
  v_mfma_f32_16x16x32_bf16 v[120:123], a[136:139], a[8:11], v[120:123]
  v_mfma_f32_16x16x32_bf16 v[124:127], a[140:143], a[8:11], v[124:127]
  v_mfma_f32_16x16x32_bf16 v[128:131], a[112:115], a[12:15], v[128:131]
  ds_read_b64_tr_b16 a[160:161], v11 offset:40960
  v_mfma_f32_16x16x32_bf16 v[132:135], a[116:119], a[12:15], v[132:135]
  v_mfma_f32_16x16x32_bf16 v[136:139], a[120:123], a[12:15], v[136:139]
  v_mfma_f32_16x16x32_bf16 v[140:143], a[124:127], a[12:15], v[140:143]
  ds_read_b64_tr_b16 a[162:163], v11 offset:41984
  v_mfma_f32_16x16x32_bf16 v[144:147], a[128:131], a[12:15], v[144:147]
  v_mfma_f32_16x16x32_bf16 v[148:151], a[132:135], a[12:15], v[148:151]
  v_mfma_f32_16x16x32_bf16 v[152:155], a[136:139], a[12:15], v[152:155]
  ds_read_b64_tr_b16 a[164:165], v11 offset:40968
  v_mfma_f32_16x16x32_bf16 v[156:159], a[140:143], a[12:15], v[156:159]
  v_mfma_f32_16x16x32_bf16 v[160:163], a[112:115], a[16:19], v[160:163]
  v_mfma_f32_16x16x32_bf16 v[164:167], a[116:119], a[16:19], v[164:167]
  ds_read_b64_tr_b16 a[166:167], v11 offset:41992
  v_mfma_f32_16x16x32_bf16 v[168:171], a[120:123], a[16:19], v[168:171]
  v_mfma_f32_16x16x32_bf16 v[172:175], a[124:127], a[16:19], v[172:175]
  v_mfma_f32_16x16x32_bf16 v[176:179], a[128:131], a[16:19], v[176:179]
  ds_read_b64_tr_b16 a[168:169], v12 offset:40960
  v_mfma_f32_16x16x32_bf16 v[180:183], a[132:135], a[16:19], v[180:183]
  v_mfma_f32_16x16x32_bf16 v[184:187], a[136:139], a[16:19], v[184:187]
  v_mfma_f32_16x16x32_bf16 v[188:191], a[140:143], a[16:19], v[188:191]
  ds_read_b64_tr_b16 a[170:171], v12 offset:41984
  v_mfma_f32_16x16x32_bf16 v[192:195], a[112:115], a[20:23], v[192:195]
  v_mfma_f32_16x16x32_bf16 v[196:199], a[116:119], a[20:23], v[196:199]
  v_mfma_f32_16x16x32_bf16 v[200:203], a[120:123], a[20:23], v[200:203]
  ds_read_b64_tr_b16 a[172:173], v12 offset:40968
  v_mfma_f32_16x16x32_bf16 v[204:207], a[124:127], a[20:23], v[204:207]
  v_mfma_f32_16x16x32_bf16 v[208:211], a[128:131], a[20:23], v[208:211]
  v_mfma_f32_16x16x32_bf16 v[212:215], a[132:135], a[20:23], v[212:215]
  s_waitcnt lgkmcnt(8)
  ds_read_b64_tr_b16 a[174:175], v12 offset:41992
  v_mfma_f32_16x16x32_bf16 v[216:219], a[136:139], a[20:23], v[216:219]
  v_mfma_f32_16x16x32_bf16 v[220:223], a[140:143], a[20:23], v[220:223]
  v_mfma_f32_16x16x32_bf16 v[224:227], a[112:115], a[24:27], v[224:227]
  v_mfma_f32_16x16x32_bf16 v[228:231], a[116:119], a[24:27], v[228:231]
  v_mfma_f32_16x16x32_bf16 v[232:235], a[120:123], a[24:27], v[232:235]
  v_mfma_f32_16x16x32_bf16 v[236:239], a[124:127], a[24:27], v[236:239]
  v_mfma_f32_16x16x32_bf16 v[240:243], a[128:131], a[24:27], v[240:243]
  v_mfma_f32_16x16x32_bf16 v[244:247], a[132:135], a[24:27], v[244:247]
  v_mfma_f32_16x16x32_bf16 v[248:251], a[136:139], a[24:27], v[248:251]
  v_mfma_f32_16x16x32_bf16 v[252:255], a[140:143], a[24:27], v[252:255]
  s_waitcnt lgkmcnt(0)
  s_barrier
  v_mfma_f32_16x16x32_bf16 v[32:35], a[144:147], a[28:31], v[32:35]
  ds_read_b64_tr_b16 a[112:113], v9 offset:24576
  v_mfma_f32_16x16x32_bf16 v[36:39], a[148:151], a[28:31], v[36:39]
  ds_read_b64_tr_b16 a[114:115], v9 offset:25600
  v_mfma_f32_16x16x32_bf16 v[40:43], a[152:155], a[28:31], v[40:43]
  v_mfma_f32_16x16x32_bf16 v[44:47], a[156:159], a[28:31], v[44:47]
  ds_read_b64_tr_b16 a[116:117], v9 offset:24584
  v_mfma_f32_16x16x32_bf16 v[48:51], a[160:163], a[28:31], v[48:51]
  ds_read_b64_tr_b16 a[118:119], v9 offset:25608
  v_mfma_f32_16x16x32_bf16 v[52:55], a[164:167], a[28:31], v[52:55]
  v_mfma_f32_16x16x32_bf16 v[56:59], a[168:171], a[28:31], v[56:59]
  ds_read_b64_tr_b16 a[120:121], v10 offset:24576
  v_mfma_f32_16x16x32_bf16 v[60:63], a[172:175], a[28:31], v[60:63]
  v_mfma_f32_16x16x32_bf16 v[64:67], a[144:147], a[32:35], v[64:67]
  ds_read_b64_tr_b16 a[122:123], v10 offset:25600
  v_mfma_f32_16x16x32_bf16 v[68:71], a[148:151], a[32:35], v[68:71]
  ds_read_b64_tr_b16 a[124:125], v10 offset:24584
  v_mfma_f32_16x16x32_bf16 v[72:75], a[152:155], a[32:35], v[72:75]
  v_mfma_f32_16x16x32_bf16 v[76:79], a[156:159], a[32:35], v[76:79]
  ds_read_b64_tr_b16 a[126:127], v10 offset:25608
  v_mfma_f32_16x16x32_bf16 v[80:83], a[160:163], a[32:35], v[80:83]
  ds_read_b64_tr_b16 a[128:129], v11 offset:24576
  v_mfma_f32_16x16x32_bf16 v[84:87], a[164:167], a[32:35], v[84:87]
  v_mfma_f32_16x16x32_bf16 v[88:91], a[168:171], a[32:35], v[88:91]
  ds_read_b64_tr_b16 a[130:131], v11 offset:25600
  v_mfma_f32_16x16x32_bf16 v[92:95], a[172:175], a[32:35], v[92:95]
  v_mfma_f32_16x16x32_bf16 v[96:99], a[144:147], a[36:39], v[96:99]
  ds_read_b64_tr_b16 a[132:133], v11 offset:24584
  v_mfma_f32_16x16x32_bf16 v[100:103], a[148:151], a[36:39], v[100:103]
  ds_read_b64_tr_b16 a[134:135], v11 offset:25608
  v_mfma_f32_16x16x32_bf16 v[104:107], a[152:155], a[36:39], v[104:107]
  v_mfma_f32_16x16x32_bf16 v[108:111], a[156:159], a[36:39], v[108:111]
  ds_read_b64_tr_b16 a[136:137], v12 offset:24576
  v_mfma_f32_16x16x32_bf16 v[112:115], a[160:163], a[36:39], v[112:115]
  ds_read_b64_tr_b16 a[138:139], v12 offset:25600
  v_mfma_f32_16x16x32_bf16 v[116:119], a[164:167], a[36:39], v[116:119]
  v_mfma_f32_16x16x32_bf16 v[120:123], a[168:171], a[36:39], v[120:123]
  ds_read_b64_tr_b16 a[140:141], v12 offset:24584
  v_mfma_f32_16x16x32_bf16 v[124:127], a[172:175], a[36:39], v[124:127]
  v_mfma_f32_16x16x32_bf16 v[128:131], a[144:147], a[40:43], v[128:131]
  s_waitcnt lgkmcnt(8)
  ds_read_b64_tr_b16 a[142:143], v12 offset:25608
  v_mfma_f32_16x16x32_bf16 v[132:135], a[148:151], a[40:43], v[132:135]
  ds_read_b128 a[56:59], v7 offset:16384
  v_mfma_f32_16x16x32_bf16 v[136:139], a[152:155], a[40:43], v[136:139]
  v_mfma_f32_16x16x32_bf16 v[140:143], a[156:159], a[40:43], v[140:143]
  ds_read_b128 a[60:63], v7 offset:17408
  v_mfma_f32_16x16x32_bf16 v[144:147], a[160:163], a[40:43], v[144:147]
  ds_read_b128 a[64:67], v7 offset:18432
  v_mfma_f32_16x16x32_bf16 v[148:151], a[164:167], a[40:43], v[148:151]
  v_mfma_f32_16x16x32_bf16 v[152:155], a[168:171], a[40:43], v[152:155]
  ds_read_b128 a[68:71], v7 offset:19456
  v_mfma_f32_16x16x32_bf16 v[156:159], a[172:175], a[40:43], v[156:159]
  v_mfma_f32_16x16x32_bf16 v[160:163], a[144:147], a[44:47], v[160:163]
  ds_read_b128 a[72:75], v7 offset:20480
  v_mfma_f32_16x16x32_bf16 v[164:167], a[148:151], a[44:47], v[164:167]
  ds_read_b128 a[76:79], v7 offset:21504
  v_mfma_f32_16x16x32_bf16 v[168:171], a[152:155], a[44:47], v[168:171]
  v_mfma_f32_16x16x32_bf16 v[172:175], a[156:159], a[44:47], v[172:175]
  s_waitcnt lgkmcnt(8)
  ds_read_b128 a[80:83], v7 offset:22528
  v_mfma_f32_16x16x32_bf16 v[176:179], a[160:163], a[44:47], v[176:179]
  ds_read_b128 a[84:87], v8 offset:16384
  v_mfma_f32_16x16x32_bf16 v[180:183], a[164:167], a[44:47], v[180:183]
  v_mfma_f32_16x16x32_bf16 v[184:187], a[168:171], a[44:47], v[184:187]
  ds_read_b128 a[88:91], v8 offset:17408
  v_mfma_f32_16x16x32_bf16 v[188:191], a[172:175], a[44:47], v[188:191]
  v_mfma_f32_16x16x32_bf16 v[192:195], a[144:147], a[48:51], v[192:195]
  ds_read_b128 a[92:95], v8 offset:18432
  v_mfma_f32_16x16x32_bf16 v[196:199], a[148:151], a[48:51], v[196:199]
  ds_read_b128 a[96:99], v8 offset:19456
  v_mfma_f32_16x16x32_bf16 v[200:203], a[152:155], a[48:51], v[200:203]
  v_mfma_f32_16x16x32_bf16 v[204:207], a[156:159], a[48:51], v[204:207]
  ds_read_b128 a[100:103], v8 offset:20480
  v_mfma_f32_16x16x32_bf16 v[208:211], a[160:163], a[48:51], v[208:211]
  ds_read_b128 a[104:107], v8 offset:21504
  v_mfma_f32_16x16x32_bf16 v[212:215], a[164:167], a[48:51], v[212:215]
  v_mfma_f32_16x16x32_bf16 v[216:219], a[168:171], a[48:51], v[216:219]
  s_waitcnt lgkmcnt(8)
  ds_read_b128 a[108:111], v8 offset:22528
  v_mfma_f32_16x16x32_bf16 v[220:223], a[172:175], a[48:51], v[220:223]
  v_mfma_f32_16x16x32_bf16 v[224:227], a[144:147], a[52:55], v[224:227]
  v_mfma_f32_16x16x32_bf16 v[228:231], a[148:151], a[52:55], v[228:231]
  v_mfma_f32_16x16x32_bf16 v[232:235], a[152:155], a[52:55], v[232:235]
  v_mfma_f32_16x16x32_bf16 v[236:239], a[156:159], a[52:55], v[236:239]
  v_mfma_f32_16x16x32_bf16 v[240:243], a[160:163], a[52:55], v[240:243]
  v_mfma_f32_16x16x32_bf16 v[244:247], a[164:167], a[52:55], v[244:247]
  v_mfma_f32_16x16x32_bf16 v[248:251], a[168:171], a[52:55], v[248:251]
  v_mfma_f32_16x16x32_bf16 v[252:255], a[172:175], a[52:55], v[252:255]
  s_waitcnt lgkmcnt(0)
  s_barrier
  v_mfma_f32_16x16x32_bf16 v[32:35], a[112:115], a[56:59], v[32:35]
  ds_read_b128 a[192:195], v24 offset:0
  v_mfma_f32_16x16x32_bf16 v[36:39], a[116:119], a[56:59], v[36:39]
  ds_read_b128 a[196:199], v25 offset:0
  v_mfma_f32_16x16x32_bf16 v[40:43], a[120:123], a[56:59], v[40:43]
  v_mfma_f32_16x16x32_bf16 v[44:47], a[124:127], a[56:59], v[44:47]
  ds_read_b128 a[200:203], v26 offset:0
  v_mfma_f32_16x16x32_bf16 v[48:51], a[128:131], a[56:59], v[48:51]
  v_mfma_f32_16x16x32_bf16 v[52:55], a[132:135], a[56:59], v[52:55]
  ds_read_b128 a[204:207], v27 offset:0
  v_mfma_f32_16x16x32_bf16 v[56:59], a[136:139], a[56:59], v[56:59]
  ds_read_b128 a[208:211], v24 offset:2048
  v_mfma_f32_16x16x32_bf16 v[60:63], a[140:143], a[56:59], v[60:63]
  v_mfma_f32_16x16x32_bf16 v[64:67], a[112:115], a[60:63], v[64:67]
  ds_read_b128 a[212:215], v25 offset:2048
  v_mfma_f32_16x16x32_bf16 v[68:71], a[116:119], a[60:63], v[68:71]
  v_mfma_f32_16x16x32_bf16 v[72:75], a[120:123], a[60:63], v[72:75]
  ds_read_b128 a[216:219], v26 offset:2048
  v_mfma_f32_16x16x32_bf16 v[76:79], a[124:127], a[60:63], v[76:79]
  ds_read_b128 a[220:223], v27 offset:2048
  v_mfma_f32_16x16x32_bf16 v[80:83], a[128:131], a[60:63], v[80:83]
  v_mfma_f32_16x16x32_bf16 v[84:87], a[132:135], a[60:63], v[84:87]
  ds_read_b64_tr_b16 a[144:145], v9 offset:57344
  v_mfma_f32_16x16x32_bf16 v[88:91], a[136:139], a[60:63], v[88:91]
  v_mfma_f32_16x16x32_bf16 v[92:95], a[140:143], a[60:63], v[92:95]
  ds_read_b64_tr_b16 a[146:147], v9 offset:58368
  v_mfma_f32_16x16x32_bf16 v[96:99], a[112:115], a[64:67], v[96:99]
  ds_read_b64_tr_b16 a[148:149], v9 offset:57352
  v_mfma_f32_16x16x32_bf16 v[100:103], a[116:119], a[64:67], v[100:103]
  v_mfma_f32_16x16x32_bf16 v[104:107], a[120:123], a[64:67], v[104:107]
  ds_read_b64_tr_b16 a[150:151], v9 offset:58376
  v_mfma_f32_16x16x32_bf16 v[108:111], a[124:127], a[64:67], v[108:111]
  v_mfma_f32_16x16x32_bf16 v[112:115], a[128:131], a[64:67], v[112:115]
  ds_read_b64_tr_b16 a[152:153], v10 offset:57344
  v_mfma_f32_16x16x32_bf16 v[116:119], a[132:135], a[64:67], v[116:119]
  ds_read_b64_tr_b16 a[154:155], v10 offset:58368
  v_mfma_f32_16x16x32_bf16 v[120:123], a[136:139], a[64:67], v[120:123]
  v_mfma_f32_16x16x32_bf16 v[124:127], a[140:143], a[64:67], v[124:127]
  ds_read_b64_tr_b16 a[156:157], v10 offset:57352
  v_mfma_f32_16x16x32_bf16 v[128:131], a[112:115], a[68:71], v[128:131]
  v_mfma_f32_16x16x32_bf16 v[132:135], a[116:119], a[68:71], v[132:135]
  s_waitcnt lgkmcnt(8)
  ds_read_b64_tr_b16 a[158:159], v10 offset:58376
  v_mfma_f32_16x16x32_bf16 v[136:139], a[120:123], a[68:71], v[136:139]
  ds_read_b64_tr_b16 a[160:161], v11 offset:57344
  v_mfma_f32_16x16x32_bf16 v[140:143], a[124:127], a[68:71], v[140:143]
  v_mfma_f32_16x16x32_bf16 v[144:147], a[128:131], a[68:71], v[144:147]
  ds_read_b64_tr_b16 a[162:163], v11 offset:58368
  v_mfma_f32_16x16x32_bf16 v[148:151], a[132:135], a[68:71], v[148:151]
  v_mfma_f32_16x16x32_bf16 v[152:155], a[136:139], a[68:71], v[152:155]
  s_sub_u32 s48, s42, s41
  s_sub_u32 s48, s48, 24576
  ds_read_b64_tr_b16 a[164:165], v11 offset:57352
  v_mfma_f32_16x16x32_bf16 v[156:159], a[140:143], a[68:71], v[156:159]
  ds_read_b64_tr_b16 a[166:167], v11 offset:58376
  v_mfma_f32_16x16x32_bf16 v[160:163], a[112:115], a[72:75], v[160:163]
  v_add_u32 v0, s48, v17
  v_mfma_f32_16x16x32_bf16 v[164:167], a[116:119], a[72:75], v[164:167]
  v_add_u32 v2, s48, v18
  v_mfma_f32_16x16x32_bf16 v[168:171], a[120:123], a[72:75], v[168:171]
  v_add_u32 v3, s48, v19
  v_mfma_f32_16x16x32_bf16 v[172:175], a[124:127], a[72:75], v[172:175]
  v_add_u32 v29, s48, v20
  v_mfma_f32_16x16x32_bf16 v[176:179], a[128:131], a[72:75], v[176:179]
  v_add_u32 v24, s48, v21
  v_mfma_f32_16x16x32_bf16 v[180:183], a[132:135], a[72:75], v[180:183]
  v_add_u32 v25, s48, v22
  v_mfma_f32_16x16x32_bf16 v[184:187], a[136:139], a[72:75], v[184:187]
  v_add_u32 v26, s48, v23
  v_mfma_f32_16x16x32_bf16 v[188:191], a[140:143], a[72:75], v[188:191]
  v_add_u32 v27, s48, v28
  v_mfma_f32_16x16x32_bf16 v[192:195], a[112:115], a[76:79], v[192:195]
  v_mfma_f32_16x16x32_bf16 v[196:199], a[116:119], a[76:79], v[196:199]
  ds_read_b64_tr_b16 a[168:169], v12 offset:57344
  v_mfma_f32_16x16x32_bf16 v[200:203], a[120:123], a[76:79], v[200:203]
  v_mfma_f32_16x16x32_bf16 v[204:207], a[124:127], a[76:79], v[204:207]
  ds_read_b64_tr_b16 a[170:171], v12 offset:58368
  v_mfma_f32_16x16x32_bf16 v[208:211], a[128:131], a[76:79], v[208:211]
  s_waitcnt lgkmcnt(8)
  ds_read_b64_tr_b16 a[172:173], v12 offset:57352
  v_mfma_f32_16x16x32_bf16 v[212:215], a[132:135], a[76:79], v[212:215]
  v_mfma_f32_16x16x32_bf16 v[216:219], a[136:139], a[76:79], v[216:219]
  ds_read_b64_tr_b16 a[174:175], v12 offset:58376
  v_mfma_f32_16x16x32_bf16 v[220:223], a[140:143], a[76:79], v[220:223]
  v_mfma_f32_16x16x32_bf16 v[224:227], a[112:115], a[80:83], v[224:227]
  v_mfma_f32_16x16x32_bf16 v[228:231], a[116:119], a[80:83], v[228:231]
  v_mfma_f32_16x16x32_bf16 v[232:235], a[120:123], a[80:83], v[232:235]
  v_mfma_f32_16x16x32_bf16 v[236:239], a[124:127], a[80:83], v[236:239]
  v_mfma_f32_16x16x32_bf16 v[240:243], a[128:131], a[80:83], v[240:243]
  v_mfma_f32_16x16x32_bf16 v[244:247], a[132:135], a[80:83], v[244:247]
  v_mfma_f32_16x16x32_bf16 v[248:251], a[136:139], a[80:83], v[248:251]
  v_mfma_f32_16x16x32_bf16 v[252:255], a[140:143], a[80:83], v[252:255]
  s_waitcnt lgkmcnt(0)
  s_barrier
  v_mfma_f32_16x16x32_bf16 v[32:35], a[144:147], a[84:87], v[32:35]
  s_lshr_b32 s42, s2, 3
  s_and_b32 s42, s42, 3
  ds_read_b64_tr_b16 a[224:225], v0 offset:0
  v_mfma_f32_16x16x32_bf16 v[36:39], a[148:151], a[84:87], v[36:39]
  s_lshl_b32 s46, s3, 4
  s_add_u32 s42, s42, s46
  v_mfma_f32_16x16x32_bf16 v[40:43], a[152:155], a[84:87], v[40:43]
  s_lshr_b32 s46, s7, 3
  s_lshl_b32 s47, s6, 2
  ds_read_b64_tr_b16 a[226:227], v0 offset:2048
  v_mfma_f32_16x16x32_bf16 v[44:47], a[156:159], a[84:87], v[44:47]
  s_add_u32 s46, s46, s47
  s_lshl_b32 s46, s46, 7
  v_mfma_f32_16x16x32_bf16 v[48:51], a[160:163], a[84:87], v[48:51]
  s_and_b32 s47, s7, 6
  s_lshl_b32 s47, s47, 1
  ds_read_b64_tr_b16 a[228:229], v2 offset:0
  v_mfma_f32_16x16x32_bf16 v[52:55], a[164:167], a[84:87], v[52:55]
  s_add_u32 s46, s46, s47
  s_add_u32 s46, s46, 75497472
  v_mfma_f32_16x16x32_bf16 v[56:59], a[168:171], a[84:87], v[56:59]
  v_mov_b32 v12, s46
  v_mfma_f32_16x16x32_bf16 v[60:63], a[172:175], a[84:87], v[60:63]
  s_and_b32 s46, s2, 7
  s_lshr_b32 s47, s2, 3
  v_mfma_f32_16x16x32_bf16 v[64:67], a[144:147], a[88:91], v[64:67]
  s_lshr_b32 s32, s46, 1
  s_lshl_b32 s32, s32, 2
  ds_read_b64_tr_b16 a[230:231], v2 offset:2048
  v_mfma_f32_16x16x32_bf16 v[68:71], a[148:151], a[88:91], v[68:71]
  s_and_b32 s48, s47, 3
  s_add_u32 s32, s32, s48
  v_mfma_f32_16x16x32_bf16 v[72:75], a[152:155], a[88:91], v[72:75]
  s_lshr_b32 s33, s47, 2
  s_and_b32 s33, s33, 1
  ds_read_b64_tr_b16 a[232:233], v3 offset:0
  v_mfma_f32_16x16x32_bf16 v[76:79], a[156:159], a[88:91], v[76:79]
  s_and_b32 s34, s46, 1
  s_lshl_b32 s34, s34, 2
  v_mfma_f32_16x16x32_bf16 v[80:83], a[160:163], a[88:91], v[80:83]
  s_lshr_b32 s48, s47, 3
  s_add_u32 s34, s34, s48
  ds_read_b64_tr_b16 a[234:235], v3 offset:2048
  v_mfma_f32_16x16x32_bf16 v[84:87], a[164:167], a[88:91], v[84:87]
  s_lshl_b32 s28, s3, 15
  v_lshrrev_b32 v4, 4, v1
  v_mfma_f32_16x16x32_bf16 v[88:91], a[168:171], a[88:91], v[88:91]
  v_lshlrev_b32 v9, 1, v4
  v_and_b32 v10, 15, v1
  v_mul_f32 v32, s52, v32
  v_mul_f32 v33, s52, v33
  v_mfma_f32_16x16x32_bf16 v[92:95], a[172:175], a[88:91], v[92:95]
  v_xor_b32 v10, v10, v9
  v_lshlrev_b32 v10, 4, v10
  v_mul_f32 v34, s52, v34
  v_mfma_f32_16x16x32_bf16 v[96:99], a[144:147], a[92:95], v[96:99]
  v_lshl_add_u32 v7, v4, 11, v10
  v_lshrrev_b32 v9, 1, v1
  v_mul_f32 v35, s52, v35
  v_mfma_f32_16x16x32_bf16 v[100:103], a[148:151], a[92:95], v[100:103]
  v_and_b32 v10, 1, v1
  v_lshlrev_b32 v10, 7, v10
  v_mul_f32 v36, s52, v36
  v_mfma_f32_16x16x32_bf16 v[104:107], a[152:155], a[92:95], v[104:107]
  v_lshl_add_u32 v5, v9, 11, v10
  v_xor_b32 v8, 128, v7
  v_mul_f32 v37, s52, v37
  v_mfma_f32_16x16x32_bf16 v[108:111], a[156:159], a[92:95], v[108:111]
  v_add_u32 v8, 7168, v8
  v_add_u32 v9, 14336, v7
  v_mul_f32 v38, s52, v38
  v_mfma_f32_16x16x32_bf16 v[112:115], a[160:163], a[92:95], v[112:115]
  v_add_u32 v10, 14336, v8
  v_mul_f32 v39, s52, v39
  v_mfma_f32_16x16x32_bf16 v[116:119], a[164:167], a[92:95], v[116:119]
  s_lshl_b32 s30, s3, 21
  s_lshl_b32 s43, s32, 1
  v_cvt_pk_bf16_f32 v32, v32, v33
  v_cvt_pk_bf16_f32 v33, v34, v35
  v_mfma_f32_16x16x32_bf16 v[120:123], a[168:171], a[92:95], v[120:123]
  s_add_u32 s43, s43, s33
  s_lshl_b32 s43, s43, 2
  v_cvt_pk_bf16_f32 v34, v36, v37
  v_mfma_f32_16x16x32_bf16 v[124:127], a[172:175], a[92:95], v[124:127]
  s_add_u32 s43, s43, s3
  s_lshl_b32 s43, s43, 16
  ds_read_b64_tr_b16 a[236:237], v29 offset:0
  v_cvt_pk_bf16_f32 v35, v38, v39
  v_mfma_f32_16x16x32_bf16 v[128:131], a[144:147], a[96:99], v[128:131]
  s_mul_i32 s29, s3, 851968
  s_mul_i32 s46, s33, 14336
  v_mul_f32 v40, s52, v40
  v_mfma_f32_16x16x32_bf16 v[132:135], a[148:151], a[96:99], v[132:135]
  s_add_u32 s29, s29, s46
  s_lshl_b32 s46, s34, 8
  ds_read_b64_tr_b16 a[238:239], v29 offset:2048
  v_mul_f32 v41, s52, v41
  v_mfma_f32_16x16x32_bf16 v[136:139], a[152:155], a[96:99], v[136:139]
  s_add_u32 s12, s92, s46
  s_addc_u32 s13, s93, 0
  v_mul_f32 v42, s52, v42
  v_mfma_f32_16x16x32_bf16 v[140:143], a[156:159], a[96:99], v[140:143]
  s_sub_u32 s14, 8388608, s46
  s_mov_b32 s15, 131072
  v_mul_f32 v43, s52, v43
  v_mfma_f32_16x16x32_bf16 v[144:147], a[160:163], a[96:99], v[144:147]
  s_add_u32 s46, s46, 83885824
  s_add_u32 s47, s98, s46
  s_addc_u32 s48, s99, 0
  ds_read_b64_tr_b16 a[240:241], v24 offset:0
  v_mul_f32 v44, s52, v44
  v_mul_f32 v45, s52, v45
  v_mfma_f32_16x16x32_bf16 v[148:151], a[164:167], a[96:99], v[148:151]
  s_and_b32 s46, s34, 3
  s_cmp_eq_u32 s46, 1
  s_cselect_b32 s12, s47, s12
  s_cselect_b32 s13, s48, s13
  s_cselect_b32 s43, 16777216, s43
  v_mul_f32 v46, s52, v46
  v_mfma_f32_16x16x32_bf16 v[152:155], a[168:171], a[96:99], v[152:155]
  s_lshl_b32 s46, s32, 22
  s_add_u32 s8, s98, s46
  s_addc_u32 s9, s99, 0
  ds_read_b64_tr_b16 a[242:243], v24 offset:2048
  v_mul_f32 v47, s52, v47
  v_mfma_f32_16x16x32_bf16 v[156:159], a[172:175], a[96:99], v[156:159]
  s_mov_b32 s10, 4194304
  s_mov_b32 s11, 131072
  v_cvt_pk_bf16_f32 v36, v40, v41
  v_mfma_f32_16x16x32_bf16 v[160:163], a[144:147], a[100:103], v[160:163]
  s_lshl_b32 s47, s32, 2
  s_add_u32 s46, s47, s3
  ds_read_b64_tr_b16 a[244:245], v25 offset:0
  v_cvt_pk_bf16_f32 v37, v42, v43
  v_mfma_f32_16x16x32_bf16 v[164:167], a[148:151], a[100:103], v[164:167]
  s_lshl_b32 s46, s46, 7
  s_add_u32 s46, s46, 75497472
  v_cvt_pk_bf16_f32 v38, v44, v45
  v_mfma_f32_16x16x32_bf16 v[168:171], a[152:155], a[100:103], v[168:171]
  v_mov_b32 v11, s46
  v_cvt_pk_bf16_f32 v39, v46, v47
  v_mfma_f32_16x16x32_bf16 v[172:175], a[156:159], a[100:103], v[172:175]
  s_mov_b32 s37, 0
  s_mov_b32 s31, 0
  v_mul_f32 v48, s52, v48
  v_mul_f32 v49, s52, v49
  v_mfma_f32_16x16x32_bf16 v[176:179], a[160:163], a[100:103], v[176:179]
  s_mov_b32 s35, 6
  s_add_u32 s36, s30, 786432
  ds_read_b64_tr_b16 a[246:247], v25 offset:2048
  v_mul_f32 v50, s52, v50
  v_mfma_f32_16x16x32_bf16 v[180:183], a[164:167], a[100:103], v[180:183]
  s_mov_b32 s44, s54
  v_mul_f32 v51, s52, v51
  v_mfma_f32_16x16x32_bf16 v[184:187], a[168:171], a[100:103], v[184:187]
  ds_read_b64_tr_b16 a[248:249], v26 offset:0
  v_mul_f32 v52, s52, v52
  v_mfma_f32_16x16x32_bf16 v[188:191], a[172:175], a[100:103], v[188:191]
  v_mul_f32 v53, s52, v53
  v_mfma_f32_16x16x32_bf16 v[192:195], a[144:147], a[104:107], v[192:195]
  ds_read_b64_tr_b16 a[250:251], v26 offset:2048
  v_mul_f32 v54, s52, v54
  v_mfma_f32_16x16x32_bf16 v[196:199], a[148:151], a[104:107], v[196:199]
  v_mul_f32 v55, s52, v55
  v_mfma_f32_16x16x32_bf16 v[200:203], a[152:155], a[104:107], v[200:203]
  v_cvt_pk_bf16_f32 v40, v48, v49
  v_cvt_pk_bf16_f32 v41, v50, v51
  v_mfma_f32_16x16x32_bf16 v[204:207], a[156:159], a[104:107], v[204:207]
  ds_read_b64_tr_b16 a[252:253], v27 offset:0
  v_cvt_pk_bf16_f32 v42, v52, v53
  v_mfma_f32_16x16x32_bf16 v[208:211], a[160:163], a[104:107], v[208:211]
  v_cvt_pk_bf16_f32 v43, v54, v55
  v_mfma_f32_16x16x32_bf16 v[212:215], a[164:167], a[104:107], v[212:215]
  s_waitcnt lgkmcnt(8)
  ds_read_b64_tr_b16 a[254:255], v27 offset:2048
  v_mul_f32 v56, s52, v56
  v_mfma_f32_16x16x32_bf16 v[216:219], a[168:171], a[104:107], v[216:219]
  v_mul_f32 v57, s52, v57
  v_mfma_f32_16x16x32_bf16 v[220:223], a[172:175], a[104:107], v[220:223]
  v_mul_f32 v58, s52, v58
  v_mfma_f32_16x16x32_bf16 v[224:227], a[144:147], a[108:111], v[224:227]
  v_mul_f32 v59, s52, v59
  v_mfma_f32_16x16x32_bf16 v[228:231], a[148:151], a[108:111], v[228:231]
  v_mul_f32 v60, s52, v60
  v_mul_f32 v61, s52, v61
  v_mfma_f32_16x16x32_bf16 v[232:235], a[152:155], a[108:111], v[232:235]
  v_mul_f32 v62, s52, v62
  v_mfma_f32_16x16x32_bf16 v[236:239], a[156:159], a[108:111], v[236:239]
  v_mul_f32 v63, s52, v63
  v_mfma_f32_16x16x32_bf16 v[240:243], a[160:163], a[108:111], v[240:243]
  v_cvt_pk_bf16_f32 v44, v56, v57
  v_mfma_f32_16x16x32_bf16 v[244:247], a[164:167], a[108:111], v[244:247]
  v_cvt_pk_bf16_f32 v45, v58, v59
  v_mfma_f32_16x16x32_bf16 v[248:251], a[168:171], a[108:111], v[248:251]
  v_cvt_pk_bf16_f32 v46, v60, v61
  v_mfma_f32_16x16x32_bf16 v[252:255], a[172:175], a[108:111], v[252:255]
  v_cvt_pk_bf16_f32 v47, v62, v63
  v_pk_mul_f32 v[64:65], v[64:65], s[52:53]
  v_pk_mul_f32 v[66:67], v[66:67], s[52:53]
  v_pk_mul_f32 v[68:69], v[68:69], s[52:53]
  v_pk_mul_f32 v[70:71], v[70:71], s[52:53]
  v_mfma_f32_16x16x32_bf16 v[48:51], a[192:195], v[32:35], 0
  v_mfma_f32_16x16x32_bf16 v[48:51], a[196:199], v[36:39], v[48:51]
  v_mfma_f32_16x16x32_bf16 v[48:51], a[200:203], v[40:43], v[48:51]
  v_mfma_f32_16x16x32_bf16 v[48:51], a[204:207], v[44:47], v[48:51]
  v_cvt_pk_bf16_f32 v64, v64, v65
  v_cvt_pk_bf16_f32 v65, v66, v67
  v_cvt_pk_bf16_f32 v66, v68, v69
  v_cvt_pk_bf16_f32 v67, v70, v71
  v_pk_mul_f32 v[72:73], v[72:73], s[52:53]
  v_pk_mul_f32 v[74:75], v[74:75], s[52:53]
  v_pk_mul_f32 v[76:77], v[76:77], s[52:53]
  v_pk_mul_f32 v[78:79], v[78:79], s[52:53]
  v_cvt_pk_bf16_f32 v68, v72, v73
  v_cvt_pk_bf16_f32 v69, v74, v75
  v_cvt_pk_bf16_f32 v70, v76, v77
  v_cvt_pk_bf16_f32 v71, v78, v79
  v_pk_mul_f32 v[80:81], v[80:81], s[52:53]
  v_pk_mul_f32 v[82:83], v[82:83], s[52:53]
  v_pk_mul_f32 v[84:85], v[84:85], s[52:53]
  v_pk_mul_f32 v[86:87], v[86:87], s[52:53]
  v_cvt_pk_bf16_f32 v72, v80, v81
  v_cvt_pk_bf16_f32 v73, v82, v83
  v_cvt_pk_bf16_f32 v74, v84, v85
  v_cvt_pk_bf16_f32 v75, v86, v87
  v_pk_mul_f32 v[88:89], v[88:89], s[52:53]
  v_pk_mul_f32 v[90:91], v[90:91], s[52:53]
  v_pk_mul_f32 v[92:93], v[92:93], s[52:53]
  v_pk_mul_f32 v[94:95], v[94:95], s[52:53]
  v_cvt_pk_bf16_f32 v76, v88, v89
  v_cvt_pk_bf16_f32 v77, v90, v91
  v_cvt_pk_bf16_f32 v78, v92, v93
  v_cvt_pk_bf16_f32 v79, v94, v95
  v_pk_mul_f32 v[96:97], v[96:97], s[52:53]
  v_pk_mul_f32 v[98:99], v[98:99], s[52:53]
  v_pk_mul_f32 v[100:101], v[100:101], s[52:53]
  v_pk_mul_f32 v[102:103], v[102:103], s[52:53]
  v_mfma_f32_16x16x32_bf16 v[80:83], a[192:195], v[64:67], 0
  v_mfma_f32_16x16x32_bf16 v[80:83], a[196:199], v[68:71], v[80:83]
  v_mfma_f32_16x16x32_bf16 v[80:83], a[200:203], v[72:75], v[80:83]
  v_mfma_f32_16x16x32_bf16 v[80:83], a[204:207], v[76:79], v[80:83]
  v_cvt_pk_bf16_f32 v96, v96, v97
  v_cvt_pk_bf16_f32 v97, v98, v99
  v_cvt_pk_bf16_f32 v98, v100, v101
  v_cvt_pk_bf16_f32 v99, v102, v103
  v_pk_mul_f32 v[104:105], v[104:105], s[52:53]
  v_pk_mul_f32 v[106:107], v[106:107], s[52:53]
  v_pk_mul_f32 v[108:109], v[108:109], s[52:53]
  v_pk_mul_f32 v[110:111], v[110:111], s[52:53]
  v_cvt_pk_bf16_f32 v100, v104, v105
  v_cvt_pk_bf16_f32 v101, v106, v107
  v_cvt_pk_bf16_f32 v102, v108, v109
  v_cvt_pk_bf16_f32 v103, v110, v111
  v_pk_mul_f32 v[112:113], v[112:113], s[52:53]
  v_pk_mul_f32 v[114:115], v[114:115], s[52:53]
  v_pk_mul_f32 v[116:117], v[116:117], s[52:53]
  v_pk_mul_f32 v[118:119], v[118:119], s[52:53]
  v_cvt_pk_bf16_f32 v104, v112, v113
  v_cvt_pk_bf16_f32 v105, v114, v115
  v_cvt_pk_bf16_f32 v106, v116, v117
  v_cvt_pk_bf16_f32 v107, v118, v119
  v_pk_mul_f32 v[120:121], v[120:121], s[52:53]
  v_pk_mul_f32 v[122:123], v[122:123], s[52:53]
  v_pk_mul_f32 v[124:125], v[124:125], s[52:53]
  v_pk_mul_f32 v[126:127], v[126:127], s[52:53]
  v_cvt_pk_bf16_f32 v108, v120, v121
  v_cvt_pk_bf16_f32 v109, v122, v123
  v_cvt_pk_bf16_f32 v110, v124, v125
  v_cvt_pk_bf16_f32 v111, v126, v127
  v_pk_mul_f32 v[128:129], v[128:129], s[52:53]
  v_pk_mul_f32 v[130:131], v[130:131], s[52:53]
  v_pk_mul_f32 v[132:133], v[132:133], s[52:53]
  v_pk_mul_f32 v[134:135], v[134:135], s[52:53]
  v_mfma_f32_16x16x32_bf16 v[112:115], a[192:195], v[96:99], 0
  v_mfma_f32_16x16x32_bf16 v[112:115], a[196:199], v[100:103], v[112:115]
  v_mfma_f32_16x16x32_bf16 v[112:115], a[200:203], v[104:107], v[112:115]
  v_mfma_f32_16x16x32_bf16 v[112:115], a[204:207], v[108:111], v[112:115]
  v_cvt_pk_bf16_f32 v128, v128, v129
  v_cvt_pk_bf16_f32 v129, v130, v131
  v_cvt_pk_bf16_f32 v130, v132, v133
  v_cvt_pk_bf16_f32 v131, v134, v135
  v_pk_mul_f32 v[136:137], v[136:137], s[52:53]
  v_pk_mul_f32 v[138:139], v[138:139], s[52:53]
  v_pk_mul_f32 v[140:141], v[140:141], s[52:53]
  v_pk_mul_f32 v[142:143], v[142:143], s[52:53]
  v_cvt_pk_bf16_f32 v132, v136, v137
  v_cvt_pk_bf16_f32 v133, v138, v139
  v_cvt_pk_bf16_f32 v134, v140, v141
  v_cvt_pk_bf16_f32 v135, v142, v143
  v_pk_mul_f32 v[144:145], v[144:145], s[52:53]
  v_pk_mul_f32 v[146:147], v[146:147], s[52:53]
  v_pk_mul_f32 v[148:149], v[148:149], s[52:53]
  v_pk_mul_f32 v[150:151], v[150:151], s[52:53]
  v_cvt_pk_bf16_f32 v136, v144, v145
  v_cvt_pk_bf16_f32 v137, v146, v147
  v_cvt_pk_bf16_f32 v138, v148, v149
  v_cvt_pk_bf16_f32 v139, v150, v151
  v_pk_mul_f32 v[152:153], v[152:153], s[52:53]
  v_pk_mul_f32 v[154:155], v[154:155], s[52:53]
  v_pk_mul_f32 v[156:157], v[156:157], s[52:53]
  v_pk_mul_f32 v[158:159], v[158:159], s[52:53]
  v_cvt_pk_bf16_f32 v140, v152, v153
  v_cvt_pk_bf16_f32 v141, v154, v155
  v_cvt_pk_bf16_f32 v142, v156, v157
  v_cvt_pk_bf16_f32 v143, v158, v159
  v_pk_mul_f32 v[160:161], v[160:161], s[52:53]
  v_pk_mul_f32 v[162:163], v[162:163], s[52:53]
  v_pk_mul_f32 v[164:165], v[164:165], s[52:53]
  v_pk_mul_f32 v[166:167], v[166:167], s[52:53]
  v_mfma_f32_16x16x32_bf16 v[144:147], a[192:195], v[128:131], 0
  v_mfma_f32_16x16x32_bf16 v[144:147], a[196:199], v[132:135], v[144:147]
  v_mfma_f32_16x16x32_bf16 v[144:147], a[200:203], v[136:139], v[144:147]
  v_mfma_f32_16x16x32_bf16 v[144:147], a[204:207], v[140:143], v[144:147]
  v_cvt_pk_bf16_f32 v160, v160, v161
  v_cvt_pk_bf16_f32 v161, v162, v163
  v_cvt_pk_bf16_f32 v162, v164, v165
  v_cvt_pk_bf16_f32 v163, v166, v167
  v_pk_mul_f32 v[168:169], v[168:169], s[52:53]
  v_pk_mul_f32 v[170:171], v[170:171], s[52:53]
  v_pk_mul_f32 v[172:173], v[172:173], s[52:53]
  v_pk_mul_f32 v[174:175], v[174:175], s[52:53]
  v_cvt_pk_bf16_f32 v164, v168, v169
  v_cvt_pk_bf16_f32 v165, v170, v171
  v_cvt_pk_bf16_f32 v166, v172, v173
  v_cvt_pk_bf16_f32 v167, v174, v175
  v_pk_mul_f32 v[176:177], v[176:177], s[52:53]
  v_pk_mul_f32 v[178:179], v[178:179], s[52:53]
  v_pk_mul_f32 v[180:181], v[180:181], s[52:53]
  v_pk_mul_f32 v[182:183], v[182:183], s[52:53]
  v_cvt_pk_bf16_f32 v168, v176, v177
  v_cvt_pk_bf16_f32 v169, v178, v179
  v_cvt_pk_bf16_f32 v170, v180, v181
  v_cvt_pk_bf16_f32 v171, v182, v183
  v_pk_mul_f32 v[184:185], v[184:185], s[52:53]
  v_pk_mul_f32 v[186:187], v[186:187], s[52:53]
  v_pk_mul_f32 v[188:189], v[188:189], s[52:53]
  v_pk_mul_f32 v[190:191], v[190:191], s[52:53]
  v_cvt_pk_bf16_f32 v172, v184, v185
  v_cvt_pk_bf16_f32 v173, v186, v187
  v_cvt_pk_bf16_f32 v174, v188, v189
  v_cvt_pk_bf16_f32 v175, v190, v191
  v_pk_mul_f32 v[192:193], v[192:193], s[52:53]
  v_pk_mul_f32 v[194:195], v[194:195], s[52:53]
  v_pk_mul_f32 v[196:197], v[196:197], s[52:53]
  v_pk_mul_f32 v[198:199], v[198:199], s[52:53]
  v_mfma_f32_16x16x32_bf16 v[176:179], a[192:195], v[160:163], 0
  v_mfma_f32_16x16x32_bf16 v[176:179], a[196:199], v[164:167], v[176:179]
  v_mfma_f32_16x16x32_bf16 v[176:179], a[200:203], v[168:171], v[176:179]
  v_mfma_f32_16x16x32_bf16 v[176:179], a[204:207], v[172:175], v[176:179]
  v_cvt_pk_bf16_f32 v192, v192, v193
  v_cvt_pk_bf16_f32 v193, v194, v195
  v_cvt_pk_bf16_f32 v194, v196, v197
  v_cvt_pk_bf16_f32 v195, v198, v199
  v_pk_mul_f32 v[200:201], v[200:201], s[52:53]
  v_pk_mul_f32 v[202:203], v[202:203], s[52:53]
  v_pk_mul_f32 v[204:205], v[204:205], s[52:53]
  v_pk_mul_f32 v[206:207], v[206:207], s[52:53]
  v_cvt_pk_bf16_f32 v196, v200, v201
  v_cvt_pk_bf16_f32 v197, v202, v203
  v_cvt_pk_bf16_f32 v198, v204, v205
  v_cvt_pk_bf16_f32 v199, v206, v207
  v_pk_mul_f32 v[208:209], v[208:209], s[52:53]
  v_pk_mul_f32 v[210:211], v[210:211], s[52:53]
  v_pk_mul_f32 v[212:213], v[212:213], s[52:53]
  v_pk_mul_f32 v[214:215], v[214:215], s[52:53]
  v_cvt_pk_bf16_f32 v200, v208, v209
  v_cvt_pk_bf16_f32 v201, v210, v211
  v_cvt_pk_bf16_f32 v202, v212, v213
  v_cvt_pk_bf16_f32 v203, v214, v215
  v_pk_mul_f32 v[216:217], v[216:217], s[52:53]
  v_pk_mul_f32 v[218:219], v[218:219], s[52:53]
  v_pk_mul_f32 v[220:221], v[220:221], s[52:53]
  v_pk_mul_f32 v[222:223], v[222:223], s[52:53]
  v_cvt_pk_bf16_f32 v204, v216, v217
  v_cvt_pk_bf16_f32 v205, v218, v219
  v_cvt_pk_bf16_f32 v206, v220, v221
  v_cvt_pk_bf16_f32 v207, v222, v223
  v_pk_mul_f32 v[224:225], v[224:225], s[52:53]
  v_pk_mul_f32 v[226:227], v[226:227], s[52:53]
  v_pk_mul_f32 v[228:229], v[228:229], s[52:53]
  v_pk_mul_f32 v[230:231], v[230:231], s[52:53]
  v_mfma_f32_16x16x32_bf16 v[208:211], a[192:195], v[192:195], 0
  v_mfma_f32_16x16x32_bf16 v[208:211], a[196:199], v[196:199], v[208:211]
  v_mfma_f32_16x16x32_bf16 v[208:211], a[200:203], v[200:203], v[208:211]
  v_mfma_f32_16x16x32_bf16 v[208:211], a[204:207], v[204:207], v[208:211]
  v_cvt_pk_bf16_f32 v224, v224, v225
  v_cvt_pk_bf16_f32 v225, v226, v227
  v_cvt_pk_bf16_f32 v226, v228, v229
  v_cvt_pk_bf16_f32 v227, v230, v231
  v_pk_mul_f32 v[232:233], v[232:233], s[52:53]
  v_pk_mul_f32 v[234:235], v[234:235], s[52:53]
  v_pk_mul_f32 v[236:237], v[236:237], s[52:53]
  v_pk_mul_f32 v[238:239], v[238:239], s[52:53]
  v_cvt_pk_bf16_f32 v228, v232, v233
  v_cvt_pk_bf16_f32 v229, v234, v235
  v_cvt_pk_bf16_f32 v230, v236, v237
  v_cvt_pk_bf16_f32 v231, v238, v239
  v_pk_mul_f32 v[240:241], v[240:241], s[52:53]
  v_pk_mul_f32 v[242:243], v[242:243], s[52:53]
  v_pk_mul_f32 v[244:245], v[244:245], s[52:53]
  v_pk_mul_f32 v[246:247], v[246:247], s[52:53]
  v_cvt_pk_bf16_f32 v232, v240, v241
  v_cvt_pk_bf16_f32 v233, v242, v243
  v_cvt_pk_bf16_f32 v234, v244, v245
  v_cvt_pk_bf16_f32 v235, v246, v247
  v_pk_mul_f32 v[248:249], v[248:249], s[52:53]
  v_pk_mul_f32 v[250:251], v[250:251], s[52:53]
  v_pk_mul_f32 v[252:253], v[252:253], s[52:53]
  v_pk_mul_f32 v[254:255], v[254:255], s[52:53]
  v_cvt_pk_bf16_f32 v236, v248, v249
  v_cvt_pk_bf16_f32 v237, v250, v251
  v_cvt_pk_bf16_f32 v238, v252, v253
  v_cvt_pk_bf16_f32 v239, v254, v255
  s_nop 1
  v_mfma_f32_16x16x32_bf16 v[240:243], a[192:195], v[224:227], 0
  v_mfma_f32_16x16x32_bf16 v[240:243], a[196:199], v[228:231], v[240:243]
  v_mfma_f32_16x16x32_bf16 v[240:243], a[200:203], v[232:235], v[240:243]
  v_mfma_f32_16x16x32_bf16 v[240:243], a[204:207], v[236:239], v[240:243]
  v_mov_b32 v52, 0
  v_mov_b32 v84, 0
  v_mov_b32 v116, 0
  v_mov_b32 v148, 0
  v_mov_b32 v180, 0
  v_mov_b32 v212, 0
  v_mov_b32 v244, 0
  s_nop 1
  v_max3_f32 v48, v48, v49, v50
  v_max3_f32 v80, v80, v81, v82
  v_max3_f32 v112, v112, v113, v114
  v_max3_f32 v144, v144, v145, v146
  v_max3_f32 v176, v176, v177, v178
  v_max3_f32 v208, v208, v209, v210
  v_max3_f32 v240, v240, v241, v242
  v_max_f32 v48, v48, v51
  v_max_f32 v80, v80, v83
  v_max_f32 v112, v112, v115
  v_max_f32 v144, v144, v147
  v_max_f32 v176, v176, v179
  v_max_f32 v208, v208, v211
  v_max_f32 v240, v240, v243
  v_mov_b32 v49, v48
  v_mov_b32 v81, v80
  v_mov_b32 v113, v112
  v_mov_b32 v145, v144
  v_mov_b32 v177, v176
  v_mov_b32 v209, v208
  v_mov_b32 v241, v240
  s_nop 1
  v_permlane16_swap_b32 v48, v49
  v_permlane16_swap_b32 v80, v81
  v_permlane16_swap_b32 v112, v113
  v_permlane16_swap_b32 v144, v145
  v_permlane16_swap_b32 v176, v177
  v_permlane16_swap_b32 v208, v209
  v_permlane16_swap_b32 v240, v241
  s_nop 0
  v_max_f32 v48, v48, v49
  v_max_f32 v80, v80, v81
  v_max_f32 v112, v112, v113
  v_max_f32 v144, v144, v145
  v_max_f32 v176, v176, v177
  v_max_f32 v208, v208, v209
  v_max_f32 v240, v240, v241
  v_mov_b32 v49, v48
  v_mov_b32 v81, v80
  v_mov_b32 v113, v112
  v_mov_b32 v145, v144
  v_mov_b32 v177, v176
  v_mov_b32 v209, v208
  v_mov_b32 v241, v240
  s_nop 1
  v_permlane32_swap_b32 v48, v49
  v_permlane32_swap_b32 v80, v81
  v_permlane32_swap_b32 v112, v113
  v_permlane32_swap_b32 v144, v145
  v_permlane32_swap_b32 v176, v177
  v_permlane32_swap_b32 v208, v209
  v_permlane32_swap_b32 v240, v241
  s_nop 0
  v_max_f32 v48, v48, v49
  v_max_f32 v80, v80, v81
  v_max_f32 v112, v112, v113
  v_max_f32 v144, v144, v145
  v_max_f32 v176, v176, v177
  v_max_f32 v208, v208, v209
  v_max_f32 v240, v240, v241
  v_sub_f32 v51, 0, v48
  v_sub_f32 v50, 0, v48
  v_sub_f32 v49, 0, v48
  v_sub_f32 v48, 0, v48
  s_mov_b32 s50, 0
  s_nop 0
  v_mfma_f32_16x16x32_bf16 v[56:59], a[192:195], v[32:35], v[48:51]
  v_sub_f32 v83, 0, v80
  v_sub_f32 v82, 0, v80
  v_sub_f32 v81, 0, v80
  v_mfma_f32_16x16x32_bf16 v[56:59], a[196:199], v[36:39], v[56:59]
  v_sub_f32 v80, 0, v80
  v_sub_f32 v115, 0, v112
  v_sub_f32 v114, 0, v112
  v_mfma_f32_16x16x32_bf16 v[56:59], a[200:203], v[40:43], v[56:59]
  v_sub_f32 v113, 0, v112
  v_sub_f32 v112, 0, v112
  v_sub_f32 v147, 0, v144
  v_mfma_f32_16x16x32_bf16 v[56:59], a[204:207], v[44:47], v[56:59]
  v_sub_f32 v146, 0, v144
  v_sub_f32 v145, 0, v144
  v_sub_f32 v144, 0, v144
  v_mfma_f32_16x16x32_bf16 v[60:63], a[208:211], v[32:35], v[48:51]
  v_sub_f32 v179, 0, v176
  v_sub_f32 v178, 0, v176
  v_sub_f32 v177, 0, v176
  v_mfma_f32_16x16x32_bf16 v[60:63], a[212:215], v[36:39], v[60:63]
  v_sub_f32 v176, 0, v176
  v_sub_f32 v211, 0, v208
  v_sub_f32 v210, 0, v208
  v_mfma_f32_16x16x32_bf16 v[60:63], a[216:219], v[40:43], v[60:63]
  v_sub_f32 v209, 0, v208
  v_sub_f32 v208, 0, v208
  v_sub_f32 v243, 0, v240
  v_mfma_f32_16x16x32_bf16 v[60:63], a[220:223], v[44:47], v[60:63]
  v_sub_f32 v242, 0, v240
  v_sub_f32 v241, 0, v240
  v_sub_f32 v240, 0, v240
  s_nop 3
  v_exp_f32 v56, v56
  v_exp_f32 v57, v57
  v_exp_f32 v58, v58
  v_exp_f32 v59, v59
  v_exp_f32 v60, v60
  v_add_f32 v52, v52, v56
  v_add_f32 v52, v52, v57
  v_add_f32 v52, v52, v58
  v_add_f32 v52, v52, v59
  v_cvt_pk_bf16_f32 v120, v56, v57
  v_cvt_pk_bf16_f32 v121, v58, v59
  v_mfma_f32_16x16x32_bf16 v[88:91], a[192:195], v[64:67], v[80:83]
  v_add_f32 v52, v52, v60
  v_mfma_f32_16x16x32_bf16 v[88:91], a[196:199], v[68:71], v[88:91]
  v_exp_f32 v61, v61
  v_mfma_f32_16x16x32_bf16 v[88:91], a[200:203], v[72:75], v[88:91]
  v_add_f32 v52, v52, v61
  v_cvt_pk_bf16_f32 v122, v60, v61
  v_mfma_f32_16x16x32_bf16 v[88:91], a[204:207], v[76:79], v[88:91]
  v_exp_f32 v62, v62
  v_mfma_f32_16x16x32_bf16 v[92:95], a[208:211], v[64:67], v[80:83]
  v_add_f32 v52, v52, v62
  v_mfma_f32_16x16x32_bf16 v[92:95], a[212:215], v[68:71], v[92:95]
  v_exp_f32 v63, v63
  v_mfma_f32_16x16x32_bf16 v[92:95], a[216:219], v[72:75], v[92:95]
  v_add_f32 v52, v52, v63
  v_cvt_pk_bf16_f32 v123, v62, v63
  v_mfma_f32_16x16x32_bf16 v[92:95], a[220:223], v[76:79], v[92:95]
  v_exp_f32 v88, v88
  v_mfma_f32_16x16x32_bf16 a[0:3], a[224:227], v[120:123], 0
  v_add_f32 v84, v84, v88
  v_mfma_f32_16x16x32_bf16 a[4:7], a[228:231], v[120:123], 0
  v_exp_f32 v89, v89
  v_mfma_f32_16x16x32_bf16 a[8:11], a[232:235], v[120:123], 0
  s_waitcnt lgkmcnt(8)
  v_add_f32 v84, v84, v89
  v_cvt_pk_bf16_f32 v124, v88, v89
  v_mfma_f32_16x16x32_bf16 a[12:15], a[236:239], v[120:123], 0
  s_waitcnt lgkmcnt(6)
  v_exp_f32 v90, v90
  v_mfma_f32_16x16x32_bf16 a[16:19], a[240:243], v[120:123], 0
  s_waitcnt lgkmcnt(4)
  v_add_f32 v84, v84, v90
  v_mfma_f32_16x16x32_bf16 a[20:23], a[244:247], v[120:123], 0
  s_waitcnt lgkmcnt(2)
  v_exp_f32 v91, v91
  v_mfma_f32_16x16x32_bf16 a[24:27], a[248:251], v[120:123], 0
  s_waitcnt lgkmcnt(0)
  v_add_f32 v84, v84, v91
  v_cvt_pk_bf16_f32 v125, v90, v91
  v_mfma_f32_16x16x32_bf16 a[28:31], a[252:255], v[120:123], 0
  s_waitcnt vmcnt(0)
  s_barrier
  v_exp_f32 v92, v92
  v_mfma_f32_16x16x32_bf16 v[56:59], a[192:195], v[96:99], v[112:115]
  v_add_f32 v84, v84, v92
  v_mfma_f32_16x16x32_bf16 v[56:59], a[196:199], v[100:103], v[56:59]
  v_exp_f32 v93, v93
  v_mfma_f32_16x16x32_bf16 v[56:59], a[200:203], v[104:107], v[56:59]
  v_add_f32 v84, v84, v93
  v_cvt_pk_bf16_f32 v126, v92, v93
  v_mfma_f32_16x16x32_bf16 v[56:59], a[204:207], v[108:111], v[56:59]
  v_exp_f32 v94, v94
  v_mfma_f32_16x16x32_bf16 v[60:63], a[208:211], v[96:99], v[112:115]
  v_add_f32 v84, v84, v94
  v_mfma_f32_16x16x32_bf16 v[60:63], a[212:215], v[100:103], v[60:63]
  v_exp_f32 v95, v95
  v_mfma_f32_16x16x32_bf16 v[60:63], a[216:219], v[104:107], v[60:63]
  v_add_f32 v84, v84, v95
  v_cvt_pk_bf16_f32 v127, v94, v95
  v_mfma_f32_16x16x32_bf16 v[60:63], a[220:223], v[108:111], v[60:63]
  v_exp_f32 v56, v56
  v_mfma_f32_16x16x32_bf16 a[32:35], a[224:227], v[124:127], 0
  v_add_f32 v116, v116, v56
  v_mfma_f32_16x16x32_bf16 a[36:39], a[228:231], v[124:127], 0
  v_exp_f32 v57, v57
  v_mfma_f32_16x16x32_bf16 a[40:43], a[232:235], v[124:127], 0
  v_add_f32 v116, v116, v57
  v_cvt_pk_bf16_f32 v120, v56, v57
  v_mfma_f32_16x16x32_bf16 a[44:47], a[236:239], v[124:127], 0
  v_exp_f32 v58, v58
  v_mfma_f32_16x16x32_bf16 a[48:51], a[240:243], v[124:127], 0
  v_add_f32 v116, v116, v58
  v_mfma_f32_16x16x32_bf16 a[52:55], a[244:247], v[124:127], 0
  v_exp_f32 v59, v59
  v_mfma_f32_16x16x32_bf16 a[56:59], a[248:251], v[124:127], 0
  v_add_f32 v116, v116, v59
  v_cvt_pk_bf16_f32 v121, v58, v59
  v_mfma_f32_16x16x32_bf16 a[60:63], a[252:255], v[124:127], 0
  v_exp_f32 v60, v60
  v_mfma_f32_16x16x32_bf16 v[88:91], a[192:195], v[128:131], v[144:147]
  v_add_f32 v116, v116, v60
  v_mfma_f32_16x16x32_bf16 v[88:91], a[196:199], v[132:135], v[88:91]
  v_exp_f32 v61, v61
  v_mfma_f32_16x16x32_bf16 v[88:91], a[200:203], v[136:139], v[88:91]
  v_add_f32 v116, v116, v61
  v_cvt_pk_bf16_f32 v122, v60, v61
  v_mfma_f32_16x16x32_bf16 v[88:91], a[204:207], v[140:143], v[88:91]
  v_exp_f32 v62, v62
  v_mfma_f32_16x16x32_bf16 v[92:95], a[208:211], v[128:131], v[144:147]
  v_add_f32 v116, v116, v62
  v_mfma_f32_16x16x32_bf16 v[92:95], a[212:215], v[132:135], v[92:95]
  v_exp_f32 v63, v63
  v_mfma_f32_16x16x32_bf16 v[92:95], a[216:219], v[136:139], v[92:95]
  v_add_f32 v116, v116, v63
  v_cvt_pk_bf16_f32 v123, v62, v63
  v_mfma_f32_16x16x32_bf16 v[92:95], a[220:223], v[140:143], v[92:95]
  v_exp_f32 v88, v88
  v_mfma_f32_16x16x32_bf16 a[64:67], a[224:227], v[120:123], 0
  v_add_f32 v148, v148, v88
  v_mfma_f32_16x16x32_bf16 a[68:71], a[228:231], v[120:123], 0
  v_exp_f32 v89, v89
  v_mfma_f32_16x16x32_bf16 a[72:75], a[232:235], v[120:123], 0
  v_add_f32 v148, v148, v89
  v_cvt_pk_bf16_f32 v124, v88, v89
  v_mfma_f32_16x16x32_bf16 a[76:79], a[236:239], v[120:123], 0
  v_exp_f32 v90, v90
  v_mfma_f32_16x16x32_bf16 a[80:83], a[240:243], v[120:123], 0
  v_add_f32 v148, v148, v90
  v_mfma_f32_16x16x32_bf16 a[84:87], a[244:247], v[120:123], 0
  v_exp_f32 v91, v91
  v_mfma_f32_16x16x32_bf16 a[88:91], a[248:251], v[120:123], 0
  v_add_f32 v148, v148, v91
  v_cvt_pk_bf16_f32 v125, v90, v91
  v_mfma_f32_16x16x32_bf16 a[92:95], a[252:255], v[120:123], 0
  v_exp_f32 v92, v92
  v_mfma_f32_16x16x32_bf16 v[56:59], a[192:195], v[160:163], v[176:179]
  v_add_f32 v148, v148, v92
  v_mfma_f32_16x16x32_bf16 v[56:59], a[196:199], v[164:167], v[56:59]
  v_exp_f32 v93, v93
  v_mfma_f32_16x16x32_bf16 v[56:59], a[200:203], v[168:171], v[56:59]
  v_add_f32 v148, v148, v93
  v_cvt_pk_bf16_f32 v126, v92, v93
  v_mfma_f32_16x16x32_bf16 v[56:59], a[204:207], v[172:175], v[56:59]
  v_exp_f32 v94, v94
  v_mfma_f32_16x16x32_bf16 v[60:63], a[208:211], v[160:163], v[176:179]
  v_add_f32 v148, v148, v94
  v_mfma_f32_16x16x32_bf16 v[60:63], a[212:215], v[164:167], v[60:63]
  v_exp_f32 v95, v95
  v_mfma_f32_16x16x32_bf16 v[60:63], a[216:219], v[168:171], v[60:63]
  v_add_f32 v148, v148, v95
  v_cvt_pk_bf16_f32 v127, v94, v95
  v_mfma_f32_16x16x32_bf16 v[60:63], a[220:223], v[172:175], v[60:63]
  v_exp_f32 v56, v56
  v_mfma_f32_16x16x32_bf16 a[96:99], a[224:227], v[124:127], 0
  v_add_f32 v180, v180, v56
  v_mfma_f32_16x16x32_bf16 a[100:103], a[228:231], v[124:127], 0
  v_exp_f32 v57, v57
  v_mfma_f32_16x16x32_bf16 a[104:107], a[232:235], v[124:127], 0
  v_add_f32 v180, v180, v57
  v_cvt_pk_bf16_f32 v120, v56, v57
  v_mfma_f32_16x16x32_bf16 a[108:111], a[236:239], v[124:127], 0
  v_exp_f32 v58, v58
  v_mfma_f32_16x16x32_bf16 a[112:115], a[240:243], v[124:127], 0
  v_add_f32 v180, v180, v58
  v_mfma_f32_16x16x32_bf16 a[116:119], a[244:247], v[124:127], 0
  v_exp_f32 v59, v59
  v_mfma_f32_16x16x32_bf16 a[120:123], a[248:251], v[124:127], 0
  v_add_f32 v180, v180, v59
  v_cvt_pk_bf16_f32 v121, v58, v59
  v_mfma_f32_16x16x32_bf16 a[124:127], a[252:255], v[124:127], 0
  v_exp_f32 v60, v60
  v_mfma_f32_16x16x32_bf16 v[88:91], a[192:195], v[192:195], v[208:211]
  v_add_f32 v180, v180, v60
  v_mfma_f32_16x16x32_bf16 v[88:91], a[196:199], v[196:199], v[88:91]
  v_exp_f32 v61, v61
  v_mfma_f32_16x16x32_bf16 v[88:91], a[200:203], v[200:203], v[88:91]
  v_add_f32 v180, v180, v61
  v_cvt_pk_bf16_f32 v122, v60, v61
  v_mfma_f32_16x16x32_bf16 v[88:91], a[204:207], v[204:207], v[88:91]
  v_exp_f32 v62, v62
  v_mfma_f32_16x16x32_bf16 v[92:95], a[208:211], v[192:195], v[208:211]
  v_add_f32 v180, v180, v62
  v_mfma_f32_16x16x32_bf16 v[92:95], a[212:215], v[196:199], v[92:95]
  v_exp_f32 v63, v63
  v_mfma_f32_16x16x32_bf16 v[92:95], a[216:219], v[200:203], v[92:95]
  v_add_f32 v180, v180, v63
  v_cvt_pk_bf16_f32 v123, v62, v63
  v_mfma_f32_16x16x32_bf16 v[92:95], a[220:223], v[204:207], v[92:95]
  v_exp_f32 v88, v88
  v_mfma_f32_16x16x32_bf16 a[128:131], a[224:227], v[120:123], 0
  v_add_f32 v212, v212, v88
  v_mfma_f32_16x16x32_bf16 a[132:135], a[228:231], v[120:123], 0
  v_exp_f32 v89, v89
  v_mfma_f32_16x16x32_bf16 a[136:139], a[232:235], v[120:123], 0
  v_add_f32 v212, v212, v89
  v_cvt_pk_bf16_f32 v124, v88, v89
  v_mfma_f32_16x16x32_bf16 a[140:143], a[236:239], v[120:123], 0
  v_exp_f32 v90, v90
  v_mfma_f32_16x16x32_bf16 a[144:147], a[240:243], v[120:123], 0
  v_add_f32 v212, v212, v90
  v_mfma_f32_16x16x32_bf16 a[148:151], a[244:247], v[120:123], 0
  v_exp_f32 v91, v91
  v_mfma_f32_16x16x32_bf16 a[152:155], a[248:251], v[120:123], 0
  v_add_f32 v212, v212, v91
  v_cvt_pk_bf16_f32 v125, v90, v91
  v_mfma_f32_16x16x32_bf16 a[156:159], a[252:255], v[120:123], 0
  v_exp_f32 v92, v92
  v_mfma_f32_16x16x32_bf16 v[56:59], a[192:195], v[224:227], v[240:243]
  ds_read_b128 a[192:195], v13 offset:0
  v_add_f32 v212, v212, v92
  v_mfma_f32_16x16x32_bf16 v[56:59], a[196:199], v[228:231], v[56:59]
  v_exp_f32 v93, v93
  v_mfma_f32_16x16x32_bf16 v[56:59], a[200:203], v[232:235], v[56:59]
  ds_read_b128 a[196:199], v14 offset:0
  v_add_f32 v212, v212, v93
  v_cvt_pk_bf16_f32 v126, v92, v93
  v_mfma_f32_16x16x32_bf16 v[56:59], a[204:207], v[236:239], v[56:59]
  v_exp_f32 v94, v94
  v_mfma_f32_16x16x32_bf16 v[60:63], a[208:211], v[224:227], v[240:243]
  ds_read_b128 a[200:203], v15 offset:0
  v_add_f32 v212, v212, v94
  v_mfma_f32_16x16x32_bf16 v[60:63], a[212:215], v[228:231], v[60:63]
  v_exp_f32 v95, v95
  v_mfma_f32_16x16x32_bf16 v[60:63], a[216:219], v[232:235], v[60:63]
  ds_read_b128 a[204:207], v16 offset:0
  v_add_f32 v212, v212, v95
  v_cvt_pk_bf16_f32 v127, v94, v95
  v_mfma_f32_16x16x32_bf16 v[60:63], a[220:223], v[236:239], v[60:63]
  v_exp_f32 v56, v56
  v_mfma_f32_16x16x32_bf16 a[160:163], a[224:227], v[124:127], 0
  ds_read_b128 a[208:211], v13 offset:2048
  v_add_f32 v244, v244, v56
  v_mfma_f32_16x16x32_bf16 a[164:167], a[228:231], v[124:127], 0
  v_exp_f32 v57, v57
  v_mfma_f32_16x16x32_bf16 a[168:171], a[232:235], v[124:127], 0
  ds_read_b128 a[212:215], v14 offset:2048
  v_add_f32 v244, v244, v57
  v_cvt_pk_bf16_f32 v120, v56, v57
  v_mfma_f32_16x16x32_bf16 a[172:175], a[236:239], v[124:127], 0
  v_exp_f32 v58, v58
  v_mfma_f32_16x16x32_bf16 a[176:179], a[240:243], v[124:127], 0
  ds_read_b128 a[216:219], v15 offset:2048
  v_add_f32 v244, v244, v58
  v_mfma_f32_16x16x32_bf16 a[180:183], a[244:247], v[124:127], 0
  v_exp_f32 v59, v59
  v_mfma_f32_16x16x32_bf16 a[184:187], a[248:251], v[124:127], 0
  ds_read_b128 a[220:223], v16 offset:2048
  v_add_f32 v244, v244, v59
  v_cvt_pk_bf16_f32 v121, v58, v59
  v_mfma_f32_16x16x32_bf16 a[188:191], a[252:255], v[124:127], 0
  s_waitcnt lgkmcnt(7)
  v_exp_f32 v60, v60
  v_mfma_f32_16x16x32_bf16 v[88:91], a[192:195], v[32:35], v[48:51]
  s_waitcnt lgkmcnt(6)
  v_add_f32 v244, v244, v60
  v_mfma_f32_16x16x32_bf16 v[88:91], a[196:199], v[36:39], v[88:91]
  s_waitcnt lgkmcnt(5)
  v_exp_f32 v61, v61
  v_mfma_f32_16x16x32_bf16 v[88:91], a[200:203], v[40:43], v[88:91]
  s_waitcnt lgkmcnt(4)
  v_add_f32 v244, v244, v61
  v_cvt_pk_bf16_f32 v122, v60, v61
  v_mfma_f32_16x16x32_bf16 v[88:91], a[204:207], v[44:47], v[88:91]
  s_waitcnt lgkmcnt(3)
  v_exp_f32 v62, v62
  v_mfma_f32_16x16x32_bf16 v[92:95], a[208:211], v[32:35], v[48:51]
  s_waitcnt lgkmcnt(2)
  v_add_f32 v244, v244, v62
  v_mfma_f32_16x16x32_bf16 v[92:95], a[212:215], v[36:39], v[92:95]
  s_waitcnt lgkmcnt(1)
  v_exp_f32 v63, v63
  v_mfma_f32_16x16x32_bf16 v[92:95], a[216:219], v[40:43], v[92:95]
  s_waitcnt lgkmcnt(0)
  v_add_f32 v244, v244, v63
  v_cvt_pk_bf16_f32 v123, v62, v63
  v_mfma_f32_16x16x32_bf16 v[92:95], a[220:223], v[44:47], v[92:95]
  v_exp_f32 v88, v88
  v_mfma_f32_16x16x32_bf16 v[152:155], a[224:227], v[120:123], 0
  ds_read_b64_tr_b16 a[224:225], v17 offset:0
  v_add_f32 v52, v52, v88
  v_mfma_f32_16x16x32_bf16 v[156:159], a[228:231], v[120:123], 0
  ds_read_b64_tr_b16 a[226:227], v17 offset:2048
  v_exp_f32 v89, v89
  v_mfma_f32_16x16x32_bf16 v[184:187], a[232:235], v[120:123], 0
  ds_read_b64_tr_b16 a[228:229], v18 offset:0
  v_add_f32 v52, v52, v89
  v_cvt_pk_bf16_f32 v124, v88, v89
  v_mfma_f32_16x16x32_bf16 v[188:191], a[236:239], v[120:123], 0
  ds_read_b64_tr_b16 a[230:231], v18 offset:2048
  v_exp_f32 v90, v90
  v_mfma_f32_16x16x32_bf16 v[216:219], a[240:243], v[120:123], 0
  ds_read_b64_tr_b16 a[232:233], v19 offset:0
  v_add_f32 v52, v52, v90
  v_mfma_f32_16x16x32_bf16 v[220:223], a[244:247], v[120:123], 0
  ds_read_b64_tr_b16 a[234:235], v19 offset:2048
  v_exp_f32 v91, v91
  v_mfma_f32_16x16x32_bf16 v[248:251], a[248:251], v[120:123], 0
  ds_read_b64_tr_b16 a[236:237], v20 offset:0
  v_add_f32 v52, v52, v91
  v_cvt_pk_bf16_f32 v125, v90, v91
  v_mfma_f32_16x16x32_bf16 v[252:255], a[252:255], v[120:123], 0
  ds_read_b64_tr_b16 a[238:239], v20 offset:2048
  v_exp_f32 v92, v92
L1a_aloop:
  v_mfma_f32_16x16x32_bf16 v[56:59], a[192:195], v[64:67], v[80:83]
  ds_read_b64_tr_b16 a[240:241], v21 offset:0
  v_add_f32 v52, v52, v92
  v_mfma_f32_16x16x32_bf16 v[56:59], a[196:199], v[68:71], v[56:59]
  ds_read_b64_tr_b16 a[242:243], v21 offset:2048
  v_exp_f32 v93, v93
  v_mfma_f32_16x16x32_bf16 v[56:59], a[200:203], v[72:75], v[56:59]
  ds_read_b64_tr_b16 a[244:245], v22 offset:0
  v_add_f32 v52, v52, v93
  v_cvt_pk_bf16_f32 v126, v92, v93
  v_mfma_f32_16x16x32_bf16 v[56:59], a[204:207], v[76:79], v[56:59]
  ds_read_b64_tr_b16 a[246:247], v22 offset:2048
  v_exp_f32 v94, v94
  v_mfma_f32_16x16x32_bf16 v[60:63], a[208:211], v[64:67], v[80:83]
  ds_read_b64_tr_b16 a[248:249], v23 offset:0
  v_add_f32 v52, v52, v94
  v_mfma_f32_16x16x32_bf16 v[60:63], a[212:215], v[68:71], v[60:63]
  ds_read_b64_tr_b16 a[250:251], v23 offset:2048
  v_exp_f32 v95, v95
  v_mfma_f32_16x16x32_bf16 v[60:63], a[216:219], v[72:75], v[60:63]
  ds_read_b64_tr_b16 a[252:253], v28 offset:0
  v_add_f32 v52, v52, v95
  v_cvt_pk_bf16_f32 v127, v94, v95
  v_mfma_f32_16x16x32_bf16 v[60:63], a[220:223], v[76:79], v[60:63]
  s_waitcnt lgkmcnt(8)
  ds_read_b64_tr_b16 a[254:255], v28 offset:2048
  v_exp_f32 v56, v56
  v_mfma_f32_16x16x32_bf16 a[0:3], a[224:227], v[124:127], a[0:3]
  v_add_f32 v84, v84, v56
  v_mfma_f32_16x16x32_bf16 a[4:7], a[228:231], v[124:127], a[4:7]
  v_exp_f32 v57, v57
  v_mfma_f32_16x16x32_bf16 a[8:11], a[232:235], v[124:127], a[8:11]
  s_waitcnt lgkmcnt(8)
  v_add_f32 v84, v84, v57
  v_cvt_pk_bf16_f32 v120, v56, v57
  v_mfma_f32_16x16x32_bf16 a[12:15], a[236:239], v[124:127], a[12:15]
  s_waitcnt lgkmcnt(6)
  v_exp_f32 v58, v58
  v_mfma_f32_16x16x32_bf16 a[16:19], a[240:243], v[124:127], a[16:19]
  s_waitcnt lgkmcnt(4)
  v_add_f32 v84, v84, v58
  v_mfma_f32_16x16x32_bf16 a[20:23], a[244:247], v[124:127], a[20:23]
  s_waitcnt lgkmcnt(2)
  v_exp_f32 v59, v59
  v_mfma_f32_16x16x32_bf16 a[24:27], a[248:251], v[124:127], a[24:27]
  s_waitcnt lgkmcnt(0)
  v_add_f32 v84, v84, v59
  v_cvt_pk_bf16_f32 v121, v58, v59
  v_mfma_f32_16x16x32_bf16 a[28:31], a[252:255], v[124:127], a[28:31]
  s_barrier
  v_exp_f32 v60, v60
  v_mfma_f32_16x16x32_bf16 v[88:91], a[192:195], v[96:99], v[112:115]
  s_add_u32 s47, s43, 0
  v_add_f32 v84, v84, v60
  v_mfma_f32_16x16x32_bf16 v[88:91], a[196:199], v[100:103], v[88:91]
  v_exp_f32 v61, v61
  v_mfma_f32_16x16x32_bf16 v[88:91], a[200:203], v[104:107], v[88:91]
  v_add_f32 v84, v84, v61
  v_cvt_pk_bf16_f32 v122, v60, v61
  v_mfma_f32_16x16x32_bf16 v[88:91], a[204:207], v[108:111], v[88:91]
  v_exp_f32 v62, v62
  v_mfma_f32_16x16x32_bf16 v[92:95], a[208:211], v[96:99], v[112:115]
  s_cmp_eq_u32 s50, 7
  s_cselect_b32 s46, s47, 16777216
  buffer_load_dword v29, v5, s[12:15], s46 offen offset:0
  v_add_f32 v84, v84, v62
  v_mfma_f32_16x16x32_bf16 v[92:95], a[212:215], v[100:103], v[92:95]
  v_exp_f32 v63, v63
  v_mfma_f32_16x16x32_bf16 v[92:95], a[216:219], v[104:107], v[92:95]
  v_add_f32 v84, v84, v63
  v_cvt_pk_bf16_f32 v123, v62, v63
  v_mfma_f32_16x16x32_bf16 v[92:95], a[220:223], v[108:111], v[92:95]
  v_exp_f32 v88, v88
  v_mfma_f32_16x16x32_bf16 a[32:35], a[224:227], v[120:123], a[32:35]
  v_add_f32 v116, v116, v88
  v_mfma_f32_16x16x32_bf16 a[36:39], a[228:231], v[120:123], a[36:39]
  v_exp_f32 v89, v89
  v_mfma_f32_16x16x32_bf16 a[40:43], a[232:235], v[120:123], a[40:43]
  v_add_f32 v116, v116, v89
  v_cvt_pk_bf16_f32 v124, v88, v89
  v_mfma_f32_16x16x32_bf16 a[44:47], a[236:239], v[120:123], a[44:47]
  v_exp_f32 v90, v90
  v_mfma_f32_16x16x32_bf16 a[48:51], a[240:243], v[120:123], a[48:51]
  v_add_f32 v116, v116, v90
  v_mfma_f32_16x16x32_bf16 a[52:55], a[244:247], v[120:123], a[52:55]
  v_exp_f32 v91, v91
  v_mfma_f32_16x16x32_bf16 a[56:59], a[248:251], v[120:123], a[56:59]
  v_add_f32 v116, v116, v91
  v_cvt_pk_bf16_f32 v125, v90, v91
  v_mfma_f32_16x16x32_bf16 a[60:63], a[252:255], v[120:123], a[60:63]
  v_exp_f32 v92, v92
  v_mfma_f32_16x16x32_bf16 v[56:59], a[192:195], v[128:131], v[144:147]
  s_add_u32 s47, s43, 65536
  v_add_f32 v116, v116, v92
  v_mfma_f32_16x16x32_bf16 v[56:59], a[196:199], v[132:135], v[56:59]
  v_exp_f32 v93, v93
  v_mfma_f32_16x16x32_bf16 v[56:59], a[200:203], v[136:139], v[56:59]
  v_add_f32 v116, v116, v93
  v_cvt_pk_bf16_f32 v126, v92, v93
  v_mfma_f32_16x16x32_bf16 v[56:59], a[204:207], v[140:143], v[56:59]
  v_exp_f32 v94, v94
  v_mfma_f32_16x16x32_bf16 v[60:63], a[208:211], v[128:131], v[144:147]
  s_cmp_eq_u32 s50, 7
  s_cselect_b32 s46, s47, 16777216
  buffer_load_dword v29, v5, s[12:15], s46 offen offset:0
  v_add_f32 v116, v116, v94
  v_mfma_f32_16x16x32_bf16 v[60:63], a[212:215], v[132:135], v[60:63]
  v_exp_f32 v95, v95
  v_mfma_f32_16x16x32_bf16 v[60:63], a[216:219], v[136:139], v[60:63]
  v_add_f32 v116, v116, v95
  v_cvt_pk_bf16_f32 v127, v94, v95
  v_mfma_f32_16x16x32_bf16 v[60:63], a[220:223], v[140:143], v[60:63]
  v_exp_f32 v56, v56
  v_mfma_f32_16x16x32_bf16 a[64:67], a[224:227], v[124:127], a[64:67]
  v_add_f32 v148, v148, v56
  v_mfma_f32_16x16x32_bf16 a[68:71], a[228:231], v[124:127], a[68:71]
  v_exp_f32 v57, v57
  v_mfma_f32_16x16x32_bf16 a[72:75], a[232:235], v[124:127], a[72:75]
  v_add_f32 v148, v148, v57
  v_cvt_pk_bf16_f32 v120, v56, v57
  v_mfma_f32_16x16x32_bf16 a[76:79], a[236:239], v[124:127], a[76:79]
  v_exp_f32 v58, v58
  v_mfma_f32_16x16x32_bf16 a[80:83], a[240:243], v[124:127], a[80:83]
  v_add_f32 v148, v148, v58
  v_mfma_f32_16x16x32_bf16 a[84:87], a[244:247], v[124:127], a[84:87]
  v_exp_f32 v59, v59
  v_mfma_f32_16x16x32_bf16 a[88:91], a[248:251], v[124:127], a[88:91]
  v_add_f32 v148, v148, v59
  v_cvt_pk_bf16_f32 v121, v58, v59
  v_mfma_f32_16x16x32_bf16 a[92:95], a[252:255], v[124:127], a[92:95]
  v_exp_f32 v60, v60
  v_mfma_f32_16x16x32_bf16 v[88:91], a[192:195], v[160:163], v[176:179]
  v_add_f32 v148, v148, v60
  v_mfma_f32_16x16x32_bf16 v[88:91], a[196:199], v[164:167], v[88:91]
  v_exp_f32 v61, v61
  v_mfma_f32_16x16x32_bf16 v[88:91], a[200:203], v[168:171], v[88:91]
  v_add_f32 v148, v148, v61
  v_cvt_pk_bf16_f32 v122, v60, v61
  v_mfma_f32_16x16x32_bf16 v[88:91], a[204:207], v[172:175], v[88:91]
  v_exp_f32 v62, v62
  v_mfma_f32_16x16x32_bf16 v[92:95], a[208:211], v[160:163], v[176:179]
  v_add_f32 v148, v148, v62
  v_mfma_f32_16x16x32_bf16 v[92:95], a[212:215], v[164:167], v[92:95]
  v_exp_f32 v63, v63
  v_mfma_f32_16x16x32_bf16 v[92:95], a[216:219], v[168:171], v[92:95]
  v_add_f32 v148, v148, v63
  v_cvt_pk_bf16_f32 v123, v62, v63
  v_mfma_f32_16x16x32_bf16 v[92:95], a[220:223], v[172:175], v[92:95]
  v_exp_f32 v88, v88
  v_mfma_f32_16x16x32_bf16 a[96:99], a[224:227], v[120:123], a[96:99]
  v_add_f32 v180, v180, v88
  v_mfma_f32_16x16x32_bf16 a[100:103], a[228:231], v[120:123], a[100:103]
  v_exp_f32 v89, v89
  v_mfma_f32_16x16x32_bf16 a[104:107], a[232:235], v[120:123], a[104:107]
  v_add_f32 v180, v180, v89
  v_cvt_pk_bf16_f32 v124, v88, v89
  v_mfma_f32_16x16x32_bf16 a[108:111], a[236:239], v[120:123], a[108:111]
  v_exp_f32 v90, v90
  v_mfma_f32_16x16x32_bf16 a[112:115], a[240:243], v[120:123], a[112:115]
  v_add_f32 v180, v180, v90
  v_mfma_f32_16x16x32_bf16 a[116:119], a[244:247], v[120:123], a[116:119]
  v_exp_f32 v91, v91
  v_mfma_f32_16x16x32_bf16 a[120:123], a[248:251], v[120:123], a[120:123]
  v_add_f32 v180, v180, v91
  v_cvt_pk_bf16_f32 v125, v90, v91
  v_mfma_f32_16x16x32_bf16 a[124:127], a[252:255], v[120:123], a[124:127]
  v_exp_f32 v92, v92
  v_mfma_f32_16x16x32_bf16 v[56:59], a[192:195], v[192:195], v[208:211]
  v_add_f32 v180, v180, v92
  v_mfma_f32_16x16x32_bf16 v[56:59], a[196:199], v[196:199], v[56:59]
  v_exp_f32 v93, v93
  v_mfma_f32_16x16x32_bf16 v[56:59], a[200:203], v[200:203], v[56:59]
  v_add_f32 v180, v180, v93
  v_cvt_pk_bf16_f32 v126, v92, v93
  v_mfma_f32_16x16x32_bf16 v[56:59], a[204:207], v[204:207], v[56:59]
  v_exp_f32 v94, v94
  v_mfma_f32_16x16x32_bf16 v[60:63], a[208:211], v[192:195], v[208:211]
  v_add_f32 v180, v180, v94
  v_mfma_f32_16x16x32_bf16 v[60:63], a[212:215], v[196:199], v[60:63]
  v_exp_f32 v95, v95
  v_mfma_f32_16x16x32_bf16 v[60:63], a[216:219], v[200:203], v[60:63]
  v_add_f32 v180, v180, v95
  v_cvt_pk_bf16_f32 v127, v94, v95
  v_mfma_f32_16x16x32_bf16 v[60:63], a[220:223], v[204:207], v[60:63]
  v_exp_f32 v56, v56
  v_mfma_f32_16x16x32_bf16 a[128:131], a[224:227], v[124:127], a[128:131]
  v_add_f32 v212, v212, v56
  v_mfma_f32_16x16x32_bf16 a[132:135], a[228:231], v[124:127], a[132:135]
  v_exp_f32 v57, v57
  v_mfma_f32_16x16x32_bf16 a[136:139], a[232:235], v[124:127], a[136:139]
  v_add_f32 v212, v212, v57
  v_cvt_pk_bf16_f32 v120, v56, v57
  v_mfma_f32_16x16x32_bf16 a[140:143], a[236:239], v[124:127], a[140:143]
  v_exp_f32 v58, v58
  v_mfma_f32_16x16x32_bf16 a[144:147], a[240:243], v[124:127], a[144:147]
  v_add_f32 v212, v212, v58
  v_mfma_f32_16x16x32_bf16 a[148:151], a[244:247], v[124:127], a[148:151]
  v_exp_f32 v59, v59
  v_mfma_f32_16x16x32_bf16 a[152:155], a[248:251], v[124:127], a[152:155]
  v_add_f32 v212, v212, v59
  v_cvt_pk_bf16_f32 v121, v58, v59
  v_mfma_f32_16x16x32_bf16 a[156:159], a[252:255], v[124:127], a[156:159]
  v_exp_f32 v60, v60
  v_mfma_f32_16x16x32_bf16 v[88:91], a[192:195], v[224:227], v[240:243]
  ds_read_b128 a[192:195], v13 offset:8192
  v_add_f32 v212, v212, v60
  v_mfma_f32_16x16x32_bf16 v[88:91], a[196:199], v[228:231], v[88:91]
  v_exp_f32 v61, v61
  v_mfma_f32_16x16x32_bf16 v[88:91], a[200:203], v[232:235], v[88:91]
  ds_read_b128 a[196:199], v14 offset:8192
  v_add_f32 v212, v212, v61
  v_cvt_pk_bf16_f32 v122, v60, v61
  v_mfma_f32_16x16x32_bf16 v[88:91], a[204:207], v[236:239], v[88:91]
  v_exp_f32 v62, v62
  v_mfma_f32_16x16x32_bf16 v[92:95], a[208:211], v[224:227], v[240:243]
  ds_read_b128 a[200:203], v15 offset:8192
  v_add_f32 v212, v212, v62
  v_mfma_f32_16x16x32_bf16 v[92:95], a[212:215], v[228:231], v[92:95]
  v_exp_f32 v63, v63
  v_mfma_f32_16x16x32_bf16 v[92:95], a[216:219], v[232:235], v[92:95]
  ds_read_b128 a[204:207], v16 offset:8192
  v_add_f32 v212, v212, v63
  v_cvt_pk_bf16_f32 v123, v62, v63
  v_mfma_f32_16x16x32_bf16 v[92:95], a[220:223], v[236:239], v[92:95]
  v_exp_f32 v88, v88
  v_mfma_f32_16x16x32_bf16 a[160:163], a[224:227], v[120:123], a[160:163]
  ds_read_b128 a[208:211], v13 offset:10240
  v_add_f32 v244, v244, v88
  v_mfma_f32_16x16x32_bf16 a[164:167], a[228:231], v[120:123], a[164:167]
  v_exp_f32 v89, v89
  v_mfma_f32_16x16x32_bf16 a[168:171], a[232:235], v[120:123], a[168:171]
  ds_read_b128 a[212:215], v14 offset:10240
  v_add_f32 v244, v244, v89
  v_cvt_pk_bf16_f32 v124, v88, v89
  v_mfma_f32_16x16x32_bf16 a[172:175], a[236:239], v[120:123], a[172:175]
  v_exp_f32 v90, v90
  v_mfma_f32_16x16x32_bf16 a[176:179], a[240:243], v[120:123], a[176:179]
  ds_read_b128 a[216:219], v15 offset:10240
  v_add_f32 v244, v244, v90
  v_mfma_f32_16x16x32_bf16 a[180:183], a[244:247], v[120:123], a[180:183]
  v_exp_f32 v91, v91
  v_mfma_f32_16x16x32_bf16 a[184:187], a[248:251], v[120:123], a[184:187]
  ds_read_b128 a[220:223], v16 offset:10240
  v_add_f32 v244, v244, v91
  v_cvt_pk_bf16_f32 v125, v90, v91
  v_mfma_f32_16x16x32_bf16 a[188:191], a[252:255], v[120:123], a[188:191]
  s_waitcnt lgkmcnt(7)
  v_exp_f32 v92, v92
  v_mfma_f32_16x16x32_bf16 v[56:59], a[192:195], v[32:35], v[48:51]
  s_waitcnt lgkmcnt(6)
  v_add_f32 v244, v244, v92
  v_mfma_f32_16x16x32_bf16 v[56:59], a[196:199], v[36:39], v[56:59]
  s_waitcnt lgkmcnt(5)
  v_exp_f32 v93, v93
  v_mfma_f32_16x16x32_bf16 v[56:59], a[200:203], v[40:43], v[56:59]
  s_waitcnt lgkmcnt(4)
  v_add_f32 v244, v244, v93
  v_cvt_pk_bf16_f32 v126, v92, v93
  v_mfma_f32_16x16x32_bf16 v[56:59], a[204:207], v[44:47], v[56:59]
  s_waitcnt lgkmcnt(3)
  v_exp_f32 v94, v94
  v_mfma_f32_16x16x32_bf16 v[60:63], a[208:211], v[32:35], v[48:51]
  s_waitcnt lgkmcnt(2)
  v_add_f32 v244, v244, v94
  v_mfma_f32_16x16x32_bf16 v[60:63], a[212:215], v[36:39], v[60:63]
  s_waitcnt lgkmcnt(1)
  v_exp_f32 v95, v95
  v_mfma_f32_16x16x32_bf16 v[60:63], a[216:219], v[40:43], v[60:63]
  s_waitcnt lgkmcnt(0)
  v_add_f32 v244, v244, v95
  v_cvt_pk_bf16_f32 v127, v94, v95
  v_mfma_f32_16x16x32_bf16 v[60:63], a[220:223], v[44:47], v[60:63]
  v_exp_f32 v56, v56
  v_mfma_f32_16x16x32_bf16 v[152:155], a[224:227], v[124:127], v[152:155]
  ds_read_b64_tr_b16 a[224:225], v17 offset:8192
  v_add_f32 v52, v52, v56
  v_mfma_f32_16x16x32_bf16 v[156:159], a[228:231], v[124:127], v[156:159]
  ds_read_b64_tr_b16 a[226:227], v17 offset:10240
  v_exp_f32 v57, v57
  v_mfma_f32_16x16x32_bf16 v[184:187], a[232:235], v[124:127], v[184:187]
  ds_read_b64_tr_b16 a[228:229], v18 offset:8192
  v_add_f32 v52, v52, v57
  v_cvt_pk_bf16_f32 v120, v56, v57
  v_mfma_f32_16x16x32_bf16 v[188:191], a[236:239], v[124:127], v[188:191]
  ds_read_b64_tr_b16 a[230:231], v18 offset:10240
  v_exp_f32 v58, v58
  v_mfma_f32_16x16x32_bf16 v[216:219], a[240:243], v[124:127], v[216:219]
  ds_read_b64_tr_b16 a[232:233], v19 offset:8192
  v_add_f32 v52, v52, v58
  v_mfma_f32_16x16x32_bf16 v[220:223], a[244:247], v[124:127], v[220:223]
  ds_read_b64_tr_b16 a[234:235], v19 offset:10240
  v_exp_f32 v59, v59
  v_mfma_f32_16x16x32_bf16 v[248:251], a[248:251], v[124:127], v[248:251]
  ds_read_b64_tr_b16 a[236:237], v20 offset:8192
  v_add_f32 v52, v52, v59
  v_cvt_pk_bf16_f32 v121, v58, v59
  v_mfma_f32_16x16x32_bf16 v[252:255], a[252:255], v[124:127], v[252:255]
  ds_read_b64_tr_b16 a[238:239], v20 offset:10240
  v_exp_f32 v60, v60
  s_cmp_lg_u32 s50, s42
  s_cbranch_scc1 L1a_nocnt
  s_lshr_b32 s46, s7, 3
  s_lshl_b32 s47, s6, 2
  s_add_u32 s46, s46, s47
  s_lshl_b32 s46, s46, 2
  v_mov_b32 v0, s46
  v_mov_b32 v31, 1
  s_mov_b64 exec, 1
  global_atomic_add v0, v31, s[96:97] sc1
  s_mov_b64 exec, -1
L1a_nocnt:
  v_mfma_f32_16x16x32_bf16 v[88:91], a[192:195], v[64:67], v[80:83]
  ds_read_b64_tr_b16 a[240:241], v21 offset:8192
  v_add_f32 v52, v52, v60
  v_mfma_f32_16x16x32_bf16 v[88:91], a[196:199], v[68:71], v[88:91]
  ds_read_b64_tr_b16 a[242:243], v21 offset:10240
  v_exp_f32 v61, v61
  v_mfma_f32_16x16x32_bf16 v[88:91], a[200:203], v[72:75], v[88:91]
  ds_read_b64_tr_b16 a[244:245], v22 offset:8192
  v_add_f32 v52, v52, v61
  v_cvt_pk_bf16_f32 v122, v60, v61
  v_mfma_f32_16x16x32_bf16 v[88:91], a[204:207], v[76:79], v[88:91]
  ds_read_b64_tr_b16 a[246:247], v22 offset:10240
  v_exp_f32 v62, v62
  v_mfma_f32_16x16x32_bf16 v[92:95], a[208:211], v[64:67], v[80:83]
  ds_read_b64_tr_b16 a[248:249], v23 offset:8192
  v_add_f32 v52, v52, v62
  v_mfma_f32_16x16x32_bf16 v[92:95], a[212:215], v[68:71], v[92:95]
  ds_read_b64_tr_b16 a[250:251], v23 offset:10240
  v_exp_f32 v63, v63
  v_mfma_f32_16x16x32_bf16 v[92:95], a[216:219], v[72:75], v[92:95]
  ds_read_b64_tr_b16 a[252:253], v28 offset:8192
  v_add_f32 v52, v52, v63
  v_cvt_pk_bf16_f32 v123, v62, v63
  v_mfma_f32_16x16x32_bf16 v[92:95], a[220:223], v[76:79], v[92:95]
  s_waitcnt lgkmcnt(8)
  ds_read_b64_tr_b16 a[254:255], v28 offset:10240
  v_exp_f32 v88, v88
  v_mfma_f32_16x16x32_bf16 a[0:3], a[224:227], v[120:123], a[0:3]
  v_add_f32 v84, v84, v88
  v_mfma_f32_16x16x32_bf16 a[4:7], a[228:231], v[120:123], a[4:7]
  v_exp_f32 v89, v89
  v_mfma_f32_16x16x32_bf16 a[8:11], a[232:235], v[120:123], a[8:11]
  s_waitcnt lgkmcnt(8)
  v_add_f32 v84, v84, v89
  v_cvt_pk_bf16_f32 v124, v88, v89
  v_mfma_f32_16x16x32_bf16 a[12:15], a[236:239], v[120:123], a[12:15]
  s_waitcnt lgkmcnt(6)
  v_exp_f32 v90, v90
  v_mfma_f32_16x16x32_bf16 a[16:19], a[240:243], v[120:123], a[16:19]
  s_waitcnt lgkmcnt(4)
  v_add_f32 v84, v84, v90
  v_mfma_f32_16x16x32_bf16 a[20:23], a[244:247], v[120:123], a[20:23]
  s_waitcnt lgkmcnt(2)
  v_exp_f32 v91, v91
  v_mfma_f32_16x16x32_bf16 a[24:27], a[248:251], v[120:123], a[24:27]
  s_waitcnt lgkmcnt(0)
  v_add_f32 v84, v84, v91
  v_cvt_pk_bf16_f32 v125, v90, v91
  v_mfma_f32_16x16x32_bf16 a[28:31], a[252:255], v[120:123], a[28:31]
  s_barrier
  v_exp_f32 v92, v92
  v_mfma_f32_16x16x32_bf16 v[56:59], a[192:195], v[96:99], v[112:115]
  v_add_f32 v84, v84, v92
  v_mfma_f32_16x16x32_bf16 v[56:59], a[196:199], v[100:103], v[56:59]
  v_exp_f32 v93, v93
  v_mfma_f32_16x16x32_bf16 v[56:59], a[200:203], v[104:107], v[56:59]
  v_add_f32 v84, v84, v93
  v_cvt_pk_bf16_f32 v126, v92, v93
  v_mfma_f32_16x16x32_bf16 v[56:59], a[204:207], v[108:111], v[56:59]
  v_exp_f32 v94, v94
  v_mfma_f32_16x16x32_bf16 v[60:63], a[208:211], v[96:99], v[112:115]
  v_add_f32 v84, v84, v94
  v_mfma_f32_16x16x32_bf16 v[60:63], a[212:215], v[100:103], v[60:63]
  v_exp_f32 v95, v95
  v_mfma_f32_16x16x32_bf16 v[60:63], a[216:219], v[104:107], v[60:63]
  v_add_f32 v84, v84, v95
  v_cvt_pk_bf16_f32 v127, v94, v95
  v_mfma_f32_16x16x32_bf16 v[60:63], a[220:223], v[108:111], v[60:63]
  v_exp_f32 v56, v56
  v_mfma_f32_16x16x32_bf16 a[32:35], a[224:227], v[124:127], a[32:35]
  v_add_f32 v116, v116, v56
  v_mfma_f32_16x16x32_bf16 a[36:39], a[228:231], v[124:127], a[36:39]
  v_exp_f32 v57, v57
  v_mfma_f32_16x16x32_bf16 a[40:43], a[232:235], v[124:127], a[40:43]
  v_add_f32 v116, v116, v57
  v_cvt_pk_bf16_f32 v120, v56, v57
  v_mfma_f32_16x16x32_bf16 a[44:47], a[236:239], v[124:127], a[44:47]
  v_exp_f32 v58, v58
  v_mfma_f32_16x16x32_bf16 a[48:51], a[240:243], v[124:127], a[48:51]
  v_add_f32 v116, v116, v58
  v_mfma_f32_16x16x32_bf16 a[52:55], a[244:247], v[124:127], a[52:55]
  v_exp_f32 v59, v59
  v_mfma_f32_16x16x32_bf16 a[56:59], a[248:251], v[124:127], a[56:59]
  v_add_f32 v116, v116, v59
  v_cvt_pk_bf16_f32 v121, v58, v59
  v_mfma_f32_16x16x32_bf16 a[60:63], a[252:255], v[124:127], a[60:63]
  v_exp_f32 v60, v60
  v_mfma_f32_16x16x32_bf16 v[88:91], a[192:195], v[128:131], v[144:147]
  v_add_f32 v116, v116, v60
  v_mfma_f32_16x16x32_bf16 v[88:91], a[196:199], v[132:135], v[88:91]
  v_exp_f32 v61, v61
  v_mfma_f32_16x16x32_bf16 v[88:91], a[200:203], v[136:139], v[88:91]
  v_add_f32 v116, v116, v61
  v_cvt_pk_bf16_f32 v122, v60, v61
  v_mfma_f32_16x16x32_bf16 v[88:91], a[204:207], v[140:143], v[88:91]
  v_exp_f32 v62, v62
  v_mfma_f32_16x16x32_bf16 v[92:95], a[208:211], v[128:131], v[144:147]
  v_add_f32 v116, v116, v62
  v_mfma_f32_16x16x32_bf16 v[92:95], a[212:215], v[132:135], v[92:95]
  v_exp_f32 v63, v63
  v_mfma_f32_16x16x32_bf16 v[92:95], a[216:219], v[136:139], v[92:95]
  v_add_f32 v116, v116, v63
  v_cvt_pk_bf16_f32 v123, v62, v63
  v_mfma_f32_16x16x32_bf16 v[92:95], a[220:223], v[140:143], v[92:95]
  v_exp_f32 v88, v88
  v_mfma_f32_16x16x32_bf16 a[64:67], a[224:227], v[120:123], a[64:67]
  v_add_f32 v148, v148, v88
  v_mfma_f32_16x16x32_bf16 a[68:71], a[228:231], v[120:123], a[68:71]
  v_exp_f32 v89, v89
  v_mfma_f32_16x16x32_bf16 a[72:75], a[232:235], v[120:123], a[72:75]
  v_add_f32 v148, v148, v89
  v_cvt_pk_bf16_f32 v124, v88, v89
  v_mfma_f32_16x16x32_bf16 a[76:79], a[236:239], v[120:123], a[76:79]
  v_exp_f32 v90, v90
  v_mfma_f32_16x16x32_bf16 a[80:83], a[240:243], v[120:123], a[80:83]
  v_add_f32 v148, v148, v90
  v_mfma_f32_16x16x32_bf16 a[84:87], a[244:247], v[120:123], a[84:87]
  v_exp_f32 v91, v91
  v_mfma_f32_16x16x32_bf16 a[88:91], a[248:251], v[120:123], a[88:91]
  v_add_f32 v148, v148, v91
  v_cvt_pk_bf16_f32 v125, v90, v91
  v_mfma_f32_16x16x32_bf16 a[92:95], a[252:255], v[120:123], a[92:95]
  v_exp_f32 v92, v92
  v_mfma_f32_16x16x32_bf16 v[56:59], a[192:195], v[160:163], v[176:179]
  v_add_f32 v148, v148, v92
  v_mfma_f32_16x16x32_bf16 v[56:59], a[196:199], v[164:167], v[56:59]
  v_exp_f32 v93, v93
  v_mfma_f32_16x16x32_bf16 v[56:59], a[200:203], v[168:171], v[56:59]
  v_add_f32 v148, v148, v93
  v_cvt_pk_bf16_f32 v126, v92, v93
  v_mfma_f32_16x16x32_bf16 v[56:59], a[204:207], v[172:175], v[56:59]
  v_exp_f32 v94, v94
  v_mfma_f32_16x16x32_bf16 v[60:63], a[208:211], v[160:163], v[176:179]
  v_add_f32 v148, v148, v94
  v_mfma_f32_16x16x32_bf16 v[60:63], a[212:215], v[164:167], v[60:63]
  v_exp_f32 v95, v95
  v_mfma_f32_16x16x32_bf16 v[60:63], a[216:219], v[168:171], v[60:63]
  v_add_f32 v148, v148, v95
  v_cvt_pk_bf16_f32 v127, v94, v95
  v_mfma_f32_16x16x32_bf16 v[60:63], a[220:223], v[172:175], v[60:63]
  v_exp_f32 v56, v56
  v_mfma_f32_16x16x32_bf16 a[96:99], a[224:227], v[124:127], a[96:99]
  v_add_f32 v180, v180, v56
  v_mfma_f32_16x16x32_bf16 a[100:103], a[228:231], v[124:127], a[100:103]
  v_exp_f32 v57, v57
  v_mfma_f32_16x16x32_bf16 a[104:107], a[232:235], v[124:127], a[104:107]
  v_add_f32 v180, v180, v57
  v_cvt_pk_bf16_f32 v120, v56, v57
  v_mfma_f32_16x16x32_bf16 a[108:111], a[236:239], v[124:127], a[108:111]
  v_exp_f32 v58, v58
  v_mfma_f32_16x16x32_bf16 a[112:115], a[240:243], v[124:127], a[112:115]
  v_add_f32 v180, v180, v58
  v_mfma_f32_16x16x32_bf16 a[116:119], a[244:247], v[124:127], a[116:119]
  v_exp_f32 v59, v59
  v_mfma_f32_16x16x32_bf16 a[120:123], a[248:251], v[124:127], a[120:123]
  v_add_f32 v180, v180, v59
  v_cvt_pk_bf16_f32 v121, v58, v59
  v_mfma_f32_16x16x32_bf16 a[124:127], a[252:255], v[124:127], a[124:127]
  v_exp_f32 v60, v60
  v_mfma_f32_16x16x32_bf16 v[88:91], a[192:195], v[192:195], v[208:211]
  v_add_f32 v180, v180, v60
  v_mfma_f32_16x16x32_bf16 v[88:91], a[196:199], v[196:199], v[88:91]
  v_exp_f32 v61, v61
  v_mfma_f32_16x16x32_bf16 v[88:91], a[200:203], v[200:203], v[88:91]
  v_add_f32 v180, v180, v61
  v_cvt_pk_bf16_f32 v122, v60, v61
  v_mfma_f32_16x16x32_bf16 v[88:91], a[204:207], v[204:207], v[88:91]
  v_exp_f32 v62, v62
  v_mfma_f32_16x16x32_bf16 v[92:95], a[208:211], v[192:195], v[208:211]
  v_add_f32 v180, v180, v62
  v_mfma_f32_16x16x32_bf16 v[92:95], a[212:215], v[196:199], v[92:95]
  v_exp_f32 v63, v63
  v_mfma_f32_16x16x32_bf16 v[92:95], a[216:219], v[200:203], v[92:95]
  v_add_f32 v180, v180, v63
  v_cvt_pk_bf16_f32 v123, v62, v63
  v_mfma_f32_16x16x32_bf16 v[92:95], a[220:223], v[204:207], v[92:95]
  v_exp_f32 v88, v88
  v_mfma_f32_16x16x32_bf16 a[128:131], a[224:227], v[120:123], a[128:131]
  v_add_f32 v212, v212, v88
  v_mfma_f32_16x16x32_bf16 a[132:135], a[228:231], v[120:123], a[132:135]
  v_exp_f32 v89, v89
  v_mfma_f32_16x16x32_bf16 a[136:139], a[232:235], v[120:123], a[136:139]
  v_add_f32 v212, v212, v89
  v_cvt_pk_bf16_f32 v124, v88, v89
  v_mfma_f32_16x16x32_bf16 a[140:143], a[236:239], v[120:123], a[140:143]
  v_exp_f32 v90, v90
  v_mfma_f32_16x16x32_bf16 a[144:147], a[240:243], v[120:123], a[144:147]
  v_add_f32 v212, v212, v90
  v_mfma_f32_16x16x32_bf16 a[148:151], a[244:247], v[120:123], a[148:151]
  v_exp_f32 v91, v91
  v_mfma_f32_16x16x32_bf16 a[152:155], a[248:251], v[120:123], a[152:155]
  v_add_f32 v212, v212, v91
  v_cvt_pk_bf16_f32 v125, v90, v91
  v_mfma_f32_16x16x32_bf16 a[156:159], a[252:255], v[120:123], a[156:159]
  v_exp_f32 v92, v92
  v_mfma_f32_16x16x32_bf16 v[56:59], a[192:195], v[224:227], v[240:243]
  ds_read_b128 a[192:195], v13 offset:24576
  v_add_f32 v212, v212, v92
  v_mfma_f32_16x16x32_bf16 v[56:59], a[196:199], v[228:231], v[56:59]
  v_exp_f32 v93, v93
  v_mfma_f32_16x16x32_bf16 v[56:59], a[200:203], v[232:235], v[56:59]
  ds_read_b128 a[196:199], v14 offset:24576
  v_add_f32 v212, v212, v93
  v_cvt_pk_bf16_f32 v126, v92, v93
  v_mfma_f32_16x16x32_bf16 v[56:59], a[204:207], v[236:239], v[56:59]
  v_exp_f32 v94, v94
  v_mfma_f32_16x16x32_bf16 v[60:63], a[208:211], v[224:227], v[240:243]
  ds_read_b128 a[200:203], v15 offset:24576
  v_add_f32 v212, v212, v94
  v_mfma_f32_16x16x32_bf16 v[60:63], a[212:215], v[228:231], v[60:63]
  v_exp_f32 v95, v95
  v_mfma_f32_16x16x32_bf16 v[60:63], a[216:219], v[232:235], v[60:63]
  ds_read_b128 a[204:207], v16 offset:24576
  v_add_f32 v212, v212, v95
  v_cvt_pk_bf16_f32 v127, v94, v95
  v_mfma_f32_16x16x32_bf16 v[60:63], a[220:223], v[236:239], v[60:63]
  v_exp_f32 v56, v56
  v_mfma_f32_16x16x32_bf16 a[160:163], a[224:227], v[124:127], a[160:163]
  ds_read_b128 a[208:211], v13 offset:26624
  v_add_f32 v244, v244, v56
  v_mfma_f32_16x16x32_bf16 a[164:167], a[228:231], v[124:127], a[164:167]
  v_exp_f32 v57, v57
  v_mfma_f32_16x16x32_bf16 a[168:171], a[232:235], v[124:127], a[168:171]
  ds_read_b128 a[212:215], v14 offset:26624
  v_add_f32 v244, v244, v57
  v_cvt_pk_bf16_f32 v120, v56, v57
  v_mfma_f32_16x16x32_bf16 a[172:175], a[236:239], v[124:127], a[172:175]
  v_exp_f32 v58, v58
  v_mfma_f32_16x16x32_bf16 a[176:179], a[240:243], v[124:127], a[176:179]
  ds_read_b128 a[216:219], v15 offset:26624
  v_add_f32 v244, v244, v58
  v_mfma_f32_16x16x32_bf16 a[180:183], a[244:247], v[124:127], a[180:183]
  v_exp_f32 v59, v59
  v_mfma_f32_16x16x32_bf16 a[184:187], a[248:251], v[124:127], a[184:187]
  ds_read_b128 a[220:223], v16 offset:26624
  v_add_f32 v244, v244, v59
  v_cvt_pk_bf16_f32 v121, v58, v59
  v_mfma_f32_16x16x32_bf16 a[188:191], a[252:255], v[124:127], a[188:191]
  s_waitcnt lgkmcnt(7)
  v_exp_f32 v60, v60
  v_mfma_f32_16x16x32_bf16 v[88:91], a[192:195], v[32:35], v[48:51]
  s_waitcnt lgkmcnt(6)
  v_add_f32 v244, v244, v60
  v_mfma_f32_16x16x32_bf16 v[88:91], a[196:199], v[36:39], v[88:91]
  s_waitcnt lgkmcnt(5)
  v_exp_f32 v61, v61
  v_mfma_f32_16x16x32_bf16 v[88:91], a[200:203], v[40:43], v[88:91]
  s_waitcnt lgkmcnt(4)
  v_add_f32 v244, v244, v61
  v_cvt_pk_bf16_f32 v122, v60, v61
  v_mfma_f32_16x16x32_bf16 v[88:91], a[204:207], v[44:47], v[88:91]
  s_waitcnt lgkmcnt(3)
  v_exp_f32 v62, v62
  v_mfma_f32_16x16x32_bf16 v[92:95], a[208:211], v[32:35], v[48:51]
  s_waitcnt lgkmcnt(2)
  v_add_f32 v244, v244, v62
  v_mfma_f32_16x16x32_bf16 v[92:95], a[212:215], v[36:39], v[92:95]
  s_waitcnt lgkmcnt(1)
  v_exp_f32 v63, v63
  v_mfma_f32_16x16x32_bf16 v[92:95], a[216:219], v[40:43], v[92:95]
  s_waitcnt lgkmcnt(0)
  v_add_f32 v244, v244, v63
  v_cvt_pk_bf16_f32 v123, v62, v63
  v_mfma_f32_16x16x32_bf16 v[92:95], a[220:223], v[44:47], v[92:95]
  v_exp_f32 v88, v88
  v_mfma_f32_16x16x32_bf16 v[152:155], a[224:227], v[120:123], v[152:155]
  ds_read_b64_tr_b16 a[224:225], v17 offset:24576
  v_add_f32 v52, v52, v88
  v_mfma_f32_16x16x32_bf16 v[156:159], a[228:231], v[120:123], v[156:159]
  ds_read_b64_tr_b16 a[226:227], v17 offset:26624
  v_exp_f32 v89, v89
  v_mfma_f32_16x16x32_bf16 v[184:187], a[232:235], v[120:123], v[184:187]
  ds_read_b64_tr_b16 a[228:229], v18 offset:24576
  v_add_f32 v52, v52, v89
  v_cvt_pk_bf16_f32 v124, v88, v89
  v_mfma_f32_16x16x32_bf16 v[188:191], a[236:239], v[120:123], v[188:191]
  ds_read_b64_tr_b16 a[230:231], v18 offset:26624
  v_exp_f32 v90, v90
  v_mfma_f32_16x16x32_bf16 v[216:219], a[240:243], v[120:123], v[216:219]
  ds_read_b64_tr_b16 a[232:233], v19 offset:24576
  v_add_f32 v52, v52, v90
  v_mfma_f32_16x16x32_bf16 v[220:223], a[244:247], v[120:123], v[220:223]
  ds_read_b64_tr_b16 a[234:235], v19 offset:26624
  v_exp_f32 v91, v91
  v_mfma_f32_16x16x32_bf16 v[248:251], a[248:251], v[120:123], v[248:251]
  ds_read_b64_tr_b16 a[236:237], v20 offset:24576
  v_add_f32 v52, v52, v91
  v_cvt_pk_bf16_f32 v125, v90, v91
  v_mfma_f32_16x16x32_bf16 v[252:255], a[252:255], v[120:123], v[252:255]
  ds_read_b64_tr_b16 a[238:239], v20 offset:26624
  v_exp_f32 v92, v92
  v_mfma_f32_16x16x32_bf16 v[56:59], a[192:195], v[64:67], v[80:83]
  ds_read_b64_tr_b16 a[240:241], v21 offset:24576
  v_add_f32 v52, v52, v92
  v_mfma_f32_16x16x32_bf16 v[56:59], a[196:199], v[68:71], v[56:59]
  ds_read_b64_tr_b16 a[242:243], v21 offset:26624
  v_exp_f32 v93, v93
  v_mfma_f32_16x16x32_bf16 v[56:59], a[200:203], v[72:75], v[56:59]
  ds_read_b64_tr_b16 a[244:245], v22 offset:24576
  v_add_f32 v52, v52, v93
  v_cvt_pk_bf16_f32 v126, v92, v93
  v_mfma_f32_16x16x32_bf16 v[56:59], a[204:207], v[76:79], v[56:59]
  ds_read_b64_tr_b16 a[246:247], v22 offset:26624
  v_exp_f32 v94, v94
  v_mfma_f32_16x16x32_bf16 v[60:63], a[208:211], v[64:67], v[80:83]
  ds_read_b64_tr_b16 a[248:249], v23 offset:24576
  v_add_f32 v52, v52, v94
  v_mfma_f32_16x16x32_bf16 v[60:63], a[212:215], v[68:71], v[60:63]
  ds_read_b64_tr_b16 a[250:251], v23 offset:26624
  v_exp_f32 v95, v95
  v_mfma_f32_16x16x32_bf16 v[60:63], a[216:219], v[72:75], v[60:63]
  ds_read_b64_tr_b16 a[252:253], v28 offset:24576
  v_add_f32 v52, v52, v95
  v_cvt_pk_bf16_f32 v127, v94, v95
  v_mfma_f32_16x16x32_bf16 v[60:63], a[220:223], v[76:79], v[60:63]
  s_waitcnt lgkmcnt(8)
  ds_read_b64_tr_b16 a[254:255], v28 offset:26624
  v_exp_f32 v56, v56
  v_mfma_f32_16x16x32_bf16 a[0:3], a[224:227], v[124:127], a[0:3]
  v_add_f32 v84, v84, v56
  v_mfma_f32_16x16x32_bf16 a[4:7], a[228:231], v[124:127], a[4:7]
  v_exp_f32 v57, v57
  v_mfma_f32_16x16x32_bf16 a[8:11], a[232:235], v[124:127], a[8:11]
  s_waitcnt lgkmcnt(8)
  v_add_f32 v84, v84, v57
  v_cvt_pk_bf16_f32 v120, v56, v57
  v_mfma_f32_16x16x32_bf16 a[12:15], a[236:239], v[124:127], a[12:15]
  s_waitcnt lgkmcnt(6)
  v_exp_f32 v58, v58
  v_mfma_f32_16x16x32_bf16 a[16:19], a[240:243], v[124:127], a[16:19]
  s_waitcnt lgkmcnt(4)
  v_add_f32 v84, v84, v58
  v_mfma_f32_16x16x32_bf16 a[20:23], a[244:247], v[124:127], a[20:23]
  s_waitcnt lgkmcnt(2)
  v_exp_f32 v59, v59
  v_mfma_f32_16x16x32_bf16 a[24:27], a[248:251], v[124:127], a[24:27]
  s_waitcnt lgkmcnt(0)
  v_add_f32 v84, v84, v59
  v_cvt_pk_bf16_f32 v121, v58, v59
  v_mfma_f32_16x16x32_bf16 a[28:31], a[252:255], v[124:127], a[28:31]
  s_barrier
  v_exp_f32 v60, v60
  v_mfma_f32_16x16x32_bf16 v[88:91], a[192:195], v[96:99], v[112:115]
  v_add_f32 v84, v84, v60
  v_mfma_f32_16x16x32_bf16 v[88:91], a[196:199], v[100:103], v[88:91]
  v_exp_f32 v61, v61
  v_mfma_f32_16x16x32_bf16 v[88:91], a[200:203], v[104:107], v[88:91]
  v_add_f32 v84, v84, v61
  v_cvt_pk_bf16_f32 v122, v60, v61
  v_mfma_f32_16x16x32_bf16 v[88:91], a[204:207], v[108:111], v[88:91]
  v_exp_f32 v62, v62
  v_mfma_f32_16x16x32_bf16 v[92:95], a[208:211], v[96:99], v[112:115]
  v_add_f32 v84, v84, v62
  v_mfma_f32_16x16x32_bf16 v[92:95], a[212:215], v[100:103], v[92:95]
  v_exp_f32 v63, v63
  v_mfma_f32_16x16x32_bf16 v[92:95], a[216:219], v[104:107], v[92:95]
  v_add_f32 v84, v84, v63
  v_cvt_pk_bf16_f32 v123, v62, v63
  v_mfma_f32_16x16x32_bf16 v[92:95], a[220:223], v[108:111], v[92:95]
  v_exp_f32 v88, v88
  v_mfma_f32_16x16x32_bf16 a[32:35], a[224:227], v[120:123], a[32:35]
  v_add_f32 v116, v116, v88
  v_mfma_f32_16x16x32_bf16 a[36:39], a[228:231], v[120:123], a[36:39]
  v_exp_f32 v89, v89
  v_mfma_f32_16x16x32_bf16 a[40:43], a[232:235], v[120:123], a[40:43]
  v_add_f32 v116, v116, v89
  v_cvt_pk_bf16_f32 v124, v88, v89
  v_mfma_f32_16x16x32_bf16 a[44:47], a[236:239], v[120:123], a[44:47]
  v_exp_f32 v90, v90
  v_mfma_f32_16x16x32_bf16 a[48:51], a[240:243], v[120:123], a[48:51]
  v_add_f32 v116, v116, v90
  v_mfma_f32_16x16x32_bf16 a[52:55], a[244:247], v[120:123], a[52:55]
  v_exp_f32 v91, v91
  v_mfma_f32_16x16x32_bf16 a[56:59], a[248:251], v[120:123], a[56:59]
  v_add_f32 v116, v116, v91
  v_cvt_pk_bf16_f32 v125, v90, v91
  v_mfma_f32_16x16x32_bf16 a[60:63], a[252:255], v[120:123], a[60:63]
  v_exp_f32 v92, v92
  v_mfma_f32_16x16x32_bf16 v[56:59], a[192:195], v[128:131], v[144:147]
  v_add_f32 v116, v116, v92
  v_mfma_f32_16x16x32_bf16 v[56:59], a[196:199], v[132:135], v[56:59]
  v_exp_f32 v93, v93
  v_mfma_f32_16x16x32_bf16 v[56:59], a[200:203], v[136:139], v[56:59]
  v_add_f32 v116, v116, v93
  v_cvt_pk_bf16_f32 v126, v92, v93
  v_mfma_f32_16x16x32_bf16 v[56:59], a[204:207], v[140:143], v[56:59]
  v_exp_f32 v94, v94
  v_mfma_f32_16x16x32_bf16 v[60:63], a[208:211], v[128:131], v[144:147]
  v_add_f32 v116, v116, v94
  v_mfma_f32_16x16x32_bf16 v[60:63], a[212:215], v[132:135], v[60:63]
  v_exp_f32 v95, v95
  v_mfma_f32_16x16x32_bf16 v[60:63], a[216:219], v[136:139], v[60:63]
  v_add_f32 v116, v116, v95
  v_cvt_pk_bf16_f32 v127, v94, v95
  v_mfma_f32_16x16x32_bf16 v[60:63], a[220:223], v[140:143], v[60:63]
  v_exp_f32 v56, v56
  v_mfma_f32_16x16x32_bf16 a[64:67], a[224:227], v[124:127], a[64:67]
  v_add_f32 v148, v148, v56
  v_mfma_f32_16x16x32_bf16 a[68:71], a[228:231], v[124:127], a[68:71]
  v_exp_f32 v57, v57
  v_mfma_f32_16x16x32_bf16 a[72:75], a[232:235], v[124:127], a[72:75]
  v_add_f32 v148, v148, v57
  v_cvt_pk_bf16_f32 v120, v56, v57
  v_mfma_f32_16x16x32_bf16 a[76:79], a[236:239], v[124:127], a[76:79]
  v_exp_f32 v58, v58
  v_mfma_f32_16x16x32_bf16 a[80:83], a[240:243], v[124:127], a[80:83]
  v_add_f32 v148, v148, v58
  v_mfma_f32_16x16x32_bf16 a[84:87], a[244:247], v[124:127], a[84:87]
  v_exp_f32 v59, v59
  v_mfma_f32_16x16x32_bf16 a[88:91], a[248:251], v[124:127], a[88:91]
  v_add_f32 v148, v148, v59
  v_cvt_pk_bf16_f32 v121, v58, v59
  v_mfma_f32_16x16x32_bf16 a[92:95], a[252:255], v[124:127], a[92:95]
  v_exp_f32 v60, v60
  v_mfma_f32_16x16x32_bf16 v[88:91], a[192:195], v[160:163], v[176:179]
  v_add_f32 v148, v148, v60
  v_mfma_f32_16x16x32_bf16 v[88:91], a[196:199], v[164:167], v[88:91]
  v_exp_f32 v61, v61
  v_mfma_f32_16x16x32_bf16 v[88:91], a[200:203], v[168:171], v[88:91]
  v_add_f32 v148, v148, v61
  v_cvt_pk_bf16_f32 v122, v60, v61
  v_mfma_f32_16x16x32_bf16 v[88:91], a[204:207], v[172:175], v[88:91]
  v_exp_f32 v62, v62
  v_mfma_f32_16x16x32_bf16 v[92:95], a[208:211], v[160:163], v[176:179]
  v_add_f32 v148, v148, v62
  v_mfma_f32_16x16x32_bf16 v[92:95], a[212:215], v[164:167], v[92:95]
  v_exp_f32 v63, v63
  v_mfma_f32_16x16x32_bf16 v[92:95], a[216:219], v[168:171], v[92:95]
  v_add_f32 v148, v148, v63
  v_cvt_pk_bf16_f32 v123, v62, v63
  v_mfma_f32_16x16x32_bf16 v[92:95], a[220:223], v[172:175], v[92:95]
  v_exp_f32 v88, v88
  v_mfma_f32_16x16x32_bf16 a[96:99], a[224:227], v[120:123], a[96:99]
  v_add_f32 v180, v180, v88
  v_mfma_f32_16x16x32_bf16 a[100:103], a[228:231], v[120:123], a[100:103]
  v_exp_f32 v89, v89
  v_mfma_f32_16x16x32_bf16 a[104:107], a[232:235], v[120:123], a[104:107]
  v_add_f32 v180, v180, v89
  v_cvt_pk_bf16_f32 v124, v88, v89
  v_mfma_f32_16x16x32_bf16 a[108:111], a[236:239], v[120:123], a[108:111]
  v_exp_f32 v90, v90
  v_mfma_f32_16x16x32_bf16 a[112:115], a[240:243], v[120:123], a[112:115]
  v_add_f32 v180, v180, v90
  v_mfma_f32_16x16x32_bf16 a[116:119], a[244:247], v[120:123], a[116:119]
  v_exp_f32 v91, v91
  v_mfma_f32_16x16x32_bf16 a[120:123], a[248:251], v[120:123], a[120:123]
  v_add_f32 v180, v180, v91
  v_cvt_pk_bf16_f32 v125, v90, v91
  v_mfma_f32_16x16x32_bf16 a[124:127], a[252:255], v[120:123], a[124:127]
  v_exp_f32 v92, v92
  v_mfma_f32_16x16x32_bf16 v[56:59], a[192:195], v[192:195], v[208:211]
  v_add_f32 v180, v180, v92
  v_mfma_f32_16x16x32_bf16 v[56:59], a[196:199], v[196:199], v[56:59]
  v_exp_f32 v93, v93
  v_mfma_f32_16x16x32_bf16 v[56:59], a[200:203], v[200:203], v[56:59]
  v_add_f32 v180, v180, v93
  v_cvt_pk_bf16_f32 v126, v92, v93
  v_mfma_f32_16x16x32_bf16 v[56:59], a[204:207], v[204:207], v[56:59]
  v_exp_f32 v94, v94
  v_mfma_f32_16x16x32_bf16 v[60:63], a[208:211], v[192:195], v[208:211]
  v_add_f32 v180, v180, v94
  v_mfma_f32_16x16x32_bf16 v[60:63], a[212:215], v[196:199], v[60:63]
  v_exp_f32 v95, v95
  v_mfma_f32_16x16x32_bf16 v[60:63], a[216:219], v[200:203], v[60:63]
  v_add_f32 v180, v180, v95
  v_cvt_pk_bf16_f32 v127, v94, v95
  v_mfma_f32_16x16x32_bf16 v[60:63], a[220:223], v[204:207], v[60:63]
  v_exp_f32 v56, v56
  v_mfma_f32_16x16x32_bf16 a[128:131], a[224:227], v[124:127], a[128:131]
  v_add_f32 v212, v212, v56
  v_mfma_f32_16x16x32_bf16 a[132:135], a[228:231], v[124:127], a[132:135]
  v_exp_f32 v57, v57
  v_mfma_f32_16x16x32_bf16 a[136:139], a[232:235], v[124:127], a[136:139]
  v_add_f32 v212, v212, v57
  v_cvt_pk_bf16_f32 v120, v56, v57
  v_mfma_f32_16x16x32_bf16 a[140:143], a[236:239], v[124:127], a[140:143]
  v_exp_f32 v58, v58
  v_mfma_f32_16x16x32_bf16 a[144:147], a[240:243], v[124:127], a[144:147]
  v_add_f32 v212, v212, v58
  v_mfma_f32_16x16x32_bf16 a[148:151], a[244:247], v[124:127], a[148:151]
  v_exp_f32 v59, v59
  v_mfma_f32_16x16x32_bf16 a[152:155], a[248:251], v[124:127], a[152:155]
  v_add_f32 v212, v212, v59
  v_cvt_pk_bf16_f32 v121, v58, v59
  v_mfma_f32_16x16x32_bf16 a[156:159], a[252:255], v[124:127], a[156:159]
  v_exp_f32 v60, v60
  v_mfma_f32_16x16x32_bf16 v[88:91], a[192:195], v[224:227], v[240:243]
  ds_read_b128 a[192:195], v13 offset:16384
  v_add_f32 v212, v212, v60
  v_mfma_f32_16x16x32_bf16 v[88:91], a[196:199], v[228:231], v[88:91]
  v_exp_f32 v61, v61
  v_mfma_f32_16x16x32_bf16 v[88:91], a[200:203], v[232:235], v[88:91]
  ds_read_b128 a[196:199], v14 offset:16384
  v_add_f32 v212, v212, v61
  v_cvt_pk_bf16_f32 v122, v60, v61
  v_mfma_f32_16x16x32_bf16 v[88:91], a[204:207], v[236:239], v[88:91]
  v_exp_f32 v62, v62
  v_mfma_f32_16x16x32_bf16 v[92:95], a[208:211], v[224:227], v[240:243]
  ds_read_b128 a[200:203], v15 offset:16384
  v_add_f32 v212, v212, v62
  v_mfma_f32_16x16x32_bf16 v[92:95], a[212:215], v[228:231], v[92:95]
  v_exp_f32 v63, v63
  v_mfma_f32_16x16x32_bf16 v[92:95], a[216:219], v[232:235], v[92:95]
  ds_read_b128 a[204:207], v16 offset:16384
  v_add_f32 v212, v212, v63
  v_cvt_pk_bf16_f32 v123, v62, v63
  v_mfma_f32_16x16x32_bf16 v[92:95], a[220:223], v[236:239], v[92:95]
  v_exp_f32 v88, v88
  v_mfma_f32_16x16x32_bf16 a[160:163], a[224:227], v[120:123], a[160:163]
  ds_read_b128 a[208:211], v13 offset:18432
  v_add_f32 v244, v244, v88
  v_mfma_f32_16x16x32_bf16 a[164:167], a[228:231], v[120:123], a[164:167]
  v_exp_f32 v89, v89
  v_mfma_f32_16x16x32_bf16 a[168:171], a[232:235], v[120:123], a[168:171]
  ds_read_b128 a[212:215], v14 offset:18432
  v_add_f32 v244, v244, v89
  v_cvt_pk_bf16_f32 v124, v88, v89
  v_mfma_f32_16x16x32_bf16 a[172:175], a[236:239], v[120:123], a[172:175]
  v_exp_f32 v90, v90
  v_mfma_f32_16x16x32_bf16 a[176:179], a[240:243], v[120:123], a[176:179]
  ds_read_b128 a[216:219], v15 offset:18432
  v_add_f32 v244, v244, v90
  v_mfma_f32_16x16x32_bf16 a[180:183], a[244:247], v[120:123], a[180:183]
  v_exp_f32 v91, v91
  v_mfma_f32_16x16x32_bf16 a[184:187], a[248:251], v[120:123], a[184:187]
  ds_read_b128 a[220:223], v16 offset:18432
  v_add_f32 v244, v244, v91
  v_cvt_pk_bf16_f32 v125, v90, v91
  v_mfma_f32_16x16x32_bf16 a[188:191], a[252:255], v[120:123], a[188:191]
  s_cmp_eq_u32 s50, 7
  v_exp_f32 v92, v92
  s_cbranch_scc1 L1a_tail
  s_waitcnt lgkmcnt(7)
  v_mfma_f32_16x16x32_bf16 v[56:59], a[192:195], v[32:35], v[48:51]
  s_waitcnt lgkmcnt(6)
  v_add_f32 v244, v244, v92
  v_mfma_f32_16x16x32_bf16 v[56:59], a[196:199], v[36:39], v[56:59]
  s_waitcnt lgkmcnt(5)
  v_exp_f32 v93, v93
  v_mfma_f32_16x16x32_bf16 v[56:59], a[200:203], v[40:43], v[56:59]
  s_waitcnt lgkmcnt(4)
  v_add_f32 v244, v244, v93
  v_cvt_pk_bf16_f32 v126, v92, v93
  v_mfma_f32_16x16x32_bf16 v[56:59], a[204:207], v[44:47], v[56:59]
  s_waitcnt lgkmcnt(3)
  v_exp_f32 v94, v94
  v_mfma_f32_16x16x32_bf16 v[60:63], a[208:211], v[32:35], v[48:51]
  s_waitcnt lgkmcnt(2)
  v_add_f32 v244, v244, v94
  v_mfma_f32_16x16x32_bf16 v[60:63], a[212:215], v[36:39], v[60:63]
  s_waitcnt lgkmcnt(1)
  v_exp_f32 v95, v95
  v_mfma_f32_16x16x32_bf16 v[60:63], a[216:219], v[40:43], v[60:63]
  s_waitcnt lgkmcnt(0)
  v_add_f32 v244, v244, v95
  v_cvt_pk_bf16_f32 v127, v94, v95
  v_mfma_f32_16x16x32_bf16 v[60:63], a[220:223], v[44:47], v[60:63]
  v_exp_f32 v56, v56
  v_mfma_f32_16x16x32_bf16 v[152:155], a[224:227], v[124:127], v[152:155]
  ds_read_b64_tr_b16 a[224:225], v17 offset:16384
  v_add_f32 v52, v52, v56
  v_mfma_f32_16x16x32_bf16 v[156:159], a[228:231], v[124:127], v[156:159]
  ds_read_b64_tr_b16 a[226:227], v17 offset:18432
  v_exp_f32 v57, v57
  v_mfma_f32_16x16x32_bf16 v[184:187], a[232:235], v[124:127], v[184:187]
  ds_read_b64_tr_b16 a[228:229], v18 offset:16384
  v_add_f32 v52, v52, v57
  v_cvt_pk_bf16_f32 v120, v56, v57
  v_mfma_f32_16x16x32_bf16 v[188:191], a[236:239], v[124:127], v[188:191]
  ds_read_b64_tr_b16 a[230:231], v18 offset:18432
  v_exp_f32 v58, v58
  v_mfma_f32_16x16x32_bf16 v[216:219], a[240:243], v[124:127], v[216:219]
  ds_read_b64_tr_b16 a[232:233], v19 offset:16384
  v_add_f32 v52, v52, v58
  v_mfma_f32_16x16x32_bf16 v[220:223], a[244:247], v[124:127], v[220:223]
  ds_read_b64_tr_b16 a[234:235], v19 offset:18432
  v_exp_f32 v59, v59
  v_mfma_f32_16x16x32_bf16 v[248:251], a[248:251], v[124:127], v[248:251]
  ds_read_b64_tr_b16 a[236:237], v20 offset:16384
  v_add_f32 v52, v52, v59
  v_cvt_pk_bf16_f32 v121, v58, v59
  v_mfma_f32_16x16x32_bf16 v[252:255], a[252:255], v[124:127], v[252:255]
  ds_read_b64_tr_b16 a[238:239], v20 offset:18432
  v_exp_f32 v60, v60
  v_mfma_f32_16x16x32_bf16 v[88:91], a[192:195], v[64:67], v[80:83]
  ds_read_b64_tr_b16 a[240:241], v21 offset:16384
  v_add_f32 v52, v52, v60
  v_mfma_f32_16x16x32_bf16 v[88:91], a[196:199], v[68:71], v[88:91]
  ds_read_b64_tr_b16 a[242:243], v21 offset:18432
  v_exp_f32 v61, v61
  v_mfma_f32_16x16x32_bf16 v[88:91], a[200:203], v[72:75], v[88:91]
  ds_read_b64_tr_b16 a[244:245], v22 offset:16384
  v_add_f32 v52, v52, v61
  v_cvt_pk_bf16_f32 v122, v60, v61
  v_mfma_f32_16x16x32_bf16 v[88:91], a[204:207], v[76:79], v[88:91]
  ds_read_b64_tr_b16 a[246:247], v22 offset:18432
  v_exp_f32 v62, v62
  v_mfma_f32_16x16x32_bf16 v[92:95], a[208:211], v[64:67], v[80:83]
  ds_read_b64_tr_b16 a[248:249], v23 offset:16384
  v_add_f32 v52, v52, v62
  v_mfma_f32_16x16x32_bf16 v[92:95], a[212:215], v[68:71], v[92:95]
  ds_read_b64_tr_b16 a[250:251], v23 offset:18432
  v_exp_f32 v63, v63
  v_mfma_f32_16x16x32_bf16 v[92:95], a[216:219], v[72:75], v[92:95]
  ds_read_b64_tr_b16 a[252:253], v28 offset:16384
  v_add_f32 v52, v52, v63
  v_cvt_pk_bf16_f32 v123, v62, v63
  v_mfma_f32_16x16x32_bf16 v[92:95], a[220:223], v[76:79], v[92:95]
  s_waitcnt lgkmcnt(8)
  ds_read_b64_tr_b16 a[254:255], v28 offset:18432
  v_exp_f32 v88, v88
  v_mfma_f32_16x16x32_bf16 a[0:3], a[224:227], v[120:123], a[0:3]
  v_add_f32 v84, v84, v88
  v_mfma_f32_16x16x32_bf16 a[4:7], a[228:231], v[120:123], a[4:7]
  v_exp_f32 v89, v89
  v_mfma_f32_16x16x32_bf16 a[8:11], a[232:235], v[120:123], a[8:11]
  s_waitcnt lgkmcnt(8)
  v_add_f32 v84, v84, v89
  v_cvt_pk_bf16_f32 v124, v88, v89
  v_mfma_f32_16x16x32_bf16 a[12:15], a[236:239], v[120:123], a[12:15]
  s_waitcnt lgkmcnt(6)
  v_exp_f32 v90, v90
  v_mfma_f32_16x16x32_bf16 a[16:19], a[240:243], v[120:123], a[16:19]
  s_waitcnt lgkmcnt(4)
  v_add_f32 v84, v84, v90
  v_mfma_f32_16x16x32_bf16 a[20:23], a[244:247], v[120:123], a[20:23]
  s_waitcnt lgkmcnt(2)
  v_exp_f32 v91, v91
  v_mfma_f32_16x16x32_bf16 a[24:27], a[248:251], v[120:123], a[24:27]
  s_waitcnt lgkmcnt(0)
  v_add_f32 v84, v84, v91
  v_cvt_pk_bf16_f32 v125, v90, v91
  v_mfma_f32_16x16x32_bf16 a[28:31], a[252:255], v[120:123], a[28:31]
  s_barrier
  v_exp_f32 v92, v92
  v_mfma_f32_16x16x32_bf16 v[56:59], a[192:195], v[96:99], v[112:115]
  v_add_f32 v84, v84, v92
  v_mfma_f32_16x16x32_bf16 v[56:59], a[196:199], v[100:103], v[56:59]
  v_exp_f32 v93, v93
  v_mfma_f32_16x16x32_bf16 v[56:59], a[200:203], v[104:107], v[56:59]
  v_add_f32 v84, v84, v93
  v_cvt_pk_bf16_f32 v126, v92, v93
  v_mfma_f32_16x16x32_bf16 v[56:59], a[204:207], v[108:111], v[56:59]
  v_exp_f32 v94, v94
  v_mfma_f32_16x16x32_bf16 v[60:63], a[208:211], v[96:99], v[112:115]
  v_add_f32 v84, v84, v94
  v_mfma_f32_16x16x32_bf16 v[60:63], a[212:215], v[100:103], v[60:63]
  v_exp_f32 v95, v95
  v_mfma_f32_16x16x32_bf16 v[60:63], a[216:219], v[104:107], v[60:63]
  v_add_f32 v84, v84, v95
  v_cvt_pk_bf16_f32 v127, v94, v95
  v_mfma_f32_16x16x32_bf16 v[60:63], a[220:223], v[108:111], v[60:63]
  v_exp_f32 v56, v56
  v_mfma_f32_16x16x32_bf16 a[32:35], a[224:227], v[124:127], a[32:35]
  v_add_f32 v116, v116, v56
  v_mfma_f32_16x16x32_bf16 a[36:39], a[228:231], v[124:127], a[36:39]
  v_exp_f32 v57, v57
  v_mfma_f32_16x16x32_bf16 a[40:43], a[232:235], v[124:127], a[40:43]
  v_add_f32 v116, v116, v57
  v_cvt_pk_bf16_f32 v120, v56, v57
  v_mfma_f32_16x16x32_bf16 a[44:47], a[236:239], v[124:127], a[44:47]
  v_exp_f32 v58, v58
  v_mfma_f32_16x16x32_bf16 a[48:51], a[240:243], v[124:127], a[48:51]
  v_add_f32 v116, v116, v58
  v_mfma_f32_16x16x32_bf16 a[52:55], a[244:247], v[124:127], a[52:55]
  v_exp_f32 v59, v59
  v_mfma_f32_16x16x32_bf16 a[56:59], a[248:251], v[124:127], a[56:59]
  v_add_f32 v116, v116, v59
  v_cvt_pk_bf16_f32 v121, v58, v59
  v_mfma_f32_16x16x32_bf16 a[60:63], a[252:255], v[124:127], a[60:63]
  v_exp_f32 v60, v60
  v_mfma_f32_16x16x32_bf16 v[88:91], a[192:195], v[128:131], v[144:147]
  v_add_f32 v116, v116, v60
  v_mfma_f32_16x16x32_bf16 v[88:91], a[196:199], v[132:135], v[88:91]
  v_exp_f32 v61, v61
  v_mfma_f32_16x16x32_bf16 v[88:91], a[200:203], v[136:139], v[88:91]
  v_add_f32 v116, v116, v61
  v_cvt_pk_bf16_f32 v122, v60, v61
  v_mfma_f32_16x16x32_bf16 v[88:91], a[204:207], v[140:143], v[88:91]
  v_exp_f32 v62, v62
  v_mfma_f32_16x16x32_bf16 v[92:95], a[208:211], v[128:131], v[144:147]
  v_add_f32 v116, v116, v62
  v_mfma_f32_16x16x32_bf16 v[92:95], a[212:215], v[132:135], v[92:95]
  v_exp_f32 v63, v63
  v_mfma_f32_16x16x32_bf16 v[92:95], a[216:219], v[136:139], v[92:95]
  v_add_f32 v116, v116, v63
  v_cvt_pk_bf16_f32 v123, v62, v63
  v_mfma_f32_16x16x32_bf16 v[92:95], a[220:223], v[140:143], v[92:95]
  v_exp_f32 v88, v88
  v_mfma_f32_16x16x32_bf16 a[64:67], a[224:227], v[120:123], a[64:67]
  v_add_f32 v148, v148, v88
  v_mfma_f32_16x16x32_bf16 a[68:71], a[228:231], v[120:123], a[68:71]
  v_exp_f32 v89, v89
  v_mfma_f32_16x16x32_bf16 a[72:75], a[232:235], v[120:123], a[72:75]
  v_add_f32 v148, v148, v89
  v_cvt_pk_bf16_f32 v124, v88, v89
  v_mfma_f32_16x16x32_bf16 a[76:79], a[236:239], v[120:123], a[76:79]
  v_exp_f32 v90, v90
  v_mfma_f32_16x16x32_bf16 a[80:83], a[240:243], v[120:123], a[80:83]
  v_add_f32 v148, v148, v90
  v_mfma_f32_16x16x32_bf16 a[84:87], a[244:247], v[120:123], a[84:87]
  v_exp_f32 v91, v91
  v_mfma_f32_16x16x32_bf16 a[88:91], a[248:251], v[120:123], a[88:91]
  v_add_f32 v148, v148, v91
  v_cvt_pk_bf16_f32 v125, v90, v91
  v_mfma_f32_16x16x32_bf16 a[92:95], a[252:255], v[120:123], a[92:95]
  v_exp_f32 v92, v92
  v_mfma_f32_16x16x32_bf16 v[56:59], a[192:195], v[160:163], v[176:179]
  v_add_f32 v148, v148, v92
  v_mfma_f32_16x16x32_bf16 v[56:59], a[196:199], v[164:167], v[56:59]
  v_exp_f32 v93, v93
  v_mfma_f32_16x16x32_bf16 v[56:59], a[200:203], v[168:171], v[56:59]
  v_add_f32 v148, v148, v93
  v_cvt_pk_bf16_f32 v126, v92, v93
  v_mfma_f32_16x16x32_bf16 v[56:59], a[204:207], v[172:175], v[56:59]
  v_exp_f32 v94, v94
  v_mfma_f32_16x16x32_bf16 v[60:63], a[208:211], v[160:163], v[176:179]
  v_add_f32 v148, v148, v94
  v_mfma_f32_16x16x32_bf16 v[60:63], a[212:215], v[164:167], v[60:63]
  v_exp_f32 v95, v95
  v_mfma_f32_16x16x32_bf16 v[60:63], a[216:219], v[168:171], v[60:63]
  v_add_f32 v148, v148, v95
  v_cvt_pk_bf16_f32 v127, v94, v95
  v_mfma_f32_16x16x32_bf16 v[60:63], a[220:223], v[172:175], v[60:63]
  v_exp_f32 v56, v56
  v_mfma_f32_16x16x32_bf16 a[96:99], a[224:227], v[124:127], a[96:99]
  v_add_f32 v180, v180, v56
  v_mfma_f32_16x16x32_bf16 a[100:103], a[228:231], v[124:127], a[100:103]
  v_exp_f32 v57, v57
  v_mfma_f32_16x16x32_bf16 a[104:107], a[232:235], v[124:127], a[104:107]
  v_add_f32 v180, v180, v57
  v_cvt_pk_bf16_f32 v120, v56, v57
  v_mfma_f32_16x16x32_bf16 a[108:111], a[236:239], v[124:127], a[108:111]
  v_exp_f32 v58, v58
  v_mfma_f32_16x16x32_bf16 a[112:115], a[240:243], v[124:127], a[112:115]
  v_add_f32 v180, v180, v58
  v_mfma_f32_16x16x32_bf16 a[116:119], a[244:247], v[124:127], a[116:119]
  v_exp_f32 v59, v59
  v_mfma_f32_16x16x32_bf16 a[120:123], a[248:251], v[124:127], a[120:123]
  v_add_f32 v180, v180, v59
  v_cvt_pk_bf16_f32 v121, v58, v59
  v_mfma_f32_16x16x32_bf16 a[124:127], a[252:255], v[124:127], a[124:127]
  v_exp_f32 v60, v60
  v_mfma_f32_16x16x32_bf16 v[88:91], a[192:195], v[192:195], v[208:211]
  v_add_f32 v180, v180, v60
  v_mfma_f32_16x16x32_bf16 v[88:91], a[196:199], v[196:199], v[88:91]
  v_exp_f32 v61, v61
  v_mfma_f32_16x16x32_bf16 v[88:91], a[200:203], v[200:203], v[88:91]
  v_add_f32 v180, v180, v61
  v_cvt_pk_bf16_f32 v122, v60, v61
  v_mfma_f32_16x16x32_bf16 v[88:91], a[204:207], v[204:207], v[88:91]
  v_exp_f32 v62, v62
  v_mfma_f32_16x16x32_bf16 v[92:95], a[208:211], v[192:195], v[208:211]
  v_add_f32 v180, v180, v62
  v_mfma_f32_16x16x32_bf16 v[92:95], a[212:215], v[196:199], v[92:95]
  v_exp_f32 v63, v63
  v_mfma_f32_16x16x32_bf16 v[92:95], a[216:219], v[200:203], v[92:95]
  v_add_f32 v180, v180, v63
  v_cvt_pk_bf16_f32 v123, v62, v63
  v_mfma_f32_16x16x32_bf16 v[92:95], a[220:223], v[204:207], v[92:95]
  v_exp_f32 v88, v88
  v_mfma_f32_16x16x32_bf16 a[128:131], a[224:227], v[120:123], a[128:131]
  v_add_f32 v212, v212, v88
  v_mfma_f32_16x16x32_bf16 a[132:135], a[228:231], v[120:123], a[132:135]
  v_exp_f32 v89, v89
  v_mfma_f32_16x16x32_bf16 a[136:139], a[232:235], v[120:123], a[136:139]
  v_add_f32 v212, v212, v89
  v_cvt_pk_bf16_f32 v124, v88, v89
  v_mfma_f32_16x16x32_bf16 a[140:143], a[236:239], v[120:123], a[140:143]
  v_exp_f32 v90, v90
  v_mfma_f32_16x16x32_bf16 a[144:147], a[240:243], v[120:123], a[144:147]
  v_add_f32 v212, v212, v90
  v_mfma_f32_16x16x32_bf16 a[148:151], a[244:247], v[120:123], a[148:151]
  v_exp_f32 v91, v91
  v_mfma_f32_16x16x32_bf16 a[152:155], a[248:251], v[120:123], a[152:155]
  v_add_f32 v212, v212, v91
  v_cvt_pk_bf16_f32 v125, v90, v91
  v_mfma_f32_16x16x32_bf16 a[156:159], a[252:255], v[120:123], a[156:159]
  v_exp_f32 v92, v92
  v_mfma_f32_16x16x32_bf16 v[56:59], a[192:195], v[224:227], v[240:243]
  ds_read_b128 a[192:195], v13 offset:0
  v_add_f32 v212, v212, v92
  v_mfma_f32_16x16x32_bf16 v[56:59], a[196:199], v[228:231], v[56:59]
  v_exp_f32 v93, v93
  v_mfma_f32_16x16x32_bf16 v[56:59], a[200:203], v[232:235], v[56:59]
  ds_read_b128 a[196:199], v14 offset:0
  v_add_f32 v212, v212, v93
  v_cvt_pk_bf16_f32 v126, v92, v93
  v_mfma_f32_16x16x32_bf16 v[56:59], a[204:207], v[236:239], v[56:59]
  v_exp_f32 v94, v94
  v_mfma_f32_16x16x32_bf16 v[60:63], a[208:211], v[224:227], v[240:243]
  ds_read_b128 a[200:203], v15 offset:0
  v_add_f32 v212, v212, v94
  v_mfma_f32_16x16x32_bf16 v[60:63], a[212:215], v[228:231], v[60:63]
  v_exp_f32 v95, v95
  v_mfma_f32_16x16x32_bf16 v[60:63], a[216:219], v[232:235], v[60:63]
  ds_read_b128 a[204:207], v16 offset:0
  v_add_f32 v212, v212, v95
  v_cvt_pk_bf16_f32 v127, v94, v95
  v_mfma_f32_16x16x32_bf16 v[60:63], a[220:223], v[236:239], v[60:63]
  v_exp_f32 v56, v56
  v_mfma_f32_16x16x32_bf16 a[160:163], a[224:227], v[124:127], a[160:163]
  ds_read_b128 a[208:211], v13 offset:2048
  v_add_f32 v244, v244, v56
  v_mfma_f32_16x16x32_bf16 a[164:167], a[228:231], v[124:127], a[164:167]
  v_exp_f32 v57, v57
  v_mfma_f32_16x16x32_bf16 a[168:171], a[232:235], v[124:127], a[168:171]
  ds_read_b128 a[212:215], v14 offset:2048
  v_add_f32 v244, v244, v57
  v_cvt_pk_bf16_f32 v120, v56, v57
  v_mfma_f32_16x16x32_bf16 a[172:175], a[236:239], v[124:127], a[172:175]
  v_exp_f32 v58, v58
  v_mfma_f32_16x16x32_bf16 a[176:179], a[240:243], v[124:127], a[176:179]
  ds_read_b128 a[216:219], v15 offset:2048
  v_add_f32 v244, v244, v58
  v_mfma_f32_16x16x32_bf16 a[180:183], a[244:247], v[124:127], a[180:183]
  v_exp_f32 v59, v59
  v_mfma_f32_16x16x32_bf16 a[184:187], a[248:251], v[124:127], a[184:187]
  ds_read_b128 a[220:223], v16 offset:2048
  v_add_f32 v244, v244, v59
  v_cvt_pk_bf16_f32 v121, v58, v59
  v_mfma_f32_16x16x32_bf16 a[188:191], a[252:255], v[124:127], a[188:191]
  s_waitcnt lgkmcnt(7)
  v_exp_f32 v60, v60
  v_mfma_f32_16x16x32_bf16 v[88:91], a[192:195], v[32:35], v[48:51]
  s_waitcnt lgkmcnt(6)
  v_add_f32 v244, v244, v60
  v_mfma_f32_16x16x32_bf16 v[88:91], a[196:199], v[36:39], v[88:91]
  s_waitcnt lgkmcnt(5)
  v_exp_f32 v61, v61
  v_mfma_f32_16x16x32_bf16 v[88:91], a[200:203], v[40:43], v[88:91]
  s_waitcnt lgkmcnt(4)
  v_add_f32 v244, v244, v61
  v_cvt_pk_bf16_f32 v122, v60, v61
  v_mfma_f32_16x16x32_bf16 v[88:91], a[204:207], v[44:47], v[88:91]
  s_waitcnt lgkmcnt(3)
  v_exp_f32 v62, v62
  v_mfma_f32_16x16x32_bf16 v[92:95], a[208:211], v[32:35], v[48:51]
  s_waitcnt lgkmcnt(2)
  v_add_f32 v244, v244, v62
  v_mfma_f32_16x16x32_bf16 v[92:95], a[212:215], v[36:39], v[92:95]
  s_waitcnt lgkmcnt(1)
  v_exp_f32 v63, v63
  v_mfma_f32_16x16x32_bf16 v[92:95], a[216:219], v[40:43], v[92:95]
  s_waitcnt lgkmcnt(0)
  v_add_f32 v244, v244, v63
  v_cvt_pk_bf16_f32 v123, v62, v63
  v_mfma_f32_16x16x32_bf16 v[92:95], a[220:223], v[44:47], v[92:95]
  v_exp_f32 v88, v88
  v_mfma_f32_16x16x32_bf16 v[152:155], a[224:227], v[120:123], v[152:155]
  ds_read_b64_tr_b16 a[224:225], v17 offset:0
  v_add_f32 v52, v52, v88
  v_mfma_f32_16x16x32_bf16 v[156:159], a[228:231], v[120:123], v[156:159]
  ds_read_b64_tr_b16 a[226:227], v17 offset:2048
  v_exp_f32 v89, v89
  v_mfma_f32_16x16x32_bf16 v[184:187], a[232:235], v[120:123], v[184:187]
  ds_read_b64_tr_b16 a[228:229], v18 offset:0
  v_add_f32 v52, v52, v89
  v_cvt_pk_bf16_f32 v124, v88, v89
  v_mfma_f32_16x16x32_bf16 v[188:191], a[236:239], v[120:123], v[188:191]
  ds_read_b64_tr_b16 a[230:231], v18 offset:2048
  v_exp_f32 v90, v90
  v_mfma_f32_16x16x32_bf16 v[216:219], a[240:243], v[120:123], v[216:219]
  ds_read_b64_tr_b16 a[232:233], v19 offset:0
  v_add_f32 v52, v52, v90
  v_mfma_f32_16x16x32_bf16 v[220:223], a[244:247], v[120:123], v[220:223]
  ds_read_b64_tr_b16 a[234:235], v19 offset:2048
  v_exp_f32 v91, v91
  v_mfma_f32_16x16x32_bf16 v[248:251], a[248:251], v[120:123], v[248:251]
  ds_read_b64_tr_b16 a[236:237], v20 offset:0
  v_add_f32 v52, v52, v91
  v_cvt_pk_bf16_f32 v125, v90, v91
  v_mfma_f32_16x16x32_bf16 v[252:255], a[252:255], v[120:123], v[252:255]
  ds_read_b64_tr_b16 a[238:239], v20 offset:2048
  v_exp_f32 v92, v92
  s_add_u32 s50, s50, 1
  s_branch L1a_aloop
L1a_tail:
  v_exp_f32 v93, v93
  v_exp_f32 v94, v94
  v_exp_f32 v95, v95
  s_nop 0
  v_add_f32 v244, v244, v92
  v_add_f32 v244, v244, v93
  v_cvt_pk_bf16_f32 v126, v92, v93
  v_add_f32 v244, v244, v94
  v_add_f32 v244, v244, v95
  v_cvt_pk_bf16_f32 v127, v94, v95
  s_nop 1
  v_mfma_f32_16x16x32_bf16 v[152:155], a[224:227], v[124:127], v[152:155]
  v_mfma_f32_16x16x32_bf16 v[156:159], a[228:231], v[124:127], v[156:159]
  v_mfma_f32_16x16x32_bf16 v[184:187], a[232:235], v[124:127], v[184:187]
  v_mfma_f32_16x16x32_bf16 v[188:191], a[236:239], v[124:127], v[188:191]
  v_mfma_f32_16x16x32_bf16 v[216:219], a[240:243], v[124:127], v[216:219]
  v_mfma_f32_16x16x32_bf16 v[220:223], a[244:247], v[124:127], v[220:223]
  v_mfma_f32_16x16x32_bf16 v[248:251], a[248:251], v[124:127], v[248:251]
  v_mfma_f32_16x16x32_bf16 v[252:255], a[252:255], v[124:127], v[252:255]
  v_lshlrev_b32 v5, 2, v1
  global_load_dword v29, v5, s[96:97] sc1
  s_waitcnt vmcnt(0)
  s_barrier
  s_mov_b32 s49, 524288
L1a_val_c:
  v_cmp_gt_u32 vcc, 4, v29
  s_sub_u32 s49, s49, 1
  s_cbranch_scc1 L1a_val_go
  s_nop 3
  s_cbranch_vccz L1a_val_go
  s_sleep 8
  global_load_dword v29, v5, s[96:97] sc1
  s_waitcnt vmcnt(0)
  s_branch L1a_val_c
L1a_val_go:
L1a_epi:
  v_mov_b32 v53, v52
  v_mov_b32 v85, v84
  v_mov_b32 v117, v116
  v_mov_b32 v149, v148
  v_mov_b32 v181, v180
  v_mov_b32 v213, v212
  v_mov_b32 v245, v244
  s_nop 1
  v_permlane16_swap_b32 v52, v53
  v_permlane16_swap_b32 v84, v85
  v_permlane16_swap_b32 v116, v117
  v_permlane16_swap_b32 v148, v149
  v_permlane16_swap_b32 v180, v181
  v_permlane16_swap_b32 v212, v213
  v_permlane16_swap_b32 v244, v245
  s_nop 0
  v_add_f32 v52, v52, v53
  v_add_f32 v84, v84, v85
  v_add_f32 v116, v116, v117
  v_add_f32 v148, v148, v149
  v_add_f32 v180, v180, v181
  v_add_f32 v212, v212, v213
  v_add_f32 v244, v244, v245
  v_mov_b32 v53, v52
  v_mov_b32 v85, v84
  v_mov_b32 v117, v116
  v_mov_b32 v149, v148
  v_mov_b32 v181, v180
  v_mov_b32 v213, v212
  v_mov_b32 v245, v244
  s_nop 1
  v_permlane32_swap_b32 v52, v53
  v_permlane32_swap_b32 v84, v85
  v_permlane32_swap_b32 v116, v117
  v_permlane32_swap_b32 v148, v149
  v_permlane32_swap_b32 v180, v181
  v_permlane32_swap_b32 v212, v213
  v_permlane32_swap_b32 v244, v245
  s_nop 0
  v_add_f32 v52, v52, v53
  v_add_f32 v84, v84, v85
  v_add_f32 v116, v116, v117
  v_add_f32 v148, v148, v149
  v_add_f32 v180, v180, v181
  v_add_f32 v212, v212, v213
  v_add_f32 v244, v244, v245
  v_mov_b32 v2, 0
  v_mov_b32 v3, 0
  v_maximum3_f32 v3, v52, v84, v3
  v_maximum3_f32 v3, v116, v148, v3
  v_maximum3_f32 v3, v180, v212, v3
  v_maximum3_f32 v3, v244, v244, v3
  v_rcp_f32 v54, v52
  v_rcp_f32 v86, v84
  v_rcp_f32 v118, v116
  v_rcp_f32 v150, v148
  v_rcp_f32 v182, v180
  v_rcp_f32 v214, v212
  v_rcp_f32 v246, v244
  s_mov_b32 s47, 0x4d800000
  v_mul_f32 v2, s47, v3
  s_cmp_lg_u32 s37, 0
  s_cbranch_scc1 L1a_epi2
  v_accvgpr_read_b32 v56, a0
  v_accvgpr_read_b32 v57, a1
  v_accvgpr_read_b32 v58, a2
  v_accvgpr_read_b32 v59, a3
  v_accvgpr_read_b32 v60, a4
  v_accvgpr_read_b32 v61, a5
  v_accvgpr_read_b32 v62, a6
  v_accvgpr_read_b32 v63, a7
  v_maximum3_f32 v2, |v56|, |v57|, v2
  v_maximum3_f32 v2, |v58|, |v59|, v2
  v_maximum3_f32 v2, |v60|, |v61|, v2
  v_maximum3_f32 v2, |v62|, |v63|, v2
  v_pk_mul_f32 v[56:57], v[56:57], v[54:55] op_sel_hi:[1,0]
  v_pk_mul_f32 v[58:59], v[58:59], v[54:55] op_sel_hi:[1,0]
  v_pk_mul_f32 v[60:61], v[60:61], v[54:55] op_sel_hi:[1,0]
  v_pk_mul_f32 v[62:63], v[62:63], v[54:55] op_sel_hi:[1,0]
  v_cvt_pk_bf16_f32 v120, v56, v57
  v_cvt_pk_bf16_f32 v121, v58, v59
  v_cvt_pk_bf16_f32 v122, v60, v61
  v_cvt_pk_bf16_f32 v123, v62, v63
  s_add_u32 s46, s54, 0
  buffer_store_dwordx4 v[120:123], v30, s[24:27], s46 offen offset:0 sc1
  v_accvgpr_read_b32 v88, a32
  v_accvgpr_read_b32 v89, a33
  v_accvgpr_read_b32 v90, a34
  v_accvgpr_read_b32 v91, a35
  v_accvgpr_read_b32 v92, a36
  v_accvgpr_read_b32 v93, a37
  v_accvgpr_read_b32 v94, a38
  v_accvgpr_read_b32 v95, a39
  v_maximum3_f32 v2, |v88|, |v89|, v2
  v_maximum3_f32 v2, |v90|, |v91|, v2
  v_maximum3_f32 v2, |v92|, |v93|, v2
  v_maximum3_f32 v2, |v94|, |v95|, v2
  v_pk_mul_f32 v[88:89], v[88:89], v[86:87] op_sel_hi:[1,0]
  v_pk_mul_f32 v[90:91], v[90:91], v[86:87] op_sel_hi:[1,0]
  v_pk_mul_f32 v[92:93], v[92:93], v[86:87] op_sel_hi:[1,0]
  v_pk_mul_f32 v[94:95], v[94:95], v[86:87] op_sel_hi:[1,0]
  v_cvt_pk_bf16_f32 v124, v88, v89
  v_cvt_pk_bf16_f32 v125, v90, v91
  v_cvt_pk_bf16_f32 v126, v92, v93
  v_cvt_pk_bf16_f32 v127, v94, v95
  s_add_u32 s46, s54, 2048
  buffer_store_dwordx4 v[124:127], v30, s[24:27], s46 offen offset:0 sc1
  v_accvgpr_read_b32 v56, a64
  v_accvgpr_read_b32 v57, a65
  v_accvgpr_read_b32 v58, a66
  v_accvgpr_read_b32 v59, a67
  v_accvgpr_read_b32 v60, a68
  v_accvgpr_read_b32 v61, a69
  v_accvgpr_read_b32 v62, a70
  v_accvgpr_read_b32 v63, a71
  v_maximum3_f32 v2, |v56|, |v57|, v2
  v_maximum3_f32 v2, |v58|, |v59|, v2
  v_maximum3_f32 v2, |v60|, |v61|, v2
  v_maximum3_f32 v2, |v62|, |v63|, v2
  v_pk_mul_f32 v[56:57], v[56:57], v[118:119] op_sel_hi:[1,0]
  v_pk_mul_f32 v[58:59], v[58:59], v[118:119] op_sel_hi:[1,0]
  v_pk_mul_f32 v[60:61], v[60:61], v[118:119] op_sel_hi:[1,0]
  v_pk_mul_f32 v[62:63], v[62:63], v[118:119] op_sel_hi:[1,0]
  v_cvt_pk_bf16_f32 v120, v56, v57
  v_cvt_pk_bf16_f32 v121, v58, v59
  v_cvt_pk_bf16_f32 v122, v60, v61
  v_cvt_pk_bf16_f32 v123, v62, v63
  s_add_u32 s46, s54, 4096
  buffer_store_dwordx4 v[120:123], v30, s[24:27], s46 offen offset:0 sc1
  v_accvgpr_read_b32 v88, a96
  v_accvgpr_read_b32 v89, a97
  v_accvgpr_read_b32 v90, a98
  v_accvgpr_read_b32 v91, a99
  v_accvgpr_read_b32 v92, a100
  v_accvgpr_read_b32 v93, a101
  v_accvgpr_read_b32 v94, a102
  v_accvgpr_read_b32 v95, a103
  v_maximum3_f32 v2, |v88|, |v89|, v2
  v_maximum3_f32 v2, |v90|, |v91|, v2
  v_maximum3_f32 v2, |v92|, |v93|, v2
  v_maximum3_f32 v2, |v94|, |v95|, v2
  v_pk_mul_f32 v[88:89], v[88:89], v[150:151] op_sel_hi:[1,0]
  v_pk_mul_f32 v[90:91], v[90:91], v[150:151] op_sel_hi:[1,0]
  v_pk_mul_f32 v[92:93], v[92:93], v[150:151] op_sel_hi:[1,0]
  v_pk_mul_f32 v[94:95], v[94:95], v[150:151] op_sel_hi:[1,0]
  v_cvt_pk_bf16_f32 v124, v88, v89
  v_cvt_pk_bf16_f32 v125, v90, v91
  v_cvt_pk_bf16_f32 v126, v92, v93
  v_cvt_pk_bf16_f32 v127, v94, v95
  s_add_u32 s46, s54, 6144
  buffer_store_dwordx4 v[124:127], v30, s[24:27], s46 offen offset:0 sc1
  v_accvgpr_read_b32 v56, a128
  v_accvgpr_read_b32 v57, a129
  v_accvgpr_read_b32 v58, a130
  v_accvgpr_read_b32 v59, a131
  v_accvgpr_read_b32 v60, a132
  v_accvgpr_read_b32 v61, a133
  v_accvgpr_read_b32 v62, a134
  v_accvgpr_read_b32 v63, a135
  v_maximum3_f32 v2, |v56|, |v57|, v2
  v_maximum3_f32 v2, |v58|, |v59|, v2
  v_maximum3_f32 v2, |v60|, |v61|, v2
  v_maximum3_f32 v2, |v62|, |v63|, v2
  v_pk_mul_f32 v[56:57], v[56:57], v[182:183] op_sel_hi:[1,0]
  v_pk_mul_f32 v[58:59], v[58:59], v[182:183] op_sel_hi:[1,0]
  v_pk_mul_f32 v[60:61], v[60:61], v[182:183] op_sel_hi:[1,0]
  v_pk_mul_f32 v[62:63], v[62:63], v[182:183] op_sel_hi:[1,0]
  v_cvt_pk_bf16_f32 v120, v56, v57
  v_cvt_pk_bf16_f32 v121, v58, v59
  v_cvt_pk_bf16_f32 v122, v60, v61
  v_cvt_pk_bf16_f32 v123, v62, v63
  s_add_u32 s46, s54, 8192
  buffer_store_dwordx4 v[120:123], v30, s[24:27], s46 offen offset:0 sc1
  v_accvgpr_read_b32 v88, a160
  v_accvgpr_read_b32 v89, a161
  v_accvgpr_read_b32 v90, a162
  v_accvgpr_read_b32 v91, a163
  v_accvgpr_read_b32 v92, a164
  v_accvgpr_read_b32 v93, a165
  v_accvgpr_read_b32 v94, a166
  v_accvgpr_read_b32 v95, a167
  v_maximum3_f32 v2, |v88|, |v89|, v2
  v_maximum3_f32 v2, |v90|, |v91|, v2
  v_maximum3_f32 v2, |v92|, |v93|, v2
  v_maximum3_f32 v2, |v94|, |v95|, v2
  v_pk_mul_f32 v[88:89], v[88:89], v[214:215] op_sel_hi:[1,0]
  v_pk_mul_f32 v[90:91], v[90:91], v[214:215] op_sel_hi:[1,0]
  v_pk_mul_f32 v[92:93], v[92:93], v[214:215] op_sel_hi:[1,0]
  v_pk_mul_f32 v[94:95], v[94:95], v[214:215] op_sel_hi:[1,0]
  v_cvt_pk_bf16_f32 v124, v88, v89
  v_cvt_pk_bf16_f32 v125, v90, v91
  v_cvt_pk_bf16_f32 v126, v92, v93
  v_cvt_pk_bf16_f32 v127, v94, v95
  s_add_u32 s46, s54, 10240
  buffer_store_dwordx4 v[124:127], v30, s[24:27], s46 offen offset:0 sc1
  v_maximum3_f32 v2, |v152|, |v153|, v2
  v_maximum3_f32 v2, |v154|, |v155|, v2
  v_maximum3_f32 v2, |v156|, |v157|, v2
  v_maximum3_f32 v2, |v158|, |v159|, v2
  v_pk_mul_f32 v[56:57], v[152:153], v[246:247] op_sel_hi:[1,0]
  v_pk_mul_f32 v[58:59], v[154:155], v[246:247] op_sel_hi:[1,0]
  v_pk_mul_f32 v[60:61], v[156:157], v[246:247] op_sel_hi:[1,0]
  v_pk_mul_f32 v[62:63], v[158:159], v[246:247] op_sel_hi:[1,0]
  v_cvt_pk_bf16_f32 v120, v56, v57
  v_cvt_pk_bf16_f32 v121, v58, v59
  v_cvt_pk_bf16_f32 v122, v60, v61
  v_cvt_pk_bf16_f32 v123, v62, v63
  s_add_u32 s46, s54, 12288
  buffer_store_dwordx4 v[120:123], v30, s[24:27], s46 offen offset:0 sc1
  v_accvgpr_read_b32 v88, a8
  v_accvgpr_read_b32 v89, a9
  v_accvgpr_read_b32 v90, a10
  v_accvgpr_read_b32 v91, a11
  v_accvgpr_read_b32 v92, a12
  v_accvgpr_read_b32 v93, a13
  v_accvgpr_read_b32 v94, a14
  v_accvgpr_read_b32 v95, a15
  v_maximum3_f32 v2, |v88|, |v89|, v2
  v_maximum3_f32 v2, |v90|, |v91|, v2
  v_maximum3_f32 v2, |v92|, |v93|, v2
  v_maximum3_f32 v2, |v94|, |v95|, v2
  v_pk_mul_f32 v[88:89], v[88:89], v[54:55] op_sel_hi:[1,0]
  v_pk_mul_f32 v[90:91], v[90:91], v[54:55] op_sel_hi:[1,0]
  v_pk_mul_f32 v[92:93], v[92:93], v[54:55] op_sel_hi:[1,0]
  v_pk_mul_f32 v[94:95], v[94:95], v[54:55] op_sel_hi:[1,0]
  v_cvt_pk_bf16_f32 v124, v88, v89
  v_cvt_pk_bf16_f32 v125, v90, v91
  v_cvt_pk_bf16_f32 v126, v92, v93
  v_cvt_pk_bf16_f32 v127, v94, v95
  s_add_u32 s46, s54, 26624
  buffer_store_dwordx4 v[124:127], v30, s[24:27], s46 offen offset:0 sc1
  v_accvgpr_read_b32 v56, a40
  v_accvgpr_read_b32 v57, a41
  v_accvgpr_read_b32 v58, a42
  v_accvgpr_read_b32 v59, a43
  v_accvgpr_read_b32 v60, a44
  v_accvgpr_read_b32 v61, a45
  v_accvgpr_read_b32 v62, a46
  v_accvgpr_read_b32 v63, a47
  v_maximum3_f32 v2, |v56|, |v57|, v2
  v_maximum3_f32 v2, |v58|, |v59|, v2
  v_maximum3_f32 v2, |v60|, |v61|, v2
  v_maximum3_f32 v2, |v62|, |v63|, v2
  v_pk_mul_f32 v[56:57], v[56:57], v[86:87] op_sel_hi:[1,0]
  v_pk_mul_f32 v[58:59], v[58:59], v[86:87] op_sel_hi:[1,0]
  v_pk_mul_f32 v[60:61], v[60:61], v[86:87] op_sel_hi:[1,0]
  v_pk_mul_f32 v[62:63], v[62:63], v[86:87] op_sel_hi:[1,0]
  v_cvt_pk_bf16_f32 v120, v56, v57
  v_cvt_pk_bf16_f32 v121, v58, v59
  v_cvt_pk_bf16_f32 v122, v60, v61
  v_cvt_pk_bf16_f32 v123, v62, v63
  s_add_u32 s46, s54, 28672
  buffer_store_dwordx4 v[120:123], v30, s[24:27], s46 offen offset:0 sc1
  v_accvgpr_read_b32 v88, a72
  v_accvgpr_read_b32 v89, a73
  v_accvgpr_read_b32 v90, a74
  v_accvgpr_read_b32 v91, a75
  v_accvgpr_read_b32 v92, a76
  v_accvgpr_read_b32 v93, a77
  v_accvgpr_read_b32 v94, a78
  v_accvgpr_read_b32 v95, a79
  v_maximum3_f32 v2, |v88|, |v89|, v2
  v_maximum3_f32 v2, |v90|, |v91|, v2
  v_maximum3_f32 v2, |v92|, |v93|, v2
  v_maximum3_f32 v2, |v94|, |v95|, v2
  v_pk_mul_f32 v[88:89], v[88:89], v[118:119] op_sel_hi:[1,0]
  v_pk_mul_f32 v[90:91], v[90:91], v[118:119] op_sel_hi:[1,0]
  v_pk_mul_f32 v[92:93], v[92:93], v[118:119] op_sel_hi:[1,0]
  v_pk_mul_f32 v[94:95], v[94:95], v[118:119] op_sel_hi:[1,0]
  v_cvt_pk_bf16_f32 v124, v88, v89
  v_cvt_pk_bf16_f32 v125, v90, v91
  v_cvt_pk_bf16_f32 v126, v92, v93
  v_cvt_pk_bf16_f32 v127, v94, v95
  s_add_u32 s46, s54, 30720
  buffer_store_dwordx4 v[124:127], v30, s[24:27], s46 offen offset:0 sc1
  v_accvgpr_read_b32 v56, a104
  v_accvgpr_read_b32 v57, a105
  v_accvgpr_read_b32 v58, a106
  v_accvgpr_read_b32 v59, a107
  v_accvgpr_read_b32 v60, a108
  v_accvgpr_read_b32 v61, a109
  v_accvgpr_read_b32 v62, a110
  v_accvgpr_read_b32 v63, a111
  v_maximum3_f32 v2, |v56|, |v57|, v2
  v_maximum3_f32 v2, |v58|, |v59|, v2
  v_maximum3_f32 v2, |v60|, |v61|, v2
  v_maximum3_f32 v2, |v62|, |v63|, v2
  v_pk_mul_f32 v[56:57], v[56:57], v[150:151] op_sel_hi:[1,0]
  v_pk_mul_f32 v[58:59], v[58:59], v[150:151] op_sel_hi:[1,0]
  v_pk_mul_f32 v[60:61], v[60:61], v[150:151] op_sel_hi:[1,0]
  v_pk_mul_f32 v[62:63], v[62:63], v[150:151] op_sel_hi:[1,0]
  v_cvt_pk_bf16_f32 v120, v56, v57
  v_cvt_pk_bf16_f32 v121, v58, v59
  v_cvt_pk_bf16_f32 v122, v60, v61
  v_cvt_pk_bf16_f32 v123, v62, v63
  s_add_u32 s46, s54, 32768
  buffer_store_dwordx4 v[120:123], v30, s[24:27], s46 offen offset:0 sc1
  v_accvgpr_read_b32 v88, a136
  v_accvgpr_read_b32 v89, a137
  v_accvgpr_read_b32 v90, a138
  v_accvgpr_read_b32 v91, a139
  v_accvgpr_read_b32 v92, a140
  v_accvgpr_read_b32 v93, a141
  v_accvgpr_read_b32 v94, a142
  v_accvgpr_read_b32 v95, a143
  v_maximum3_f32 v2, |v88|, |v89|, v2
  v_maximum3_f32 v2, |v90|, |v91|, v2
  v_maximum3_f32 v2, |v92|, |v93|, v2
  v_maximum3_f32 v2, |v94|, |v95|, v2
  v_pk_mul_f32 v[88:89], v[88:89], v[182:183] op_sel_hi:[1,0]
  v_pk_mul_f32 v[90:91], v[90:91], v[182:183] op_sel_hi:[1,0]
  v_pk_mul_f32 v[92:93], v[92:93], v[182:183] op_sel_hi:[1,0]
  v_pk_mul_f32 v[94:95], v[94:95], v[182:183] op_sel_hi:[1,0]
  v_cvt_pk_bf16_f32 v124, v88, v89
  v_cvt_pk_bf16_f32 v125, v90, v91
  v_cvt_pk_bf16_f32 v126, v92, v93
  v_cvt_pk_bf16_f32 v127, v94, v95
  s_add_u32 s46, s54, 34816
  buffer_store_dwordx4 v[124:127], v30, s[24:27], s46 offen offset:0 sc1
  v_accvgpr_read_b32 v56, a168
  v_accvgpr_read_b32 v57, a169
  v_accvgpr_read_b32 v58, a170
  v_accvgpr_read_b32 v59, a171
  v_accvgpr_read_b32 v60, a172
  v_accvgpr_read_b32 v61, a173
  v_accvgpr_read_b32 v62, a174
  v_accvgpr_read_b32 v63, a175
  v_maximum3_f32 v2, |v56|, |v57|, v2
  v_maximum3_f32 v2, |v58|, |v59|, v2
  v_maximum3_f32 v2, |v60|, |v61|, v2
  v_maximum3_f32 v2, |v62|, |v63|, v2
  v_pk_mul_f32 v[56:57], v[56:57], v[214:215] op_sel_hi:[1,0]
  v_pk_mul_f32 v[58:59], v[58:59], v[214:215] op_sel_hi:[1,0]
  v_pk_mul_f32 v[60:61], v[60:61], v[214:215] op_sel_hi:[1,0]
  v_pk_mul_f32 v[62:63], v[62:63], v[214:215] op_sel_hi:[1,0]
  v_cvt_pk_bf16_f32 v120, v56, v57
  v_cvt_pk_bf16_f32 v121, v58, v59
  v_cvt_pk_bf16_f32 v122, v60, v61
  v_cvt_pk_bf16_f32 v123, v62, v63
  s_add_u32 s46, s54, 36864
  buffer_store_dwordx4 v[120:123], v30, s[24:27], s46 offen offset:0 sc1
  v_maximum3_f32 v2, |v184|, |v185|, v2
  v_maximum3_f32 v2, |v186|, |v187|, v2
  v_maximum3_f32 v2, |v188|, |v189|, v2
  v_maximum3_f32 v2, |v190|, |v191|, v2
  v_pk_mul_f32 v[88:89], v[184:185], v[246:247] op_sel_hi:[1,0]
  v_pk_mul_f32 v[90:91], v[186:187], v[246:247] op_sel_hi:[1,0]
  v_pk_mul_f32 v[92:93], v[188:189], v[246:247] op_sel_hi:[1,0]
  v_pk_mul_f32 v[94:95], v[190:191], v[246:247] op_sel_hi:[1,0]
  v_cvt_pk_bf16_f32 v124, v88, v89
  v_cvt_pk_bf16_f32 v125, v90, v91
  v_cvt_pk_bf16_f32 v126, v92, v93
  v_cvt_pk_bf16_f32 v127, v94, v95
  s_add_u32 s46, s54, 38912
  buffer_store_dwordx4 v[124:127], v30, s[24:27], s46 offen offset:0 sc1
  s_mov_b32 s46, 2139095040
  v_cmp_ngt_f32 vcc, s46, v2
  s_cmp_lg_u32 s51, 0
  s_cbranch_scc1 L1a_ck1
  s_nop 3
  s_cbranch_vccnz L1a_fb
L1a_ck1:
L1a_epi2:
  v_lshrrev_b32 v112, 2, v1
  v_lshlrev_b32 v48, 8, v112
  v_and_b32 v112, 7, v112
  v_lshl_add_u32 v48, v112, 5, v48
  v_and_b32 v112, 3, v1
  v_lshl_add_u32 v48, v112, 3, v48
  s_lshl_b32 s46, s3, 6
  v_xor_b32 v48, s46, v48
  v_add_u32 v48, s28, v48
  v_xor_b32 v49, 32, v48
  v_xor_b32 v50, 64, v48
  v_xor_b32 v51, 96, v48
  v_xor_b32 v80, 128, v48
  v_xor_b32 v81, 160, v48
  v_xor_b32 v82, 192, v48
  v_xor_b32 v83, 224, v48
  s_waitcnt lgkmcnt(7)
  ds_read_b64_tr_b16 a[192:193], v48 offset:16384
  ds_read_b64_tr_b16 a[194:195], v48 offset:20480
  s_waitcnt lgkmcnt(8)
  ds_read_b64_tr_b16 a[196:197], v49 offset:16384
  ds_read_b64_tr_b16 a[198:199], v49 offset:20480
  s_waitcnt lgkmcnt(9)
  ds_read_b64_tr_b16 a[200:201], v50 offset:16384
  ds_read_b64_tr_b16 a[202:203], v50 offset:20480
  s_waitcnt lgkmcnt(10)
  ds_read_b64_tr_b16 a[204:205], v51 offset:16384
  ds_read_b64_tr_b16 a[206:207], v51 offset:20480
  v_accvgpr_read_b32 v56, a16
  v_accvgpr_read_b32 v57, a17
  v_accvgpr_read_b32 v58, a18
  v_accvgpr_read_b32 v59, a19
  v_accvgpr_read_b32 v60, a20
  v_accvgpr_read_b32 v61, a21
  v_accvgpr_read_b32 v62, a22
  v_accvgpr_read_b32 v63, a23
  v_maximum3_f32 v2, |v56|, |v57|, v2
  v_maximum3_f32 v2, |v58|, |v59|, v2
  v_maximum3_f32 v2, |v60|, |v61|, v2
  v_maximum3_f32 v2, |v62|, |v63|, v2
  v_pk_mul_f32 v[56:57], v[56:57], v[54:55] op_sel_hi:[1,0]
  v_pk_mul_f32 v[58:59], v[58:59], v[54:55] op_sel_hi:[1,0]
  v_pk_mul_f32 v[60:61], v[60:61], v[54:55] op_sel_hi:[1,0]
  v_pk_mul_f32 v[62:63], v[62:63], v[54:55] op_sel_hi:[1,0]
  v_cvt_pk_bf16_f32 v120, v56, v57
  v_cvt_pk_bf16_f32 v121, v58, v59
  v_cvt_pk_bf16_f32 v122, v60, v61
  v_cvt_pk_bf16_f32 v123, v62, v63
  v_accvgpr_write_b32 a0, v120
  v_accvgpr_write_b32 a1, v121
  v_accvgpr_write_b32 a2, v122
  v_accvgpr_write_b32 a3, v123
  s_waitcnt lgkmcnt(11)
  ds_read_b64_tr_b16 a[208:209], v80 offset:16384
  ds_read_b64_tr_b16 a[210:211], v80 offset:20480
  s_waitcnt lgkmcnt(12)
  ds_read_b64_tr_b16 a[212:213], v81 offset:16384
  ds_read_b64_tr_b16 a[214:215], v81 offset:20480
  s_waitcnt lgkmcnt(13)
  ds_read_b64_tr_b16 a[216:217], v82 offset:16384
  ds_read_b64_tr_b16 a[218:219], v82 offset:20480
  s_waitcnt lgkmcnt(14)
  ds_read_b64_tr_b16 a[220:221], v83 offset:16384
  s_waitcnt lgkmcnt(8)
  ds_read_b64_tr_b16 a[222:223], v83 offset:20480
  v_accvgpr_read_b32 v88, a48
  v_accvgpr_read_b32 v89, a49
  v_accvgpr_read_b32 v90, a50
  v_accvgpr_read_b32 v91, a51
  v_accvgpr_read_b32 v92, a52
  v_accvgpr_read_b32 v93, a53
  v_accvgpr_read_b32 v94, a54
  v_accvgpr_read_b32 v95, a55
  v_maximum3_f32 v2, |v88|, |v89|, v2
  v_maximum3_f32 v2, |v90|, |v91|, v2
  v_maximum3_f32 v2, |v92|, |v93|, v2
  v_maximum3_f32 v2, |v94|, |v95|, v2
  v_pk_mul_f32 v[88:89], v[88:89], v[86:87] op_sel_hi:[1,0]
  v_pk_mul_f32 v[90:91], v[90:91], v[86:87] op_sel_hi:[1,0]
  v_pk_mul_f32 v[92:93], v[92:93], v[86:87] op_sel_hi:[1,0]
  v_pk_mul_f32 v[94:95], v[94:95], v[86:87] op_sel_hi:[1,0]
  v_cvt_pk_bf16_f32 v124, v88, v89
  v_cvt_pk_bf16_f32 v125, v90, v91
  v_cvt_pk_bf16_f32 v126, v92, v93
  v_cvt_pk_bf16_f32 v127, v94, v95
  v_accvgpr_write_b32 a4, v124
  v_accvgpr_write_b32 a5, v125
  v_accvgpr_write_b32 a6, v126
  v_accvgpr_write_b32 a7, v127
  ds_read_b64_tr_b16 a[224:225], v48 offset:0
  ds_read_b64_tr_b16 a[226:227], v48 offset:4096
  ds_read_b64_tr_b16 a[228:229], v49 offset:0
  ds_read_b64_tr_b16 a[230:231], v49 offset:4096
  ds_read_b64_tr_b16 a[232:233], v50 offset:0
  ds_read_b64_tr_b16 a[234:235], v50 offset:4096
  s_waitcnt lgkmcnt(8)
  ds_read_b64_tr_b16 a[236:237], v51 offset:0
  ds_read_b64_tr_b16 a[238:239], v51 offset:4096
  v_accvgpr_read_b32 v56, a80
  v_accvgpr_read_b32 v57, a81
  v_accvgpr_read_b32 v58, a82
  v_accvgpr_read_b32 v59, a83
  v_accvgpr_read_b32 v60, a84
  v_accvgpr_read_b32 v61, a85
  v_accvgpr_read_b32 v62, a86
  v_accvgpr_read_b32 v63, a87
  v_maximum3_f32 v2, |v56|, |v57|, v2
  v_maximum3_f32 v2, |v58|, |v59|, v2
  v_maximum3_f32 v2, |v60|, |v61|, v2
  v_maximum3_f32 v2, |v62|, |v63|, v2
  v_pk_mul_f32 v[56:57], v[56:57], v[118:119] op_sel_hi:[1,0]
  v_pk_mul_f32 v[58:59], v[58:59], v[118:119] op_sel_hi:[1,0]
  v_pk_mul_f32 v[60:61], v[60:61], v[118:119] op_sel_hi:[1,0]
  v_pk_mul_f32 v[62:63], v[62:63], v[118:119] op_sel_hi:[1,0]
  v_cvt_pk_bf16_f32 v120, v56, v57
  v_cvt_pk_bf16_f32 v121, v58, v59
  v_cvt_pk_bf16_f32 v122, v60, v61
  v_cvt_pk_bf16_f32 v123, v62, v63
  v_accvgpr_write_b32 a8, v120
  v_accvgpr_write_b32 a9, v121
  v_accvgpr_write_b32 a10, v122
  v_accvgpr_write_b32 a11, v123
  ds_read_b64_tr_b16 a[240:241], v80 offset:0
  ds_read_b64_tr_b16 a[242:243], v80 offset:4096
  ds_read_b64_tr_b16 a[244:245], v81 offset:0
  ds_read_b64_tr_b16 a[246:247], v81 offset:4096
  ds_read_b64_tr_b16 a[248:249], v82 offset:0
  s_waitcnt lgkmcnt(8)
  ds_read_b64_tr_b16 a[250:251], v82 offset:4096
  ds_read_b64_tr_b16 a[252:253], v83 offset:0
  ds_read_b64_tr_b16 a[254:255], v83 offset:4096
  v_accvgpr_read_b32 v88, a112
  v_accvgpr_read_b32 v89, a113
  v_accvgpr_read_b32 v90, a114
  v_accvgpr_read_b32 v91, a115
  v_accvgpr_read_b32 v92, a116
  v_accvgpr_read_b32 v93, a117
  v_accvgpr_read_b32 v94, a118
  v_accvgpr_read_b32 v95, a119
  v_maximum3_f32 v2, |v88|, |v89|, v2
  v_maximum3_f32 v2, |v90|, |v91|, v2
  v_maximum3_f32 v2, |v92|, |v93|, v2
  v_maximum3_f32 v2, |v94|, |v95|, v2
  v_pk_mul_f32 v[88:89], v[88:89], v[150:151] op_sel_hi:[1,0]
  v_pk_mul_f32 v[90:91], v[90:91], v[150:151] op_sel_hi:[1,0]
  v_pk_mul_f32 v[92:93], v[92:93], v[150:151] op_sel_hi:[1,0]
  v_pk_mul_f32 v[94:95], v[94:95], v[150:151] op_sel_hi:[1,0]
  v_cvt_pk_bf16_f32 v124, v88, v89
  v_cvt_pk_bf16_f32 v125, v90, v91
  v_cvt_pk_bf16_f32 v126, v92, v93
  v_cvt_pk_bf16_f32 v127, v94, v95
  v_accvgpr_write_b32 a12, v124
  v_accvgpr_write_b32 a13, v125
  v_accvgpr_write_b32 a14, v126
  v_accvgpr_write_b32 a15, v127
  v_accvgpr_read_b32 v56, a144
  v_accvgpr_read_b32 v57, a145
  v_accvgpr_read_b32 v58, a146
  v_accvgpr_read_b32 v59, a147
  v_accvgpr_read_b32 v60, a148
  v_accvgpr_read_b32 v61, a149
  v_accvgpr_read_b32 v62, a150
  v_accvgpr_read_b32 v63, a151
  v_maximum3_f32 v2, |v56|, |v57|, v2
  v_maximum3_f32 v2, |v58|, |v59|, v2
  v_maximum3_f32 v2, |v60|, |v61|, v2
  v_maximum3_f32 v2, |v62|, |v63|, v2
  v_pk_mul_f32 v[56:57], v[56:57], v[182:183] op_sel_hi:[1,0]
  v_pk_mul_f32 v[58:59], v[58:59], v[182:183] op_sel_hi:[1,0]
  v_pk_mul_f32 v[60:61], v[60:61], v[182:183] op_sel_hi:[1,0]
  v_pk_mul_f32 v[62:63], v[62:63], v[182:183] op_sel_hi:[1,0]
  v_cvt_pk_bf16_f32 v120, v56, v57
  v_cvt_pk_bf16_f32 v121, v58, v59
  v_cvt_pk_bf16_f32 v122, v60, v61
  v_cvt_pk_bf16_f32 v123, v62, v63
  v_accvgpr_write_b32 a32, v120
  v_accvgpr_write_b32 a33, v121
  v_accvgpr_write_b32 a34, v122
  v_accvgpr_write_b32 a35, v123
  v_accvgpr_read_b32 v88, a176
  v_accvgpr_read_b32 v89, a177
  v_accvgpr_read_b32 v90, a178
  v_accvgpr_read_b32 v91, a179
  v_accvgpr_read_b32 v92, a180
  v_accvgpr_read_b32 v93, a181
  v_accvgpr_read_b32 v94, a182
  v_accvgpr_read_b32 v95, a183
  v_maximum3_f32 v2, |v88|, |v89|, v2
  v_maximum3_f32 v2, |v90|, |v91|, v2
  v_maximum3_f32 v2, |v92|, |v93|, v2
  v_maximum3_f32 v2, |v94|, |v95|, v2
  v_pk_mul_f32 v[88:89], v[88:89], v[214:215] op_sel_hi:[1,0]
  v_pk_mul_f32 v[90:91], v[90:91], v[214:215] op_sel_hi:[1,0]
  v_pk_mul_f32 v[92:93], v[92:93], v[214:215] op_sel_hi:[1,0]
  v_pk_mul_f32 v[94:95], v[94:95], v[214:215] op_sel_hi:[1,0]
  v_cvt_pk_bf16_f32 v124, v88, v89
  v_cvt_pk_bf16_f32 v125, v90, v91
  v_cvt_pk_bf16_f32 v126, v92, v93
  v_cvt_pk_bf16_f32 v127, v94, v95
  v_accvgpr_write_b32 a36, v124
  v_accvgpr_write_b32 a37, v125
  v_accvgpr_write_b32 a38, v126
  v_accvgpr_write_b32 a39, v127
  s_cmp_lg_u32 s37, 0
  s_cbranch_scc1 L1a_epi3
  s_waitcnt vmcnt(0)
  s_barrier
  s_cmp_lg_u32 s3, 0
  s_cbranch_scc1 L1a_sig1
  v_mov_b32 v0, 1
  s_mov_b64 exec, 1
  global_store_dword v12, v0, s[98:99] sc1
  s_mov_b64 exec, -1
L1a_sig1:
  s_mov_b32 s37, 1
L1a_epi3:
  s_waitcnt lgkmcnt(0)
  s_add_u32 m0, s28, 16384
  s_add_u32 s38, s30, 524288
  buffer_load_dwordx4 v7, s[12:15], s38 offen offset:0 sc1 lds
  s_add_u32 m0, s28, 16384
  s_add_u32 s38, s30, 524288
  buffer_load_dwordx4 v8, s[12:15], s38 offen offset:1024 sc1 lds
  s_add_u32 m0, s28, 16384
  s_add_u32 s38, s30, 524288
  buffer_load_dwordx4 v9, s[12:15], s38 offen offset:2048 sc1 lds
  v_maximum3_f32 v2, |v216|, |v217|, v2
  v_maximum3_f32 v2, |v218|, |v219|, v2
  v_maximum3_f32 v2, |v220|, |v221|, v2
  v_maximum3_f32 v2, |v222|, |v223|, v2
  v_pk_mul_f32 v[56:57], v[216:217], v[246:247] op_sel_hi:[1,0]
  v_pk_mul_f32 v[58:59], v[218:219], v[246:247] op_sel_hi:[1,0]
  v_pk_mul_f32 v[60:61], v[220:221], v[246:247] op_sel_hi:[1,0]
  v_pk_mul_f32 v[62:63], v[222:223], v[246:247] op_sel_hi:[1,0]
  v_cvt_pk_bf16_f32 v120, v56, v57
  v_cvt_pk_bf16_f32 v121, v58, v59
  v_cvt_pk_bf16_f32 v122, v60, v61
  v_cvt_pk_bf16_f32 v123, v62, v63
  v_accvgpr_write_b32 a40, v120
  v_accvgpr_write_b32 a41, v121
  v_accvgpr_write_b32 a42, v122
  v_accvgpr_write_b32 a43, v123
  s_add_u32 m0, s28, 16384
  s_add_u32 s38, s30, 524288
  buffer_load_dwordx4 v10, s[12:15], s38 offen offset:3072 sc1 lds
  s_add_u32 m0, s28, 20480
  s_add_u32 s38, s30, 557056
  buffer_load_dwordx4 v7, s[12:15], s38 offen offset:0 sc1 lds
  s_add_u32 m0, s28, 20480
  s_add_u32 s38, s30, 557056
  buffer_load_dwordx4 v8, s[12:15], s38 offen offset:1024 sc1 lds
  v_accvgpr_read_b32 v88, a24
  v_accvgpr_read_b32 v89, a25
  v_accvgpr_read_b32 v90, a26
  v_accvgpr_read_b32 v91, a27
  v_accvgpr_read_b32 v92, a28
  v_accvgpr_read_b32 v93, a29
  v_accvgpr_read_b32 v94, a30
  v_accvgpr_read_b32 v95, a31
  v_maximum3_f32 v2, |v88|, |v89|, v2
  v_maximum3_f32 v2, |v90|, |v91|, v2
  v_maximum3_f32 v2, |v92|, |v93|, v2
  v_maximum3_f32 v2, |v94|, |v95|, v2
  v_pk_mul_f32 v[88:89], v[88:89], v[54:55] op_sel_hi:[1,0]
  v_pk_mul_f32 v[90:91], v[90:91], v[54:55] op_sel_hi:[1,0]
  v_pk_mul_f32 v[92:93], v[92:93], v[54:55] op_sel_hi:[1,0]
  v_pk_mul_f32 v[94:95], v[94:95], v[54:55] op_sel_hi:[1,0]
  v_cvt_pk_bf16_f32 v124, v88, v89
  v_cvt_pk_bf16_f32 v125, v90, v91
  v_cvt_pk_bf16_f32 v126, v92, v93
  v_cvt_pk_bf16_f32 v127, v94, v95
  v_accvgpr_write_b32 a44, v124
  v_accvgpr_write_b32 a45, v125
  v_accvgpr_write_b32 a46, v126
  v_accvgpr_write_b32 a47, v127
  s_add_u32 m0, s28, 20480
  s_add_u32 s38, s30, 557056
  buffer_load_dwordx4 v9, s[12:15], s38 offen offset:2048 sc1 lds
  s_add_u32 m0, s28, 20480
  s_add_u32 s38, s30, 557056
  buffer_load_dwordx4 v10, s[12:15], s38 offen offset:3072 sc1 lds
  s_add_u32 m0, s28, 0
  s_add_u32 s38, s30, 589824
  buffer_load_dwordx4 v7, s[12:15], s38 offen offset:0 sc1 lds
  v_accvgpr_read_b32 v56, a56
  v_accvgpr_read_b32 v57, a57
  v_accvgpr_read_b32 v58, a58
  v_accvgpr_read_b32 v59, a59
  v_accvgpr_read_b32 v60, a60
  v_accvgpr_read_b32 v61, a61
  v_accvgpr_read_b32 v62, a62
  v_accvgpr_read_b32 v63, a63
  v_maximum3_f32 v2, |v56|, |v57|, v2
  v_maximum3_f32 v2, |v58|, |v59|, v2
  v_maximum3_f32 v2, |v60|, |v61|, v2
  v_maximum3_f32 v2, |v62|, |v63|, v2
  v_pk_mul_f32 v[56:57], v[56:57], v[86:87] op_sel_hi:[1,0]
  v_pk_mul_f32 v[58:59], v[58:59], v[86:87] op_sel_hi:[1,0]
  v_pk_mul_f32 v[60:61], v[60:61], v[86:87] op_sel_hi:[1,0]
  v_pk_mul_f32 v[62:63], v[62:63], v[86:87] op_sel_hi:[1,0]
  v_cvt_pk_bf16_f32 v120, v56, v57
  v_cvt_pk_bf16_f32 v121, v58, v59
  v_cvt_pk_bf16_f32 v122, v60, v61
  v_cvt_pk_bf16_f32 v123, v62, v63
  v_accvgpr_write_b32 a64, v120
  v_accvgpr_write_b32 a65, v121
  v_accvgpr_write_b32 a66, v122
  v_accvgpr_write_b32 a67, v123
  s_add_u32 m0, s28, 0
  s_add_u32 s38, s30, 589824
  buffer_load_dwordx4 v8, s[12:15], s38 offen offset:1024 sc1 lds
  s_add_u32 m0, s28, 0
  s_add_u32 s38, s30, 589824
  buffer_load_dwordx4 v9, s[12:15], s38 offen offset:2048 sc1 lds
  s_add_u32 m0, s28, 0
  s_add_u32 s38, s30, 589824
  buffer_load_dwordx4 v10, s[12:15], s38 offen offset:3072 sc1 lds
  v_accvgpr_read_b32 v88, a88
  v_accvgpr_read_b32 v89, a89
  v_accvgpr_read_b32 v90, a90
  v_accvgpr_read_b32 v91, a91
  v_accvgpr_read_b32 v92, a92
  v_accvgpr_read_b32 v93, a93
  v_accvgpr_read_b32 v94, a94
  v_accvgpr_read_b32 v95, a95
  v_maximum3_f32 v2, |v88|, |v89|, v2
  v_maximum3_f32 v2, |v90|, |v91|, v2
  v_maximum3_f32 v2, |v92|, |v93|, v2
  v_maximum3_f32 v2, |v94|, |v95|, v2
  v_pk_mul_f32 v[88:89], v[88:89], v[118:119] op_sel_hi:[1,0]
  v_pk_mul_f32 v[90:91], v[90:91], v[118:119] op_sel_hi:[1,0]
  v_pk_mul_f32 v[92:93], v[92:93], v[118:119] op_sel_hi:[1,0]
  v_pk_mul_f32 v[94:95], v[94:95], v[118:119] op_sel_hi:[1,0]
  v_cvt_pk_bf16_f32 v124, v88, v89
  v_cvt_pk_bf16_f32 v125, v90, v91
  v_cvt_pk_bf16_f32 v126, v92, v93
  v_cvt_pk_bf16_f32 v127, v94, v95
  v_accvgpr_write_b32 a68, v124
  v_accvgpr_write_b32 a69, v125
  v_accvgpr_write_b32 a70, v126
  v_accvgpr_write_b32 a71, v127
  s_add_u32 m0, s28, 4096
  s_add_u32 s38, s30, 622592
  buffer_load_dwordx4 v7, s[12:15], s38 offen offset:0 sc1 lds
  s_add_u32 m0, s28, 4096
  s_add_u32 s38, s30, 622592
  buffer_load_dwordx4 v8, s[12:15], s38 offen offset:1024 sc1 lds
  s_add_u32 m0, s28, 4096
  s_add_u32 s38, s30, 622592
  buffer_load_dwordx4 v9, s[12:15], s38 offen offset:2048 sc1 lds
  v_accvgpr_read_b32 v56, a120
  v_accvgpr_read_b32 v57, a121
  v_accvgpr_read_b32 v58, a122
  v_accvgpr_read_b32 v59, a123
  v_accvgpr_read_b32 v60, a124
  v_accvgpr_read_b32 v61, a125
  v_accvgpr_read_b32 v62, a126
  v_accvgpr_read_b32 v63, a127
  v_maximum3_f32 v2, |v56|, |v57|, v2
  v_maximum3_f32 v2, |v58|, |v59|, v2
  v_maximum3_f32 v2, |v60|, |v61|, v2
  v_maximum3_f32 v2, |v62|, |v63|, v2
  v_pk_mul_f32 v[56:57], v[56:57], v[150:151] op_sel_hi:[1,0]
  v_pk_mul_f32 v[58:59], v[58:59], v[150:151] op_sel_hi:[1,0]
  v_pk_mul_f32 v[60:61], v[60:61], v[150:151] op_sel_hi:[1,0]
  v_pk_mul_f32 v[62:63], v[62:63], v[150:151] op_sel_hi:[1,0]
  v_cvt_pk_bf16_f32 v120, v56, v57
  v_cvt_pk_bf16_f32 v121, v58, v59
  v_cvt_pk_bf16_f32 v122, v60, v61
  v_cvt_pk_bf16_f32 v123, v62, v63
  v_accvgpr_write_b32 a72, v120
  v_accvgpr_write_b32 a73, v121
  v_accvgpr_write_b32 a74, v122
  v_accvgpr_write_b32 a75, v123
  s_add_u32 m0, s28, 4096
  s_add_u32 s38, s30, 622592
  buffer_load_dwordx4 v10, s[12:15], s38 offen offset:3072 sc1 lds
  v_accvgpr_read_b32 v88, a152
  v_accvgpr_read_b32 v89, a153
  v_accvgpr_read_b32 v90, a154
  v_accvgpr_read_b32 v91, a155
  v_accvgpr_read_b32 v92, a156
  v_accvgpr_read_b32 v93, a157
  v_accvgpr_read_b32 v94, a158
  v_accvgpr_read_b32 v95, a159
  v_maximum3_f32 v2, |v88|, |v89|, v2
  v_maximum3_f32 v2, |v90|, |v91|, v2
  v_maximum3_f32 v2, |v92|, |v93|, v2
  v_maximum3_f32 v2, |v94|, |v95|, v2
  v_pk_mul_f32 v[88:89], v[88:89], v[182:183] op_sel_hi:[1,0]
  v_pk_mul_f32 v[90:91], v[90:91], v[182:183] op_sel_hi:[1,0]
  v_pk_mul_f32 v[92:93], v[92:93], v[182:183] op_sel_hi:[1,0]
  v_pk_mul_f32 v[94:95], v[94:95], v[182:183] op_sel_hi:[1,0]
  v_cvt_pk_bf16_f32 v124, v88, v89
  v_cvt_pk_bf16_f32 v125, v90, v91
  v_cvt_pk_bf16_f32 v126, v92, v93
  v_cvt_pk_bf16_f32 v127, v94, v95
  v_accvgpr_write_b32 a76, v124
  v_accvgpr_write_b32 a77, v125
  v_accvgpr_write_b32 a78, v126
  v_accvgpr_write_b32 a79, v127
  v_accvgpr_read_b32 v56, a184
  v_accvgpr_read_b32 v57, a185
  v_accvgpr_read_b32 v58, a186
  v_accvgpr_read_b32 v59, a187
  v_accvgpr_read_b32 v60, a188
  v_accvgpr_read_b32 v61, a189
  v_accvgpr_read_b32 v62, a190
  v_accvgpr_read_b32 v63, a191
  v_maximum3_f32 v2, |v56|, |v57|, v2
  v_maximum3_f32 v2, |v58|, |v59|, v2
  v_maximum3_f32 v2, |v60|, |v61|, v2
  v_maximum3_f32 v2, |v62|, |v63|, v2
  v_pk_mul_f32 v[56:57], v[56:57], v[214:215] op_sel_hi:[1,0]
  v_pk_mul_f32 v[58:59], v[58:59], v[214:215] op_sel_hi:[1,0]
  v_pk_mul_f32 v[60:61], v[60:61], v[214:215] op_sel_hi:[1,0]
  v_pk_mul_f32 v[62:63], v[62:63], v[214:215] op_sel_hi:[1,0]
  v_cvt_pk_bf16_f32 v120, v56, v57
  v_cvt_pk_bf16_f32 v121, v58, v59
  v_cvt_pk_bf16_f32 v122, v60, v61
  v_cvt_pk_bf16_f32 v123, v62, v63
  v_accvgpr_write_b32 a96, v120
  v_accvgpr_write_b32 a97, v121
  v_accvgpr_write_b32 a98, v122
  v_accvgpr_write_b32 a99, v123
  global_load_dwordx4 v[24:27], v11, s[98:99] sc1
  v_maximum3_f32 v2, |v248|, |v249|, v2
  v_maximum3_f32 v2, |v250|, |v251|, v2
  v_maximum3_f32 v2, |v252|, |v253|, v2
  v_maximum3_f32 v2, |v254|, |v255|, v2
  v_pk_mul_f32 v[88:89], v[248:249], v[246:247] op_sel_hi:[1,0]
  v_pk_mul_f32 v[90:91], v[250:251], v[246:247] op_sel_hi:[1,0]
  v_pk_mul_f32 v[92:93], v[252:253], v[246:247] op_sel_hi:[1,0]
  v_pk_mul_f32 v[94:95], v[254:255], v[246:247] op_sel_hi:[1,0]
  v_cvt_pk_bf16_f32 v124, v88, v89
  v_cvt_pk_bf16_f32 v125, v90, v91
  v_cvt_pk_bf16_f32 v126, v92, v93
  v_cvt_pk_bf16_f32 v127, v94, v95
  v_accvgpr_write_b32 a100, v124
  v_accvgpr_write_b32 a101, v125
  v_accvgpr_write_b32 a102, v126
  v_accvgpr_write_b32 a103, v127
  s_mov_b32 s46, 2139095040
  v_cmp_ngt_f32 vcc, s46, v2
  s_cmp_lg_u32 s51, 0
  s_cbranch_scc1 L1a_ck2
  s_nop 3
  s_cbranch_vccnz L1a_fb
L1a_ck2:
  s_waitcnt vmcnt(0)
  s_branch L1_done
L1a_fb:
  s_waitcnt vmcnt(0) lgkmcnt(0)
  s_mov_b32 s51, 1
  v_xor_b32 v31, 4224, v6
  s_lshl_b32 s40, s3, 13
  s_add_u32 s40, s40, 131072
  s_sub_u32 s46, s40, s41
  v_add_u32 v13, s46, v13
  v_add_u32 v14, s46, v14
  v_add_u32 v15, s46, v15
  v_add_u32 v16, s46, v16
  s_sub_u32 s46, s46, 32768
  v_add_u32 v17, s46, v17
  v_add_u32 v18, s46, v18
  v_add_u32 v19, s46, v19
  v_add_u32 v20, s46, v20
  v_add_u32 v21, s46, v21
  v_add_u32 v22, s46, v22
  v_add_u32 v23, s46, v23
  v_add_u32 v28, s46, v28
  v_mov_b32 v52, 0xff800000
  v_mov_b32 v84, 0xff800000
  v_mov_b32 v116, 0xff800000
  v_mov_b32 v148, 0xff800000
  v_mov_b32 v180, 0xff800000
  v_mov_b32 v212, 0xff800000
  v_mov_b32 v244, 0xff800000
  s_mov_b32 s45, 0
L1a_fb1:
  s_add_u32 m0, s40, 0
  s_nop 0
  buffer_load_dwordx4 v6, s[16:19], s45 offen offset:0 nt lds
  buffer_load_dwordx4 v6, s[16:19], s45 offen offset:1024 nt lds
  buffer_load_dwordx4 v6, s[16:19], s45 offen offset:2048 nt lds
  buffer_load_dwordx4 v6, s[16:19], s45 offen offset:3072 nt lds
  s_add_u32 m0, s40, 4096
  s_nop 0
  buffer_load_dwordx4 v31, s[16:19], s45 offen offset:0 nt lds
  buffer_load_dwordx4 v31, s[16:19], s45 offen offset:1024 nt lds
  buffer_load_dwordx4 v31, s[16:19], s45 offen offset:2048 nt lds
  buffer_load_dwordx4 v31, s[16:19], s45 offen offset:3072 nt lds
  s_waitcnt vmcnt(0)
  ds_read_b128 a[192:195], v13 offset:0
  ds_read_b128 a[196:199], v14 offset:0
  ds_read_b128 a[200:203], v15 offset:0
  ds_read_b128 a[204:207], v16 offset:0
  ds_read_b128 a[208:211], v13 offset:2048
  ds_read_b128 a[212:215], v14 offset:2048
  ds_read_b128 a[216:219], v15 offset:2048
  ds_read_b128 a[220:223], v16 offset:2048
  s_waitcnt lgkmcnt(0)
  v_mfma_f32_16x16x32_bf16 v[56:59], a[192:195], v[32:35], 0
  v_mfma_f32_16x16x32_bf16 v[56:59], a[196:199], v[36:39], v[56:59]
  v_mfma_f32_16x16x32_bf16 v[56:59], a[200:203], v[40:43], v[56:59]
  v_mfma_f32_16x16x32_bf16 v[56:59], a[204:207], v[44:47], v[56:59]
  v_mfma_f32_16x16x32_bf16 v[60:63], a[208:211], v[32:35], 0
  v_mfma_f32_16x16x32_bf16 v[60:63], a[212:215], v[36:39], v[60:63]
  v_mfma_f32_16x16x32_bf16 v[60:63], a[216:219], v[40:43], v[60:63]
  v_mfma_f32_16x16x32_bf16 v[60:63], a[220:223], v[44:47], v[60:63]
  s_nop 7
  v_max3_f32 v52, v52, v56, v57
  v_max3_f32 v52, v52, v58, v59
  v_max3_f32 v52, v52, v60, v61
  v_max3_f32 v52, v52, v62, v63
  v_mfma_f32_16x16x32_bf16 v[88:91], a[192:195], v[64:67], 0
  v_mfma_f32_16x16x32_bf16 v[88:91], a[196:199], v[68:71], v[88:91]
  v_mfma_f32_16x16x32_bf16 v[88:91], a[200:203], v[72:75], v[88:91]
  v_mfma_f32_16x16x32_bf16 v[88:91], a[204:207], v[76:79], v[88:91]
  v_mfma_f32_16x16x32_bf16 v[92:95], a[208:211], v[64:67], 0
  v_mfma_f32_16x16x32_bf16 v[92:95], a[212:215], v[68:71], v[92:95]
  v_mfma_f32_16x16x32_bf16 v[92:95], a[216:219], v[72:75], v[92:95]
  v_mfma_f32_16x16x32_bf16 v[92:95], a[220:223], v[76:79], v[92:95]
  s_nop 7
  v_max3_f32 v84, v84, v88, v89
  v_max3_f32 v84, v84, v90, v91
  v_max3_f32 v84, v84, v92, v93
  v_max3_f32 v84, v84, v94, v95
  v_mfma_f32_16x16x32_bf16 v[56:59], a[192:195], v[96:99], 0
  v_mfma_f32_16x16x32_bf16 v[56:59], a[196:199], v[100:103], v[56:59]
  v_mfma_f32_16x16x32_bf16 v[56:59], a[200:203], v[104:107], v[56:59]
  v_mfma_f32_16x16x32_bf16 v[56:59], a[204:207], v[108:111], v[56:59]
  v_mfma_f32_16x16x32_bf16 v[60:63], a[208:211], v[96:99], 0
  v_mfma_f32_16x16x32_bf16 v[60:63], a[212:215], v[100:103], v[60:63]
  v_mfma_f32_16x16x32_bf16 v[60:63], a[216:219], v[104:107], v[60:63]
  v_mfma_f32_16x16x32_bf16 v[60:63], a[220:223], v[108:111], v[60:63]
  s_nop 7
  v_max3_f32 v116, v116, v56, v57
  v_max3_f32 v116, v116, v58, v59
  v_max3_f32 v116, v116, v60, v61
  v_max3_f32 v116, v116, v62, v63
  v_mfma_f32_16x16x32_bf16 v[88:91], a[192:195], v[128:131], 0
  v_mfma_f32_16x16x32_bf16 v[88:91], a[196:199], v[132:135], v[88:91]
  v_mfma_f32_16x16x32_bf16 v[88:91], a[200:203], v[136:139], v[88:91]
  v_mfma_f32_16x16x32_bf16 v[88:91], a[204:207], v[140:143], v[88:91]
  v_mfma_f32_16x16x32_bf16 v[92:95], a[208:211], v[128:131], 0
  v_mfma_f32_16x16x32_bf16 v[92:95], a[212:215], v[132:135], v[92:95]
  v_mfma_f32_16x16x32_bf16 v[92:95], a[216:219], v[136:139], v[92:95]
  v_mfma_f32_16x16x32_bf16 v[92:95], a[220:223], v[140:143], v[92:95]
  s_nop 7
  v_max3_f32 v148, v148, v88, v89
  v_max3_f32 v148, v148, v90, v91
  v_max3_f32 v148, v148, v92, v93
  v_max3_f32 v148, v148, v94, v95
  v_mfma_f32_16x16x32_bf16 v[56:59], a[192:195], v[160:163], 0
  v_mfma_f32_16x16x32_bf16 v[56:59], a[196:199], v[164:167], v[56:59]
  v_mfma_f32_16x16x32_bf16 v[56:59], a[200:203], v[168:171], v[56:59]
  v_mfma_f32_16x16x32_bf16 v[56:59], a[204:207], v[172:175], v[56:59]
  v_mfma_f32_16x16x32_bf16 v[60:63], a[208:211], v[160:163], 0
  v_mfma_f32_16x16x32_bf16 v[60:63], a[212:215], v[164:167], v[60:63]
  v_mfma_f32_16x16x32_bf16 v[60:63], a[216:219], v[168:171], v[60:63]
  v_mfma_f32_16x16x32_bf16 v[60:63], a[220:223], v[172:175], v[60:63]
  s_nop 7
  v_max3_f32 v180, v180, v56, v57
  v_max3_f32 v180, v180, v58, v59
  v_max3_f32 v180, v180, v60, v61
  v_max3_f32 v180, v180, v62, v63
  v_mfma_f32_16x16x32_bf16 v[88:91], a[192:195], v[192:195], 0
  v_mfma_f32_16x16x32_bf16 v[88:91], a[196:199], v[196:199], v[88:91]
  v_mfma_f32_16x16x32_bf16 v[88:91], a[200:203], v[200:203], v[88:91]
  v_mfma_f32_16x16x32_bf16 v[88:91], a[204:207], v[204:207], v[88:91]
  v_mfma_f32_16x16x32_bf16 v[92:95], a[208:211], v[192:195], 0
  v_mfma_f32_16x16x32_bf16 v[92:95], a[212:215], v[196:199], v[92:95]
  v_mfma_f32_16x16x32_bf16 v[92:95], a[216:219], v[200:203], v[92:95]
  v_mfma_f32_16x16x32_bf16 v[92:95], a[220:223], v[204:207], v[92:95]
  s_nop 7
  v_max3_f32 v212, v212, v88, v89
  v_max3_f32 v212, v212, v90, v91
  v_max3_f32 v212, v212, v92, v93
  v_max3_f32 v212, v212, v94, v95
  v_mfma_f32_16x16x32_bf16 v[56:59], a[192:195], v[224:227], 0
  v_mfma_f32_16x16x32_bf16 v[56:59], a[196:199], v[228:231], v[56:59]
  v_mfma_f32_16x16x32_bf16 v[56:59], a[200:203], v[232:235], v[56:59]
  v_mfma_f32_16x16x32_bf16 v[56:59], a[204:207], v[236:239], v[56:59]
  v_mfma_f32_16x16x32_bf16 v[60:63], a[208:211], v[224:227], 0
  v_mfma_f32_16x16x32_bf16 v[60:63], a[212:215], v[228:231], v[60:63]
  v_mfma_f32_16x16x32_bf16 v[60:63], a[216:219], v[232:235], v[60:63]
  v_mfma_f32_16x16x32_bf16 v[60:63], a[220:223], v[236:239], v[60:63]
  s_nop 7
  v_max3_f32 v244, v244, v56, v57
  v_max3_f32 v244, v244, v58, v59
  v_max3_f32 v244, v244, v60, v61
  v_max3_f32 v244, v244, v62, v63
  s_add_u32 s45, s45, 8192
  s_cmp_lt_u32 s45, 262144
  s_cbranch_scc1 L1a_fb1
  v_mov_b32 v53, v52
  v_mov_b32 v85, v84
  v_mov_b32 v117, v116
  v_mov_b32 v149, v148
  v_mov_b32 v181, v180
  v_mov_b32 v213, v212
  v_mov_b32 v245, v244
  s_nop 1
  v_permlane16_swap_b32 v52, v53
  v_permlane16_swap_b32 v84, v85
  v_permlane16_swap_b32 v116, v117
  v_permlane16_swap_b32 v148, v149
  v_permlane16_swap_b32 v180, v181
  v_permlane16_swap_b32 v212, v213
  v_permlane16_swap_b32 v244, v245
  s_nop 0
  v_max_f32 v52, v52, v53
  v_max_f32 v84, v84, v85
  v_max_f32 v116, v116, v117
  v_max_f32 v148, v148, v149
  v_max_f32 v180, v180, v181
  v_max_f32 v212, v212, v213
  v_max_f32 v244, v244, v245
  v_mov_b32 v53, v52
  v_mov_b32 v85, v84
  v_mov_b32 v117, v116
  v_mov_b32 v149, v148
  v_mov_b32 v181, v180
  v_mov_b32 v213, v212
  v_mov_b32 v245, v244
  s_nop 1
  v_permlane32_swap_b32 v52, v53
  v_permlane32_swap_b32 v84, v85
  v_permlane32_swap_b32 v116, v117
  v_permlane32_swap_b32 v148, v149
  v_permlane32_swap_b32 v180, v181
  v_permlane32_swap_b32 v212, v213
  v_permlane32_swap_b32 v244, v245
  s_nop 0
  v_max_f32 v52, v52, v53
  v_max_f32 v84, v84, v85
  v_max_f32 v116, v116, v117
  v_max_f32 v148, v148, v149
  v_max_f32 v180, v180, v181
  v_max_f32 v212, v212, v213
  v_max_f32 v244, v244, v245
  v_sub_f32 v48, 0, v52
  v_sub_f32 v49, 0, v52
  v_sub_f32 v50, 0, v52
  v_sub_f32 v51, 0, v52
  v_sub_f32 v80, 0, v84
  v_sub_f32 v81, 0, v84
  v_sub_f32 v82, 0, v84
  v_sub_f32 v83, 0, v84
  v_sub_f32 v112, 0, v116
  v_sub_f32 v113, 0, v116
  v_sub_f32 v114, 0, v116
  v_sub_f32 v115, 0, v116
  v_sub_f32 v144, 0, v148
  v_sub_f32 v145, 0, v148
  v_sub_f32 v146, 0, v148
  v_sub_f32 v147, 0, v148
  v_sub_f32 v176, 0, v180
  v_sub_f32 v177, 0, v180
  v_sub_f32 v178, 0, v180
  v_sub_f32 v179, 0, v180
  v_sub_f32 v208, 0, v212
  v_sub_f32 v209, 0, v212
  v_sub_f32 v210, 0, v212
  v_sub_f32 v211, 0, v212
  v_sub_f32 v240, 0, v244
  v_sub_f32 v241, 0, v244
  v_sub_f32 v242, 0, v244
  v_sub_f32 v243, 0, v244
  v_mov_b32 v52, 0
  v_mov_b32 v84, 0
  v_mov_b32 v116, 0
  v_mov_b32 v148, 0
  v_mov_b32 v180, 0
  v_mov_b32 v212, 0
  v_mov_b32 v244, 0
  v_accvgpr_write_b32 a0, 0
  v_accvgpr_write_b32 a1, 0
  v_accvgpr_write_b32 a2, 0
  v_accvgpr_write_b32 a3, 0
  v_accvgpr_write_b32 a4, 0
  v_accvgpr_write_b32 a5, 0
  v_accvgpr_write_b32 a6, 0
  v_accvgpr_write_b32 a7, 0
  v_accvgpr_write_b32 a8, 0
  v_accvgpr_write_b32 a9, 0
  v_accvgpr_write_b32 a10, 0
  v_accvgpr_write_b32 a11, 0
  v_accvgpr_write_b32 a12, 0
  v_accvgpr_write_b32 a13, 0
  v_accvgpr_write_b32 a14, 0
  v_accvgpr_write_b32 a15, 0
  v_accvgpr_write_b32 a16, 0
  v_accvgpr_write_b32 a17, 0
  v_accvgpr_write_b32 a18, 0
  v_accvgpr_write_b32 a19, 0
  v_accvgpr_write_b32 a20, 0
  v_accvgpr_write_b32 a21, 0
  v_accvgpr_write_b32 a22, 0
  v_accvgpr_write_b32 a23, 0
  v_accvgpr_write_b32 a24, 0
  v_accvgpr_write_b32 a25, 0
  v_accvgpr_write_b32 a26, 0
  v_accvgpr_write_b32 a27, 0
  v_accvgpr_write_b32 a28, 0
  v_accvgpr_write_b32 a29, 0
  v_accvgpr_write_b32 a30, 0
  v_accvgpr_write_b32 a31, 0
  v_accvgpr_write_b32 a32, 0
  v_accvgpr_write_b32 a33, 0
  v_accvgpr_write_b32 a34, 0
  v_accvgpr_write_b32 a35, 0
  v_accvgpr_write_b32 a36, 0
  v_accvgpr_write_b32 a37, 0
  v_accvgpr_write_b32 a38, 0
  v_accvgpr_write_b32 a39, 0
  v_accvgpr_write_b32 a40, 0
  v_accvgpr_write_b32 a41, 0
  v_accvgpr_write_b32 a42, 0
  v_accvgpr_write_b32 a43, 0
  v_accvgpr_write_b32 a44, 0
  v_accvgpr_write_b32 a45, 0
  v_accvgpr_write_b32 a46, 0
  v_accvgpr_write_b32 a47, 0
  v_accvgpr_write_b32 a48, 0
  v_accvgpr_write_b32 a49, 0
  v_accvgpr_write_b32 a50, 0
  v_accvgpr_write_b32 a51, 0
  v_accvgpr_write_b32 a52, 0
  v_accvgpr_write_b32 a53, 0
  v_accvgpr_write_b32 a54, 0
  v_accvgpr_write_b32 a55, 0
  v_accvgpr_write_b32 a56, 0
  v_accvgpr_write_b32 a57, 0
  v_accvgpr_write_b32 a58, 0
  v_accvgpr_write_b32 a59, 0
  v_accvgpr_write_b32 a60, 0
  v_accvgpr_write_b32 a61, 0
  v_accvgpr_write_b32 a62, 0
  v_accvgpr_write_b32 a63, 0
  v_accvgpr_write_b32 a64, 0
  v_accvgpr_write_b32 a65, 0
  v_accvgpr_write_b32 a66, 0
  v_accvgpr_write_b32 a67, 0
  v_accvgpr_write_b32 a68, 0
  v_accvgpr_write_b32 a69, 0
  v_accvgpr_write_b32 a70, 0
  v_accvgpr_write_b32 a71, 0
  v_accvgpr_write_b32 a72, 0
  v_accvgpr_write_b32 a73, 0
  v_accvgpr_write_b32 a74, 0
  v_accvgpr_write_b32 a75, 0
  v_accvgpr_write_b32 a76, 0
  v_accvgpr_write_b32 a77, 0
  v_accvgpr_write_b32 a78, 0
  v_accvgpr_write_b32 a79, 0
  v_accvgpr_write_b32 a80, 0
  v_accvgpr_write_b32 a81, 0
  v_accvgpr_write_b32 a82, 0
  v_accvgpr_write_b32 a83, 0
  v_accvgpr_write_b32 a84, 0
  v_accvgpr_write_b32 a85, 0
  v_accvgpr_write_b32 a86, 0
  v_accvgpr_write_b32 a87, 0
  v_accvgpr_write_b32 a88, 0
  v_accvgpr_write_b32 a89, 0
  v_accvgpr_write_b32 a90, 0
  v_accvgpr_write_b32 a91, 0
  v_accvgpr_write_b32 a92, 0
  v_accvgpr_write_b32 a93, 0
  v_accvgpr_write_b32 a94, 0
  v_accvgpr_write_b32 a95, 0
  v_accvgpr_write_b32 a96, 0
  v_accvgpr_write_b32 a97, 0
  v_accvgpr_write_b32 a98, 0
  v_accvgpr_write_b32 a99, 0
  v_accvgpr_write_b32 a100, 0
  v_accvgpr_write_b32 a101, 0
  v_accvgpr_write_b32 a102, 0
  v_accvgpr_write_b32 a103, 0
  v_accvgpr_write_b32 a104, 0
  v_accvgpr_write_b32 a105, 0
  v_accvgpr_write_b32 a106, 0
  v_accvgpr_write_b32 a107, 0
  v_accvgpr_write_b32 a108, 0
  v_accvgpr_write_b32 a109, 0
  v_accvgpr_write_b32 a110, 0
  v_accvgpr_write_b32 a111, 0
  v_accvgpr_write_b32 a112, 0
  v_accvgpr_write_b32 a113, 0
  v_accvgpr_write_b32 a114, 0
  v_accvgpr_write_b32 a115, 0
  v_accvgpr_write_b32 a116, 0
  v_accvgpr_write_b32 a117, 0
  v_accvgpr_write_b32 a118, 0
  v_accvgpr_write_b32 a119, 0
  v_accvgpr_write_b32 a120, 0
  v_accvgpr_write_b32 a121, 0
  v_accvgpr_write_b32 a122, 0
  v_accvgpr_write_b32 a123, 0
  v_accvgpr_write_b32 a124, 0
  v_accvgpr_write_b32 a125, 0
  v_accvgpr_write_b32 a126, 0
  v_accvgpr_write_b32 a127, 0
  v_accvgpr_write_b32 a128, 0
  v_accvgpr_write_b32 a129, 0
  v_accvgpr_write_b32 a130, 0
  v_accvgpr_write_b32 a131, 0
  v_accvgpr_write_b32 a132, 0
  v_accvgpr_write_b32 a133, 0
  v_accvgpr_write_b32 a134, 0
  v_accvgpr_write_b32 a135, 0
  v_accvgpr_write_b32 a136, 0
  v_accvgpr_write_b32 a137, 0
  v_accvgpr_write_b32 a138, 0
  v_accvgpr_write_b32 a139, 0
  v_accvgpr_write_b32 a140, 0
  v_accvgpr_write_b32 a141, 0
  v_accvgpr_write_b32 a142, 0
  v_accvgpr_write_b32 a143, 0
  v_accvgpr_write_b32 a144, 0
  v_accvgpr_write_b32 a145, 0
  v_accvgpr_write_b32 a146, 0
  v_accvgpr_write_b32 a147, 0
  v_accvgpr_write_b32 a148, 0
  v_accvgpr_write_b32 a149, 0
  v_accvgpr_write_b32 a150, 0
  v_accvgpr_write_b32 a151, 0
  v_accvgpr_write_b32 a152, 0
  v_accvgpr_write_b32 a153, 0
  v_accvgpr_write_b32 a154, 0
  v_accvgpr_write_b32 a155, 0
  v_accvgpr_write_b32 a156, 0
  v_accvgpr_write_b32 a157, 0
  v_accvgpr_write_b32 a158, 0
  v_accvgpr_write_b32 a159, 0
  v_accvgpr_write_b32 a160, 0
  v_accvgpr_write_b32 a161, 0
  v_accvgpr_write_b32 a162, 0
  v_accvgpr_write_b32 a163, 0
  v_accvgpr_write_b32 a164, 0
  v_accvgpr_write_b32 a165, 0
  v_accvgpr_write_b32 a166, 0
  v_accvgpr_write_b32 a167, 0
  v_accvgpr_write_b32 a168, 0
  v_accvgpr_write_b32 a169, 0
  v_accvgpr_write_b32 a170, 0
  v_accvgpr_write_b32 a171, 0
  v_accvgpr_write_b32 a172, 0
  v_accvgpr_write_b32 a173, 0
  v_accvgpr_write_b32 a174, 0
  v_accvgpr_write_b32 a175, 0
  v_accvgpr_write_b32 a176, 0
  v_accvgpr_write_b32 a177, 0
  v_accvgpr_write_b32 a178, 0
  v_accvgpr_write_b32 a179, 0
  v_accvgpr_write_b32 a180, 0
  v_accvgpr_write_b32 a181, 0
  v_accvgpr_write_b32 a182, 0
  v_accvgpr_write_b32 a183, 0
  v_accvgpr_write_b32 a184, 0
  v_accvgpr_write_b32 a185, 0
  v_accvgpr_write_b32 a186, 0
  v_accvgpr_write_b32 a187, 0
  v_accvgpr_write_b32 a188, 0
  v_accvgpr_write_b32 a189, 0
  v_accvgpr_write_b32 a190, 0
  v_accvgpr_write_b32 a191, 0
  v_mov_b32 v152, 0
  v_mov_b32 v153, 0
  v_mov_b32 v154, 0
  v_mov_b32 v155, 0
  v_mov_b32 v156, 0
  v_mov_b32 v157, 0
  v_mov_b32 v158, 0
  v_mov_b32 v159, 0
  v_mov_b32 v184, 0
  v_mov_b32 v185, 0
  v_mov_b32 v186, 0
  v_mov_b32 v187, 0
  v_mov_b32 v188, 0
  v_mov_b32 v189, 0
  v_mov_b32 v190, 0
  v_mov_b32 v191, 0
  v_mov_b32 v216, 0
  v_mov_b32 v217, 0
  v_mov_b32 v218, 0
  v_mov_b32 v219, 0
  v_mov_b32 v220, 0
  v_mov_b32 v221, 0
  v_mov_b32 v222, 0
  v_mov_b32 v223, 0
  v_mov_b32 v248, 0
  v_mov_b32 v249, 0
  v_mov_b32 v250, 0
  v_mov_b32 v251, 0
  v_mov_b32 v252, 0
  v_mov_b32 v253, 0
  v_mov_b32 v254, 0
  v_mov_b32 v255, 0
  s_mov_b32 s45, 0
L1a_fb2:
  s_add_u32 m0, s40, 0
  s_nop 0
  buffer_load_dwordx4 v6, s[16:19], s45 offen offset:0 nt lds
  buffer_load_dwordx4 v6, s[16:19], s45 offen offset:1024 nt lds
  buffer_load_dwordx4 v6, s[16:19], s45 offen offset:2048 nt lds
  buffer_load_dwordx4 v6, s[16:19], s45 offen offset:3072 nt lds
  s_add_u32 m0, s40, 4096
  s_nop 0
  buffer_load_dwordx4 v31, s[16:19], s45 offen offset:0 nt lds
  buffer_load_dwordx4 v31, s[16:19], s45 offen offset:1024 nt lds
  buffer_load_dwordx4 v31, s[16:19], s45 offen offset:2048 nt lds
  buffer_load_dwordx4 v31, s[16:19], s45 offen offset:3072 nt lds
  s_waitcnt vmcnt(0)
  ds_read_b128 a[192:195], v13 offset:0
  ds_read_b128 a[196:199], v14 offset:0
  ds_read_b128 a[200:203], v15 offset:0
  ds_read_b128 a[204:207], v16 offset:0
  ds_read_b128 a[208:211], v13 offset:2048
  ds_read_b128 a[212:215], v14 offset:2048
  ds_read_b128 a[216:219], v15 offset:2048
  ds_read_b128 a[220:223], v16 offset:2048
  s_waitcnt lgkmcnt(0)
  s_add_u32 m0, s40, 0
  s_nop 0
  buffer_load_dwordx4 v6, s[20:23], s45 offen offset:0 nt lds
  buffer_load_dwordx4 v6, s[20:23], s45 offen offset:1024 nt lds
  buffer_load_dwordx4 v6, s[20:23], s45 offen offset:2048 nt lds
  buffer_load_dwordx4 v6, s[20:23], s45 offen offset:3072 nt lds
  s_add_u32 m0, s40, 4096
  s_nop 0
  buffer_load_dwordx4 v31, s[20:23], s45 offen offset:0 nt lds
  buffer_load_dwordx4 v31, s[20:23], s45 offen offset:1024 nt lds
  buffer_load_dwordx4 v31, s[20:23], s45 offen offset:2048 nt lds
  buffer_load_dwordx4 v31, s[20:23], s45 offen offset:3072 nt lds
  s_waitcnt vmcnt(0)
  ds_read_b64_tr_b16 a[224:225], v17 offset:0
  ds_read_b64_tr_b16 a[226:227], v17 offset:2048
  ds_read_b64_tr_b16 a[228:229], v18 offset:0
  ds_read_b64_tr_b16 a[230:231], v18 offset:2048
  ds_read_b64_tr_b16 a[232:233], v19 offset:0
  ds_read_b64_tr_b16 a[234:235], v19 offset:2048
  ds_read_b64_tr_b16 a[236:237], v20 offset:0
  ds_read_b64_tr_b16 a[238:239], v20 offset:2048
  ds_read_b64_tr_b16 a[240:241], v21 offset:0
  ds_read_b64_tr_b16 a[242:243], v21 offset:2048
  ds_read_b64_tr_b16 a[244:245], v22 offset:0
  ds_read_b64_tr_b16 a[246:247], v22 offset:2048
  ds_read_b64_tr_b16 a[248:249], v23 offset:0
  ds_read_b64_tr_b16 a[250:251], v23 offset:2048
  ds_read_b64_tr_b16 a[252:253], v28 offset:0
  s_waitcnt lgkmcnt(8)
  ds_read_b64_tr_b16 a[254:255], v28 offset:2048
  s_waitcnt lgkmcnt(0)
  v_mfma_f32_16x16x32_bf16 v[56:59], a[192:195], v[32:35], v[48:51]
  v_mfma_f32_16x16x32_bf16 v[56:59], a[196:199], v[36:39], v[56:59]
  v_mfma_f32_16x16x32_bf16 v[56:59], a[200:203], v[40:43], v[56:59]
  v_mfma_f32_16x16x32_bf16 v[56:59], a[204:207], v[44:47], v[56:59]
  v_mfma_f32_16x16x32_bf16 v[60:63], a[208:211], v[32:35], v[48:51]
  v_mfma_f32_16x16x32_bf16 v[60:63], a[212:215], v[36:39], v[60:63]
  v_mfma_f32_16x16x32_bf16 v[60:63], a[216:219], v[40:43], v[60:63]
  v_mfma_f32_16x16x32_bf16 v[60:63], a[220:223], v[44:47], v[60:63]
  s_nop 7
  v_exp_f32 v56, v56
  v_exp_f32 v57, v57
  v_exp_f32 v58, v58
  v_exp_f32 v59, v59
  v_exp_f32 v60, v60
  v_exp_f32 v61, v61
  v_exp_f32 v62, v62
  v_exp_f32 v63, v63
  s_nop 0
  v_add_f32 v52, v52, v56
  v_add_f32 v52, v52, v57
  v_add_f32 v52, v52, v58
  v_add_f32 v52, v52, v59
  v_add_f32 v52, v52, v60
  v_add_f32 v52, v52, v61
  v_add_f32 v52, v52, v62
  v_add_f32 v52, v52, v63
  v_cvt_pk_bf16_f32 v120, v56, v57
  v_cvt_pk_bf16_f32 v121, v58, v59
  v_cvt_pk_bf16_f32 v122, v60, v61
  v_cvt_pk_bf16_f32 v123, v62, v63
  s_nop 1
  v_mfma_f32_16x16x32_bf16 a[0:3], a[224:227], v[120:123], a[0:3]
  v_mfma_f32_16x16x32_bf16 a[4:7], a[228:231], v[120:123], a[4:7]
  v_mfma_f32_16x16x32_bf16 a[8:11], a[232:235], v[120:123], a[8:11]
  v_mfma_f32_16x16x32_bf16 a[12:15], a[236:239], v[120:123], a[12:15]
  v_mfma_f32_16x16x32_bf16 a[16:19], a[240:243], v[120:123], a[16:19]
  v_mfma_f32_16x16x32_bf16 a[20:23], a[244:247], v[120:123], a[20:23]
  v_mfma_f32_16x16x32_bf16 a[24:27], a[248:251], v[120:123], a[24:27]
  v_mfma_f32_16x16x32_bf16 a[28:31], a[252:255], v[120:123], a[28:31]
  v_mfma_f32_16x16x32_bf16 v[88:91], a[192:195], v[64:67], v[80:83]
  v_mfma_f32_16x16x32_bf16 v[88:91], a[196:199], v[68:71], v[88:91]
  v_mfma_f32_16x16x32_bf16 v[88:91], a[200:203], v[72:75], v[88:91]
  v_mfma_f32_16x16x32_bf16 v[88:91], a[204:207], v[76:79], v[88:91]
  v_mfma_f32_16x16x32_bf16 v[92:95], a[208:211], v[64:67], v[80:83]
  v_mfma_f32_16x16x32_bf16 v[92:95], a[212:215], v[68:71], v[92:95]
  v_mfma_f32_16x16x32_bf16 v[92:95], a[216:219], v[72:75], v[92:95]
  v_mfma_f32_16x16x32_bf16 v[92:95], a[220:223], v[76:79], v[92:95]
  s_nop 7
  v_exp_f32 v88, v88
  v_exp_f32 v89, v89
  v_exp_f32 v90, v90
  v_exp_f32 v91, v91
  v_exp_f32 v92, v92
  v_exp_f32 v93, v93
  v_exp_f32 v94, v94
  v_exp_f32 v95, v95
  s_nop 0
  v_add_f32 v84, v84, v88
  v_add_f32 v84, v84, v89
  v_add_f32 v84, v84, v90
  v_add_f32 v84, v84, v91
  v_add_f32 v84, v84, v92
  v_add_f32 v84, v84, v93
  v_add_f32 v84, v84, v94
  v_add_f32 v84, v84, v95
  v_cvt_pk_bf16_f32 v124, v88, v89
  v_cvt_pk_bf16_f32 v125, v90, v91
  v_cvt_pk_bf16_f32 v126, v92, v93
  v_cvt_pk_bf16_f32 v127, v94, v95
  s_nop 1
  v_mfma_f32_16x16x32_bf16 a[32:35], a[224:227], v[124:127], a[32:35]
  v_mfma_f32_16x16x32_bf16 a[36:39], a[228:231], v[124:127], a[36:39]
  v_mfma_f32_16x16x32_bf16 a[40:43], a[232:235], v[124:127], a[40:43]
  v_mfma_f32_16x16x32_bf16 a[44:47], a[236:239], v[124:127], a[44:47]
  v_mfma_f32_16x16x32_bf16 a[48:51], a[240:243], v[124:127], a[48:51]
  v_mfma_f32_16x16x32_bf16 a[52:55], a[244:247], v[124:127], a[52:55]
  v_mfma_f32_16x16x32_bf16 a[56:59], a[248:251], v[124:127], a[56:59]
  v_mfma_f32_16x16x32_bf16 a[60:63], a[252:255], v[124:127], a[60:63]
  v_mfma_f32_16x16x32_bf16 v[56:59], a[192:195], v[96:99], v[112:115]
  v_mfma_f32_16x16x32_bf16 v[56:59], a[196:199], v[100:103], v[56:59]
  v_mfma_f32_16x16x32_bf16 v[56:59], a[200:203], v[104:107], v[56:59]
  v_mfma_f32_16x16x32_bf16 v[56:59], a[204:207], v[108:111], v[56:59]
  v_mfma_f32_16x16x32_bf16 v[60:63], a[208:211], v[96:99], v[112:115]
  v_mfma_f32_16x16x32_bf16 v[60:63], a[212:215], v[100:103], v[60:63]
  v_mfma_f32_16x16x32_bf16 v[60:63], a[216:219], v[104:107], v[60:63]
  v_mfma_f32_16x16x32_bf16 v[60:63], a[220:223], v[108:111], v[60:63]
  s_nop 7
  v_exp_f32 v56, v56
  v_exp_f32 v57, v57
  v_exp_f32 v58, v58
  v_exp_f32 v59, v59
  v_exp_f32 v60, v60
  v_exp_f32 v61, v61
  v_exp_f32 v62, v62
  v_exp_f32 v63, v63
  s_nop 0
  v_add_f32 v116, v116, v56
  v_add_f32 v116, v116, v57
  v_add_f32 v116, v116, v58
  v_add_f32 v116, v116, v59
  v_add_f32 v116, v116, v60
  v_add_f32 v116, v116, v61
  v_add_f32 v116, v116, v62
  v_add_f32 v116, v116, v63
  v_cvt_pk_bf16_f32 v120, v56, v57
  v_cvt_pk_bf16_f32 v121, v58, v59
  v_cvt_pk_bf16_f32 v122, v60, v61
  v_cvt_pk_bf16_f32 v123, v62, v63
  s_nop 1
  v_mfma_f32_16x16x32_bf16 a[64:67], a[224:227], v[120:123], a[64:67]
  v_mfma_f32_16x16x32_bf16 a[68:71], a[228:231], v[120:123], a[68:71]
  v_mfma_f32_16x16x32_bf16 a[72:75], a[232:235], v[120:123], a[72:75]
  v_mfma_f32_16x16x32_bf16 a[76:79], a[236:239], v[120:123], a[76:79]
  v_mfma_f32_16x16x32_bf16 a[80:83], a[240:243], v[120:123], a[80:83]
  v_mfma_f32_16x16x32_bf16 a[84:87], a[244:247], v[120:123], a[84:87]
  v_mfma_f32_16x16x32_bf16 a[88:91], a[248:251], v[120:123], a[88:91]
  v_mfma_f32_16x16x32_bf16 a[92:95], a[252:255], v[120:123], a[92:95]
  v_mfma_f32_16x16x32_bf16 v[88:91], a[192:195], v[128:131], v[144:147]
  v_mfma_f32_16x16x32_bf16 v[88:91], a[196:199], v[132:135], v[88:91]
  v_mfma_f32_16x16x32_bf16 v[88:91], a[200:203], v[136:139], v[88:91]
  v_mfma_f32_16x16x32_bf16 v[88:91], a[204:207], v[140:143], v[88:91]
  v_mfma_f32_16x16x32_bf16 v[92:95], a[208:211], v[128:131], v[144:147]
  v_mfma_f32_16x16x32_bf16 v[92:95], a[212:215], v[132:135], v[92:95]
  v_mfma_f32_16x16x32_bf16 v[92:95], a[216:219], v[136:139], v[92:95]
  v_mfma_f32_16x16x32_bf16 v[92:95], a[220:223], v[140:143], v[92:95]
  s_nop 7
  v_exp_f32 v88, v88
  v_exp_f32 v89, v89
  v_exp_f32 v90, v90
  v_exp_f32 v91, v91
  v_exp_f32 v92, v92
  v_exp_f32 v93, v93
  v_exp_f32 v94, v94
  v_exp_f32 v95, v95
  s_nop 0
  v_add_f32 v148, v148, v88
  v_add_f32 v148, v148, v89
  v_add_f32 v148, v148, v90
  v_add_f32 v148, v148, v91
  v_add_f32 v148, v148, v92
  v_add_f32 v148, v148, v93
  v_add_f32 v148, v148, v94
  v_add_f32 v148, v148, v95
  v_cvt_pk_bf16_f32 v124, v88, v89
  v_cvt_pk_bf16_f32 v125, v90, v91
  v_cvt_pk_bf16_f32 v126, v92, v93
  v_cvt_pk_bf16_f32 v127, v94, v95
  s_nop 1
  v_mfma_f32_16x16x32_bf16 a[96:99], a[224:227], v[124:127], a[96:99]
  v_mfma_f32_16x16x32_bf16 a[100:103], a[228:231], v[124:127], a[100:103]
  v_mfma_f32_16x16x32_bf16 a[104:107], a[232:235], v[124:127], a[104:107]
  v_mfma_f32_16x16x32_bf16 a[108:111], a[236:239], v[124:127], a[108:111]
  v_mfma_f32_16x16x32_bf16 a[112:115], a[240:243], v[124:127], a[112:115]
  v_mfma_f32_16x16x32_bf16 a[116:119], a[244:247], v[124:127], a[116:119]
  v_mfma_f32_16x16x32_bf16 a[120:123], a[248:251], v[124:127], a[120:123]
  v_mfma_f32_16x16x32_bf16 a[124:127], a[252:255], v[124:127], a[124:127]
  v_mfma_f32_16x16x32_bf16 v[56:59], a[192:195], v[160:163], v[176:179]
  v_mfma_f32_16x16x32_bf16 v[56:59], a[196:199], v[164:167], v[56:59]
  v_mfma_f32_16x16x32_bf16 v[56:59], a[200:203], v[168:171], v[56:59]
  v_mfma_f32_16x16x32_bf16 v[56:59], a[204:207], v[172:175], v[56:59]
  v_mfma_f32_16x16x32_bf16 v[60:63], a[208:211], v[160:163], v[176:179]
  v_mfma_f32_16x16x32_bf16 v[60:63], a[212:215], v[164:167], v[60:63]
  v_mfma_f32_16x16x32_bf16 v[60:63], a[216:219], v[168:171], v[60:63]
  v_mfma_f32_16x16x32_bf16 v[60:63], a[220:223], v[172:175], v[60:63]
  s_nop 7
  v_exp_f32 v56, v56
  v_exp_f32 v57, v57
  v_exp_f32 v58, v58
  v_exp_f32 v59, v59
  v_exp_f32 v60, v60
  v_exp_f32 v61, v61
  v_exp_f32 v62, v62
  v_exp_f32 v63, v63
  s_nop 0
  v_add_f32 v180, v180, v56
  v_add_f32 v180, v180, v57
  v_add_f32 v180, v180, v58
  v_add_f32 v180, v180, v59
  v_add_f32 v180, v180, v60
  v_add_f32 v180, v180, v61
  v_add_f32 v180, v180, v62
  v_add_f32 v180, v180, v63
  v_cvt_pk_bf16_f32 v120, v56, v57
  v_cvt_pk_bf16_f32 v121, v58, v59
  v_cvt_pk_bf16_f32 v122, v60, v61
  v_cvt_pk_bf16_f32 v123, v62, v63
  s_nop 1
  v_mfma_f32_16x16x32_bf16 a[128:131], a[224:227], v[120:123], a[128:131]
  v_mfma_f32_16x16x32_bf16 a[132:135], a[228:231], v[120:123], a[132:135]
  v_mfma_f32_16x16x32_bf16 a[136:139], a[232:235], v[120:123], a[136:139]
  v_mfma_f32_16x16x32_bf16 a[140:143], a[236:239], v[120:123], a[140:143]
  v_mfma_f32_16x16x32_bf16 a[144:147], a[240:243], v[120:123], a[144:147]
  v_mfma_f32_16x16x32_bf16 a[148:151], a[244:247], v[120:123], a[148:151]
  v_mfma_f32_16x16x32_bf16 a[152:155], a[248:251], v[120:123], a[152:155]
  v_mfma_f32_16x16x32_bf16 a[156:159], a[252:255], v[120:123], a[156:159]
  v_mfma_f32_16x16x32_bf16 v[88:91], a[192:195], v[192:195], v[208:211]
  v_mfma_f32_16x16x32_bf16 v[88:91], a[196:199], v[196:199], v[88:91]
  v_mfma_f32_16x16x32_bf16 v[88:91], a[200:203], v[200:203], v[88:91]
  v_mfma_f32_16x16x32_bf16 v[88:91], a[204:207], v[204:207], v[88:91]
  v_mfma_f32_16x16x32_bf16 v[92:95], a[208:211], v[192:195], v[208:211]
  v_mfma_f32_16x16x32_bf16 v[92:95], a[212:215], v[196:199], v[92:95]
  v_mfma_f32_16x16x32_bf16 v[92:95], a[216:219], v[200:203], v[92:95]
  v_mfma_f32_16x16x32_bf16 v[92:95], a[220:223], v[204:207], v[92:95]
  s_nop 7
  v_exp_f32 v88, v88
  v_exp_f32 v89, v89
  v_exp_f32 v90, v90
  v_exp_f32 v91, v91
  v_exp_f32 v92, v92
  v_exp_f32 v93, v93
  v_exp_f32 v94, v94
  v_exp_f32 v95, v95
  s_nop 0
  v_add_f32 v212, v212, v88
  v_add_f32 v212, v212, v89
  v_add_f32 v212, v212, v90
  v_add_f32 v212, v212, v91
  v_add_f32 v212, v212, v92
  v_add_f32 v212, v212, v93
  v_add_f32 v212, v212, v94
  v_add_f32 v212, v212, v95
  v_cvt_pk_bf16_f32 v124, v88, v89
  v_cvt_pk_bf16_f32 v125, v90, v91
  v_cvt_pk_bf16_f32 v126, v92, v93
  v_cvt_pk_bf16_f32 v127, v94, v95
  s_nop 1
  v_mfma_f32_16x16x32_bf16 a[160:163], a[224:227], v[124:127], a[160:163]
  v_mfma_f32_16x16x32_bf16 a[164:167], a[228:231], v[124:127], a[164:167]
  v_mfma_f32_16x16x32_bf16 a[168:171], a[232:235], v[124:127], a[168:171]
  v_mfma_f32_16x16x32_bf16 a[172:175], a[236:239], v[124:127], a[172:175]
  v_mfma_f32_16x16x32_bf16 a[176:179], a[240:243], v[124:127], a[176:179]
  v_mfma_f32_16x16x32_bf16 a[180:183], a[244:247], v[124:127], a[180:183]
  v_mfma_f32_16x16x32_bf16 a[184:187], a[248:251], v[124:127], a[184:187]
  v_mfma_f32_16x16x32_bf16 a[188:191], a[252:255], v[124:127], a[188:191]
  v_mfma_f32_16x16x32_bf16 v[56:59], a[192:195], v[224:227], v[240:243]
  v_mfma_f32_16x16x32_bf16 v[56:59], a[196:199], v[228:231], v[56:59]
  v_mfma_f32_16x16x32_bf16 v[56:59], a[200:203], v[232:235], v[56:59]
  v_mfma_f32_16x16x32_bf16 v[56:59], a[204:207], v[236:239], v[56:59]
  v_mfma_f32_16x16x32_bf16 v[60:63], a[208:211], v[224:227], v[240:243]
  v_mfma_f32_16x16x32_bf16 v[60:63], a[212:215], v[228:231], v[60:63]
  v_mfma_f32_16x16x32_bf16 v[60:63], a[216:219], v[232:235], v[60:63]
  v_mfma_f32_16x16x32_bf16 v[60:63], a[220:223], v[236:239], v[60:63]
  s_nop 7
  v_exp_f32 v56, v56
  v_exp_f32 v57, v57
  v_exp_f32 v58, v58
  v_exp_f32 v59, v59
  v_exp_f32 v60, v60
  v_exp_f32 v61, v61
  v_exp_f32 v62, v62
  v_exp_f32 v63, v63
  s_nop 0
  v_add_f32 v244, v244, v56
  v_add_f32 v244, v244, v57
  v_add_f32 v244, v244, v58
  v_add_f32 v244, v244, v59
  v_add_f32 v244, v244, v60
  v_add_f32 v244, v244, v61
  v_add_f32 v244, v244, v62
  v_add_f32 v244, v244, v63
  v_cvt_pk_bf16_f32 v120, v56, v57
  v_cvt_pk_bf16_f32 v121, v58, v59
  v_cvt_pk_bf16_f32 v122, v60, v61
  v_cvt_pk_bf16_f32 v123, v62, v63
  s_nop 1
  v_mfma_f32_16x16x32_bf16 v[152:155], a[224:227], v[120:123], v[152:155]
  v_mfma_f32_16x16x32_bf16 v[156:159], a[228:231], v[120:123], v[156:159]
  v_mfma_f32_16x16x32_bf16 v[184:187], a[232:235], v[120:123], v[184:187]
  v_mfma_f32_16x16x32_bf16 v[188:191], a[236:239], v[120:123], v[188:191]
  v_mfma_f32_16x16x32_bf16 v[216:219], a[240:243], v[120:123], v[216:219]
  v_mfma_f32_16x16x32_bf16 v[220:223], a[244:247], v[120:123], v[220:223]
  v_mfma_f32_16x16x32_bf16 v[248:251], a[248:251], v[120:123], v[248:251]
  v_mfma_f32_16x16x32_bf16 v[252:255], a[252:255], v[120:123], v[252:255]
  s_add_u32 s45, s45, 8192
  s_cmp_lt_u32 s45, 262144
  s_cbranch_scc1 L1a_fb2
  s_add_u32 m0, s28, 16384
  s_add_u32 s38, s30, 0
  buffer_load_dwordx4 v7, s[12:15], s38 offen offset:0 sc1 lds
  s_add_u32 m0, s28, 16384
  s_add_u32 s38, s30, 0
  buffer_load_dwordx4 v8, s[12:15], s38 offen offset:1024 sc1 lds
  s_add_u32 m0, s28, 16384
  s_add_u32 s38, s30, 0
  buffer_load_dwordx4 v9, s[12:15], s38 offen offset:2048 sc1 lds
  s_add_u32 m0, s28, 16384
  s_add_u32 s38, s30, 0
  buffer_load_dwordx4 v10, s[12:15], s38 offen offset:3072 sc1 lds
  s_add_u32 m0, s28, 20480
  s_add_u32 s38, s30, 32768
  buffer_load_dwordx4 v7, s[12:15], s38 offen offset:0 sc1 lds
  s_add_u32 m0, s28, 20480
  s_add_u32 s38, s30, 32768
  buffer_load_dwordx4 v8, s[12:15], s38 offen offset:1024 sc1 lds
  s_add_u32 m0, s28, 20480
  s_add_u32 s38, s30, 32768
  buffer_load_dwordx4 v9, s[12:15], s38 offen offset:2048 sc1 lds
  s_add_u32 m0, s28, 20480
  s_add_u32 s38, s30, 32768
  buffer_load_dwordx4 v10, s[12:15], s38 offen offset:3072 sc1 lds
  s_add_u32 m0, s28, 0
  s_add_u32 s38, s30, 65536
  buffer_load_dwordx4 v7, s[12:15], s38 offen offset:0 sc1 lds
  s_add_u32 m0, s28, 0
  s_add_u32 s38, s30, 65536
  buffer_load_dwordx4 v8, s[12:15], s38 offen offset:1024 sc1 lds
  s_add_u32 m0, s28, 0
  s_add_u32 s38, s30, 65536
  buffer_load_dwordx4 v9, s[12:15], s38 offen offset:2048 sc1 lds
  s_add_u32 m0, s28, 0
  s_add_u32 s38, s30, 65536
  buffer_load_dwordx4 v10, s[12:15], s38 offen offset:3072 sc1 lds
  s_add_u32 m0, s28, 4096
  s_add_u32 s38, s30, 98304
  buffer_load_dwordx4 v7, s[12:15], s38 offen offset:0 sc1 lds
  s_add_u32 m0, s28, 4096
  s_add_u32 s38, s30, 98304
  buffer_load_dwordx4 v8, s[12:15], s38 offen offset:1024 sc1 lds
  s_add_u32 m0, s28, 4096
  s_add_u32 s38, s30, 98304
  buffer_load_dwordx4 v9, s[12:15], s38 offen offset:2048 sc1 lds
  s_add_u32 m0, s28, 4096
  s_add_u32 s38, s30, 98304
  buffer_load_dwordx4 v10, s[12:15], s38 offen offset:3072 sc1 lds
  s_waitcnt vmcnt(0)
  s_nop 7
  s_branch L1a_epi
L1_end:
  s_endpgm
L1_done:
  s_mov_b32 s49, 524288
L2_p1_c:
  v_min_u32 v24, v24, v25
  v_min3_u32 v24, v24, v26, v27
  s_nop 0
  v_readfirstlane_b32 s48, v24
  s_sub_u32 s49, s49, 1
  s_cbranch_scc1 L2_p1_go
  s_cmp_ge_u32 s48, 1
  s_cbranch_scc1 L2_p1_go
  s_sleep 2
  global_load_dwordx4 v[24:27], v11, s[98:99] sc1
  s_waitcnt vmcnt(0)
  s_branch L2_p1_c
L2_p1_go:
  s_cmp_eq_u32 s33, 1
  s_cbranch_scc1 L2b_start
  s_add_u32 s47, s29, 0
  buffer_load_dwordx4 a[16:19], v30, s[8:11], s47 offen offset:0 sc1
  buffer_load_dwordx4 a[20:23], v30, s[8:11], s47 offen offset:2048 sc1
  s_add_u32 s47, s29, 4096
  buffer_load_dwordx4 a[24:27], v30, s[8:11], s47 offen offset:0 sc1
  buffer_load_dwordx4 a[28:31], v30, s[8:11], s47 offen offset:2048 sc1
  s_add_u32 s47, s29, 8192
  buffer_load_dwordx4 a[48:51], v30, s[8:11], s47 offen offset:0 sc1
  buffer_load_dwordx4 a[52:55], v30, s[8:11], s47 offen offset:2048 sc1
  s_add_u32 s47, s29, 12288
  buffer_load_dwordx4 a[56:59], v30, s[8:11], s47 offen offset:0 sc1
  s_add_u32 s29, s29, 26624
  s_add_u32 s47, s29, 0
  buffer_load_dwordx4 a[60:63], v30, s[8:11], s47 offen offset:0 sc1
  buffer_load_dwordx4 a[80:83], v30, s[8:11], s47 offen offset:2048 sc1
  s_add_u32 s47, s29, 4096
  buffer_load_dwordx4 a[84:87], v30, s[8:11], s47 offen offset:0 sc1
  buffer_load_dwordx4 a[88:91], v30, s[8:11], s47 offen offset:2048 sc1
  s_add_u32 s47, s29, 8192
  buffer_load_dwordx4 a[92:95], v30, s[8:11], s47 offen offset:0 sc1
  buffer_load_dwordx4 a[112:115], v30, s[8:11], s47 offen offset:2048 sc1
  s_add_u32 s47, s29, 12288
  buffer_load_dwordx4 a[116:119], v30, s[8:11], s47 offen offset:0 sc1
  s_add_u32 s29, s29, 26624
  s_mul_i32 s46, s32, 425984
  s_add_u32 s16, s94, s46
  s_addc_u32 s17, s95, 0
  s_mov_b32 s18, 425984
  s_mov_b32 s19, 131072
  v_lshrrev_b32 v5, 2, v1
  v_lshlrev_b32 v13, 8, v5
  v_and_b32 v5, 7, v5
  v_lshl_add_u32 v13, v5, 5, v13
  v_and_b32 v5, 3, v1
  v_lshl_add_u32 v13, v5, 3, v13
  s_lshl_b32 s46, s3, 6
  v_xor_b32 v13, s46, v13
  v_add_u32 v13, s28, v13
  v_xor_b32 v14, 32, v13
  v_xor_b32 v15, 64, v13
  v_xor_b32 v16, 96, v13
  v_xor_b32 v17, 128, v13
  v_xor_b32 v18, 160, v13
  v_xor_b32 v19, 192, v13
  v_xor_b32 v20, 224, v13
  v_and_b32 v5, 15, v1
  v_lshlrev_b32 v21, 11, v5
  v_and_b32 v5, 1, v4
  v_lshl_add_u32 v21, v5, 5, v21
  v_lshrrev_b32 v5, 1, v4
  v_lshl_add_u32 v21, v5, 4, v21
  s_mul_i32 s48, s33, 229376
  s_lshl_b32 s49, s34, 8
  s_add_u32 s48, s48, s49
  s_lshl_b32 s49, s3, 6
  s_add_u32 s48, s48, s49
  v_add_u32 v21, s48, v21
  s_waitcnt vmcnt(7) lgkmcnt(0)
  v_mfma_f32_16x16x32_bf16 v[32:35], a[192:195], a[16:19], 0
  v_mfma_f32_16x16x32_bf16 v[60:63], a[196:199], a[16:19], 0
  v_mfma_f32_16x16x32_bf16 v[88:91], a[200:203], a[16:19], 0
  v_mfma_f32_16x16x32_bf16 v[116:119], a[204:207], a[16:19], 0
  v_mfma_f32_16x16x32_bf16 v[144:147], a[208:211], a[16:19], 0
  v_mfma_f32_16x16x32_bf16 v[172:175], a[212:215], a[16:19], 0
  v_mfma_f32_16x16x32_bf16 v[200:203], a[216:219], a[16:19], 0
  v_mfma_f32_16x16x32_bf16 v[228:231], a[220:223], a[16:19], 0
  v_mfma_f32_16x16x32_bf16 v[36:39], a[192:195], a[20:23], 0
  s_add_u32 s47, s29, 0
  buffer_load_dwordx4 a[16:19], v30, s[8:11], s47 offen offset:0 sc1
  v_mfma_f32_16x16x32_bf16 v[64:67], a[196:199], a[20:23], 0
  v_mfma_f32_16x16x32_bf16 v[92:95], a[200:203], a[20:23], 0
  v_mfma_f32_16x16x32_bf16 v[120:123], a[204:207], a[20:23], 0
  v_mfma_f32_16x16x32_bf16 v[148:151], a[208:211], a[20:23], 0
  v_mfma_f32_16x16x32_bf16 v[176:179], a[212:215], a[20:23], 0
  s_add_u32 s46, s54, 425984
  buffer_store_dwordx4 a[0:3], v30, s[24:27], s46 offen offset:0 sc1
  v_mfma_f32_16x16x32_bf16 v[204:207], a[216:219], a[20:23], 0
  v_mfma_f32_16x16x32_bf16 v[232:235], a[220:223], a[20:23], 0
  v_mfma_f32_16x16x32_bf16 v[40:43], a[192:195], a[24:27], 0
  buffer_load_dwordx4 a[20:23], v30, s[8:11], s47 offen offset:2048 sc1
  v_mfma_f32_16x16x32_bf16 v[68:71], a[196:199], a[24:27], 0
  v_mfma_f32_16x16x32_bf16 v[96:99], a[200:203], a[24:27], 0
  v_mfma_f32_16x16x32_bf16 v[124:127], a[204:207], a[24:27], 0
  v_mfma_f32_16x16x32_bf16 v[152:155], a[208:211], a[24:27], 0
  v_mfma_f32_16x16x32_bf16 v[180:183], a[212:215], a[24:27], 0
  v_mfma_f32_16x16x32_bf16 v[208:211], a[216:219], a[24:27], 0
  v_mfma_f32_16x16x32_bf16 v[236:239], a[220:223], a[24:27], 0
  v_mfma_f32_16x16x32_bf16 v[44:47], a[192:195], a[28:31], 0
  s_add_u32 s47, s29, 4096
  buffer_load_dwordx4 a[24:27], v30, s[8:11], s47 offen offset:0 sc1
  v_mfma_f32_16x16x32_bf16 v[72:75], a[196:199], a[28:31], 0
  v_mfma_f32_16x16x32_bf16 v[100:103], a[200:203], a[28:31], 0
  v_mfma_f32_16x16x32_bf16 v[128:131], a[204:207], a[28:31], 0
  v_mfma_f32_16x16x32_bf16 v[156:159], a[208:211], a[28:31], 0
  v_mfma_f32_16x16x32_bf16 v[184:187], a[212:215], a[28:31], 0
  v_mfma_f32_16x16x32_bf16 v[212:215], a[216:219], a[28:31], 0
  v_mfma_f32_16x16x32_bf16 v[240:243], a[220:223], a[28:31], 0
  v_mfma_f32_16x16x32_bf16 v[48:51], a[192:195], a[48:51], 0
  buffer_load_dwordx4 a[28:31], v30, s[8:11], s47 offen offset:2048 sc1
  v_mfma_f32_16x16x32_bf16 v[76:79], a[196:199], a[48:51], 0
  s_add_u32 s46, s54, 428032
  buffer_store_dwordx4 a[4:7], v30, s[24:27], s46 offen offset:0 sc1
  v_mfma_f32_16x16x32_bf16 v[104:107], a[200:203], a[48:51], 0
  v_mfma_f32_16x16x32_bf16 v[132:135], a[204:207], a[48:51], 0
  v_mfma_f32_16x16x32_bf16 v[160:163], a[208:211], a[48:51], 0
  v_mfma_f32_16x16x32_bf16 v[188:191], a[212:215], a[48:51], 0
  v_mfma_f32_16x16x32_bf16 v[216:219], a[216:219], a[48:51], 0
  v_mfma_f32_16x16x32_bf16 v[244:247], a[220:223], a[48:51], 0
  v_mfma_f32_16x16x32_bf16 v[52:55], a[192:195], a[52:55], 0
  s_add_u32 s47, s29, 8192
  buffer_load_dwordx4 a[48:51], v30, s[8:11], s47 offen offset:0 sc1
  v_mfma_f32_16x16x32_bf16 v[80:83], a[196:199], a[52:55], 0
  v_mfma_f32_16x16x32_bf16 v[108:111], a[200:203], a[52:55], 0
  v_mfma_f32_16x16x32_bf16 v[136:139], a[204:207], a[52:55], 0
  v_mfma_f32_16x16x32_bf16 v[164:167], a[208:211], a[52:55], 0
  v_mfma_f32_16x16x32_bf16 v[192:195], a[212:215], a[52:55], 0
  v_mfma_f32_16x16x32_bf16 v[220:223], a[216:219], a[52:55], 0
  v_mfma_f32_16x16x32_bf16 v[248:251], a[220:223], a[52:55], 0
  v_mfma_f32_16x16x32_bf16 v[56:59], a[192:195], a[56:59], 0
  buffer_load_dwordx4 a[52:55], v30, s[8:11], s47 offen offset:2048 sc1
  v_mfma_f32_16x16x32_bf16 v[84:87], a[196:199], a[56:59], 0
  v_mfma_f32_16x16x32_bf16 v[112:115], a[200:203], a[56:59], 0
  v_mfma_f32_16x16x32_bf16 v[140:143], a[204:207], a[56:59], 0
  v_mfma_f32_16x16x32_bf16 v[168:171], a[208:211], a[56:59], 0
  v_mfma_f32_16x16x32_bf16 v[196:199], a[212:215], a[56:59], 0
  v_mfma_f32_16x16x32_bf16 v[224:227], a[216:219], a[56:59], 0
  v_mfma_f32_16x16x32_bf16 v[252:255], a[220:223], a[56:59], 0
  s_add_u32 s47, s29, 12288
  buffer_load_dwordx4 a[56:59], v30, s[8:11], s47 offen offset:0 sc1
  s_add_u32 s29, s29, 26624
  s_waitcnt vmcnt(9) lgkmcnt(0)
  v_mfma_f32_16x16x32_bf16 v[32:35], a[224:227], a[60:63], v[32:35]
  v_mfma_f32_16x16x32_bf16 v[60:63], a[228:231], a[60:63], v[60:63]
  ds_read_b64_tr_b16 a[192:193], v13 offset:8192
  v_mfma_f32_16x16x32_bf16 v[88:91], a[232:235], a[60:63], v[88:91]
  v_mfma_f32_16x16x32_bf16 v[116:119], a[236:239], a[60:63], v[116:119]
  ds_read_b64_tr_b16 a[194:195], v13 offset:12288
  v_mfma_f32_16x16x32_bf16 v[144:147], a[240:243], a[60:63], v[144:147]
  v_mfma_f32_16x16x32_bf16 v[172:175], a[244:247], a[60:63], v[172:175]
  ds_read_b64_tr_b16 a[196:197], v14 offset:8192
  v_mfma_f32_16x16x32_bf16 v[200:203], a[248:251], a[60:63], v[200:203]
  v_mfma_f32_16x16x32_bf16 v[228:231], a[252:255], a[60:63], v[228:231]
  ds_read_b64_tr_b16 a[198:199], v14 offset:12288
  v_mfma_f32_16x16x32_bf16 v[36:39], a[224:227], a[80:83], v[36:39]
  s_add_u32 s47, s29, 0
  buffer_load_dwordx4 a[60:63], v30, s[8:11], s47 offen offset:0 sc1
  v_mfma_f32_16x16x32_bf16 v[64:67], a[228:231], a[80:83], v[64:67]
  ds_read_b64_tr_b16 a[200:201], v15 offset:8192
  v_mfma_f32_16x16x32_bf16 v[92:95], a[232:235], a[80:83], v[92:95]
  v_mfma_f32_16x16x32_bf16 v[120:123], a[236:239], a[80:83], v[120:123]
  ds_read_b64_tr_b16 a[202:203], v15 offset:12288
  v_mfma_f32_16x16x32_bf16 v[148:151], a[240:243], a[80:83], v[148:151]
  v_mfma_f32_16x16x32_bf16 v[176:179], a[244:247], a[80:83], v[176:179]
  s_add_u32 s46, s54, 430080
  ds_read_b64_tr_b16 a[204:205], v16 offset:8192
  buffer_store_dwordx4 a[8:11], v30, s[24:27], s46 offen offset:0 sc1
  v_mfma_f32_16x16x32_bf16 v[204:207], a[248:251], a[80:83], v[204:207]
  v_mfma_f32_16x16x32_bf16 v[232:235], a[252:255], a[80:83], v[232:235]
  ds_read_b64_tr_b16 a[206:207], v16 offset:12288
  v_mfma_f32_16x16x32_bf16 v[40:43], a[224:227], a[84:87], v[40:43]
  buffer_load_dwordx4 a[80:83], v30, s[8:11], s47 offen offset:2048 sc1
  v_mfma_f32_16x16x32_bf16 v[68:71], a[228:231], a[84:87], v[68:71]
  ds_read_b64_tr_b16 a[208:209], v17 offset:8192
  v_mfma_f32_16x16x32_bf16 v[96:99], a[232:235], a[84:87], v[96:99]
  v_mfma_f32_16x16x32_bf16 v[124:127], a[236:239], a[84:87], v[124:127]
  ds_read_b64_tr_b16 a[210:211], v17 offset:12288
  v_mfma_f32_16x16x32_bf16 v[152:155], a[240:243], a[84:87], v[152:155]
  v_mfma_f32_16x16x32_bf16 v[180:183], a[244:247], a[84:87], v[180:183]
  ds_read_b64_tr_b16 a[212:213], v18 offset:8192
  v_mfma_f32_16x16x32_bf16 v[208:211], a[248:251], a[84:87], v[208:211]
  v_mfma_f32_16x16x32_bf16 v[236:239], a[252:255], a[84:87], v[236:239]
  ds_read_b64_tr_b16 a[214:215], v18 offset:12288
  v_mfma_f32_16x16x32_bf16 v[44:47], a[224:227], a[88:91], v[44:47]
  s_add_u32 s47, s29, 4096
  buffer_load_dwordx4 a[84:87], v30, s[8:11], s47 offen offset:0 sc1
  v_mfma_f32_16x16x32_bf16 v[72:75], a[228:231], a[88:91], v[72:75]
  ds_read_b64_tr_b16 a[216:217], v19 offset:8192
  v_mfma_f32_16x16x32_bf16 v[100:103], a[232:235], a[88:91], v[100:103]
  v_mfma_f32_16x16x32_bf16 v[128:131], a[236:239], a[88:91], v[128:131]
  ds_read_b64_tr_b16 a[218:219], v19 offset:12288
  v_mfma_f32_16x16x32_bf16 v[156:159], a[240:243], a[88:91], v[156:159]
  v_mfma_f32_16x16x32_bf16 v[184:187], a[244:247], a[88:91], v[184:187]
  ds_read_b64_tr_b16 a[220:221], v20 offset:8192
  v_mfma_f32_16x16x32_bf16 v[212:215], a[248:251], a[88:91], v[212:215]
  v_mfma_f32_16x16x32_bf16 v[240:243], a[252:255], a[88:91], v[240:243]
  s_waitcnt lgkmcnt(8)
  ds_read_b64_tr_b16 a[222:223], v20 offset:12288
  v_mfma_f32_16x16x32_bf16 v[48:51], a[224:227], a[92:95], v[48:51]
  buffer_load_dwordx4 a[88:91], v30, s[8:11], s47 offen offset:2048 sc1
  v_mfma_f32_16x16x32_bf16 v[76:79], a[228:231], a[92:95], v[76:79]
  s_add_u32 s46, s54, 432128
  buffer_store_dwordx4 a[12:15], v30, s[24:27], s46 offen offset:0 sc1
  v_mfma_f32_16x16x32_bf16 v[104:107], a[232:235], a[92:95], v[104:107]
  v_mfma_f32_16x16x32_bf16 v[132:135], a[236:239], a[92:95], v[132:135]
  v_mfma_f32_16x16x32_bf16 v[160:163], a[240:243], a[92:95], v[160:163]
  v_mfma_f32_16x16x32_bf16 v[188:191], a[244:247], a[92:95], v[188:191]
  v_mfma_f32_16x16x32_bf16 v[216:219], a[248:251], a[92:95], v[216:219]
  v_mfma_f32_16x16x32_bf16 v[244:247], a[252:255], a[92:95], v[244:247]
  v_mfma_f32_16x16x32_bf16 v[52:55], a[224:227], a[112:115], v[52:55]
  s_add_u32 s47, s29, 8192
  buffer_load_dwordx4 a[92:95], v30, s[8:11], s47 offen offset:0 sc1
  v_mfma_f32_16x16x32_bf16 v[80:83], a[228:231], a[112:115], v[80:83]
  v_mfma_f32_16x16x32_bf16 v[108:111], a[232:235], a[112:115], v[108:111]
  v_mfma_f32_16x16x32_bf16 v[136:139], a[236:239], a[112:115], v[136:139]
  v_mfma_f32_16x16x32_bf16 v[164:167], a[240:243], a[112:115], v[164:167]
  v_mfma_f32_16x16x32_bf16 v[192:195], a[244:247], a[112:115], v[192:195]
  v_mfma_f32_16x16x32_bf16 v[220:223], a[248:251], a[112:115], v[220:223]
  v_mfma_f32_16x16x32_bf16 v[248:251], a[252:255], a[112:115], v[248:251]
  v_mfma_f32_16x16x32_bf16 v[56:59], a[224:227], a[116:119], v[56:59]
  buffer_load_dwordx4 a[112:115], v30, s[8:11], s47 offen offset:2048 sc1
  v_mfma_f32_16x16x32_bf16 v[84:87], a[228:231], a[116:119], v[84:87]
  v_mfma_f32_16x16x32_bf16 v[112:115], a[232:235], a[116:119], v[112:115]
  v_mfma_f32_16x16x32_bf16 v[140:143], a[236:239], a[116:119], v[140:143]
  v_mfma_f32_16x16x32_bf16 v[168:171], a[240:243], a[116:119], v[168:171]
  v_mfma_f32_16x16x32_bf16 v[196:199], a[244:247], a[116:119], v[196:199]
  v_mfma_f32_16x16x32_bf16 v[224:227], a[248:251], a[116:119], v[224:227]
  v_mfma_f32_16x16x32_bf16 v[252:255], a[252:255], a[116:119], v[252:255]
  s_add_u32 s47, s29, 12288
  buffer_load_dwordx4 a[116:119], v30, s[8:11], s47 offen offset:0 sc1
  s_add_u32 s29, s29, 26624
  s_waitcnt vmcnt(9) lgkmcnt(0)
  v_mfma_f32_16x16x32_bf16 v[32:35], a[192:195], a[16:19], v[32:35]
  v_mfma_f32_16x16x32_bf16 v[60:63], a[196:199], a[16:19], v[60:63]
  ds_read_b64_tr_b16 a[224:225], v13 offset:24576
  v_mfma_f32_16x16x32_bf16 v[88:91], a[200:203], a[16:19], v[88:91]
  v_mfma_f32_16x16x32_bf16 v[116:119], a[204:207], a[16:19], v[116:119]
  ds_read_b64_tr_b16 a[226:227], v13 offset:28672
  v_mfma_f32_16x16x32_bf16 v[144:147], a[208:211], a[16:19], v[144:147]
  s_add_u32 m0, s28, 8192
  s_add_u32 s38, s36, 0
  buffer_load_dwordx4 v7, s[12:15], s38 offen offset:0 sc1 lds
  v_mfma_f32_16x16x32_bf16 v[172:175], a[212:215], a[16:19], v[172:175]
  ds_read_b64_tr_b16 a[228:229], v14 offset:24576
  v_mfma_f32_16x16x32_bf16 v[200:203], a[216:219], a[16:19], v[200:203]
  v_mfma_f32_16x16x32_bf16 v[228:231], a[220:223], a[16:19], v[228:231]
  ds_read_b64_tr_b16 a[230:231], v14 offset:28672
  v_mfma_f32_16x16x32_bf16 v[36:39], a[192:195], a[20:23], v[36:39]
  s_add_u32 s47, s29, 0
  buffer_load_dwordx4 a[16:19], v30, s[8:11], s47 offen offset:0 sc1
  v_mfma_f32_16x16x32_bf16 v[64:67], a[196:199], a[20:23], v[64:67]
  ds_read_b64_tr_b16 a[232:233], v15 offset:24576
  v_mfma_f32_16x16x32_bf16 v[92:95], a[200:203], a[20:23], v[92:95]
  buffer_load_dwordx4 v8, s[12:15], s38 offen offset:1024 sc1 lds
  v_mfma_f32_16x16x32_bf16 v[120:123], a[204:207], a[20:23], v[120:123]
  ds_read_b64_tr_b16 a[234:235], v15 offset:28672
  v_mfma_f32_16x16x32_bf16 v[148:151], a[208:211], a[20:23], v[148:151]
  v_mfma_f32_16x16x32_bf16 v[176:179], a[212:215], a[20:23], v[176:179]
  s_add_u32 s46, s54, 434176
  ds_read_b64_tr_b16 a[236:237], v16 offset:24576
  buffer_store_dwordx4 a[32:35], v30, s[24:27], s46 offen offset:0 sc1
  v_mfma_f32_16x16x32_bf16 v[204:207], a[216:219], a[20:23], v[204:207]
  v_mfma_f32_16x16x32_bf16 v[232:235], a[220:223], a[20:23], v[232:235]
  ds_read_b64_tr_b16 a[238:239], v16 offset:28672
  v_mfma_f32_16x16x32_bf16 v[40:43], a[192:195], a[24:27], v[40:43]
  buffer_load_dwordx4 a[20:23], v30, s[8:11], s47 offen offset:2048 sc1
  v_mfma_f32_16x16x32_bf16 v[68:71], a[196:199], a[24:27], v[68:71]
  ds_read_b64_tr_b16 a[240:241], v17 offset:24576
  v_mfma_f32_16x16x32_bf16 v[96:99], a[200:203], a[24:27], v[96:99]
  buffer_load_dwordx4 v9, s[12:15], s38 offen offset:2048 sc1 lds
  v_mfma_f32_16x16x32_bf16 v[124:127], a[204:207], a[24:27], v[124:127]
  ds_read_b64_tr_b16 a[242:243], v17 offset:28672
  v_mfma_f32_16x16x32_bf16 v[152:155], a[208:211], a[24:27], v[152:155]
  v_mfma_f32_16x16x32_bf16 v[180:183], a[212:215], a[24:27], v[180:183]
  ds_read_b64_tr_b16 a[244:245], v18 offset:24576
  v_mfma_f32_16x16x32_bf16 v[208:211], a[216:219], a[24:27], v[208:211]
  buffer_load_dwordx4 v10, s[12:15], s38 offen offset:3072 sc1 lds
  v_mfma_f32_16x16x32_bf16 v[236:239], a[220:223], a[24:27], v[236:239]
  ds_read_b64_tr_b16 a[246:247], v18 offset:28672
  v_mfma_f32_16x16x32_bf16 v[44:47], a[192:195], a[28:31], v[44:47]
  s_add_u32 s47, s29, 4096
  buffer_load_dwordx4 a[24:27], v30, s[8:11], s47 offen offset:0 sc1
  v_mfma_f32_16x16x32_bf16 v[72:75], a[196:199], a[28:31], v[72:75]
  ds_read_b64_tr_b16 a[248:249], v19 offset:24576
  v_mfma_f32_16x16x32_bf16 v[100:103], a[200:203], a[28:31], v[100:103]
  v_mfma_f32_16x16x32_bf16 v[128:131], a[204:207], a[28:31], v[128:131]
  ds_read_b64_tr_b16 a[250:251], v19 offset:28672
  v_mfma_f32_16x16x32_bf16 v[156:159], a[208:211], a[28:31], v[156:159]
  s_add_u32 m0, s28, 12288
  s_add_u32 s38, s36, 32768
  buffer_load_dwordx4 v7, s[12:15], s38 offen offset:0 sc1 lds
  v_mfma_f32_16x16x32_bf16 v[184:187], a[212:215], a[28:31], v[184:187]
  s_add_u32 s35, s35, 1
  ds_read_b64_tr_b16 a[252:253], v20 offset:24576
  v_mfma_f32_16x16x32_bf16 v[212:215], a[216:219], a[28:31], v[212:215]
  s_and_b32 s48, s35, 14
  v_mfma_f32_16x16x32_bf16 v[240:243], a[220:223], a[28:31], v[240:243]
  s_waitcnt lgkmcnt(8)
  s_lshl_b32 s48, s48, 17
  ds_read_b64_tr_b16 a[254:255], v20 offset:28672
  v_mfma_f32_16x16x32_bf16 v[48:51], a[192:195], a[48:51], v[48:51]
  s_add_u32 s36, s30, s48
  buffer_load_dwordx4 a[28:31], v30, s[8:11], s47 offen offset:2048 sc1
  v_mfma_f32_16x16x32_bf16 v[76:79], a[196:199], a[48:51], v[76:79]
  s_add_u32 s46, s54, 436224
  s_and_b32 s48, s35, 16
  buffer_store_dwordx4 a[36:39], v30, s[24:27], s46 offen offset:0 sc1
  v_mfma_f32_16x16x32_bf16 v[104:107], a[200:203], a[48:51], v[104:107]
  s_lshl_b32 s48, s48, 13
  buffer_load_dwordx4 v8, s[12:15], s38 offen offset:1024 sc1 lds
  v_mfma_f32_16x16x32_bf16 v[132:135], a[204:207], a[48:51], v[132:135]
  s_add_u32 s36, s36, s48
  v_mfma_f32_16x16x32_bf16 v[160:163], a[208:211], a[48:51], v[160:163]
  s_and_b32 s48, s35, 1
  v_mfma_f32_16x16x32_bf16 v[188:191], a[212:215], a[48:51], v[188:191]
  s_lshl_b32 s48, s48, 16
  v_mfma_f32_16x16x32_bf16 v[216:219], a[216:219], a[48:51], v[216:219]
  s_add_u32 s36, s36, s48
  v_mfma_f32_16x16x32_bf16 v[244:247], a[220:223], a[48:51], v[244:247]
  v_mfma_f32_16x16x32_bf16 v[52:55], a[192:195], a[52:55], v[52:55]
  s_add_u32 s47, s29, 8192
  buffer_load_dwordx4 a[48:51], v30, s[8:11], s47 offen offset:0 sc1
  v_mfma_f32_16x16x32_bf16 v[80:83], a[196:199], a[52:55], v[80:83]
  v_mfma_f32_16x16x32_bf16 v[108:111], a[200:203], a[52:55], v[108:111]
  buffer_load_dwordx4 v9, s[12:15], s38 offen offset:2048 sc1 lds
  v_mfma_f32_16x16x32_bf16 v[136:139], a[204:207], a[52:55], v[136:139]
  v_mfma_f32_16x16x32_bf16 v[164:167], a[208:211], a[52:55], v[164:167]
  v_mfma_f32_16x16x32_bf16 v[192:195], a[212:215], a[52:55], v[192:195]
  v_mfma_f32_16x16x32_bf16 v[220:223], a[216:219], a[52:55], v[220:223]
  buffer_load_dwordx4 v10, s[12:15], s38 offen offset:3072 sc1 lds
  v_mfma_f32_16x16x32_bf16 v[248:251], a[220:223], a[52:55], v[248:251]
  v_mfma_f32_16x16x32_bf16 v[56:59], a[192:195], a[56:59], v[56:59]
  buffer_load_dwordx4 a[52:55], v30, s[8:11], s47 offen offset:2048 sc1
  v_mfma_f32_16x16x32_bf16 v[84:87], a[196:199], a[56:59], v[84:87]
  v_mfma_f32_16x16x32_bf16 v[112:115], a[200:203], a[56:59], v[112:115]
  v_mfma_f32_16x16x32_bf16 v[140:143], a[204:207], a[56:59], v[140:143]
  v_mfma_f32_16x16x32_bf16 v[168:171], a[208:211], a[56:59], v[168:171]
  v_mfma_f32_16x16x32_bf16 v[196:199], a[212:215], a[56:59], v[196:199]
  v_mfma_f32_16x16x32_bf16 v[224:227], a[216:219], a[56:59], v[224:227]
  v_mfma_f32_16x16x32_bf16 v[252:255], a[220:223], a[56:59], v[252:255]
  s_add_u32 s47, s29, 12288
  buffer_load_dwordx4 a[56:59], v30, s[8:11], s47 offen offset:0 sc1
  s_add_u32 s29, s29, 26624
  s_waitcnt vmcnt(17) lgkmcnt(0)
  v_mfma_f32_16x16x32_bf16 v[32:35], a[224:227], a[60:63], v[32:35]
  v_mfma_f32_16x16x32_bf16 v[60:63], a[228:231], a[60:63], v[60:63]
  ds_read_b64_tr_b16 a[192:193], v13 offset:16384
  v_mfma_f32_16x16x32_bf16 v[88:91], a[232:235], a[60:63], v[88:91]
  v_mfma_f32_16x16x32_bf16 v[116:119], a[236:239], a[60:63], v[116:119]
  ds_read_b64_tr_b16 a[194:195], v13 offset:20480
  v_mfma_f32_16x16x32_bf16 v[144:147], a[240:243], a[60:63], v[144:147]
  s_add_u32 m0, s28, 24576
  s_add_u32 s38, s36, 0
  buffer_load_dwordx4 v7, s[12:15], s38 offen offset:0 sc1 lds
  v_mfma_f32_16x16x32_bf16 v[172:175], a[244:247], a[60:63], v[172:175]
  ds_read_b64_tr_b16 a[196:197], v14 offset:16384
  v_mfma_f32_16x16x32_bf16 v[200:203], a[248:251], a[60:63], v[200:203]
  v_mfma_f32_16x16x32_bf16 v[228:231], a[252:255], a[60:63], v[228:231]
  ds_read_b64_tr_b16 a[198:199], v14 offset:20480
  v_mfma_f32_16x16x32_bf16 v[36:39], a[224:227], a[80:83], v[36:39]
  s_add_u32 s47, s29, 0
  buffer_load_dwordx4 a[60:63], v30, s[8:11], s47 offen offset:0 sc1
  v_mfma_f32_16x16x32_bf16 v[64:67], a[228:231], a[80:83], v[64:67]
  ds_read_b64_tr_b16 a[200:201], v15 offset:16384
  v_mfma_f32_16x16x32_bf16 v[92:95], a[232:235], a[80:83], v[92:95]
  buffer_load_dwordx4 v8, s[12:15], s38 offen offset:1024 sc1 lds
  v_mfma_f32_16x16x32_bf16 v[120:123], a[236:239], a[80:83], v[120:123]
  ds_read_b64_tr_b16 a[202:203], v15 offset:20480
  v_mfma_f32_16x16x32_bf16 v[148:151], a[240:243], a[80:83], v[148:151]
  v_mfma_f32_16x16x32_bf16 v[176:179], a[244:247], a[80:83], v[176:179]
  s_add_u32 s46, s44, 438272
  ds_read_b64_tr_b16 a[204:205], v16 offset:16384
  buffer_store_dwordx4 a[40:43], v30, s[24:27], s46 offen offset:0 sc1
  v_mfma_f32_16x16x32_bf16 v[204:207], a[248:251], a[80:83], v[204:207]
  v_mfma_f32_16x16x32_bf16 v[232:235], a[252:255], a[80:83], v[232:235]
  ds_read_b64_tr_b16 a[206:207], v16 offset:20480
  v_mfma_f32_16x16x32_bf16 v[40:43], a[224:227], a[84:87], v[40:43]
  buffer_load_dwordx4 a[80:83], v30, s[8:11], s47 offen offset:2048 sc1
  v_mfma_f32_16x16x32_bf16 v[68:71], a[228:231], a[84:87], v[68:71]
  ds_read_b64_tr_b16 a[208:209], v17 offset:16384
  v_mfma_f32_16x16x32_bf16 v[96:99], a[232:235], a[84:87], v[96:99]
  buffer_load_dwordx4 v9, s[12:15], s38 offen offset:2048 sc1 lds
  v_mfma_f32_16x16x32_bf16 v[124:127], a[236:239], a[84:87], v[124:127]
  ds_read_b64_tr_b16 a[210:211], v17 offset:20480
  v_mfma_f32_16x16x32_bf16 v[152:155], a[240:243], a[84:87], v[152:155]
  v_mfma_f32_16x16x32_bf16 v[180:183], a[244:247], a[84:87], v[180:183]
  ds_read_b64_tr_b16 a[212:213], v18 offset:16384
  v_mfma_f32_16x16x32_bf16 v[208:211], a[248:251], a[84:87], v[208:211]
  buffer_load_dwordx4 v10, s[12:15], s38 offen offset:3072 sc1 lds
  v_mfma_f32_16x16x32_bf16 v[236:239], a[252:255], a[84:87], v[236:239]
  ds_read_b64_tr_b16 a[214:215], v18 offset:20480
  v_mfma_f32_16x16x32_bf16 v[44:47], a[224:227], a[88:91], v[44:47]
  s_add_u32 s47, s29, 4096
  buffer_load_dwordx4 a[84:87], v30, s[8:11], s47 offen offset:0 sc1
  v_mfma_f32_16x16x32_bf16 v[72:75], a[228:231], a[88:91], v[72:75]
  ds_read_b64_tr_b16 a[216:217], v19 offset:16384
  v_mfma_f32_16x16x32_bf16 v[100:103], a[232:235], a[88:91], v[100:103]
  v_mfma_f32_16x16x32_bf16 v[128:131], a[236:239], a[88:91], v[128:131]
  ds_read_b64_tr_b16 a[218:219], v19 offset:20480
  v_mfma_f32_16x16x32_bf16 v[156:159], a[240:243], a[88:91], v[156:159]
  s_add_u32 m0, s28, 28672
  s_add_u32 s38, s36, 32768
  buffer_load_dwordx4 v7, s[12:15], s38 offen offset:0 sc1 lds
  v_mfma_f32_16x16x32_bf16 v[184:187], a[244:247], a[88:91], v[184:187]
  s_add_u32 s35, s35, 1
  ds_read_b64_tr_b16 a[220:221], v20 offset:16384
  v_mfma_f32_16x16x32_bf16 v[212:215], a[248:251], a[88:91], v[212:215]
  s_and_b32 s48, s35, 14
  v_mfma_f32_16x16x32_bf16 v[240:243], a[252:255], a[88:91], v[240:243]
  s_waitcnt lgkmcnt(8)
  s_lshl_b32 s48, s48, 17
  ds_read_b64_tr_b16 a[222:223], v20 offset:20480
  v_mfma_f32_16x16x32_bf16 v[48:51], a[224:227], a[92:95], v[48:51]
  s_add_u32 s36, s30, s48
  buffer_load_dwordx4 a[88:91], v30, s[8:11], s47 offen offset:2048 sc1
  v_mfma_f32_16x16x32_bf16 v[76:79], a[228:231], a[92:95], v[76:79]
  s_add_u32 s46, s54, 452608
  s_and_b32 s48, s35, 16
  buffer_store_dwordx4 a[44:47], v30, s[24:27], s46 offen offset:0 sc1
  v_mfma_f32_16x16x32_bf16 v[104:107], a[232:235], a[92:95], v[104:107]
  s_lshl_b32 s48, s48, 13
  buffer_load_dwordx4 v8, s[12:15], s38 offen offset:1024 sc1 lds
  v_mfma_f32_16x16x32_bf16 v[132:135], a[236:239], a[92:95], v[132:135]
  s_add_u32 s36, s36, s48
  v_mfma_f32_16x16x32_bf16 v[160:163], a[240:243], a[92:95], v[160:163]
  s_and_b32 s48, s35, 1
  v_mfma_f32_16x16x32_bf16 v[188:191], a[244:247], a[92:95], v[188:191]
  s_lshl_b32 s48, s48, 16
  v_mfma_f32_16x16x32_bf16 v[216:219], a[248:251], a[92:95], v[216:219]
  s_add_u32 s36, s36, s48
  v_mfma_f32_16x16x32_bf16 v[244:247], a[252:255], a[92:95], v[244:247]
  v_mfma_f32_16x16x32_bf16 v[52:55], a[224:227], a[112:115], v[52:55]
  s_add_u32 s47, s29, 8192
  buffer_load_dwordx4 a[92:95], v30, s[8:11], s47 offen offset:0 sc1
  v_mfma_f32_16x16x32_bf16 v[80:83], a[228:231], a[112:115], v[80:83]
  v_mfma_f32_16x16x32_bf16 v[108:111], a[232:235], a[112:115], v[108:111]
  buffer_load_dwordx4 v9, s[12:15], s38 offen offset:2048 sc1 lds
  v_mfma_f32_16x16x32_bf16 v[136:139], a[236:239], a[112:115], v[136:139]
  v_mfma_f32_16x16x32_bf16 v[164:167], a[240:243], a[112:115], v[164:167]
  v_mfma_f32_16x16x32_bf16 v[192:195], a[244:247], a[112:115], v[192:195]
  v_mfma_f32_16x16x32_bf16 v[220:223], a[248:251], a[112:115], v[220:223]
  buffer_load_dwordx4 v10, s[12:15], s38 offen offset:3072 sc1 lds
  v_mfma_f32_16x16x32_bf16 v[248:251], a[252:255], a[112:115], v[248:251]
  v_mfma_f32_16x16x32_bf16 v[56:59], a[224:227], a[116:119], v[56:59]
  buffer_load_dwordx4 a[112:115], v30, s[8:11], s47 offen offset:2048 sc1
  v_mfma_f32_16x16x32_bf16 v[84:87], a[228:231], a[116:119], v[84:87]
  v_mfma_f32_16x16x32_bf16 v[112:115], a[232:235], a[116:119], v[112:115]
  v_mfma_f32_16x16x32_bf16 v[140:143], a[236:239], a[116:119], v[140:143]
  v_mfma_f32_16x16x32_bf16 v[168:171], a[240:243], a[116:119], v[168:171]
  v_mfma_f32_16x16x32_bf16 v[196:199], a[244:247], a[116:119], v[196:199]
  v_mfma_f32_16x16x32_bf16 v[224:227], a[248:251], a[116:119], v[224:227]
  v_mfma_f32_16x16x32_bf16 v[252:255], a[252:255], a[116:119], v[252:255]
  s_add_u32 s47, s29, 12288
  buffer_load_dwordx4 a[116:119], v30, s[8:11], s47 offen offset:0 sc1
  s_add_u32 s29, s29, 26624
  s_waitcnt vmcnt(17) lgkmcnt(0)
  v_mfma_f32_16x16x32_bf16 v[32:35], a[192:195], a[16:19], v[32:35]
  v_mfma_f32_16x16x32_bf16 v[60:63], a[196:199], a[16:19], v[60:63]
  ds_read_b64_tr_b16 a[224:225], v13 offset:0
  v_mfma_f32_16x16x32_bf16 v[88:91], a[200:203], a[16:19], v[88:91]
  v_mfma_f32_16x16x32_bf16 v[116:119], a[204:207], a[16:19], v[116:119]
  ds_read_b64_tr_b16 a[226:227], v13 offset:4096
  v_mfma_f32_16x16x32_bf16 v[144:147], a[208:211], a[16:19], v[144:147]
  s_add_u32 m0, s28, 16384
  s_add_u32 s38, s36, 0
  buffer_load_dwordx4 v7, s[12:15], s38 offen offset:0 sc1 lds
  v_mfma_f32_16x16x32_bf16 v[172:175], a[212:215], a[16:19], v[172:175]
  ds_read_b64_tr_b16 a[228:229], v14 offset:0
  v_mfma_f32_16x16x32_bf16 v[200:203], a[216:219], a[16:19], v[200:203]
  v_mfma_f32_16x16x32_bf16 v[228:231], a[220:223], a[16:19], v[228:231]
  ds_read_b64_tr_b16 a[230:231], v14 offset:4096
  v_mfma_f32_16x16x32_bf16 v[36:39], a[192:195], a[20:23], v[36:39]
  s_add_u32 s47, s29, 0
  buffer_load_dwordx4 a[16:19], v30, s[8:11], s47 offen offset:0 sc1
  v_mfma_f32_16x16x32_bf16 v[64:67], a[196:199], a[20:23], v[64:67]
  ds_read_b64_tr_b16 a[232:233], v15 offset:0
  v_mfma_f32_16x16x32_bf16 v[92:95], a[200:203], a[20:23], v[92:95]
  buffer_load_dwordx4 v8, s[12:15], s38 offen offset:1024 sc1 lds
  v_mfma_f32_16x16x32_bf16 v[120:123], a[204:207], a[20:23], v[120:123]
  ds_read_b64_tr_b16 a[234:235], v15 offset:4096
  v_mfma_f32_16x16x32_bf16 v[148:151], a[208:211], a[20:23], v[148:151]
  v_mfma_f32_16x16x32_bf16 v[176:179], a[212:215], a[20:23], v[176:179]
  s_add_u32 s46, s54, 454656
  ds_read_b64_tr_b16 a[236:237], v16 offset:0
  buffer_store_dwordx4 a[64:67], v30, s[24:27], s46 offen offset:0 sc1
  v_mfma_f32_16x16x32_bf16 v[204:207], a[216:219], a[20:23], v[204:207]
  v_mfma_f32_16x16x32_bf16 v[232:235], a[220:223], a[20:23], v[232:235]
  ds_read_b64_tr_b16 a[238:239], v16 offset:4096
  v_mfma_f32_16x16x32_bf16 v[40:43], a[192:195], a[24:27], v[40:43]
  buffer_load_dwordx4 a[20:23], v30, s[8:11], s47 offen offset:2048 sc1
  v_mfma_f32_16x16x32_bf16 v[68:71], a[196:199], a[24:27], v[68:71]
  ds_read_b64_tr_b16 a[240:241], v17 offset:0
  v_mfma_f32_16x16x32_bf16 v[96:99], a[200:203], a[24:27], v[96:99]
  buffer_load_dwordx4 v9, s[12:15], s38 offen offset:2048 sc1 lds
  v_mfma_f32_16x16x32_bf16 v[124:127], a[204:207], a[24:27], v[124:127]
  ds_read_b64_tr_b16 a[242:243], v17 offset:4096
  v_mfma_f32_16x16x32_bf16 v[152:155], a[208:211], a[24:27], v[152:155]
  v_mfma_f32_16x16x32_bf16 v[180:183], a[212:215], a[24:27], v[180:183]
  ds_read_b64_tr_b16 a[244:245], v18 offset:0
  v_mfma_f32_16x16x32_bf16 v[208:211], a[216:219], a[24:27], v[208:211]
  buffer_load_dwordx4 v10, s[12:15], s38 offen offset:3072 sc1 lds
  v_mfma_f32_16x16x32_bf16 v[236:239], a[220:223], a[24:27], v[236:239]
  ds_read_b64_tr_b16 a[246:247], v18 offset:4096
  v_mfma_f32_16x16x32_bf16 v[44:47], a[192:195], a[28:31], v[44:47]
  s_add_u32 s47, s29, 4096
  buffer_load_dwordx4 a[24:27], v30, s[8:11], s47 offen offset:0 sc1
  v_mfma_f32_16x16x32_bf16 v[72:75], a[196:199], a[28:31], v[72:75]
  ds_read_b64_tr_b16 a[248:249], v19 offset:0
  v_mfma_f32_16x16x32_bf16 v[100:103], a[200:203], a[28:31], v[100:103]
  v_mfma_f32_16x16x32_bf16 v[128:131], a[204:207], a[28:31], v[128:131]
  ds_read_b64_tr_b16 a[250:251], v19 offset:4096
  v_mfma_f32_16x16x32_bf16 v[156:159], a[208:211], a[28:31], v[156:159]
  s_add_u32 m0, s28, 20480
  s_add_u32 s38, s36, 32768
  buffer_load_dwordx4 v7, s[12:15], s38 offen offset:0 sc1 lds
  v_mfma_f32_16x16x32_bf16 v[184:187], a[212:215], a[28:31], v[184:187]
  s_add_u32 s35, s35, 1
  ds_read_b64_tr_b16 a[252:253], v20 offset:0
  v_mfma_f32_16x16x32_bf16 v[212:215], a[216:219], a[28:31], v[212:215]
  s_and_b32 s48, s35, 14
  v_mfma_f32_16x16x32_bf16 v[240:243], a[220:223], a[28:31], v[240:243]
  s_waitcnt lgkmcnt(8)
  s_lshl_b32 s48, s48, 17
  ds_read_b64_tr_b16 a[254:255], v20 offset:4096
  v_mfma_f32_16x16x32_bf16 v[48:51], a[192:195], a[48:51], v[48:51]
  s_add_u32 s36, s30, s48
  buffer_load_dwordx4 a[28:31], v30, s[8:11], s47 offen offset:2048 sc1
  v_mfma_f32_16x16x32_bf16 v[76:79], a[196:199], a[48:51], v[76:79]
  s_add_u32 s46, s54, 456704
  s_and_b32 s48, s35, 16
  buffer_store_dwordx4 a[68:71], v30, s[24:27], s46 offen offset:0 sc1
  v_mfma_f32_16x16x32_bf16 v[104:107], a[200:203], a[48:51], v[104:107]
  s_lshl_b32 s48, s48, 13
  buffer_load_dwordx4 v8, s[12:15], s38 offen offset:1024 sc1 lds
  v_mfma_f32_16x16x32_bf16 v[132:135], a[204:207], a[48:51], v[132:135]
  s_add_u32 s36, s36, s48
  v_mfma_f32_16x16x32_bf16 v[160:163], a[208:211], a[48:51], v[160:163]
  s_and_b32 s48, s35, 1
  v_mfma_f32_16x16x32_bf16 v[188:191], a[212:215], a[48:51], v[188:191]
  s_lshl_b32 s48, s48, 16
  v_mfma_f32_16x16x32_bf16 v[216:219], a[216:219], a[48:51], v[216:219]
  s_add_u32 s36, s36, s48
  v_mfma_f32_16x16x32_bf16 v[244:247], a[220:223], a[48:51], v[244:247]
  v_mfma_f32_16x16x32_bf16 v[52:55], a[192:195], a[52:55], v[52:55]
  s_add_u32 s47, s29, 8192
  buffer_load_dwordx4 a[48:51], v30, s[8:11], s47 offen offset:0 sc1
  v_mfma_f32_16x16x32_bf16 v[80:83], a[196:199], a[52:55], v[80:83]
  v_mfma_f32_16x16x32_bf16 v[108:111], a[200:203], a[52:55], v[108:111]
  buffer_load_dwordx4 v9, s[12:15], s38 offen offset:2048 sc1 lds
  v_mfma_f32_16x16x32_bf16 v[136:139], a[204:207], a[52:55], v[136:139]
  v_mfma_f32_16x16x32_bf16 v[164:167], a[208:211], a[52:55], v[164:167]
  v_mfma_f32_16x16x32_bf16 v[192:195], a[212:215], a[52:55], v[192:195]
  v_mfma_f32_16x16x32_bf16 v[220:223], a[216:219], a[52:55], v[220:223]
  buffer_load_dwordx4 v10, s[12:15], s38 offen offset:3072 sc1 lds
  v_mfma_f32_16x16x32_bf16 v[248:251], a[220:223], a[52:55], v[248:251]
  v_mfma_f32_16x16x32_bf16 v[56:59], a[192:195], a[56:59], v[56:59]
  buffer_load_dwordx4 a[52:55], v30, s[8:11], s47 offen offset:2048 sc1
  v_mfma_f32_16x16x32_bf16 v[84:87], a[196:199], a[56:59], v[84:87]
  v_mfma_f32_16x16x32_bf16 v[112:115], a[200:203], a[56:59], v[112:115]
  v_mfma_f32_16x16x32_bf16 v[140:143], a[204:207], a[56:59], v[140:143]
  v_mfma_f32_16x16x32_bf16 v[168:171], a[208:211], a[56:59], v[168:171]
  v_mfma_f32_16x16x32_bf16 v[196:199], a[212:215], a[56:59], v[196:199]
  v_mfma_f32_16x16x32_bf16 v[224:227], a[216:219], a[56:59], v[224:227]
  v_mfma_f32_16x16x32_bf16 v[252:255], a[220:223], a[56:59], v[252:255]
  s_add_u32 s47, s29, 12288
  buffer_load_dwordx4 a[56:59], v30, s[8:11], s47 offen offset:0 sc1
  s_add_u32 s29, s29, 26624
  s_waitcnt vmcnt(17) lgkmcnt(0)
  v_mfma_f32_16x16x32_bf16 v[32:35], a[224:227], a[60:63], v[32:35]
  v_mfma_f32_16x16x32_bf16 v[60:63], a[228:231], a[60:63], v[60:63]
  ds_read_b64_tr_b16 a[192:193], v13 offset:8192
  v_mfma_f32_16x16x32_bf16 v[88:91], a[232:235], a[60:63], v[88:91]
  v_mfma_f32_16x16x32_bf16 v[116:119], a[236:239], a[60:63], v[116:119]
  ds_read_b64_tr_b16 a[194:195], v13 offset:12288
  v_mfma_f32_16x16x32_bf16 v[144:147], a[240:243], a[60:63], v[144:147]
  s_add_u32 m0, s28, 0
  s_add_u32 s38, s36, 0
  buffer_load_dwordx4 v7, s[12:15], s38 offen offset:0 sc1 lds
  v_mfma_f32_16x16x32_bf16 v[172:175], a[244:247], a[60:63], v[172:175]
  ds_read_b64_tr_b16 a[196:197], v14 offset:8192
  v_mfma_f32_16x16x32_bf16 v[200:203], a[248:251], a[60:63], v[200:203]
  v_mfma_f32_16x16x32_bf16 v[228:231], a[252:255], a[60:63], v[228:231]
  ds_read_b64_tr_b16 a[198:199], v14 offset:12288
  v_mfma_f32_16x16x32_bf16 v[36:39], a[224:227], a[80:83], v[36:39]
  s_add_u32 s47, s29, 0
  buffer_load_dwordx4 a[60:63], v30, s[8:11], s47 offen offset:0 sc1
  v_mfma_f32_16x16x32_bf16 v[64:67], a[228:231], a[80:83], v[64:67]
  ds_read_b64_tr_b16 a[200:201], v15 offset:8192
  v_mfma_f32_16x16x32_bf16 v[92:95], a[232:235], a[80:83], v[92:95]
  buffer_load_dwordx4 v8, s[12:15], s38 offen offset:1024 sc1 lds
  v_mfma_f32_16x16x32_bf16 v[120:123], a[236:239], a[80:83], v[120:123]
  ds_read_b64_tr_b16 a[202:203], v15 offset:12288
  v_mfma_f32_16x16x32_bf16 v[148:151], a[240:243], a[80:83], v[148:151]
  v_mfma_f32_16x16x32_bf16 v[176:179], a[244:247], a[80:83], v[176:179]
  s_add_u32 s46, s54, 458752
  ds_read_b64_tr_b16 a[204:205], v16 offset:8192
  buffer_store_dwordx4 a[72:75], v30, s[24:27], s46 offen offset:0 sc1
  v_mfma_f32_16x16x32_bf16 v[204:207], a[248:251], a[80:83], v[204:207]
  v_mfma_f32_16x16x32_bf16 v[232:235], a[252:255], a[80:83], v[232:235]
  ds_read_b64_tr_b16 a[206:207], v16 offset:12288
  v_mfma_f32_16x16x32_bf16 v[40:43], a[224:227], a[84:87], v[40:43]
  buffer_load_dwordx4 a[80:83], v30, s[8:11], s47 offen offset:2048 sc1
  v_mfma_f32_16x16x32_bf16 v[68:71], a[228:231], a[84:87], v[68:71]
  ds_read_b64_tr_b16 a[208:209], v17 offset:8192
  v_mfma_f32_16x16x32_bf16 v[96:99], a[232:235], a[84:87], v[96:99]
  buffer_load_dwordx4 v9, s[12:15], s38 offen offset:2048 sc1 lds
  v_mfma_f32_16x16x32_bf16 v[124:127], a[236:239], a[84:87], v[124:127]
  ds_read_b64_tr_b16 a[210:211], v17 offset:12288
  v_mfma_f32_16x16x32_bf16 v[152:155], a[240:243], a[84:87], v[152:155]
  v_mfma_f32_16x16x32_bf16 v[180:183], a[244:247], a[84:87], v[180:183]
  ds_read_b64_tr_b16 a[212:213], v18 offset:8192
  v_mfma_f32_16x16x32_bf16 v[208:211], a[248:251], a[84:87], v[208:211]
  buffer_load_dwordx4 v10, s[12:15], s38 offen offset:3072 sc1 lds
  v_mfma_f32_16x16x32_bf16 v[236:239], a[252:255], a[84:87], v[236:239]
  ds_read_b64_tr_b16 a[214:215], v18 offset:12288
  v_mfma_f32_16x16x32_bf16 v[44:47], a[224:227], a[88:91], v[44:47]
  s_add_u32 s47, s29, 4096
  buffer_load_dwordx4 a[84:87], v30, s[8:11], s47 offen offset:0 sc1
  v_mfma_f32_16x16x32_bf16 v[72:75], a[228:231], a[88:91], v[72:75]
  ds_read_b64_tr_b16 a[216:217], v19 offset:8192
  v_mfma_f32_16x16x32_bf16 v[100:103], a[232:235], a[88:91], v[100:103]
  v_mfma_f32_16x16x32_bf16 v[128:131], a[236:239], a[88:91], v[128:131]
  ds_read_b64_tr_b16 a[218:219], v19 offset:12288
  v_mfma_f32_16x16x32_bf16 v[156:159], a[240:243], a[88:91], v[156:159]
  s_add_u32 m0, s28, 4096
  s_add_u32 s38, s36, 32768
  buffer_load_dwordx4 v7, s[12:15], s38 offen offset:0 sc1 lds
  v_mfma_f32_16x16x32_bf16 v[184:187], a[244:247], a[88:91], v[184:187]
  s_add_u32 s35, s35, 1
  ds_read_b64_tr_b16 a[220:221], v20 offset:8192
  v_mfma_f32_16x16x32_bf16 v[212:215], a[248:251], a[88:91], v[212:215]
  s_and_b32 s48, s35, 14
  v_mfma_f32_16x16x32_bf16 v[240:243], a[252:255], a[88:91], v[240:243]
  s_waitcnt lgkmcnt(8)
  s_lshl_b32 s48, s48, 17
  ds_read_b64_tr_b16 a[222:223], v20 offset:12288
  v_mfma_f32_16x16x32_bf16 v[48:51], a[224:227], a[92:95], v[48:51]
  s_add_u32 s36, s30, s48
  buffer_load_dwordx4 a[88:91], v30, s[8:11], s47 offen offset:2048 sc1
  v_mfma_f32_16x16x32_bf16 v[76:79], a[228:231], a[92:95], v[76:79]
  s_add_u32 s46, s54, 460800
  s_and_b32 s48, s35, 16
  buffer_store_dwordx4 a[76:79], v30, s[24:27], s46 offen offset:0 sc1
  v_mfma_f32_16x16x32_bf16 v[104:107], a[232:235], a[92:95], v[104:107]
  s_lshl_b32 s48, s48, 13
  buffer_load_dwordx4 v8, s[12:15], s38 offen offset:1024 sc1 lds
  v_mfma_f32_16x16x32_bf16 v[132:135], a[236:239], a[92:95], v[132:135]
  s_add_u32 s36, s36, s48
  v_mfma_f32_16x16x32_bf16 v[160:163], a[240:243], a[92:95], v[160:163]
  s_and_b32 s48, s35, 1
  v_mfma_f32_16x16x32_bf16 v[188:191], a[244:247], a[92:95], v[188:191]
  s_lshl_b32 s48, s48, 16
  v_mfma_f32_16x16x32_bf16 v[216:219], a[248:251], a[92:95], v[216:219]
  s_add_u32 s36, s36, s48
  v_mfma_f32_16x16x32_bf16 v[244:247], a[252:255], a[92:95], v[244:247]
  v_mfma_f32_16x16x32_bf16 v[52:55], a[224:227], a[112:115], v[52:55]
  s_add_u32 s47, s29, 8192
  buffer_load_dwordx4 a[92:95], v30, s[8:11], s47 offen offset:0 sc1
  v_mfma_f32_16x16x32_bf16 v[80:83], a[228:231], a[112:115], v[80:83]
  v_mfma_f32_16x16x32_bf16 v[108:111], a[232:235], a[112:115], v[108:111]
  buffer_load_dwordx4 v9, s[12:15], s38 offen offset:2048 sc1 lds
  v_mfma_f32_16x16x32_bf16 v[136:139], a[236:239], a[112:115], v[136:139]
  v_mfma_f32_16x16x32_bf16 v[164:167], a[240:243], a[112:115], v[164:167]
  v_mfma_f32_16x16x32_bf16 v[192:195], a[244:247], a[112:115], v[192:195]
  v_mfma_f32_16x16x32_bf16 v[220:223], a[248:251], a[112:115], v[220:223]
  buffer_load_dwordx4 v10, s[12:15], s38 offen offset:3072 sc1 lds
  v_mfma_f32_16x16x32_bf16 v[248:251], a[252:255], a[112:115], v[248:251]
  v_mfma_f32_16x16x32_bf16 v[56:59], a[224:227], a[116:119], v[56:59]
  buffer_load_dwordx4 a[112:115], v30, s[8:11], s47 offen offset:2048 sc1
  v_mfma_f32_16x16x32_bf16 v[84:87], a[228:231], a[116:119], v[84:87]
  v_mfma_f32_16x16x32_bf16 v[112:115], a[232:235], a[116:119], v[112:115]
  v_mfma_f32_16x16x32_bf16 v[140:143], a[236:239], a[116:119], v[140:143]
  v_mfma_f32_16x16x32_bf16 v[168:171], a[240:243], a[116:119], v[168:171]
  v_mfma_f32_16x16x32_bf16 v[196:199], a[244:247], a[116:119], v[196:199]
  v_mfma_f32_16x16x32_bf16 v[224:227], a[248:251], a[116:119], v[224:227]
  v_mfma_f32_16x16x32_bf16 v[252:255], a[252:255], a[116:119], v[252:255]
  s_add_u32 s47, s29, 12288
  buffer_load_dwordx4 a[116:119], v30, s[8:11], s47 offen offset:0 sc1
  s_add_u32 s29, s29, 26624
  s_waitcnt vmcnt(17) lgkmcnt(0)
  v_mfma_f32_16x16x32_bf16 v[32:35], a[192:195], a[16:19], v[32:35]
  v_mfma_f32_16x16x32_bf16 v[60:63], a[196:199], a[16:19], v[60:63]
  ds_read_b64_tr_b16 a[224:225], v13 offset:24576
  v_mfma_f32_16x16x32_bf16 v[88:91], a[200:203], a[16:19], v[88:91]
  v_mfma_f32_16x16x32_bf16 v[116:119], a[204:207], a[16:19], v[116:119]
  ds_read_b64_tr_b16 a[226:227], v13 offset:28672
  v_mfma_f32_16x16x32_bf16 v[144:147], a[208:211], a[16:19], v[144:147]
  s_add_u32 m0, s28, 8192
  s_add_u32 s38, s36, 0
  buffer_load_dwordx4 v7, s[12:15], s38 offen offset:0 sc1 lds
  v_mfma_f32_16x16x32_bf16 v[172:175], a[212:215], a[16:19], v[172:175]
  ds_read_b64_tr_b16 a[228:229], v14 offset:24576
  v_mfma_f32_16x16x32_bf16 v[200:203], a[216:219], a[16:19], v[200:203]
  v_mfma_f32_16x16x32_bf16 v[228:231], a[220:223], a[16:19], v[228:231]
  ds_read_b64_tr_b16 a[230:231], v14 offset:28672
  v_mfma_f32_16x16x32_bf16 v[36:39], a[192:195], a[20:23], v[36:39]
  s_add_u32 s47, s29, 0
  buffer_load_dwordx4 a[16:19], v30, s[8:11], s47 offen offset:0 sc1
  v_mfma_f32_16x16x32_bf16 v[64:67], a[196:199], a[20:23], v[64:67]
  ds_read_b64_tr_b16 a[232:233], v15 offset:24576
  v_mfma_f32_16x16x32_bf16 v[92:95], a[200:203], a[20:23], v[92:95]
  buffer_load_dwordx4 v8, s[12:15], s38 offen offset:1024 sc1 lds
  v_mfma_f32_16x16x32_bf16 v[120:123], a[204:207], a[20:23], v[120:123]
  ds_read_b64_tr_b16 a[234:235], v15 offset:28672
  v_mfma_f32_16x16x32_bf16 v[148:151], a[208:211], a[20:23], v[148:151]
  v_mfma_f32_16x16x32_bf16 v[176:179], a[212:215], a[20:23], v[176:179]
  s_add_u32 s46, s54, 462848
  ds_read_b64_tr_b16 a[236:237], v16 offset:24576
  buffer_store_dwordx4 a[96:99], v30, s[24:27], s46 offen offset:0 sc1
  v_mfma_f32_16x16x32_bf16 v[204:207], a[216:219], a[20:23], v[204:207]
  v_mfma_f32_16x16x32_bf16 v[232:235], a[220:223], a[20:23], v[232:235]
  ds_read_b64_tr_b16 a[238:239], v16 offset:28672
  v_mfma_f32_16x16x32_bf16 v[40:43], a[192:195], a[24:27], v[40:43]
  buffer_load_dwordx4 a[20:23], v30, s[8:11], s47 offen offset:2048 sc1
  v_mfma_f32_16x16x32_bf16 v[68:71], a[196:199], a[24:27], v[68:71]
  ds_read_b64_tr_b16 a[240:241], v17 offset:24576
  v_mfma_f32_16x16x32_bf16 v[96:99], a[200:203], a[24:27], v[96:99]
  buffer_load_dwordx4 v9, s[12:15], s38 offen offset:2048 sc1 lds
  v_mfma_f32_16x16x32_bf16 v[124:127], a[204:207], a[24:27], v[124:127]
  ds_read_b64_tr_b16 a[242:243], v17 offset:28672
  v_mfma_f32_16x16x32_bf16 v[152:155], a[208:211], a[24:27], v[152:155]
  v_mfma_f32_16x16x32_bf16 v[180:183], a[212:215], a[24:27], v[180:183]
  ds_read_b64_tr_b16 a[244:245], v18 offset:24576
  v_mfma_f32_16x16x32_bf16 v[208:211], a[216:219], a[24:27], v[208:211]
  buffer_load_dwordx4 v10, s[12:15], s38 offen offset:3072 sc1 lds
  v_mfma_f32_16x16x32_bf16 v[236:239], a[220:223], a[24:27], v[236:239]
  ds_read_b64_tr_b16 a[246:247], v18 offset:28672
  v_mfma_f32_16x16x32_bf16 v[44:47], a[192:195], a[28:31], v[44:47]
  s_add_u32 s47, s29, 4096
  buffer_load_dwordx4 a[24:27], v30, s[8:11], s47 offen offset:0 sc1
  v_mfma_f32_16x16x32_bf16 v[72:75], a[196:199], a[28:31], v[72:75]
  ds_read_b64_tr_b16 a[248:249], v19 offset:24576
  v_mfma_f32_16x16x32_bf16 v[100:103], a[200:203], a[28:31], v[100:103]
  v_mfma_f32_16x16x32_bf16 v[128:131], a[204:207], a[28:31], v[128:131]
  ds_read_b64_tr_b16 a[250:251], v19 offset:28672
  v_mfma_f32_16x16x32_bf16 v[156:159], a[208:211], a[28:31], v[156:159]
  s_add_u32 m0, s28, 12288
  s_add_u32 s38, s36, 32768
  buffer_load_dwordx4 v7, s[12:15], s38 offen offset:0 sc1 lds
  v_mfma_f32_16x16x32_bf16 v[184:187], a[212:215], a[28:31], v[184:187]
  s_add_u32 s35, s35, 1
  ds_read_b64_tr_b16 a[252:253], v20 offset:24576
  v_mfma_f32_16x16x32_bf16 v[212:215], a[216:219], a[28:31], v[212:215]
  s_and_b32 s48, s35, 14
  v_mfma_f32_16x16x32_bf16 v[240:243], a[220:223], a[28:31], v[240:243]
  s_waitcnt lgkmcnt(8)
  s_lshl_b32 s48, s48, 17
  ds_read_b64_tr_b16 a[254:255], v20 offset:28672
  v_mfma_f32_16x16x32_bf16 v[48:51], a[192:195], a[48:51], v[48:51]
  s_add_u32 s36, s30, s48
  buffer_load_dwordx4 a[28:31], v30, s[8:11], s47 offen offset:2048 sc1
  v_mfma_f32_16x16x32_bf16 v[76:79], a[196:199], a[48:51], v[76:79]
  s_add_u32 s46, s44, 464896
  s_and_b32 s48, s35, 16
  buffer_store_dwordx4 a[100:103], v30, s[24:27], s46 offen offset:0 sc1
  v_mfma_f32_16x16x32_bf16 v[104:107], a[200:203], a[48:51], v[104:107]
  s_lshl_b32 s48, s48, 13
  buffer_load_dwordx4 v8, s[12:15], s38 offen offset:1024 sc1 lds
  v_mfma_f32_16x16x32_bf16 v[132:135], a[204:207], a[48:51], v[132:135]
  s_add_u32 s36, s36, s48
  v_mfma_f32_16x16x32_bf16 v[160:163], a[208:211], a[48:51], v[160:163]
  s_and_b32 s48, s35, 1
  v_mfma_f32_16x16x32_bf16 v[188:191], a[212:215], a[48:51], v[188:191]
  s_lshl_b32 s48, s48, 16
  v_mfma_f32_16x16x32_bf16 v[216:219], a[216:219], a[48:51], v[216:219]
  s_add_u32 s36, s36, s48
  v_mfma_f32_16x16x32_bf16 v[244:247], a[220:223], a[48:51], v[244:247]
  v_mfma_f32_16x16x32_bf16 v[52:55], a[192:195], a[52:55], v[52:55]
  s_add_u32 s47, s29, 8192
  buffer_load_dwordx4 a[48:51], v30, s[8:11], s47 offen offset:0 sc1
  v_mfma_f32_16x16x32_bf16 v[80:83], a[196:199], a[52:55], v[80:83]
  v_mfma_f32_16x16x32_bf16 v[108:111], a[200:203], a[52:55], v[108:111]
  buffer_load_dwordx4 v9, s[12:15], s38 offen offset:2048 sc1 lds
  v_mfma_f32_16x16x32_bf16 v[136:139], a[204:207], a[52:55], v[136:139]
  v_mfma_f32_16x16x32_bf16 v[164:167], a[208:211], a[52:55], v[164:167]
  v_mfma_f32_16x16x32_bf16 v[192:195], a[212:215], a[52:55], v[192:195]
  v_mfma_f32_16x16x32_bf16 v[220:223], a[216:219], a[52:55], v[220:223]
  buffer_load_dwordx4 v10, s[12:15], s38 offen offset:3072 sc1 lds
  v_mfma_f32_16x16x32_bf16 v[248:251], a[220:223], a[52:55], v[248:251]
  v_mfma_f32_16x16x32_bf16 v[56:59], a[192:195], a[56:59], v[56:59]
  buffer_load_dwordx4 a[52:55], v30, s[8:11], s47 offen offset:2048 sc1
  v_mfma_f32_16x16x32_bf16 v[84:87], a[196:199], a[56:59], v[84:87]
  v_mfma_f32_16x16x32_bf16 v[112:115], a[200:203], a[56:59], v[112:115]
  v_mfma_f32_16x16x32_bf16 v[140:143], a[204:207], a[56:59], v[140:143]
  v_mfma_f32_16x16x32_bf16 v[168:171], a[208:211], a[56:59], v[168:171]
  v_mfma_f32_16x16x32_bf16 v[196:199], a[212:215], a[56:59], v[196:199]
  v_mfma_f32_16x16x32_bf16 v[224:227], a[216:219], a[56:59], v[224:227]
  v_mfma_f32_16x16x32_bf16 v[252:255], a[220:223], a[56:59], v[252:255]
  s_add_u32 s47, s29, 12288
  buffer_load_dwordx4 a[56:59], v30, s[8:11], s47 offen offset:0 sc1
  s_add_u32 s29, s29, 26624
  s_waitcnt vmcnt(17) lgkmcnt(0)
  v_mfma_f32_16x16x32_bf16 v[32:35], a[224:227], a[60:63], v[32:35]
  v_mfma_f32_16x16x32_bf16 v[60:63], a[228:231], a[60:63], v[60:63]
  ds_read_b64_tr_b16 a[192:193], v13 offset:16384
  v_mfma_f32_16x16x32_bf16 v[88:91], a[232:235], a[60:63], v[88:91]
  v_mfma_f32_16x16x32_bf16 v[116:119], a[236:239], a[60:63], v[116:119]
  ds_read_b64_tr_b16 a[194:195], v13 offset:20480
  v_mfma_f32_16x16x32_bf16 v[144:147], a[240:243], a[60:63], v[144:147]
  s_add_u32 m0, s28, 24576
  s_add_u32 s38, s36, 0
  buffer_load_dwordx4 v7, s[12:15], s38 offen offset:0 sc1 lds
  v_mfma_f32_16x16x32_bf16 v[172:175], a[244:247], a[60:63], v[172:175]
  ds_read_b64_tr_b16 a[196:197], v14 offset:16384
  v_mfma_f32_16x16x32_bf16 v[200:203], a[248:251], a[60:63], v[200:203]
  v_mfma_f32_16x16x32_bf16 v[228:231], a[252:255], a[60:63], v[228:231]
  ds_read_b64_tr_b16 a[198:199], v14 offset:20480
  v_mfma_f32_16x16x32_bf16 v[36:39], a[224:227], a[80:83], v[36:39]
  s_add_u32 s47, s29, 0
  buffer_load_dwordx4 a[60:63], v30, s[8:11], s47 offen offset:0 sc1
  v_mfma_f32_16x16x32_bf16 v[64:67], a[228:231], a[80:83], v[64:67]
  ds_read_b64_tr_b16 a[200:201], v15 offset:16384
  v_mfma_f32_16x16x32_bf16 v[92:95], a[232:235], a[80:83], v[92:95]
  buffer_load_dwordx4 v8, s[12:15], s38 offen offset:1024 sc1 lds
  v_mfma_f32_16x16x32_bf16 v[120:123], a[236:239], a[80:83], v[120:123]
  ds_read_b64_tr_b16 a[202:203], v15 offset:20480
  v_mfma_f32_16x16x32_bf16 v[148:151], a[240:243], a[80:83], v[148:151]
  v_mfma_f32_16x16x32_bf16 v[176:179], a[244:247], a[80:83], v[176:179]
  ds_read_b64_tr_b16 a[204:205], v16 offset:16384
  v_mfma_f32_16x16x32_bf16 v[204:207], a[248:251], a[80:83], v[204:207]
  v_mfma_f32_16x16x32_bf16 v[232:235], a[252:255], a[80:83], v[232:235]
  ds_read_b64_tr_b16 a[206:207], v16 offset:20480
  v_mfma_f32_16x16x32_bf16 v[40:43], a[224:227], a[84:87], v[40:43]
  buffer_load_dwordx4 a[80:83], v30, s[8:11], s47 offen offset:2048 sc1
  v_mfma_f32_16x16x32_bf16 v[68:71], a[228:231], a[84:87], v[68:71]
  ds_read_b64_tr_b16 a[208:209], v17 offset:16384
  v_mfma_f32_16x16x32_bf16 v[96:99], a[232:235], a[84:87], v[96:99]
  buffer_load_dwordx4 v9, s[12:15], s38 offen offset:2048 sc1 lds
  v_mfma_f32_16x16x32_bf16 v[124:127], a[236:239], a[84:87], v[124:127]
  ds_read_b64_tr_b16 a[210:211], v17 offset:20480
  v_mfma_f32_16x16x32_bf16 v[152:155], a[240:243], a[84:87], v[152:155]
  v_mfma_f32_16x16x32_bf16 v[180:183], a[244:247], a[84:87], v[180:183]
  ds_read_b64_tr_b16 a[212:213], v18 offset:16384
  v_mfma_f32_16x16x32_bf16 v[208:211], a[248:251], a[84:87], v[208:211]
  buffer_load_dwordx4 v10, s[12:15], s38 offen offset:3072 sc1 lds
  v_mfma_f32_16x16x32_bf16 v[236:239], a[252:255], a[84:87], v[236:239]
  ds_read_b64_tr_b16 a[214:215], v18 offset:20480
  v_mfma_f32_16x16x32_bf16 v[44:47], a[224:227], a[88:91], v[44:47]
  s_add_u32 s47, s29, 4096
  buffer_load_dwordx4 a[84:87], v30, s[8:11], s47 offen offset:0 sc1
  v_mfma_f32_16x16x32_bf16 v[72:75], a[228:231], a[88:91], v[72:75]
  ds_read_b64_tr_b16 a[216:217], v19 offset:16384
  v_mfma_f32_16x16x32_bf16 v[100:103], a[232:235], a[88:91], v[100:103]
  v_mfma_f32_16x16x32_bf16 v[128:131], a[236:239], a[88:91], v[128:131]
  ds_read_b64_tr_b16 a[218:219], v19 offset:20480
  v_mfma_f32_16x16x32_bf16 v[156:159], a[240:243], a[88:91], v[156:159]
  s_add_u32 m0, s28, 28672
  s_add_u32 s38, s36, 32768
  buffer_load_dwordx4 v7, s[12:15], s38 offen offset:0 sc1 lds
  v_mfma_f32_16x16x32_bf16 v[184:187], a[244:247], a[88:91], v[184:187]
  s_add_u32 s35, s35, 1
  ds_read_b64_tr_b16 a[220:221], v20 offset:16384
  v_mfma_f32_16x16x32_bf16 v[212:215], a[248:251], a[88:91], v[212:215]
  s_and_b32 s48, s35, 14
  v_mfma_f32_16x16x32_bf16 v[240:243], a[252:255], a[88:91], v[240:243]
  s_waitcnt lgkmcnt(8)
  s_lshl_b32 s48, s48, 17
  ds_read_b64_tr_b16 a[222:223], v20 offset:20480
  v_mfma_f32_16x16x32_bf16 v[48:51], a[224:227], a[92:95], v[48:51]
  s_add_u32 s36, s30, s48
  buffer_load_dwordx4 a[88:91], v30, s[8:11], s47 offen offset:2048 sc1
  v_mfma_f32_16x16x32_bf16 v[76:79], a[228:231], a[92:95], v[76:79]
  s_and_b32 s48, s35, 16
  v_mfma_f32_16x16x32_bf16 v[104:107], a[232:235], a[92:95], v[104:107]
  s_lshl_b32 s48, s48, 13
  buffer_load_dwordx4 v8, s[12:15], s38 offen offset:1024 sc1 lds
  v_mfma_f32_16x16x32_bf16 v[132:135], a[236:239], a[92:95], v[132:135]
  s_add_u32 s36, s36, s48
  v_mfma_f32_16x16x32_bf16 v[160:163], a[240:243], a[92:95], v[160:163]
  s_and_b32 s48, s35, 1
  v_mfma_f32_16x16x32_bf16 v[188:191], a[244:247], a[92:95], v[188:191]
  s_lshl_b32 s48, s48, 16
  v_mfma_f32_16x16x32_bf16 v[216:219], a[248:251], a[92:95], v[216:219]
  s_add_u32 s36, s36, s48
  v_mfma_f32_16x16x32_bf16 v[244:247], a[252:255], a[92:95], v[244:247]
  v_mfma_f32_16x16x32_bf16 v[52:55], a[224:227], a[112:115], v[52:55]
  s_add_u32 s47, s29, 8192
  buffer_load_dwordx4 a[92:95], v30, s[8:11], s47 offen offset:0 sc1
  v_mfma_f32_16x16x32_bf16 v[80:83], a[228:231], a[112:115], v[80:83]
  v_mfma_f32_16x16x32_bf16 v[108:111], a[232:235], a[112:115], v[108:111]
  buffer_load_dwordx4 v9, s[12:15], s38 offen offset:2048 sc1 lds
  v_mfma_f32_16x16x32_bf16 v[136:139], a[236:239], a[112:115], v[136:139]
  v_mfma_f32_16x16x32_bf16 v[164:167], a[240:243], a[112:115], v[164:167]
  v_mfma_f32_16x16x32_bf16 v[192:195], a[244:247], a[112:115], v[192:195]
  v_mfma_f32_16x16x32_bf16 v[220:223], a[248:251], a[112:115], v[220:223]
  buffer_load_dwordx4 v10, s[12:15], s38 offen offset:3072 sc1 lds
  v_mfma_f32_16x16x32_bf16 v[248:251], a[252:255], a[112:115], v[248:251]
  v_mfma_f32_16x16x32_bf16 v[56:59], a[224:227], a[116:119], v[56:59]
  buffer_load_dwordx4 a[112:115], v30, s[8:11], s47 offen offset:2048 sc1
  v_mfma_f32_16x16x32_bf16 v[84:87], a[228:231], a[116:119], v[84:87]
  v_mfma_f32_16x16x32_bf16 v[112:115], a[232:235], a[116:119], v[112:115]
  v_mfma_f32_16x16x32_bf16 v[140:143], a[236:239], a[116:119], v[140:143]
  v_mfma_f32_16x16x32_bf16 v[168:171], a[240:243], a[116:119], v[168:171]
  v_mfma_f32_16x16x32_bf16 v[196:199], a[244:247], a[116:119], v[196:199]
  v_mfma_f32_16x16x32_bf16 v[224:227], a[248:251], a[116:119], v[224:227]
  v_mfma_f32_16x16x32_bf16 v[252:255], a[252:255], a[116:119], v[252:255]
  s_add_u32 s47, s29, 12288
  buffer_load_dwordx4 a[116:119], v30, s[8:11], s47 offen offset:0 sc1
  s_add_u32 s29, s29, 26624
  s_waitcnt vmcnt(15)
  s_barrier
  s_cmp_lg_u32 s3, 0
  s_cbranch_scc1 L2a_sig2
  v_mov_b32 v0, 2
  s_mov_b64 exec, 1
  global_store_dword v12, v0, s[98:99] sc1
  s_mov_b64 exec, -1
L2a_sig2:
  s_mov_b32 s31, 2
L2a_loop:
  s_waitcnt vmcnt(15) lgkmcnt(0)
  v_mfma_f32_16x16x32_bf16 v[32:35], a[192:195], a[16:19], v[32:35]
  v_mfma_f32_16x16x32_bf16 v[60:63], a[196:199], a[16:19], v[60:63]
  ds_read_b64_tr_b16 a[224:225], v13 offset:0
  v_mfma_f32_16x16x32_bf16 v[88:91], a[200:203], a[16:19], v[88:91]
  v_mfma_f32_16x16x32_bf16 v[116:119], a[204:207], a[16:19], v[116:119]
  ds_read_b64_tr_b16 a[226:227], v13 offset:4096
  v_mfma_f32_16x16x32_bf16 v[144:147], a[208:211], a[16:19], v[144:147]
  s_add_u32 m0, s28, 16384
  s_add_u32 s38, s36, 0
  buffer_load_dwordx4 v7, s[12:15], s38 offen offset:0 sc1 lds
  v_mfma_f32_16x16x32_bf16 v[172:175], a[212:215], a[16:19], v[172:175]
  ds_read_b64_tr_b16 a[228:229], v14 offset:0
  v_mfma_f32_16x16x32_bf16 v[200:203], a[216:219], a[16:19], v[200:203]
  v_mfma_f32_16x16x32_bf16 v[228:231], a[220:223], a[16:19], v[228:231]
  ds_read_b64_tr_b16 a[230:231], v14 offset:4096
  v_mfma_f32_16x16x32_bf16 v[36:39], a[192:195], a[20:23], v[36:39]
  s_add_u32 s47, s29, 0
  buffer_load_dwordx4 a[16:19], v30, s[8:11], s47 offen offset:0 sc1
  v_mfma_f32_16x16x32_bf16 v[64:67], a[196:199], a[20:23], v[64:67]
  ds_read_b64_tr_b16 a[232:233], v15 offset:0
  v_mfma_f32_16x16x32_bf16 v[92:95], a[200:203], a[20:23], v[92:95]
  buffer_load_dwordx4 v8, s[12:15], s38 offen offset:1024 sc1 lds
  v_mfma_f32_16x16x32_bf16 v[120:123], a[204:207], a[20:23], v[120:123]
  ds_read_b64_tr_b16 a[234:235], v15 offset:4096
  v_mfma_f32_16x16x32_bf16 v[148:151], a[208:211], a[20:23], v[148:151]
  v_mfma_f32_16x16x32_bf16 v[176:179], a[212:215], a[20:23], v[176:179]
  ds_read_b64_tr_b16 a[236:237], v16 offset:0
  v_mfma_f32_16x16x32_bf16 v[204:207], a[216:219], a[20:23], v[204:207]
  v_mfma_f32_16x16x32_bf16 v[232:235], a[220:223], a[20:23], v[232:235]
  ds_read_b64_tr_b16 a[238:239], v16 offset:4096
  v_mfma_f32_16x16x32_bf16 v[40:43], a[192:195], a[24:27], v[40:43]
  buffer_load_dwordx4 a[20:23], v30, s[8:11], s47 offen offset:2048 sc1
  v_mfma_f32_16x16x32_bf16 v[68:71], a[196:199], a[24:27], v[68:71]
  ds_read_b64_tr_b16 a[240:241], v17 offset:0
  v_mfma_f32_16x16x32_bf16 v[96:99], a[200:203], a[24:27], v[96:99]
  buffer_load_dwordx4 v9, s[12:15], s38 offen offset:2048 sc1 lds
  v_mfma_f32_16x16x32_bf16 v[124:127], a[204:207], a[24:27], v[124:127]
  ds_read_b64_tr_b16 a[242:243], v17 offset:4096
  v_mfma_f32_16x16x32_bf16 v[152:155], a[208:211], a[24:27], v[152:155]
  v_mfma_f32_16x16x32_bf16 v[180:183], a[212:215], a[24:27], v[180:183]
  ds_read_b64_tr_b16 a[244:245], v18 offset:0
  v_mfma_f32_16x16x32_bf16 v[208:211], a[216:219], a[24:27], v[208:211]
  buffer_load_dwordx4 v10, s[12:15], s38 offen offset:3072 sc1 lds
  v_mfma_f32_16x16x32_bf16 v[236:239], a[220:223], a[24:27], v[236:239]
  ds_read_b64_tr_b16 a[246:247], v18 offset:4096
  v_mfma_f32_16x16x32_bf16 v[44:47], a[192:195], a[28:31], v[44:47]
  s_add_u32 s47, s29, 4096
  buffer_load_dwordx4 a[24:27], v30, s[8:11], s47 offen offset:0 sc1
  v_mfma_f32_16x16x32_bf16 v[72:75], a[196:199], a[28:31], v[72:75]
  ds_read_b64_tr_b16 a[248:249], v19 offset:0
  v_mfma_f32_16x16x32_bf16 v[100:103], a[200:203], a[28:31], v[100:103]
  v_mfma_f32_16x16x32_bf16 v[128:131], a[204:207], a[28:31], v[128:131]
  ds_read_b64_tr_b16 a[250:251], v19 offset:4096
  v_mfma_f32_16x16x32_bf16 v[156:159], a[208:211], a[28:31], v[156:159]
  s_add_u32 m0, s28, 20480
  s_add_u32 s38, s36, 32768
  buffer_load_dwordx4 v7, s[12:15], s38 offen offset:0 sc1 lds
  v_mfma_f32_16x16x32_bf16 v[184:187], a[212:215], a[28:31], v[184:187]
  s_add_u32 s35, s35, 1
  ds_read_b64_tr_b16 a[252:253], v20 offset:0
  v_mfma_f32_16x16x32_bf16 v[212:215], a[216:219], a[28:31], v[212:215]
  s_and_b32 s48, s35, 14
  v_mfma_f32_16x16x32_bf16 v[240:243], a[220:223], a[28:31], v[240:243]
  s_waitcnt lgkmcnt(8)
  s_lshl_b32 s48, s48, 17
  ds_read_b64_tr_b16 a[254:255], v20 offset:4096
  v_mfma_f32_16x16x32_bf16 v[48:51], a[192:195], a[48:51], v[48:51]
  s_add_u32 s36, s30, s48
  buffer_load_dwordx4 a[28:31], v30, s[8:11], s47 offen offset:2048 sc1
  v_mfma_f32_16x16x32_bf16 v[76:79], a[196:199], a[48:51], v[76:79]
  s_and_b32 s48, s35, 16
  v_mfma_f32_16x16x32_bf16 v[104:107], a[200:203], a[48:51], v[104:107]
  s_lshl_b32 s48, s48, 13
  buffer_load_dwordx4 v8, s[12:15], s38 offen offset:1024 sc1 lds
  v_mfma_f32_16x16x32_bf16 v[132:135], a[204:207], a[48:51], v[132:135]
  s_add_u32 s36, s36, s48
  v_mfma_f32_16x16x32_bf16 v[160:163], a[208:211], a[48:51], v[160:163]
  s_and_b32 s48, s35, 1
  v_mfma_f32_16x16x32_bf16 v[188:191], a[212:215], a[48:51], v[188:191]
  s_lshl_b32 s48, s48, 16
  v_mfma_f32_16x16x32_bf16 v[216:219], a[216:219], a[48:51], v[216:219]
  s_add_u32 s36, s36, s48
  v_mfma_f32_16x16x32_bf16 v[244:247], a[220:223], a[48:51], v[244:247]
  v_mfma_f32_16x16x32_bf16 v[52:55], a[192:195], a[52:55], v[52:55]
  s_add_u32 s47, s29, 8192
  buffer_load_dwordx4 a[48:51], v30, s[8:11], s47 offen offset:0 sc1
  v_mfma_f32_16x16x32_bf16 v[80:83], a[196:199], a[52:55], v[80:83]
  v_mfma_f32_16x16x32_bf16 v[108:111], a[200:203], a[52:55], v[108:111]
  buffer_load_dwordx4 v9, s[12:15], s38 offen offset:2048 sc1 lds
  v_mfma_f32_16x16x32_bf16 v[136:139], a[204:207], a[52:55], v[136:139]
  v_mfma_f32_16x16x32_bf16 v[164:167], a[208:211], a[52:55], v[164:167]
  v_mfma_f32_16x16x32_bf16 v[192:195], a[212:215], a[52:55], v[192:195]
  v_mfma_f32_16x16x32_bf16 v[220:223], a[216:219], a[52:55], v[220:223]
  buffer_load_dwordx4 v10, s[12:15], s38 offen offset:3072 sc1 lds
  v_mfma_f32_16x16x32_bf16 v[248:251], a[220:223], a[52:55], v[248:251]
  v_mfma_f32_16x16x32_bf16 v[56:59], a[192:195], a[56:59], v[56:59]
  buffer_load_dwordx4 a[52:55], v30, s[8:11], s47 offen offset:2048 sc1
  v_mfma_f32_16x16x32_bf16 v[84:87], a[196:199], a[56:59], v[84:87]
  v_mfma_f32_16x16x32_bf16 v[112:115], a[200:203], a[56:59], v[112:115]
  v_mfma_f32_16x16x32_bf16 v[140:143], a[204:207], a[56:59], v[140:143]
  v_mfma_f32_16x16x32_bf16 v[168:171], a[208:211], a[56:59], v[168:171]
  v_mfma_f32_16x16x32_bf16 v[196:199], a[212:215], a[56:59], v[196:199]
  v_mfma_f32_16x16x32_bf16 v[224:227], a[216:219], a[56:59], v[224:227]
  v_mfma_f32_16x16x32_bf16 v[252:255], a[220:223], a[56:59], v[252:255]
  s_add_u32 s47, s29, 12288
  buffer_load_dwordx4 a[56:59], v30, s[8:11], s47 offen offset:0 sc1
  s_add_u32 s29, s29, 26624
  s_waitcnt vmcnt(15) lgkmcnt(0)
  s_cmp_lg_u32 s31, 3
  s_cbranch_scc1 L2a_p2_go
  s_mov_b32 s49, 524288
L2a_p2_c:
  v_min_u32 v24, v24, v25
  v_min3_u32 v24, v24, v26, v27
  s_nop 0
  v_readfirstlane_b32 s48, v24
  s_sub_u32 s49, s49, 1
  s_cbranch_scc1 L2a_p2_go
  s_cmp_ge_u32 s48, 2
  s_cbranch_scc1 L2a_p2_go
  s_sleep 2
  global_load_dwordx4 v[24:27], v11, s[98:99] sc1
  s_waitcnt vmcnt(0)
  s_branch L2a_p2_c
L2a_p2_go:
  v_mfma_f32_16x16x32_bf16 v[32:35], a[224:227], a[60:63], v[32:35]
  v_mfma_f32_16x16x32_bf16 v[60:63], a[228:231], a[60:63], v[60:63]
  ds_read_b64_tr_b16 a[192:193], v13 offset:8192
  v_mfma_f32_16x16x32_bf16 v[88:91], a[232:235], a[60:63], v[88:91]
  v_mfma_f32_16x16x32_bf16 v[116:119], a[236:239], a[60:63], v[116:119]
  ds_read_b64_tr_b16 a[194:195], v13 offset:12288
  v_mfma_f32_16x16x32_bf16 v[144:147], a[240:243], a[60:63], v[144:147]
  s_add_u32 m0, s28, 0
  s_add_u32 s38, s36, 0
  buffer_load_dwordx4 v7, s[12:15], s38 offen offset:0 sc1 lds
  v_mfma_f32_16x16x32_bf16 v[172:175], a[244:247], a[60:63], v[172:175]
  ds_read_b64_tr_b16 a[196:197], v14 offset:8192
  v_mfma_f32_16x16x32_bf16 v[200:203], a[248:251], a[60:63], v[200:203]
  v_mfma_f32_16x16x32_bf16 v[228:231], a[252:255], a[60:63], v[228:231]
  ds_read_b64_tr_b16 a[198:199], v14 offset:12288
  v_mfma_f32_16x16x32_bf16 v[36:39], a[224:227], a[80:83], v[36:39]
  s_add_u32 s47, s29, 0
  buffer_load_dwordx4 a[60:63], v30, s[8:11], s47 offen offset:0 sc1
  v_mfma_f32_16x16x32_bf16 v[64:67], a[228:231], a[80:83], v[64:67]
  ds_read_b64_tr_b16 a[200:201], v15 offset:8192
  v_mfma_f32_16x16x32_bf16 v[92:95], a[232:235], a[80:83], v[92:95]
  buffer_load_dwordx4 v8, s[12:15], s38 offen offset:1024 sc1 lds
  v_mfma_f32_16x16x32_bf16 v[120:123], a[236:239], a[80:83], v[120:123]
  ds_read_b64_tr_b16 a[202:203], v15 offset:12288
  v_mfma_f32_16x16x32_bf16 v[148:151], a[240:243], a[80:83], v[148:151]
  v_mfma_f32_16x16x32_bf16 v[176:179], a[244:247], a[80:83], v[176:179]
  ds_read_b64_tr_b16 a[204:205], v16 offset:8192
  v_mfma_f32_16x16x32_bf16 v[204:207], a[248:251], a[80:83], v[204:207]
  v_mfma_f32_16x16x32_bf16 v[232:235], a[252:255], a[80:83], v[232:235]
  ds_read_b64_tr_b16 a[206:207], v16 offset:12288
  v_mfma_f32_16x16x32_bf16 v[40:43], a[224:227], a[84:87], v[40:43]
  buffer_load_dwordx4 a[80:83], v30, s[8:11], s47 offen offset:2048 sc1
  v_mfma_f32_16x16x32_bf16 v[68:71], a[228:231], a[84:87], v[68:71]
  ds_read_b64_tr_b16 a[208:209], v17 offset:8192
  v_mfma_f32_16x16x32_bf16 v[96:99], a[232:235], a[84:87], v[96:99]
  buffer_load_dwordx4 v9, s[12:15], s38 offen offset:2048 sc1 lds
  v_mfma_f32_16x16x32_bf16 v[124:127], a[236:239], a[84:87], v[124:127]
  ds_read_b64_tr_b16 a[210:211], v17 offset:12288
  v_mfma_f32_16x16x32_bf16 v[152:155], a[240:243], a[84:87], v[152:155]
  v_mfma_f32_16x16x32_bf16 v[180:183], a[244:247], a[84:87], v[180:183]
  ds_read_b64_tr_b16 a[212:213], v18 offset:8192
  v_mfma_f32_16x16x32_bf16 v[208:211], a[248:251], a[84:87], v[208:211]
  buffer_load_dwordx4 v10, s[12:15], s38 offen offset:3072 sc1 lds
  v_mfma_f32_16x16x32_bf16 v[236:239], a[252:255], a[84:87], v[236:239]
  ds_read_b64_tr_b16 a[214:215], v18 offset:12288
  v_mfma_f32_16x16x32_bf16 v[44:47], a[224:227], a[88:91], v[44:47]
  s_add_u32 s47, s29, 4096
  buffer_load_dwordx4 a[84:87], v30, s[8:11], s47 offen offset:0 sc1
  v_mfma_f32_16x16x32_bf16 v[72:75], a[228:231], a[88:91], v[72:75]
  ds_read_b64_tr_b16 a[216:217], v19 offset:8192
  v_mfma_f32_16x16x32_bf16 v[100:103], a[232:235], a[88:91], v[100:103]
  v_mfma_f32_16x16x32_bf16 v[128:131], a[236:239], a[88:91], v[128:131]
  ds_read_b64_tr_b16 a[218:219], v19 offset:12288
  v_mfma_f32_16x16x32_bf16 v[156:159], a[240:243], a[88:91], v[156:159]
  s_add_u32 m0, s28, 4096
  s_add_u32 s38, s36, 32768
  buffer_load_dwordx4 v7, s[12:15], s38 offen offset:0 sc1 lds
  v_mfma_f32_16x16x32_bf16 v[184:187], a[244:247], a[88:91], v[184:187]
  s_add_u32 s35, s35, 1
  ds_read_b64_tr_b16 a[220:221], v20 offset:8192
  v_mfma_f32_16x16x32_bf16 v[212:215], a[248:251], a[88:91], v[212:215]
  s_and_b32 s48, s35, 14
  v_mfma_f32_16x16x32_bf16 v[240:243], a[252:255], a[88:91], v[240:243]
  s_waitcnt lgkmcnt(8)
  s_lshl_b32 s48, s48, 17
  ds_read_b64_tr_b16 a[222:223], v20 offset:12288
  v_mfma_f32_16x16x32_bf16 v[48:51], a[224:227], a[92:95], v[48:51]
  s_add_u32 s36, s30, s48
  buffer_load_dwordx4 a[88:91], v30, s[8:11], s47 offen offset:2048 sc1
  v_mfma_f32_16x16x32_bf16 v[76:79], a[228:231], a[92:95], v[76:79]
  s_and_b32 s48, s35, 16
  v_mfma_f32_16x16x32_bf16 v[104:107], a[232:235], a[92:95], v[104:107]
  s_lshl_b32 s48, s48, 13
  buffer_load_dwordx4 v8, s[12:15], s38 offen offset:1024 sc1 lds
  v_mfma_f32_16x16x32_bf16 v[132:135], a[236:239], a[92:95], v[132:135]
  s_add_u32 s36, s36, s48
  v_mfma_f32_16x16x32_bf16 v[160:163], a[240:243], a[92:95], v[160:163]
  s_and_b32 s48, s35, 1
  v_mfma_f32_16x16x32_bf16 v[188:191], a[244:247], a[92:95], v[188:191]
  s_lshl_b32 s48, s48, 16
  v_mfma_f32_16x16x32_bf16 v[216:219], a[248:251], a[92:95], v[216:219]
  s_add_u32 s36, s36, s48
  v_mfma_f32_16x16x32_bf16 v[244:247], a[252:255], a[92:95], v[244:247]
  v_mfma_f32_16x16x32_bf16 v[52:55], a[224:227], a[112:115], v[52:55]
  s_add_u32 s47, s29, 8192
  buffer_load_dwordx4 a[92:95], v30, s[8:11], s47 offen offset:0 sc1
  v_mfma_f32_16x16x32_bf16 v[80:83], a[228:231], a[112:115], v[80:83]
  v_mfma_f32_16x16x32_bf16 v[108:111], a[232:235], a[112:115], v[108:111]
  buffer_load_dwordx4 v9, s[12:15], s38 offen offset:2048 sc1 lds
  v_mfma_f32_16x16x32_bf16 v[136:139], a[236:239], a[112:115], v[136:139]
  v_mfma_f32_16x16x32_bf16 v[164:167], a[240:243], a[112:115], v[164:167]
  v_mfma_f32_16x16x32_bf16 v[192:195], a[244:247], a[112:115], v[192:195]
  v_mfma_f32_16x16x32_bf16 v[220:223], a[248:251], a[112:115], v[220:223]
  buffer_load_dwordx4 v10, s[12:15], s38 offen offset:3072 sc1 lds
  v_mfma_f32_16x16x32_bf16 v[248:251], a[252:255], a[112:115], v[248:251]
  v_mfma_f32_16x16x32_bf16 v[56:59], a[224:227], a[116:119], v[56:59]
  buffer_load_dwordx4 a[112:115], v30, s[8:11], s47 offen offset:2048 sc1
  v_mfma_f32_16x16x32_bf16 v[84:87], a[228:231], a[116:119], v[84:87]
  v_mfma_f32_16x16x32_bf16 v[112:115], a[232:235], a[116:119], v[112:115]
  v_mfma_f32_16x16x32_bf16 v[140:143], a[236:239], a[116:119], v[140:143]
  v_mfma_f32_16x16x32_bf16 v[168:171], a[240:243], a[116:119], v[168:171]
  v_mfma_f32_16x16x32_bf16 v[196:199], a[244:247], a[116:119], v[196:199]
  v_mfma_f32_16x16x32_bf16 v[224:227], a[248:251], a[116:119], v[224:227]
  v_mfma_f32_16x16x32_bf16 v[252:255], a[252:255], a[116:119], v[252:255]
  s_add_u32 s47, s29, 12288
  buffer_load_dwordx4 a[116:119], v30, s[8:11], s47 offen offset:0 sc1
  s_add_u32 s29, s29, 26624
  s_waitcnt vmcnt(15) lgkmcnt(0)
  v_mfma_f32_16x16x32_bf16 v[32:35], a[192:195], a[16:19], v[32:35]
  v_mfma_f32_16x16x32_bf16 v[60:63], a[196:199], a[16:19], v[60:63]
  ds_read_b64_tr_b16 a[224:225], v13 offset:24576
  v_mfma_f32_16x16x32_bf16 v[88:91], a[200:203], a[16:19], v[88:91]
  v_mfma_f32_16x16x32_bf16 v[116:119], a[204:207], a[16:19], v[116:119]
  ds_read_b64_tr_b16 a[226:227], v13 offset:28672
  v_mfma_f32_16x16x32_bf16 v[144:147], a[208:211], a[16:19], v[144:147]
  s_add_u32 m0, s28, 8192
  s_add_u32 s38, s36, 0
  buffer_load_dwordx4 v7, s[12:15], s38 offen offset:0 sc1 lds
  v_mfma_f32_16x16x32_bf16 v[172:175], a[212:215], a[16:19], v[172:175]
  ds_read_b64_tr_b16 a[228:229], v14 offset:24576
  v_mfma_f32_16x16x32_bf16 v[200:203], a[216:219], a[16:19], v[200:203]
  v_mfma_f32_16x16x32_bf16 v[228:231], a[220:223], a[16:19], v[228:231]
  ds_read_b64_tr_b16 a[230:231], v14 offset:28672
  v_mfma_f32_16x16x32_bf16 v[36:39], a[192:195], a[20:23], v[36:39]
  s_add_u32 s47, s29, 0
  buffer_load_dwordx4 a[16:19], v30, s[8:11], s47 offen offset:0 sc1
  v_mfma_f32_16x16x32_bf16 v[64:67], a[196:199], a[20:23], v[64:67]
  ds_read_b64_tr_b16 a[232:233], v15 offset:24576
  v_mfma_f32_16x16x32_bf16 v[92:95], a[200:203], a[20:23], v[92:95]
  buffer_load_dwordx4 v8, s[12:15], s38 offen offset:1024 sc1 lds
  v_mfma_f32_16x16x32_bf16 v[120:123], a[204:207], a[20:23], v[120:123]
  ds_read_b64_tr_b16 a[234:235], v15 offset:28672
  v_mfma_f32_16x16x32_bf16 v[148:151], a[208:211], a[20:23], v[148:151]
  v_mfma_f32_16x16x32_bf16 v[176:179], a[212:215], a[20:23], v[176:179]
  ds_read_b64_tr_b16 a[236:237], v16 offset:24576
  v_mfma_f32_16x16x32_bf16 v[204:207], a[216:219], a[20:23], v[204:207]
  v_mfma_f32_16x16x32_bf16 v[232:235], a[220:223], a[20:23], v[232:235]
  ds_read_b64_tr_b16 a[238:239], v16 offset:28672
  v_mfma_f32_16x16x32_bf16 v[40:43], a[192:195], a[24:27], v[40:43]
  buffer_load_dwordx4 a[20:23], v30, s[8:11], s47 offen offset:2048 sc1
  v_mfma_f32_16x16x32_bf16 v[68:71], a[196:199], a[24:27], v[68:71]
  ds_read_b64_tr_b16 a[240:241], v17 offset:24576
  v_mfma_f32_16x16x32_bf16 v[96:99], a[200:203], a[24:27], v[96:99]
  buffer_load_dwordx4 v9, s[12:15], s38 offen offset:2048 sc1 lds
  v_mfma_f32_16x16x32_bf16 v[124:127], a[204:207], a[24:27], v[124:127]
  ds_read_b64_tr_b16 a[242:243], v17 offset:28672
  v_mfma_f32_16x16x32_bf16 v[152:155], a[208:211], a[24:27], v[152:155]
  v_mfma_f32_16x16x32_bf16 v[180:183], a[212:215], a[24:27], v[180:183]
  ds_read_b64_tr_b16 a[244:245], v18 offset:24576
  v_mfma_f32_16x16x32_bf16 v[208:211], a[216:219], a[24:27], v[208:211]
  buffer_load_dwordx4 v10, s[12:15], s38 offen offset:3072 sc1 lds
  v_mfma_f32_16x16x32_bf16 v[236:239], a[220:223], a[24:27], v[236:239]
  ds_read_b64_tr_b16 a[246:247], v18 offset:28672
  v_mfma_f32_16x16x32_bf16 v[44:47], a[192:195], a[28:31], v[44:47]
  s_add_u32 s47, s29, 4096
  buffer_load_dwordx4 a[24:27], v30, s[8:11], s47 offen offset:0 sc1
  v_mfma_f32_16x16x32_bf16 v[72:75], a[196:199], a[28:31], v[72:75]
  ds_read_b64_tr_b16 a[248:249], v19 offset:24576
  v_mfma_f32_16x16x32_bf16 v[100:103], a[200:203], a[28:31], v[100:103]
  v_mfma_f32_16x16x32_bf16 v[128:131], a[204:207], a[28:31], v[128:131]
  ds_read_b64_tr_b16 a[250:251], v19 offset:28672
  v_mfma_f32_16x16x32_bf16 v[156:159], a[208:211], a[28:31], v[156:159]
  s_add_u32 m0, s28, 12288
  s_add_u32 s38, s36, 32768
  buffer_load_dwordx4 v7, s[12:15], s38 offen offset:0 sc1 lds
  v_mfma_f32_16x16x32_bf16 v[184:187], a[212:215], a[28:31], v[184:187]
  s_add_u32 s35, s35, 1
  ds_read_b64_tr_b16 a[252:253], v20 offset:24576
  v_mfma_f32_16x16x32_bf16 v[212:215], a[216:219], a[28:31], v[212:215]
  s_and_b32 s48, s35, 14
  v_mfma_f32_16x16x32_bf16 v[240:243], a[220:223], a[28:31], v[240:243]
  s_waitcnt lgkmcnt(8)
  s_lshl_b32 s48, s48, 17
  ds_read_b64_tr_b16 a[254:255], v20 offset:28672
  v_mfma_f32_16x16x32_bf16 v[48:51], a[192:195], a[48:51], v[48:51]
  s_add_u32 s36, s30, s48
  buffer_load_dwordx4 a[28:31], v30, s[8:11], s47 offen offset:2048 sc1
  v_mfma_f32_16x16x32_bf16 v[76:79], a[196:199], a[48:51], v[76:79]
  s_and_b32 s48, s35, 16
  v_mfma_f32_16x16x32_bf16 v[104:107], a[200:203], a[48:51], v[104:107]
  s_lshl_b32 s48, s48, 13
  buffer_load_dwordx4 v8, s[12:15], s38 offen offset:1024 sc1 lds
  v_mfma_f32_16x16x32_bf16 v[132:135], a[204:207], a[48:51], v[132:135]
  s_add_u32 s36, s36, s48
  v_mfma_f32_16x16x32_bf16 v[160:163], a[208:211], a[48:51], v[160:163]
  s_and_b32 s48, s35, 1
  v_mfma_f32_16x16x32_bf16 v[188:191], a[212:215], a[48:51], v[188:191]
  s_lshl_b32 s48, s48, 16
  v_mfma_f32_16x16x32_bf16 v[216:219], a[216:219], a[48:51], v[216:219]
  s_add_u32 s36, s36, s48
  v_mfma_f32_16x16x32_bf16 v[244:247], a[220:223], a[48:51], v[244:247]
  v_mfma_f32_16x16x32_bf16 v[52:55], a[192:195], a[52:55], v[52:55]
  s_add_u32 s47, s29, 8192
  buffer_load_dwordx4 a[48:51], v30, s[8:11], s47 offen offset:0 sc1
  v_mfma_f32_16x16x32_bf16 v[80:83], a[196:199], a[52:55], v[80:83]
  v_mfma_f32_16x16x32_bf16 v[108:111], a[200:203], a[52:55], v[108:111]
  buffer_load_dwordx4 v9, s[12:15], s38 offen offset:2048 sc1 lds
  v_mfma_f32_16x16x32_bf16 v[136:139], a[204:207], a[52:55], v[136:139]
  v_mfma_f32_16x16x32_bf16 v[164:167], a[208:211], a[52:55], v[164:167]
  v_mfma_f32_16x16x32_bf16 v[192:195], a[212:215], a[52:55], v[192:195]
  v_mfma_f32_16x16x32_bf16 v[220:223], a[216:219], a[52:55], v[220:223]
  buffer_load_dwordx4 v10, s[12:15], s38 offen offset:3072 sc1 lds
  v_mfma_f32_16x16x32_bf16 v[248:251], a[220:223], a[52:55], v[248:251]
  v_mfma_f32_16x16x32_bf16 v[56:59], a[192:195], a[56:59], v[56:59]
  buffer_load_dwordx4 a[52:55], v30, s[8:11], s47 offen offset:2048 sc1
  v_mfma_f32_16x16x32_bf16 v[84:87], a[196:199], a[56:59], v[84:87]
  v_mfma_f32_16x16x32_bf16 v[112:115], a[200:203], a[56:59], v[112:115]
  v_mfma_f32_16x16x32_bf16 v[140:143], a[204:207], a[56:59], v[140:143]
  v_mfma_f32_16x16x32_bf16 v[168:171], a[208:211], a[56:59], v[168:171]
  v_mfma_f32_16x16x32_bf16 v[196:199], a[212:215], a[56:59], v[196:199]
  v_mfma_f32_16x16x32_bf16 v[224:227], a[216:219], a[56:59], v[224:227]
  v_mfma_f32_16x16x32_bf16 v[252:255], a[220:223], a[56:59], v[252:255]
  s_add_u32 s47, s29, 12288
  buffer_load_dwordx4 a[56:59], v30, s[8:11], s47 offen offset:0 sc1
  s_add_u32 s29, s29, 26624
  s_waitcnt vmcnt(15) lgkmcnt(0)
  v_mfma_f32_16x16x32_bf16 v[32:35], a[224:227], a[60:63], v[32:35]
  v_mfma_f32_16x16x32_bf16 v[60:63], a[228:231], a[60:63], v[60:63]
  ds_read_b64_tr_b16 a[192:193], v13 offset:16384
  v_mfma_f32_16x16x32_bf16 v[88:91], a[232:235], a[60:63], v[88:91]
  global_load_dwordx4 v[24:27], v11, s[98:99] sc1
  v_mfma_f32_16x16x32_bf16 v[116:119], a[236:239], a[60:63], v[116:119]
  ds_read_b64_tr_b16 a[194:195], v13 offset:20480
  v_mfma_f32_16x16x32_bf16 v[144:147], a[240:243], a[60:63], v[144:147]
  s_add_u32 m0, s28, 24576
  s_add_u32 s38, s36, 0
  buffer_load_dwordx4 v7, s[12:15], s38 offen offset:0 sc1 lds
  v_mfma_f32_16x16x32_bf16 v[172:175], a[244:247], a[60:63], v[172:175]
  ds_read_b64_tr_b16 a[196:197], v14 offset:16384
  v_mfma_f32_16x16x32_bf16 v[200:203], a[248:251], a[60:63], v[200:203]
  v_mfma_f32_16x16x32_bf16 v[228:231], a[252:255], a[60:63], v[228:231]
  ds_read_b64_tr_b16 a[198:199], v14 offset:20480
  v_mfma_f32_16x16x32_bf16 v[36:39], a[224:227], a[80:83], v[36:39]
  s_add_u32 s47, s29, 0
  buffer_load_dwordx4 a[60:63], v30, s[8:11], s47 offen offset:0 sc1
  v_mfma_f32_16x16x32_bf16 v[64:67], a[228:231], a[80:83], v[64:67]
  ds_read_b64_tr_b16 a[200:201], v15 offset:16384
  v_mfma_f32_16x16x32_bf16 v[92:95], a[232:235], a[80:83], v[92:95]
  buffer_load_dwordx4 v8, s[12:15], s38 offen offset:1024 sc1 lds
  v_mfma_f32_16x16x32_bf16 v[120:123], a[236:239], a[80:83], v[120:123]
  ds_read_b64_tr_b16 a[202:203], v15 offset:20480
  v_mfma_f32_16x16x32_bf16 v[148:151], a[240:243], a[80:83], v[148:151]
  v_mfma_f32_16x16x32_bf16 v[176:179], a[244:247], a[80:83], v[176:179]
  ds_read_b64_tr_b16 a[204:205], v16 offset:16384
  v_mfma_f32_16x16x32_bf16 v[204:207], a[248:251], a[80:83], v[204:207]
  v_mfma_f32_16x16x32_bf16 v[232:235], a[252:255], a[80:83], v[232:235]
  ds_read_b64_tr_b16 a[206:207], v16 offset:20480
  v_mfma_f32_16x16x32_bf16 v[40:43], a[224:227], a[84:87], v[40:43]
  buffer_load_dwordx4 a[80:83], v30, s[8:11], s47 offen offset:2048 sc1
  v_mfma_f32_16x16x32_bf16 v[68:71], a[228:231], a[84:87], v[68:71]
  ds_read_b64_tr_b16 a[208:209], v17 offset:16384
  v_mfma_f32_16x16x32_bf16 v[96:99], a[232:235], a[84:87], v[96:99]
  buffer_load_dwordx4 v9, s[12:15], s38 offen offset:2048 sc1 lds
  v_mfma_f32_16x16x32_bf16 v[124:127], a[236:239], a[84:87], v[124:127]
  ds_read_b64_tr_b16 a[210:211], v17 offset:20480
  v_mfma_f32_16x16x32_bf16 v[152:155], a[240:243], a[84:87], v[152:155]
  v_mfma_f32_16x16x32_bf16 v[180:183], a[244:247], a[84:87], v[180:183]
  ds_read_b64_tr_b16 a[212:213], v18 offset:16384
  v_mfma_f32_16x16x32_bf16 v[208:211], a[248:251], a[84:87], v[208:211]
  buffer_load_dwordx4 v10, s[12:15], s38 offen offset:3072 sc1 lds
  v_mfma_f32_16x16x32_bf16 v[236:239], a[252:255], a[84:87], v[236:239]
  ds_read_b64_tr_b16 a[214:215], v18 offset:20480
  v_mfma_f32_16x16x32_bf16 v[44:47], a[224:227], a[88:91], v[44:47]
  s_add_u32 s47, s29, 4096
  buffer_load_dwordx4 a[84:87], v30, s[8:11], s47 offen offset:0 sc1
  v_mfma_f32_16x16x32_bf16 v[72:75], a[228:231], a[88:91], v[72:75]
  ds_read_b64_tr_b16 a[216:217], v19 offset:16384
  v_mfma_f32_16x16x32_bf16 v[100:103], a[232:235], a[88:91], v[100:103]
  v_mfma_f32_16x16x32_bf16 v[128:131], a[236:239], a[88:91], v[128:131]
  ds_read_b64_tr_b16 a[218:219], v19 offset:20480
  v_mfma_f32_16x16x32_bf16 v[156:159], a[240:243], a[88:91], v[156:159]
  s_add_u32 m0, s28, 28672
  s_add_u32 s38, s36, 32768
  buffer_load_dwordx4 v7, s[12:15], s38 offen offset:0 sc1 lds
  v_mfma_f32_16x16x32_bf16 v[184:187], a[244:247], a[88:91], v[184:187]
  s_add_u32 s35, s35, 1
  ds_read_b64_tr_b16 a[220:221], v20 offset:16384
  v_mfma_f32_16x16x32_bf16 v[212:215], a[248:251], a[88:91], v[212:215]
  s_and_b32 s48, s35, 14
  v_mfma_f32_16x16x32_bf16 v[240:243], a[252:255], a[88:91], v[240:243]
  s_waitcnt lgkmcnt(8)
  s_lshl_b32 s48, s48, 17
  ds_read_b64_tr_b16 a[222:223], v20 offset:20480
  v_mfma_f32_16x16x32_bf16 v[48:51], a[224:227], a[92:95], v[48:51]
  s_add_u32 s36, s30, s48
  buffer_load_dwordx4 a[88:91], v30, s[8:11], s47 offen offset:2048 sc1
  v_mfma_f32_16x16x32_bf16 v[76:79], a[228:231], a[92:95], v[76:79]
  s_and_b32 s48, s35, 16
  v_mfma_f32_16x16x32_bf16 v[104:107], a[232:235], a[92:95], v[104:107]
  s_lshl_b32 s48, s48, 13
  buffer_load_dwordx4 v8, s[12:15], s38 offen offset:1024 sc1 lds
  v_mfma_f32_16x16x32_bf16 v[132:135], a[236:239], a[92:95], v[132:135]
  s_add_u32 s36, s36, s48
  v_mfma_f32_16x16x32_bf16 v[160:163], a[240:243], a[92:95], v[160:163]
  s_and_b32 s48, s35, 1
  v_mfma_f32_16x16x32_bf16 v[188:191], a[244:247], a[92:95], v[188:191]
  s_lshl_b32 s48, s48, 16
  v_mfma_f32_16x16x32_bf16 v[216:219], a[248:251], a[92:95], v[216:219]
  s_add_u32 s36, s36, s48
  v_mfma_f32_16x16x32_bf16 v[244:247], a[252:255], a[92:95], v[244:247]
  v_mfma_f32_16x16x32_bf16 v[52:55], a[224:227], a[112:115], v[52:55]
  s_add_u32 s47, s29, 8192
  buffer_load_dwordx4 a[92:95], v30, s[8:11], s47 offen offset:0 sc1
  v_mfma_f32_16x16x32_bf16 v[80:83], a[228:231], a[112:115], v[80:83]
  v_mfma_f32_16x16x32_bf16 v[108:111], a[232:235], a[112:115], v[108:111]
  buffer_load_dwordx4 v9, s[12:15], s38 offen offset:2048 sc1 lds
  v_mfma_f32_16x16x32_bf16 v[136:139], a[236:239], a[112:115], v[136:139]
  v_mfma_f32_16x16x32_bf16 v[164:167], a[240:243], a[112:115], v[164:167]
  v_mfma_f32_16x16x32_bf16 v[192:195], a[244:247], a[112:115], v[192:195]
  v_mfma_f32_16x16x32_bf16 v[220:223], a[248:251], a[112:115], v[220:223]
  buffer_load_dwordx4 v10, s[12:15], s38 offen offset:3072 sc1 lds
  v_mfma_f32_16x16x32_bf16 v[248:251], a[252:255], a[112:115], v[248:251]
  v_mfma_f32_16x16x32_bf16 v[56:59], a[224:227], a[116:119], v[56:59]
  buffer_load_dwordx4 a[112:115], v30, s[8:11], s47 offen offset:2048 sc1
  v_mfma_f32_16x16x32_bf16 v[84:87], a[228:231], a[116:119], v[84:87]
  v_mfma_f32_16x16x32_bf16 v[112:115], a[232:235], a[116:119], v[112:115]
  v_mfma_f32_16x16x32_bf16 v[140:143], a[236:239], a[116:119], v[140:143]
  v_mfma_f32_16x16x32_bf16 v[168:171], a[240:243], a[116:119], v[168:171]
  v_mfma_f32_16x16x32_bf16 v[196:199], a[244:247], a[116:119], v[196:199]
  v_mfma_f32_16x16x32_bf16 v[224:227], a[248:251], a[116:119], v[224:227]
  v_mfma_f32_16x16x32_bf16 v[252:255], a[252:255], a[116:119], v[252:255]
  s_add_u32 s47, s29, 12288
  buffer_load_dwordx4 a[116:119], v30, s[8:11], s47 offen offset:0 sc1
  s_add_u32 s29, s29, 26624
  s_add_u32 s31, s31, 1
  s_cmp_lt_u32 s31, 7
  s_cbranch_scc1 L2a_loop
  s_waitcnt vmcnt(15) lgkmcnt(0)
  v_mfma_f32_16x16x32_bf16 v[32:35], a[192:195], a[16:19], v[32:35]
  v_mfma_f32_16x16x32_bf16 v[60:63], a[196:199], a[16:19], v[60:63]
  ds_read_b64_tr_b16 a[224:225], v13 offset:0
  v_mfma_f32_16x16x32_bf16 v[88:91], a[200:203], a[16:19], v[88:91]
  v_mfma_f32_16x16x32_bf16 v[116:119], a[204:207], a[16:19], v[116:119]
  ds_read_b64_tr_b16 a[226:227], v13 offset:4096
  v_mfma_f32_16x16x32_bf16 v[144:147], a[208:211], a[16:19], v[144:147]
  v_mfma_f32_16x16x32_bf16 v[172:175], a[212:215], a[16:19], v[172:175]
  ds_read_b64_tr_b16 a[228:229], v14 offset:0
  v_mfma_f32_16x16x32_bf16 v[200:203], a[216:219], a[16:19], v[200:203]
  v_mfma_f32_16x16x32_bf16 v[228:231], a[220:223], a[16:19], v[228:231]
  ds_read_b64_tr_b16 a[230:231], v14 offset:4096
  v_mfma_f32_16x16x32_bf16 v[36:39], a[192:195], a[20:23], v[36:39]
  s_add_u32 s47, s29, 0
  buffer_load_dwordx4 a[16:19], v30, s[8:11], s47 offen offset:0 sc1
  v_mfma_f32_16x16x32_bf16 v[64:67], a[196:199], a[20:23], v[64:67]
  ds_read_b64_tr_b16 a[232:233], v15 offset:0
  v_mfma_f32_16x16x32_bf16 v[92:95], a[200:203], a[20:23], v[92:95]
  v_mfma_f32_16x16x32_bf16 v[120:123], a[204:207], a[20:23], v[120:123]
  ds_read_b64_tr_b16 a[234:235], v15 offset:4096
  v_mfma_f32_16x16x32_bf16 v[148:151], a[208:211], a[20:23], v[148:151]
  v_mfma_f32_16x16x32_bf16 v[176:179], a[212:215], a[20:23], v[176:179]
  ds_read_b64_tr_b16 a[236:237], v16 offset:0
  v_mfma_f32_16x16x32_bf16 v[204:207], a[216:219], a[20:23], v[204:207]
  v_mfma_f32_16x16x32_bf16 v[232:235], a[220:223], a[20:23], v[232:235]
  ds_read_b64_tr_b16 a[238:239], v16 offset:4096
  v_mfma_f32_16x16x32_bf16 v[40:43], a[192:195], a[24:27], v[40:43]
  buffer_load_dwordx4 a[20:23], v30, s[8:11], s47 offen offset:2048 sc1
  v_mfma_f32_16x16x32_bf16 v[68:71], a[196:199], a[24:27], v[68:71]
  ds_read_b64_tr_b16 a[240:241], v17 offset:0
  v_mfma_f32_16x16x32_bf16 v[96:99], a[200:203], a[24:27], v[96:99]
  v_mfma_f32_16x16x32_bf16 v[124:127], a[204:207], a[24:27], v[124:127]
  ds_read_b64_tr_b16 a[242:243], v17 offset:4096
  v_mfma_f32_16x16x32_bf16 v[152:155], a[208:211], a[24:27], v[152:155]
  v_mfma_f32_16x16x32_bf16 v[180:183], a[212:215], a[24:27], v[180:183]
  ds_read_b64_tr_b16 a[244:245], v18 offset:0
  v_mfma_f32_16x16x32_bf16 v[208:211], a[216:219], a[24:27], v[208:211]
  v_mfma_f32_16x16x32_bf16 v[236:239], a[220:223], a[24:27], v[236:239]
  ds_read_b64_tr_b16 a[246:247], v18 offset:4096
  v_mfma_f32_16x16x32_bf16 v[44:47], a[192:195], a[28:31], v[44:47]
  s_add_u32 s47, s29, 4096
  buffer_load_dwordx4 a[24:27], v30, s[8:11], s47 offen offset:0 sc1
  v_mfma_f32_16x16x32_bf16 v[72:75], a[196:199], a[28:31], v[72:75]
  ds_read_b64_tr_b16 a[248:249], v19 offset:0
  v_mfma_f32_16x16x32_bf16 v[100:103], a[200:203], a[28:31], v[100:103]
  v_mfma_f32_16x16x32_bf16 v[128:131], a[204:207], a[28:31], v[128:131]
  ds_read_b64_tr_b16 a[250:251], v19 offset:4096
  v_mfma_f32_16x16x32_bf16 v[156:159], a[208:211], a[28:31], v[156:159]
  v_mfma_f32_16x16x32_bf16 v[184:187], a[212:215], a[28:31], v[184:187]
  ds_read_b64_tr_b16 a[252:253], v20 offset:0
  v_mfma_f32_16x16x32_bf16 v[212:215], a[216:219], a[28:31], v[212:215]
  v_mfma_f32_16x16x32_bf16 v[240:243], a[220:223], a[28:31], v[240:243]
  s_waitcnt lgkmcnt(8)
  ds_read_b64_tr_b16 a[254:255], v20 offset:4096
  v_mfma_f32_16x16x32_bf16 v[48:51], a[192:195], a[48:51], v[48:51]
  buffer_load_dwordx4 a[28:31], v30, s[8:11], s47 offen offset:2048 sc1
  v_mfma_f32_16x16x32_bf16 v[76:79], a[196:199], a[48:51], v[76:79]
  v_mfma_f32_16x16x32_bf16 v[104:107], a[200:203], a[48:51], v[104:107]
  v_mfma_f32_16x16x32_bf16 v[132:135], a[204:207], a[48:51], v[132:135]
  v_mfma_f32_16x16x32_bf16 v[160:163], a[208:211], a[48:51], v[160:163]
  v_mfma_f32_16x16x32_bf16 v[188:191], a[212:215], a[48:51], v[188:191]
  v_mfma_f32_16x16x32_bf16 v[216:219], a[216:219], a[48:51], v[216:219]
  v_mfma_f32_16x16x32_bf16 v[244:247], a[220:223], a[48:51], v[244:247]
  v_mfma_f32_16x16x32_bf16 v[52:55], a[192:195], a[52:55], v[52:55]
  s_add_u32 s47, s29, 8192
  buffer_load_dwordx4 a[48:51], v30, s[8:11], s47 offen offset:0 sc1
  v_mfma_f32_16x16x32_bf16 v[80:83], a[196:199], a[52:55], v[80:83]
  v_mfma_f32_16x16x32_bf16 v[108:111], a[200:203], a[52:55], v[108:111]
  v_mfma_f32_16x16x32_bf16 v[136:139], a[204:207], a[52:55], v[136:139]
  v_mfma_f32_16x16x32_bf16 v[164:167], a[208:211], a[52:55], v[164:167]
  v_mfma_f32_16x16x32_bf16 v[192:195], a[212:215], a[52:55], v[192:195]
  v_mfma_f32_16x16x32_bf16 v[220:223], a[216:219], a[52:55], v[220:223]
  v_mfma_f32_16x16x32_bf16 v[248:251], a[220:223], a[52:55], v[248:251]
  v_mfma_f32_16x16x32_bf16 v[56:59], a[192:195], a[56:59], v[56:59]
  buffer_load_dwordx4 a[52:55], v30, s[8:11], s47 offen offset:2048 sc1
  v_mfma_f32_16x16x32_bf16 v[84:87], a[196:199], a[56:59], v[84:87]
  v_mfma_f32_16x16x32_bf16 v[112:115], a[200:203], a[56:59], v[112:115]
  v_mfma_f32_16x16x32_bf16 v[140:143], a[204:207], a[56:59], v[140:143]
  v_mfma_f32_16x16x32_bf16 v[168:171], a[208:211], a[56:59], v[168:171]
  v_mfma_f32_16x16x32_bf16 v[196:199], a[212:215], a[56:59], v[196:199]
  v_mfma_f32_16x16x32_bf16 v[224:227], a[216:219], a[56:59], v[224:227]
  v_mfma_f32_16x16x32_bf16 v[252:255], a[220:223], a[56:59], v[252:255]
  s_add_u32 s47, s29, 12288
  buffer_load_dwordx4 a[56:59], v30, s[8:11], s47 offen offset:0 sc1
  s_add_u32 s29, s29, 26624
  s_waitcnt vmcnt(7) lgkmcnt(0)
  v_mfma_f32_16x16x32_bf16 v[32:35], a[224:227], a[60:63], v[32:35]
  v_mfma_f32_16x16x32_bf16 v[60:63], a[228:231], a[60:63], v[60:63]
  ds_read_b64_tr_b16 a[192:193], v13 offset:8192
  v_mfma_f32_16x16x32_bf16 v[88:91], a[232:235], a[60:63], v[88:91]
  v_mfma_f32_16x16x32_bf16 v[116:119], a[236:239], a[60:63], v[116:119]
  ds_read_b64_tr_b16 a[194:195], v13 offset:12288
  v_mfma_f32_16x16x32_bf16 v[144:147], a[240:243], a[60:63], v[144:147]
  v_mfma_f32_16x16x32_bf16 v[172:175], a[244:247], a[60:63], v[172:175]
  ds_read_b64_tr_b16 a[196:197], v14 offset:8192
  v_mfma_f32_16x16x32_bf16 v[200:203], a[248:251], a[60:63], v[200:203]
  v_mfma_f32_16x16x32_bf16 v[228:231], a[252:255], a[60:63], v[228:231]
  ds_read_b64_tr_b16 a[198:199], v14 offset:12288
  v_mfma_f32_16x16x32_bf16 v[36:39], a[224:227], a[80:83], v[36:39]
  s_add_u32 s47, s29, 0
  buffer_load_dwordx4 a[60:63], v30, s[8:11], s47 offen offset:0 sc1
  v_mfma_f32_16x16x32_bf16 v[64:67], a[228:231], a[80:83], v[64:67]
  ds_read_b64_tr_b16 a[200:201], v15 offset:8192
  v_mfma_f32_16x16x32_bf16 v[92:95], a[232:235], a[80:83], v[92:95]
  v_mfma_f32_16x16x32_bf16 v[120:123], a[236:239], a[80:83], v[120:123]
  ds_read_b64_tr_b16 a[202:203], v15 offset:12288
  v_mfma_f32_16x16x32_bf16 v[148:151], a[240:243], a[80:83], v[148:151]
  v_mfma_f32_16x16x32_bf16 v[176:179], a[244:247], a[80:83], v[176:179]
  ds_read_b64_tr_b16 a[204:205], v16 offset:8192
  v_mfma_f32_16x16x32_bf16 v[204:207], a[248:251], a[80:83], v[204:207]
  v_mfma_f32_16x16x32_bf16 v[232:235], a[252:255], a[80:83], v[232:235]
  ds_read_b64_tr_b16 a[206:207], v16 offset:12288
  v_mfma_f32_16x16x32_bf16 v[40:43], a[224:227], a[84:87], v[40:43]
  buffer_load_dwordx4 a[80:83], v30, s[8:11], s47 offen offset:2048 sc1
  v_mfma_f32_16x16x32_bf16 v[68:71], a[228:231], a[84:87], v[68:71]
  ds_read_b64_tr_b16 a[208:209], v17 offset:8192
  v_mfma_f32_16x16x32_bf16 v[96:99], a[232:235], a[84:87], v[96:99]
  v_mfma_f32_16x16x32_bf16 v[124:127], a[236:239], a[84:87], v[124:127]
  ds_read_b64_tr_b16 a[210:211], v17 offset:12288
  v_mfma_f32_16x16x32_bf16 v[152:155], a[240:243], a[84:87], v[152:155]
  v_mfma_f32_16x16x32_bf16 v[180:183], a[244:247], a[84:87], v[180:183]
  ds_read_b64_tr_b16 a[212:213], v18 offset:8192
  v_mfma_f32_16x16x32_bf16 v[208:211], a[248:251], a[84:87], v[208:211]
  v_mfma_f32_16x16x32_bf16 v[236:239], a[252:255], a[84:87], v[236:239]
  ds_read_b64_tr_b16 a[214:215], v18 offset:12288
  v_mfma_f32_16x16x32_bf16 v[44:47], a[224:227], a[88:91], v[44:47]
  s_add_u32 s47, s29, 4096
  buffer_load_dwordx4 a[84:87], v30, s[8:11], s47 offen offset:0 sc1
  v_mfma_f32_16x16x32_bf16 v[72:75], a[228:231], a[88:91], v[72:75]
  ds_read_b64_tr_b16 a[216:217], v19 offset:8192
  v_mfma_f32_16x16x32_bf16 v[100:103], a[232:235], a[88:91], v[100:103]
  v_mfma_f32_16x16x32_bf16 v[128:131], a[236:239], a[88:91], v[128:131]
  ds_read_b64_tr_b16 a[218:219], v19 offset:12288
  v_mfma_f32_16x16x32_bf16 v[156:159], a[240:243], a[88:91], v[156:159]
  v_mfma_f32_16x16x32_bf16 v[184:187], a[244:247], a[88:91], v[184:187]
  ds_read_b64_tr_b16 a[220:221], v20 offset:8192
  v_mfma_f32_16x16x32_bf16 v[212:215], a[248:251], a[88:91], v[212:215]
  v_mfma_f32_16x16x32_bf16 v[240:243], a[252:255], a[88:91], v[240:243]
  s_waitcnt lgkmcnt(8)
  ds_read_b64_tr_b16 a[222:223], v20 offset:12288
  v_mfma_f32_16x16x32_bf16 v[48:51], a[224:227], a[92:95], v[48:51]
  buffer_load_dwordx4 a[88:91], v30, s[8:11], s47 offen offset:2048 sc1
  v_mfma_f32_16x16x32_bf16 v[76:79], a[228:231], a[92:95], v[76:79]
  v_mfma_f32_16x16x32_bf16 v[104:107], a[232:235], a[92:95], v[104:107]
  v_mfma_f32_16x16x32_bf16 v[132:135], a[236:239], a[92:95], v[132:135]
  v_mfma_f32_16x16x32_bf16 v[160:163], a[240:243], a[92:95], v[160:163]
  v_mfma_f32_16x16x32_bf16 v[188:191], a[244:247], a[92:95], v[188:191]
  v_mfma_f32_16x16x32_bf16 v[216:219], a[248:251], a[92:95], v[216:219]
  v_mfma_f32_16x16x32_bf16 v[244:247], a[252:255], a[92:95], v[244:247]
  v_mfma_f32_16x16x32_bf16 v[52:55], a[224:227], a[112:115], v[52:55]
  s_add_u32 s47, s29, 8192
  buffer_load_dwordx4 a[92:95], v30, s[8:11], s47 offen offset:0 sc1
  v_mfma_f32_16x16x32_bf16 v[80:83], a[228:231], a[112:115], v[80:83]
  v_mfma_f32_16x16x32_bf16 v[108:111], a[232:235], a[112:115], v[108:111]
  v_mfma_f32_16x16x32_bf16 v[136:139], a[236:239], a[112:115], v[136:139]
  v_mfma_f32_16x16x32_bf16 v[164:167], a[240:243], a[112:115], v[164:167]
  v_mfma_f32_16x16x32_bf16 v[192:195], a[244:247], a[112:115], v[192:195]
  v_mfma_f32_16x16x32_bf16 v[220:223], a[248:251], a[112:115], v[220:223]
  v_mfma_f32_16x16x32_bf16 v[248:251], a[252:255], a[112:115], v[248:251]
  v_mfma_f32_16x16x32_bf16 v[56:59], a[224:227], a[116:119], v[56:59]
  buffer_load_dwordx4 a[112:115], v30, s[8:11], s47 offen offset:2048 sc1
  v_mfma_f32_16x16x32_bf16 v[84:87], a[228:231], a[116:119], v[84:87]
  v_mfma_f32_16x16x32_bf16 v[112:115], a[232:235], a[116:119], v[112:115]
  v_mfma_f32_16x16x32_bf16 v[140:143], a[236:239], a[116:119], v[140:143]
  v_mfma_f32_16x16x32_bf16 v[168:171], a[240:243], a[116:119], v[168:171]
  v_mfma_f32_16x16x32_bf16 v[196:199], a[244:247], a[116:119], v[196:199]
  v_mfma_f32_16x16x32_bf16 v[224:227], a[248:251], a[116:119], v[224:227]
  v_mfma_f32_16x16x32_bf16 v[252:255], a[252:255], a[116:119], v[252:255]
  s_add_u32 s47, s29, 12288
  buffer_load_dwordx4 a[116:119], v30, s[8:11], s47 offen offset:0 sc1
  s_add_u32 s29, s29, 26624
  s_waitcnt vmcnt(7) lgkmcnt(0)
  v_mfma_f32_16x16x32_bf16 v[144:147], a[208:211], a[16:19], v[144:147]
  ds_read_b64_tr_b16 a[240:241], v17 offset:24576
  v_mfma_f32_16x16x32_bf16 v[172:175], a[212:215], a[16:19], v[172:175]
  ds_read_b64_tr_b16 a[242:243], v17 offset:28672
  v_lshl_add_u32 v22, v1, 4, s28
  v_mfma_f32_16x16x32_bf16 v[200:203], a[216:219], a[16:19], v[200:203]
  ds_read_b64_tr_b16 a[244:245], v18 offset:24576
  v_xor_b32 v23, 65536, v22
  v_mfma_f32_16x16x32_bf16 v[228:231], a[220:223], a[16:19], v[228:231]
  ds_read_b64_tr_b16 a[246:247], v18 offset:28672
  v_xor_b32 v28, 98304, v22
  v_mfma_f32_16x16x32_bf16 v[148:151], a[208:211], a[20:23], v[148:151]
  ds_read_b64_tr_b16 a[248:249], v19 offset:24576
  v_mfma_f32_16x16x32_bf16 v[176:179], a[212:215], a[20:23], v[176:179]
  ds_read_b64_tr_b16 a[250:251], v19 offset:28672
  v_mfma_f32_16x16x32_bf16 v[204:207], a[216:219], a[20:23], v[204:207]
  ds_read_b64_tr_b16 a[252:253], v20 offset:24576
  v_mfma_f32_16x16x32_bf16 v[232:235], a[220:223], a[20:23], v[232:235]
  ds_read_b64_tr_b16 a[254:255], v20 offset:28672
  v_mfma_f32_16x16x32_bf16 v[152:155], a[208:211], a[24:27], v[152:155]
  ds_read_b64_tr_b16 a[224:225], v13 offset:24576
  v_mfma_f32_16x16x32_bf16 v[180:183], a[212:215], a[24:27], v[180:183]
  ds_read_b64_tr_b16 a[226:227], v13 offset:28672
  v_mfma_f32_16x16x32_bf16 v[208:211], a[216:219], a[24:27], v[208:211]
  ds_read_b64_tr_b16 a[228:229], v14 offset:24576
  v_mfma_f32_16x16x32_bf16 v[236:239], a[220:223], a[24:27], v[236:239]
  ds_read_b64_tr_b16 a[230:231], v14 offset:28672
  v_mfma_f32_16x16x32_bf16 v[156:159], a[208:211], a[28:31], v[156:159]
  ds_read_b64_tr_b16 a[232:233], v15 offset:24576
  v_mfma_f32_16x16x32_bf16 v[184:187], a[212:215], a[28:31], v[184:187]
  ds_read_b64_tr_b16 a[234:235], v15 offset:28672
  v_mfma_f32_16x16x32_bf16 v[212:215], a[216:219], a[28:31], v[212:215]
  ds_read_b64_tr_b16 a[236:237], v16 offset:24576
  v_mfma_f32_16x16x32_bf16 v[240:243], a[220:223], a[28:31], v[240:243]
  s_waitcnt lgkmcnt(8)
  ds_read_b64_tr_b16 a[238:239], v16 offset:28672
  v_mfma_f32_16x16x32_bf16 v[160:163], a[208:211], a[48:51], v[160:163]
  v_mfma_f32_16x16x32_bf16 v[188:191], a[212:215], a[48:51], v[188:191]
  v_mfma_f32_16x16x32_bf16 v[216:219], a[216:219], a[48:51], v[216:219]
  v_mfma_f32_16x16x32_bf16 v[244:247], a[220:223], a[48:51], v[244:247]
  v_mfma_f32_16x16x32_bf16 v[164:167], a[208:211], a[52:55], v[164:167]
  v_mfma_f32_16x16x32_bf16 v[192:195], a[212:215], a[52:55], v[192:195]
  v_mfma_f32_16x16x32_bf16 v[220:223], a[216:219], a[52:55], v[220:223]
  v_mfma_f32_16x16x32_bf16 v[248:251], a[220:223], a[52:55], v[248:251]
  v_mfma_f32_16x16x32_bf16 v[168:171], a[208:211], a[56:59], v[168:171]
  v_mfma_f32_16x16x32_bf16 v[196:199], a[212:215], a[56:59], v[196:199]
  v_mfma_f32_16x16x32_bf16 v[224:227], a[216:219], a[56:59], v[224:227]
  v_mfma_f32_16x16x32_bf16 v[252:255], a[220:223], a[56:59], v[252:255]
  s_waitcnt vmcnt(0)
  v_mfma_f32_16x16x32_bf16 v[144:147], a[240:243], a[60:63], v[144:147]
  v_mfma_f32_16x16x32_bf16 v[172:175], a[244:247], a[60:63], v[172:175]
  v_mfma_f32_16x16x32_bf16 v[200:203], a[248:251], a[60:63], v[200:203]
  s_waitcnt lgkmcnt(8)
  v_mfma_f32_16x16x32_bf16 v[228:231], a[252:255], a[60:63], v[228:231]
  v_mfma_f32_16x16x32_bf16 v[148:151], a[240:243], a[80:83], v[148:151]
  v_mfma_f32_16x16x32_bf16 v[176:179], a[244:247], a[80:83], v[176:179]
  v_mfma_f32_16x16x32_bf16 v[204:207], a[248:251], a[80:83], v[204:207]
  v_mfma_f32_16x16x32_bf16 v[232:235], a[252:255], a[80:83], v[232:235]
  v_mfma_f32_16x16x32_bf16 v[152:155], a[240:243], a[84:87], v[152:155]
  v_mfma_f32_16x16x32_bf16 v[180:183], a[244:247], a[84:87], v[180:183]
  v_mfma_f32_16x16x32_bf16 v[208:211], a[248:251], a[84:87], v[208:211]
  ds_write_b128 v22, v[144:147] offset:14336
  v_mfma_f32_16x16x32_bf16 v[236:239], a[252:255], a[84:87], v[236:239]
  v_mfma_f32_16x16x32_bf16 v[156:159], a[240:243], a[88:91], v[156:159]
  ds_write_b128 v22, v[172:175] offset:21504
  v_mfma_f32_16x16x32_bf16 v[184:187], a[244:247], a[88:91], v[184:187]
  v_mfma_f32_16x16x32_bf16 v[212:215], a[248:251], a[88:91], v[212:215]
  v_mfma_f32_16x16x32_bf16 v[240:243], a[252:255], a[88:91], v[240:243]
  ds_write_b128 v22, v[200:203] offset:0
  v_mfma_f32_16x16x32_bf16 v[160:163], a[240:243], a[92:95], v[160:163]
  v_mfma_f32_16x16x32_bf16 v[188:191], a[244:247], a[92:95], v[188:191]
  ds_write_b128 v22, v[228:231] offset:7168
  v_mfma_f32_16x16x32_bf16 v[216:219], a[248:251], a[92:95], v[216:219]
  v_mfma_f32_16x16x32_bf16 v[244:247], a[252:255], a[92:95], v[244:247]
  v_mfma_f32_16x16x32_bf16 v[164:167], a[240:243], a[112:115], v[164:167]
  ds_write_b128 v22, v[148:151] offset:15360
  v_mfma_f32_16x16x32_bf16 v[192:195], a[244:247], a[112:115], v[192:195]
  v_mfma_f32_16x16x32_bf16 v[220:223], a[248:251], a[112:115], v[220:223]
  v_mfma_f32_16x16x32_bf16 v[248:251], a[252:255], a[112:115], v[248:251]
  ds_write_b128 v22, v[176:179] offset:22528
  v_mfma_f32_16x16x32_bf16 v[168:171], a[240:243], a[116:119], v[168:171]
  v_mfma_f32_16x16x32_bf16 v[196:199], a[244:247], a[116:119], v[196:199]
  ds_write_b128 v22, v[204:207] offset:1024
  v_mfma_f32_16x16x32_bf16 v[224:227], a[248:251], a[116:119], v[224:227]
  v_mfma_f32_16x16x32_bf16 v[252:255], a[252:255], a[116:119], v[252:255]
  v_mfma_f32_16x16x32_bf16 v[32:35], a[192:195], a[16:19], v[32:35]
  s_waitcnt lgkmcnt(8)
  ds_write_b128 v22, v[232:235] offset:8192
  v_mfma_f32_16x16x32_bf16 v[60:63], a[196:199], a[16:19], v[60:63]
  v_mfma_f32_16x16x32_bf16 v[88:91], a[200:203], a[16:19], v[88:91]
  v_mfma_f32_16x16x32_bf16 v[116:119], a[204:207], a[16:19], v[116:119]
  ds_write_b128 v22, v[152:155] offset:16384
  v_mfma_f32_16x16x32_bf16 v[36:39], a[192:195], a[20:23], v[36:39]
  v_mfma_f32_16x16x32_bf16 v[64:67], a[196:199], a[20:23], v[64:67]
  ds_write_b128 v22, v[180:183] offset:23552
  v_mfma_f32_16x16x32_bf16 v[92:95], a[200:203], a[20:23], v[92:95]
  v_mfma_f32_16x16x32_bf16 v[120:123], a[204:207], a[20:23], v[120:123]
  v_mfma_f32_16x16x32_bf16 v[40:43], a[192:195], a[24:27], v[40:43]
  ds_write_b128 v22, v[208:211] offset:2048
  v_mfma_f32_16x16x32_bf16 v[68:71], a[196:199], a[24:27], v[68:71]
  v_mfma_f32_16x16x32_bf16 v[96:99], a[200:203], a[24:27], v[96:99]
  v_mfma_f32_16x16x32_bf16 v[124:127], a[204:207], a[24:27], v[124:127]
  ds_write_b128 v22, v[236:239] offset:9216
  v_mfma_f32_16x16x32_bf16 v[44:47], a[192:195], a[28:31], v[44:47]
  v_mfma_f32_16x16x32_bf16 v[72:75], a[196:199], a[28:31], v[72:75]
  ds_write_b128 v22, v[156:159] offset:17408
  v_mfma_f32_16x16x32_bf16 v[100:103], a[200:203], a[28:31], v[100:103]
  v_mfma_f32_16x16x32_bf16 v[128:131], a[204:207], a[28:31], v[128:131]
  v_mfma_f32_16x16x32_bf16 v[48:51], a[192:195], a[48:51], v[48:51]
  ds_write_b128 v22, v[184:187] offset:24576
  v_mfma_f32_16x16x32_bf16 v[76:79], a[196:199], a[48:51], v[76:79]
  v_mfma_f32_16x16x32_bf16 v[104:107], a[200:203], a[48:51], v[104:107]
  v_mfma_f32_16x16x32_bf16 v[132:135], a[204:207], a[48:51], v[132:135]
  s_waitcnt lgkmcnt(8)
  ds_write_b128 v22, v[212:215] offset:3072
  v_mfma_f32_16x16x32_bf16 v[52:55], a[192:195], a[52:55], v[52:55]
  v_mfma_f32_16x16x32_bf16 v[80:83], a[196:199], a[52:55], v[80:83]
  ds_write_b128 v22, v[240:243] offset:10240
  v_mfma_f32_16x16x32_bf16 v[108:111], a[200:203], a[52:55], v[108:111]
  v_mfma_f32_16x16x32_bf16 v[136:139], a[204:207], a[52:55], v[136:139]
  v_mfma_f32_16x16x32_bf16 v[56:59], a[192:195], a[56:59], v[56:59]
  ds_write_b128 v22, v[160:163] offset:18432
  v_mfma_f32_16x16x32_bf16 v[84:87], a[196:199], a[56:59], v[84:87]
  v_mfma_f32_16x16x32_bf16 v[112:115], a[200:203], a[56:59], v[112:115]
  ds_write_b128 v22, v[188:191] offset:25600
  v_mfma_f32_16x16x32_bf16 v[140:143], a[204:207], a[56:59], v[140:143]
  v_mfma_f32_16x16x32_bf16 v[32:35], a[224:227], a[60:63], v[32:35]
  v_mfma_f32_16x16x32_bf16 v[60:63], a[228:231], a[60:63], v[60:63]
  ds_write_b128 v22, v[216:219] offset:4096
  v_mfma_f32_16x16x32_bf16 v[88:91], a[232:235], a[60:63], v[88:91]
  v_mfma_f32_16x16x32_bf16 v[116:119], a[236:239], a[60:63], v[116:119]
  v_mfma_f32_16x16x32_bf16 v[36:39], a[224:227], a[80:83], v[36:39]
  ds_write_b128 v22, v[244:247] offset:11264
  v_mfma_f32_16x16x32_bf16 v[64:67], a[228:231], a[80:83], v[64:67]
  v_mfma_f32_16x16x32_bf16 v[92:95], a[232:235], a[80:83], v[92:95]
  ds_write_b128 v22, v[164:167] offset:19456
  v_mfma_f32_16x16x32_bf16 v[120:123], a[236:239], a[80:83], v[120:123]
  v_mfma_f32_16x16x32_bf16 v[40:43], a[224:227], a[84:87], v[40:43]
  v_mfma_f32_16x16x32_bf16 v[68:71], a[228:231], a[84:87], v[68:71]
  s_waitcnt lgkmcnt(8)
  ds_write_b128 v22, v[192:195] offset:26624
  v_mfma_f32_16x16x32_bf16 v[96:99], a[232:235], a[84:87], v[96:99]
  v_mfma_f32_16x16x32_bf16 v[124:127], a[236:239], a[84:87], v[124:127]
  v_mfma_f32_16x16x32_bf16 v[44:47], a[224:227], a[88:91], v[44:47]
  ds_write_b128 v22, v[220:223] offset:5120
  v_mfma_f32_16x16x32_bf16 v[72:75], a[228:231], a[88:91], v[72:75]
  v_mfma_f32_16x16x32_bf16 v[100:103], a[232:235], a[88:91], v[100:103]
  ds_write_b128 v22, v[248:251] offset:12288
  v_mfma_f32_16x16x32_bf16 v[128:131], a[236:239], a[88:91], v[128:131]
  v_mfma_f32_16x16x32_bf16 v[48:51], a[224:227], a[92:95], v[48:51]
  v_mfma_f32_16x16x32_bf16 v[76:79], a[228:231], a[92:95], v[76:79]
  ds_write_b128 v22, v[168:171] offset:20480
  v_mfma_f32_16x16x32_bf16 v[104:107], a[232:235], a[92:95], v[104:107]
  v_mfma_f32_16x16x32_bf16 v[132:135], a[236:239], a[92:95], v[132:135]
  v_mfma_f32_16x16x32_bf16 v[52:55], a[224:227], a[112:115], v[52:55]
  ds_write_b128 v22, v[196:199] offset:27648
  v_mfma_f32_16x16x32_bf16 v[80:83], a[228:231], a[112:115], v[80:83]
  v_mfma_f32_16x16x32_bf16 v[108:111], a[232:235], a[112:115], v[108:111]
  ds_write_b128 v22, v[224:227] offset:6144
  v_mfma_f32_16x16x32_bf16 v[136:139], a[236:239], a[112:115], v[136:139]
  v_mfma_f32_16x16x32_bf16 v[56:59], a[224:227], a[116:119], v[56:59]
  v_mfma_f32_16x16x32_bf16 v[84:87], a[228:231], a[116:119], v[84:87]
  ds_write_b128 v22, v[252:255] offset:13312
  v_mfma_f32_16x16x32_bf16 v[112:115], a[232:235], a[116:119], v[112:115]
  v_mfma_f32_16x16x32_bf16 v[140:143], a[236:239], a[116:119], v[140:143]
  s_waitcnt lgkmcnt(0)
  s_barrier
  ds_read_b128 v[200:203], v23 offset:0
  ds_read_b128 v[204:207], v23 offset:1024
  ds_read_b128 v[208:211], v23 offset:2048
  ds_read_b128 v[212:215], v23 offset:3072
  ds_read_b128 v[216:219], v23 offset:4096
  ds_read_b128 v[220:223], v23 offset:5120
  ds_read_b128 v[224:227], v23 offset:6144
  ds_read_b128 v[228:231], v23 offset:7168
  ds_read_b128 v[232:235], v23 offset:8192
  ds_read_b128 v[236:239], v23 offset:9216
  ds_read_b128 v[240:243], v23 offset:10240
  ds_read_b128 v[244:247], v23 offset:11264
  ds_read_b128 v[248:251], v23 offset:12288
  ds_read_b128 v[252:255], v23 offset:13312
  s_waitcnt lgkmcnt(13)
  v_pk_add_f32 v[88:89], v[88:89], v[200:201]
  v_pk_add_f32 v[90:91], v[90:91], v[202:203]
  ds_write_b128 v23, v[88:91] offset:0
  ds_read_b128 v[144:147], v23 offset:14336
  s_waitcnt lgkmcnt(14)
  v_pk_add_f32 v[92:93], v[92:93], v[204:205]
  v_pk_add_f32 v[94:95], v[94:95], v[206:207]
  ds_write_b128 v23, v[92:95] offset:1024
  s_waitcnt lgkmcnt(8)
  ds_read_b128 v[148:151], v23 offset:15360
  v_pk_add_f32 v[96:97], v[96:97], v[208:209]
  v_pk_add_f32 v[98:99], v[98:99], v[210:211]
  ds_write_b128 v23, v[96:99] offset:2048
  ds_read_b128 v[152:155], v23 offset:16384
  v_pk_add_f32 v[100:101], v[100:101], v[212:213]
  v_pk_add_f32 v[102:103], v[102:103], v[214:215]
  ds_write_b128 v23, v[100:103] offset:3072
  ds_read_b128 v[156:159], v23 offset:17408
  v_pk_add_f32 v[104:105], v[104:105], v[216:217]
  v_pk_add_f32 v[106:107], v[106:107], v[218:219]
  ds_write_b128 v23, v[104:107] offset:4096
  ds_read_b128 v[160:163], v23 offset:18432
  v_pk_add_f32 v[108:109], v[108:109], v[220:221]
  v_pk_add_f32 v[110:111], v[110:111], v[222:223]
  s_waitcnt lgkmcnt(8)
  ds_write_b128 v23, v[108:111] offset:5120
  ds_read_b128 v[164:167], v23 offset:19456
  v_pk_add_f32 v[112:113], v[112:113], v[224:225]
  v_pk_add_f32 v[114:115], v[114:115], v[226:227]
  ds_write_b128 v23, v[112:115] offset:6144
  ds_read_b128 v[168:171], v23 offset:20480
  v_pk_add_f32 v[116:117], v[116:117], v[228:229]
  v_pk_add_f32 v[118:119], v[118:119], v[230:231]
  ds_write_b128 v23, v[116:119] offset:7168
  ds_read_b128 v[172:175], v23 offset:21504
  v_pk_add_f32 v[120:121], v[120:121], v[232:233]
  v_pk_add_f32 v[122:123], v[122:123], v[234:235]
  ds_write_b128 v23, v[120:123] offset:8192
  s_waitcnt lgkmcnt(8)
  ds_read_b128 v[176:179], v23 offset:22528
  v_pk_add_f32 v[124:125], v[124:125], v[236:237]
  v_pk_add_f32 v[126:127], v[126:127], v[238:239]
  ds_write_b128 v23, v[124:127] offset:9216
  ds_read_b128 v[180:183], v23 offset:23552
  v_pk_add_f32 v[128:129], v[128:129], v[240:241]
  v_pk_add_f32 v[130:131], v[130:131], v[242:243]
  ds_write_b128 v23, v[128:131] offset:10240
  ds_read_b128 v[184:187], v23 offset:24576
  v_pk_add_f32 v[132:133], v[132:133], v[244:245]
  v_pk_add_f32 v[134:135], v[134:135], v[246:247]
  ds_write_b128 v23, v[132:135] offset:11264
  ds_read_b128 v[188:191], v23 offset:25600
  v_pk_add_f32 v[136:137], v[136:137], v[248:249]
  v_pk_add_f32 v[138:139], v[138:139], v[250:251]
  s_waitcnt lgkmcnt(8)
  ds_write_b128 v23, v[136:139] offset:12288
  ds_read_b128 v[192:195], v23 offset:26624
  v_pk_add_f32 v[140:141], v[140:141], v[252:253]
  v_pk_add_f32 v[142:143], v[142:143], v[254:255]
  ds_write_b128 v23, v[140:143] offset:13312
  ds_read_b128 v[196:199], v23 offset:27648
  v_pk_add_f32 v[32:33], v[32:33], v[144:145]
  v_pk_add_f32 v[34:35], v[34:35], v[146:147]
  v_pk_add_f32 v[36:37], v[36:37], v[148:149]
  v_pk_add_f32 v[38:39], v[38:39], v[150:151]
  v_pk_add_f32 v[40:41], v[40:41], v[152:153]
  v_pk_add_f32 v[42:43], v[42:43], v[154:155]
  v_pk_add_f32 v[44:45], v[44:45], v[156:157]
  v_pk_add_f32 v[46:47], v[46:47], v[158:159]
  v_pk_add_f32 v[48:49], v[48:49], v[160:161]
  v_pk_add_f32 v[50:51], v[50:51], v[162:163]
  v_pk_add_f32 v[52:53], v[52:53], v[164:165]
  v_pk_add_f32 v[54:55], v[54:55], v[166:167]
  v_pk_add_f32 v[56:57], v[56:57], v[168:169]
  v_pk_add_f32 v[58:59], v[58:59], v[170:171]
  v_pk_add_f32 v[60:61], v[60:61], v[172:173]
  v_pk_add_f32 v[62:63], v[62:63], v[174:175]
  s_waitcnt lgkmcnt(10)
  v_pk_add_f32 v[64:65], v[64:65], v[176:177]
  v_pk_add_f32 v[66:67], v[66:67], v[178:179]
  s_waitcnt lgkmcnt(8)
  v_pk_add_f32 v[68:69], v[68:69], v[180:181]
  v_pk_add_f32 v[70:71], v[70:71], v[182:183]
  s_waitcnt lgkmcnt(6)
  v_pk_add_f32 v[72:73], v[72:73], v[184:185]
  v_pk_add_f32 v[74:75], v[74:75], v[186:187]
  s_waitcnt lgkmcnt(4)
  v_pk_add_f32 v[76:77], v[76:77], v[188:189]
  v_pk_add_f32 v[78:79], v[78:79], v[190:191]
  s_waitcnt lgkmcnt(2)
  v_pk_add_f32 v[80:81], v[80:81], v[192:193]
  v_pk_add_f32 v[82:83], v[82:83], v[194:195]
  s_waitcnt lgkmcnt(0)
  v_pk_add_f32 v[84:85], v[84:85], v[196:197]
  v_pk_add_f32 v[86:87], v[86:87], v[198:199]
  s_waitcnt lgkmcnt(0)
  s_barrier
  ds_read_b128 v[88:91], v28 offset:0
  ds_read_b128 v[116:119], v28 offset:7168
  ds_read_b128 v[92:95], v28 offset:1024
  ds_read_b128 v[120:123], v28 offset:8192
  ds_read_b128 v[96:99], v28 offset:2048
  ds_read_b128 v[124:127], v28 offset:9216
  ds_read_b128 v[100:103], v28 offset:3072
  ds_read_b128 v[128:131], v28 offset:10240
  ds_read_b128 v[104:107], v28 offset:4096
  ds_read_b128 v[132:135], v28 offset:11264
  ds_read_b128 v[108:111], v28 offset:5120
  ds_read_b128 v[136:139], v28 offset:12288
  ds_read_b128 v[112:115], v28 offset:6144
  ds_read_b128 v[140:143], v28 offset:13312
  s_waitcnt lgkmcnt(13)
  v_pk_add_f32 v[32:33], v[32:33], v[88:89]
  v_pk_add_f32 v[34:35], v[34:35], v[90:91]
  s_waitcnt lgkmcnt(12)
  v_pk_add_f32 v[60:61], v[60:61], v[116:117]
  v_pk_add_f32 v[62:63], v[62:63], v[118:119]
  v_cvt_pk_bf16_f32 v144, v32, v33
  v_cvt_pk_bf16_f32 v145, v34, v35
  v_cvt_pk_bf16_f32 v146, v60, v61
  v_cvt_pk_bf16_f32 v147, v62, v63
  s_mov_b32 s46, 0
  s_nop 0
  v_permlane16_swap_b32 v144, v146
  v_permlane16_swap_b32 v145, v147
  buffer_store_dwordx4 v[144:147], v21, s[16:19], s46 offen offset:0 sc1
  s_waitcnt lgkmcnt(11)
  v_pk_add_f32 v[36:37], v[36:37], v[92:93]
  v_pk_add_f32 v[38:39], v[38:39], v[94:95]
  s_waitcnt lgkmcnt(10)
  v_pk_add_f32 v[64:65], v[64:65], v[120:121]
  v_pk_add_f32 v[66:67], v[66:67], v[122:123]
  v_cvt_pk_bf16_f32 v148, v36, v37
  v_cvt_pk_bf16_f32 v149, v38, v39
  v_cvt_pk_bf16_f32 v150, v64, v65
  v_cvt_pk_bf16_f32 v151, v66, v67
  s_mov_b32 s46, 32768
  s_nop 0
  v_permlane16_swap_b32 v148, v150
  v_permlane16_swap_b32 v149, v151
  buffer_store_dwordx4 v[148:151], v21, s[16:19], s46 offen offset:0 sc1
  s_waitcnt lgkmcnt(9)
  v_pk_add_f32 v[40:41], v[40:41], v[96:97]
  v_pk_add_f32 v[42:43], v[42:43], v[98:99]
  s_waitcnt lgkmcnt(8)
  v_pk_add_f32 v[68:69], v[68:69], v[124:125]
  v_pk_add_f32 v[70:71], v[70:71], v[126:127]
  v_cvt_pk_bf16_f32 v152, v40, v41
  v_cvt_pk_bf16_f32 v153, v42, v43
  v_cvt_pk_bf16_f32 v154, v68, v69
  v_cvt_pk_bf16_f32 v155, v70, v71
  s_mov_b32 s46, 65536
  s_nop 0
  v_permlane16_swap_b32 v152, v154
  v_permlane16_swap_b32 v153, v155
  buffer_store_dwordx4 v[152:155], v21, s[16:19], s46 offen offset:0 sc1
  s_waitcnt lgkmcnt(7)
  v_pk_add_f32 v[44:45], v[44:45], v[100:101]
  v_pk_add_f32 v[46:47], v[46:47], v[102:103]
  s_waitcnt lgkmcnt(6)
  v_pk_add_f32 v[72:73], v[72:73], v[128:129]
  v_pk_add_f32 v[74:75], v[74:75], v[130:131]
  v_cvt_pk_bf16_f32 v156, v44, v45
  v_cvt_pk_bf16_f32 v157, v46, v47
  v_cvt_pk_bf16_f32 v158, v72, v73
  v_cvt_pk_bf16_f32 v159, v74, v75
  s_mov_b32 s46, 98304
  s_nop 0
  v_permlane16_swap_b32 v156, v158
  v_permlane16_swap_b32 v157, v159
  buffer_store_dwordx4 v[156:159], v21, s[16:19], s46 offen offset:0 sc1
  s_waitcnt lgkmcnt(5)
  v_pk_add_f32 v[48:49], v[48:49], v[104:105]
  v_pk_add_f32 v[50:51], v[50:51], v[106:107]
  s_waitcnt lgkmcnt(4)
  v_pk_add_f32 v[76:77], v[76:77], v[132:133]
  v_pk_add_f32 v[78:79], v[78:79], v[134:135]
  v_cvt_pk_bf16_f32 v160, v48, v49
  v_cvt_pk_bf16_f32 v161, v50, v51
  v_cvt_pk_bf16_f32 v162, v76, v77
  v_cvt_pk_bf16_f32 v163, v78, v79
  s_mov_b32 s46, 131072
  s_nop 0
  v_permlane16_swap_b32 v160, v162
  v_permlane16_swap_b32 v161, v163
  buffer_store_dwordx4 v[160:163], v21, s[16:19], s46 offen offset:0 sc1
  s_waitcnt lgkmcnt(3)
  v_pk_add_f32 v[52:53], v[52:53], v[108:109]
  v_pk_add_f32 v[54:55], v[54:55], v[110:111]
  s_waitcnt lgkmcnt(2)
  v_pk_add_f32 v[80:81], v[80:81], v[136:137]
  v_pk_add_f32 v[82:83], v[82:83], v[138:139]
  v_cvt_pk_bf16_f32 v164, v52, v53
  v_cvt_pk_bf16_f32 v165, v54, v55
  v_cvt_pk_bf16_f32 v166, v80, v81
  v_cvt_pk_bf16_f32 v167, v82, v83
  s_mov_b32 s46, 163840
  s_nop 0
  v_permlane16_swap_b32 v164, v166
  v_permlane16_swap_b32 v165, v167
  buffer_store_dwordx4 v[164:167], v21, s[16:19], s46 offen offset:0 sc1
  s_waitcnt lgkmcnt(1)
  v_pk_add_f32 v[56:57], v[56:57], v[112:113]
  v_pk_add_f32 v[58:59], v[58:59], v[114:115]
  s_waitcnt lgkmcnt(0)
  v_pk_add_f32 v[84:85], v[84:85], v[140:141]
  v_pk_add_f32 v[86:87], v[86:87], v[142:143]
  v_cvt_pk_bf16_f32 v168, v56, v57
  v_cvt_pk_bf16_f32 v169, v58, v59
  v_cvt_pk_bf16_f32 v170, v84, v85
  v_cvt_pk_bf16_f32 v171, v86, v87
  s_mov_b32 s46, 196608
  s_nop 0
  v_permlane16_swap_b32 v168, v170
  v_permlane16_swap_b32 v169, v171
  buffer_store_dwordx4 v[168:171], v21, s[16:19], s46 offen offset:0 sc1
  s_endpgm
L2b_start:
  s_add_u32 s47, s29, 0
  buffer_load_dwordx4 a[16:19], v30, s[8:11], s47 offen offset:0 sc1
  buffer_load_dwordx4 a[20:23], v30, s[8:11], s47 offen offset:2048 sc1
  s_add_u32 s47, s29, 4096
  buffer_load_dwordx4 a[24:27], v30, s[8:11], s47 offen offset:0 sc1
  buffer_load_dwordx4 a[28:31], v30, s[8:11], s47 offen offset:2048 sc1
  s_add_u32 s47, s29, 8192
  buffer_load_dwordx4 a[48:51], v30, s[8:11], s47 offen offset:0 sc1
  buffer_load_dwordx4 a[52:55], v30, s[8:11], s47 offen offset:2048 sc1
  s_add_u32 s29, s29, 26624
  s_add_u32 s47, s29, 0
  buffer_load_dwordx4 a[60:63], v30, s[8:11], s47 offen offset:0 sc1
  buffer_load_dwordx4 a[80:83], v30, s[8:11], s47 offen offset:2048 sc1
  s_add_u32 s47, s29, 4096
  buffer_load_dwordx4 a[84:87], v30, s[8:11], s47 offen offset:0 sc1
  buffer_load_dwordx4 a[88:91], v30, s[8:11], s47 offen offset:2048 sc1
  s_add_u32 s47, s29, 8192
  buffer_load_dwordx4 a[92:95], v30, s[8:11], s47 offen offset:0 sc1
  buffer_load_dwordx4 a[112:115], v30, s[8:11], s47 offen offset:2048 sc1
  s_add_u32 s29, s29, 26624
  s_mul_i32 s46, s32, 425984
  s_add_u32 s16, s94, s46
  s_addc_u32 s17, s95, 0
  s_mov_b32 s18, 425984
  s_mov_b32 s19, 131072
  v_lshrrev_b32 v5, 2, v1
  v_lshlrev_b32 v13, 8, v5
  v_and_b32 v5, 7, v5
  v_lshl_add_u32 v13, v5, 5, v13
  v_and_b32 v5, 3, v1
  v_lshl_add_u32 v13, v5, 3, v13
  s_lshl_b32 s46, s3, 6
  v_xor_b32 v13, s46, v13
  v_add_u32 v13, s28, v13
  v_xor_b32 v14, 32, v13
  v_xor_b32 v15, 64, v13
  v_xor_b32 v16, 96, v13
  v_xor_b32 v17, 128, v13
  v_xor_b32 v18, 160, v13
  v_xor_b32 v19, 192, v13
  v_xor_b32 v20, 224, v13
  v_and_b32 v5, 15, v1
  v_lshlrev_b32 v21, 11, v5
  v_and_b32 v5, 1, v4
  v_lshl_add_u32 v21, v5, 5, v21
  v_lshrrev_b32 v5, 1, v4
  v_lshl_add_u32 v21, v5, 4, v21
  s_mul_i32 s48, s33, 229376
  s_lshl_b32 s49, s34, 8
  s_add_u32 s48, s48, s49
  s_lshl_b32 s49, s3, 6
  s_add_u32 s48, s48, s49
  v_add_u32 v21, s48, v21
  s_waitcnt vmcnt(6) lgkmcnt(0)
  v_mfma_f32_16x16x32_bf16 v[32:35], a[192:195], a[16:19], 0
  v_mfma_f32_16x16x32_bf16 v[60:63], a[196:199], a[16:19], 0
  v_mfma_f32_16x16x32_bf16 v[88:91], a[200:203], a[16:19], 0
  v_mfma_f32_16x16x32_bf16 v[116:119], a[204:207], a[16:19], 0
  v_mfma_f32_16x16x32_bf16 v[144:147], a[208:211], a[16:19], 0
  v_mfma_f32_16x16x32_bf16 v[172:175], a[212:215], a[16:19], 0
  v_mfma_f32_16x16x32_bf16 v[200:203], a[216:219], a[16:19], 0
  v_mfma_f32_16x16x32_bf16 v[228:231], a[220:223], a[16:19], 0
  v_mfma_f32_16x16x32_bf16 v[36:39], a[192:195], a[20:23], 0
  s_add_u32 s47, s29, 0
  buffer_load_dwordx4 a[16:19], v30, s[8:11], s47 offen offset:0 sc1
  v_mfma_f32_16x16x32_bf16 v[64:67], a[196:199], a[20:23], 0
  v_mfma_f32_16x16x32_bf16 v[92:95], a[200:203], a[20:23], 0
  v_mfma_f32_16x16x32_bf16 v[120:123], a[204:207], a[20:23], 0
  v_mfma_f32_16x16x32_bf16 v[148:151], a[208:211], a[20:23], 0
  v_mfma_f32_16x16x32_bf16 v[176:179], a[212:215], a[20:23], 0
  s_add_u32 s46, s54, 425984
  buffer_store_dwordx4 a[0:3], v30, s[24:27], s46 offen offset:0 sc1
  v_mfma_f32_16x16x32_bf16 v[204:207], a[216:219], a[20:23], 0
  v_mfma_f32_16x16x32_bf16 v[232:235], a[220:223], a[20:23], 0
  v_mfma_f32_16x16x32_bf16 v[40:43], a[192:195], a[24:27], 0
  buffer_load_dwordx4 a[20:23], v30, s[8:11], s47 offen offset:2048 sc1
  v_mfma_f32_16x16x32_bf16 v[68:71], a[196:199], a[24:27], 0
  v_mfma_f32_16x16x32_bf16 v[96:99], a[200:203], a[24:27], 0
  v_mfma_f32_16x16x32_bf16 v[124:127], a[204:207], a[24:27], 0
  v_mfma_f32_16x16x32_bf16 v[152:155], a[208:211], a[24:27], 0
  v_mfma_f32_16x16x32_bf16 v[180:183], a[212:215], a[24:27], 0
  v_mfma_f32_16x16x32_bf16 v[208:211], a[216:219], a[24:27], 0
  v_mfma_f32_16x16x32_bf16 v[236:239], a[220:223], a[24:27], 0
  v_mfma_f32_16x16x32_bf16 v[44:47], a[192:195], a[28:31], 0
  s_add_u32 s47, s29, 4096
  buffer_load_dwordx4 a[24:27], v30, s[8:11], s47 offen offset:0 sc1
  v_mfma_f32_16x16x32_bf16 v[72:75], a[196:199], a[28:31], 0
  v_mfma_f32_16x16x32_bf16 v[100:103], a[200:203], a[28:31], 0
  v_mfma_f32_16x16x32_bf16 v[128:131], a[204:207], a[28:31], 0
  v_mfma_f32_16x16x32_bf16 v[156:159], a[208:211], a[28:31], 0
  v_mfma_f32_16x16x32_bf16 v[184:187], a[212:215], a[28:31], 0
  v_mfma_f32_16x16x32_bf16 v[212:215], a[216:219], a[28:31], 0
  v_mfma_f32_16x16x32_bf16 v[240:243], a[220:223], a[28:31], 0
  v_mfma_f32_16x16x32_bf16 v[48:51], a[192:195], a[48:51], 0
  buffer_load_dwordx4 a[28:31], v30, s[8:11], s47 offen offset:2048 sc1
  v_mfma_f32_16x16x32_bf16 v[76:79], a[196:199], a[48:51], 0
  s_add_u32 s46, s54, 428032
  buffer_store_dwordx4 a[4:7], v30, s[24:27], s46 offen offset:0 sc1
  v_mfma_f32_16x16x32_bf16 v[104:107], a[200:203], a[48:51], 0
  v_mfma_f32_16x16x32_bf16 v[132:135], a[204:207], a[48:51], 0
  v_mfma_f32_16x16x32_bf16 v[160:163], a[208:211], a[48:51], 0
  v_mfma_f32_16x16x32_bf16 v[188:191], a[212:215], a[48:51], 0
  v_mfma_f32_16x16x32_bf16 v[216:219], a[216:219], a[48:51], 0
  v_mfma_f32_16x16x32_bf16 v[244:247], a[220:223], a[48:51], 0
  v_mfma_f32_16x16x32_bf16 v[52:55], a[192:195], a[52:55], 0
  s_add_u32 s47, s29, 8192
  buffer_load_dwordx4 a[48:51], v30, s[8:11], s47 offen offset:0 sc1
  v_mfma_f32_16x16x32_bf16 v[80:83], a[196:199], a[52:55], 0
  v_mfma_f32_16x16x32_bf16 v[108:111], a[200:203], a[52:55], 0
  v_mfma_f32_16x16x32_bf16 v[136:139], a[204:207], a[52:55], 0
  v_mfma_f32_16x16x32_bf16 v[164:167], a[208:211], a[52:55], 0
  v_mfma_f32_16x16x32_bf16 v[192:195], a[212:215], a[52:55], 0
  v_mfma_f32_16x16x32_bf16 v[220:223], a[216:219], a[52:55], 0
  v_mfma_f32_16x16x32_bf16 v[248:251], a[220:223], a[52:55], 0
  buffer_load_dwordx4 a[52:55], v30, s[8:11], s47 offen offset:2048 sc1
  s_add_u32 s29, s29, 26624
  s_waitcnt vmcnt(8) lgkmcnt(0)
  v_mfma_f32_16x16x32_bf16 v[32:35], a[224:227], a[60:63], v[32:35]
  v_mfma_f32_16x16x32_bf16 v[60:63], a[228:231], a[60:63], v[60:63]
  ds_read_b64_tr_b16 a[192:193], v13 offset:8192
  v_mfma_f32_16x16x32_bf16 v[88:91], a[232:235], a[60:63], v[88:91]
  v_mfma_f32_16x16x32_bf16 v[116:119], a[236:239], a[60:63], v[116:119]
  ds_read_b64_tr_b16 a[194:195], v13 offset:12288
  v_mfma_f32_16x16x32_bf16 v[144:147], a[240:243], a[60:63], v[144:147]
  v_mfma_f32_16x16x32_bf16 v[172:175], a[244:247], a[60:63], v[172:175]
  ds_read_b64_tr_b16 a[196:197], v14 offset:8192
  v_mfma_f32_16x16x32_bf16 v[200:203], a[248:251], a[60:63], v[200:203]
  v_mfma_f32_16x16x32_bf16 v[228:231], a[252:255], a[60:63], v[228:231]
  ds_read_b64_tr_b16 a[198:199], v14 offset:12288
  v_mfma_f32_16x16x32_bf16 v[36:39], a[224:227], a[80:83], v[36:39]
  s_add_u32 s47, s29, 0
  buffer_load_dwordx4 a[60:63], v30, s[8:11], s47 offen offset:0 sc1
  v_mfma_f32_16x16x32_bf16 v[64:67], a[228:231], a[80:83], v[64:67]
  ds_read_b64_tr_b16 a[200:201], v15 offset:8192
  v_mfma_f32_16x16x32_bf16 v[92:95], a[232:235], a[80:83], v[92:95]
  v_mfma_f32_16x16x32_bf16 v[120:123], a[236:239], a[80:83], v[120:123]
  ds_read_b64_tr_b16 a[202:203], v15 offset:12288
  v_mfma_f32_16x16x32_bf16 v[148:151], a[240:243], a[80:83], v[148:151]
  v_mfma_f32_16x16x32_bf16 v[176:179], a[244:247], a[80:83], v[176:179]
  s_add_u32 s46, s54, 430080
  ds_read_b64_tr_b16 a[204:205], v16 offset:8192
  buffer_store_dwordx4 a[8:11], v30, s[24:27], s46 offen offset:0 sc1
  v_mfma_f32_16x16x32_bf16 v[204:207], a[248:251], a[80:83], v[204:207]
  v_mfma_f32_16x16x32_bf16 v[232:235], a[252:255], a[80:83], v[232:235]
  ds_read_b64_tr_b16 a[206:207], v16 offset:12288
  v_mfma_f32_16x16x32_bf16 v[40:43], a[224:227], a[84:87], v[40:43]
  buffer_load_dwordx4 a[80:83], v30, s[8:11], s47 offen offset:2048 sc1
  v_mfma_f32_16x16x32_bf16 v[68:71], a[228:231], a[84:87], v[68:71]
  ds_read_b64_tr_b16 a[208:209], v17 offset:8192
  v_mfma_f32_16x16x32_bf16 v[96:99], a[232:235], a[84:87], v[96:99]
  v_mfma_f32_16x16x32_bf16 v[124:127], a[236:239], a[84:87], v[124:127]
  ds_read_b64_tr_b16 a[210:211], v17 offset:12288
  v_mfma_f32_16x16x32_bf16 v[152:155], a[240:243], a[84:87], v[152:155]
  v_mfma_f32_16x16x32_bf16 v[180:183], a[244:247], a[84:87], v[180:183]
  ds_read_b64_tr_b16 a[212:213], v18 offset:8192
  v_mfma_f32_16x16x32_bf16 v[208:211], a[248:251], a[84:87], v[208:211]
  v_mfma_f32_16x16x32_bf16 v[236:239], a[252:255], a[84:87], v[236:239]
  ds_read_b64_tr_b16 a[214:215], v18 offset:12288
  v_mfma_f32_16x16x32_bf16 v[44:47], a[224:227], a[88:91], v[44:47]
  s_add_u32 s47, s29, 4096
  buffer_load_dwordx4 a[84:87], v30, s[8:11], s47 offen offset:0 sc1
  v_mfma_f32_16x16x32_bf16 v[72:75], a[228:231], a[88:91], v[72:75]
  ds_read_b64_tr_b16 a[216:217], v19 offset:8192
  v_mfma_f32_16x16x32_bf16 v[100:103], a[232:235], a[88:91], v[100:103]
  v_mfma_f32_16x16x32_bf16 v[128:131], a[236:239], a[88:91], v[128:131]
  ds_read_b64_tr_b16 a[218:219], v19 offset:12288
  v_mfma_f32_16x16x32_bf16 v[156:159], a[240:243], a[88:91], v[156:159]
  v_mfma_f32_16x16x32_bf16 v[184:187], a[244:247], a[88:91], v[184:187]
  ds_read_b64_tr_b16 a[220:221], v20 offset:8192
  v_mfma_f32_16x16x32_bf16 v[212:215], a[248:251], a[88:91], v[212:215]
  v_mfma_f32_16x16x32_bf16 v[240:243], a[252:255], a[88:91], v[240:243]
  s_waitcnt lgkmcnt(8)
  ds_read_b64_tr_b16 a[222:223], v20 offset:12288
  v_mfma_f32_16x16x32_bf16 v[48:51], a[224:227], a[92:95], v[48:51]
  buffer_load_dwordx4 a[88:91], v30, s[8:11], s47 offen offset:2048 sc1
  v_mfma_f32_16x16x32_bf16 v[76:79], a[228:231], a[92:95], v[76:79]
  s_add_u32 s46, s54, 432128
  buffer_store_dwordx4 a[12:15], v30, s[24:27], s46 offen offset:0 sc1
  v_mfma_f32_16x16x32_bf16 v[104:107], a[232:235], a[92:95], v[104:107]
  v_mfma_f32_16x16x32_bf16 v[132:135], a[236:239], a[92:95], v[132:135]
  v_mfma_f32_16x16x32_bf16 v[160:163], a[240:243], a[92:95], v[160:163]
  v_mfma_f32_16x16x32_bf16 v[188:191], a[244:247], a[92:95], v[188:191]
  v_mfma_f32_16x16x32_bf16 v[216:219], a[248:251], a[92:95], v[216:219]
  v_mfma_f32_16x16x32_bf16 v[244:247], a[252:255], a[92:95], v[244:247]
  v_mfma_f32_16x16x32_bf16 v[52:55], a[224:227], a[112:115], v[52:55]
  s_add_u32 s47, s29, 8192
  buffer_load_dwordx4 a[92:95], v30, s[8:11], s47 offen offset:0 sc1
  v_mfma_f32_16x16x32_bf16 v[80:83], a[228:231], a[112:115], v[80:83]
  v_mfma_f32_16x16x32_bf16 v[108:111], a[232:235], a[112:115], v[108:111]
  v_mfma_f32_16x16x32_bf16 v[136:139], a[236:239], a[112:115], v[136:139]
  v_mfma_f32_16x16x32_bf16 v[164:167], a[240:243], a[112:115], v[164:167]
  v_mfma_f32_16x16x32_bf16 v[192:195], a[244:247], a[112:115], v[192:195]
  v_mfma_f32_16x16x32_bf16 v[220:223], a[248:251], a[112:115], v[220:223]
  v_mfma_f32_16x16x32_bf16 v[248:251], a[252:255], a[112:115], v[248:251]
  buffer_load_dwordx4 a[112:115], v30, s[8:11], s47 offen offset:2048 sc1
  s_add_u32 s29, s29, 26624
  s_waitcnt vmcnt(8) lgkmcnt(0)
  v_mfma_f32_16x16x32_bf16 v[32:35], a[192:195], a[16:19], v[32:35]
  v_mfma_f32_16x16x32_bf16 v[60:63], a[196:199], a[16:19], v[60:63]
  ds_read_b64_tr_b16 a[224:225], v13 offset:24576
  v_mfma_f32_16x16x32_bf16 v[88:91], a[200:203], a[16:19], v[88:91]
  v_mfma_f32_16x16x32_bf16 v[116:119], a[204:207], a[16:19], v[116:119]
  ds_read_b64_tr_b16 a[226:227], v13 offset:28672
  v_mfma_f32_16x16x32_bf16 v[144:147], a[208:211], a[16:19], v[144:147]
  s_add_u32 m0, s28, 8192
  s_add_u32 s38, s36, 0
  buffer_load_dwordx4 v7, s[12:15], s38 offen offset:0 sc1 lds
  v_mfma_f32_16x16x32_bf16 v[172:175], a[212:215], a[16:19], v[172:175]
  ds_read_b64_tr_b16 a[228:229], v14 offset:24576
  v_mfma_f32_16x16x32_bf16 v[200:203], a[216:219], a[16:19], v[200:203]
  v_mfma_f32_16x16x32_bf16 v[228:231], a[220:223], a[16:19], v[228:231]
  ds_read_b64_tr_b16 a[230:231], v14 offset:28672
  v_mfma_f32_16x16x32_bf16 v[36:39], a[192:195], a[20:23], v[36:39]
  s_add_u32 s47, s29, 0
  buffer_load_dwordx4 a[16:19], v30, s[8:11], s47 offen offset:0 sc1
  v_mfma_f32_16x16x32_bf16 v[64:67], a[196:199], a[20:23], v[64:67]
  ds_read_b64_tr_b16 a[232:233], v15 offset:24576
  v_mfma_f32_16x16x32_bf16 v[92:95], a[200:203], a[20:23], v[92:95]
  buffer_load_dwordx4 v8, s[12:15], s38 offen offset:1024 sc1 lds
  v_mfma_f32_16x16x32_bf16 v[120:123], a[204:207], a[20:23], v[120:123]
  ds_read_b64_tr_b16 a[234:235], v15 offset:28672
  v_mfma_f32_16x16x32_bf16 v[148:151], a[208:211], a[20:23], v[148:151]
  v_mfma_f32_16x16x32_bf16 v[176:179], a[212:215], a[20:23], v[176:179]
  s_add_u32 s46, s54, 434176
  ds_read_b64_tr_b16 a[236:237], v16 offset:24576
  buffer_store_dwordx4 a[32:35], v30, s[24:27], s46 offen offset:0 sc1
  v_mfma_f32_16x16x32_bf16 v[204:207], a[216:219], a[20:23], v[204:207]
  buffer_load_dwordx4 v9, s[12:15], s38 offen offset:2048 sc1 lds
  v_mfma_f32_16x16x32_bf16 v[232:235], a[220:223], a[20:23], v[232:235]
  ds_read_b64_tr_b16 a[238:239], v16 offset:28672
  v_mfma_f32_16x16x32_bf16 v[40:43], a[192:195], a[24:27], v[40:43]
  buffer_load_dwordx4 a[20:23], v30, s[8:11], s47 offen offset:2048 sc1
  v_mfma_f32_16x16x32_bf16 v[68:71], a[196:199], a[24:27], v[68:71]
  ds_read_b64_tr_b16 a[240:241], v17 offset:24576
  v_mfma_f32_16x16x32_bf16 v[96:99], a[200:203], a[24:27], v[96:99]
  buffer_load_dwordx4 v10, s[12:15], s38 offen offset:3072 sc1 lds
  v_mfma_f32_16x16x32_bf16 v[124:127], a[204:207], a[24:27], v[124:127]
  ds_read_b64_tr_b16 a[242:243], v17 offset:28672
  v_mfma_f32_16x16x32_bf16 v[152:155], a[208:211], a[24:27], v[152:155]
  v_mfma_f32_16x16x32_bf16 v[180:183], a[212:215], a[24:27], v[180:183]
  ds_read_b64_tr_b16 a[244:245], v18 offset:24576
  v_mfma_f32_16x16x32_bf16 v[208:211], a[216:219], a[24:27], v[208:211]
  v_mfma_f32_16x16x32_bf16 v[236:239], a[220:223], a[24:27], v[236:239]
  ds_read_b64_tr_b16 a[246:247], v18 offset:28672
  v_mfma_f32_16x16x32_bf16 v[44:47], a[192:195], a[28:31], v[44:47]
  s_add_u32 s47, s29, 4096
  buffer_load_dwordx4 a[24:27], v30, s[8:11], s47 offen offset:0 sc1
  v_mfma_f32_16x16x32_bf16 v[72:75], a[196:199], a[28:31], v[72:75]
  ds_read_b64_tr_b16 a[248:249], v19 offset:24576
  v_mfma_f32_16x16x32_bf16 v[100:103], a[200:203], a[28:31], v[100:103]
  s_add_u32 m0, s28, 12288
  s_add_u32 s38, s36, 32768
  buffer_load_dwordx4 v7, s[12:15], s38 offen offset:0 sc1 lds
  v_mfma_f32_16x16x32_bf16 v[128:131], a[204:207], a[28:31], v[128:131]
  s_add_u32 s35, s35, 1
  ds_read_b64_tr_b16 a[250:251], v19 offset:28672
  v_mfma_f32_16x16x32_bf16 v[156:159], a[208:211], a[28:31], v[156:159]
  s_and_b32 s48, s35, 14
  v_mfma_f32_16x16x32_bf16 v[184:187], a[212:215], a[28:31], v[184:187]
  s_lshl_b32 s48, s48, 17
  ds_read_b64_tr_b16 a[252:253], v20 offset:24576
  v_mfma_f32_16x16x32_bf16 v[212:215], a[216:219], a[28:31], v[212:215]
  s_add_u32 s36, s30, s48
  buffer_load_dwordx4 v8, s[12:15], s38 offen offset:1024 sc1 lds
  v_mfma_f32_16x16x32_bf16 v[240:243], a[220:223], a[28:31], v[240:243]
  s_waitcnt lgkmcnt(8)
  s_and_b32 s48, s35, 16
  ds_read_b64_tr_b16 a[254:255], v20 offset:28672
  v_mfma_f32_16x16x32_bf16 v[48:51], a[192:195], a[48:51], v[48:51]
  s_lshl_b32 s48, s48, 13
  buffer_load_dwordx4 a[28:31], v30, s[8:11], s47 offen offset:2048 sc1
  v_mfma_f32_16x16x32_bf16 v[76:79], a[196:199], a[48:51], v[76:79]
  s_add_u32 s46, s54, 436224
  s_add_u32 s36, s36, s48
  buffer_store_dwordx4 a[36:39], v30, s[24:27], s46 offen offset:0 sc1
  v_mfma_f32_16x16x32_bf16 v[104:107], a[200:203], a[48:51], v[104:107]
  s_and_b32 s48, s35, 1
  buffer_load_dwordx4 v9, s[12:15], s38 offen offset:2048 sc1 lds
  v_mfma_f32_16x16x32_bf16 v[132:135], a[204:207], a[48:51], v[132:135]
  s_lshl_b32 s48, s48, 16
  v_mfma_f32_16x16x32_bf16 v[160:163], a[208:211], a[48:51], v[160:163]
  s_add_u32 s36, s36, s48
  v_mfma_f32_16x16x32_bf16 v[188:191], a[212:215], a[48:51], v[188:191]
  v_mfma_f32_16x16x32_bf16 v[216:219], a[216:219], a[48:51], v[216:219]
  v_mfma_f32_16x16x32_bf16 v[244:247], a[220:223], a[48:51], v[244:247]
  v_mfma_f32_16x16x32_bf16 v[52:55], a[192:195], a[52:55], v[52:55]
  s_add_u32 s47, s29, 8192
  buffer_load_dwordx4 a[48:51], v30, s[8:11], s47 offen offset:0 sc1
  v_mfma_f32_16x16x32_bf16 v[80:83], a[196:199], a[52:55], v[80:83]
  v_mfma_f32_16x16x32_bf16 v[108:111], a[200:203], a[52:55], v[108:111]
  buffer_load_dwordx4 v10, s[12:15], s38 offen offset:3072 sc1 lds
  v_mfma_f32_16x16x32_bf16 v[136:139], a[204:207], a[52:55], v[136:139]
  v_mfma_f32_16x16x32_bf16 v[164:167], a[208:211], a[52:55], v[164:167]
  v_mfma_f32_16x16x32_bf16 v[192:195], a[212:215], a[52:55], v[192:195]
  v_mfma_f32_16x16x32_bf16 v[220:223], a[216:219], a[52:55], v[220:223]
  v_mfma_f32_16x16x32_bf16 v[248:251], a[220:223], a[52:55], v[248:251]
  buffer_load_dwordx4 a[52:55], v30, s[8:11], s47 offen offset:2048 sc1
  s_add_u32 s29, s29, 26624
  s_waitcnt vmcnt(16) lgkmcnt(0)
  v_mfma_f32_16x16x32_bf16 v[32:35], a[224:227], a[60:63], v[32:35]
  v_mfma_f32_16x16x32_bf16 v[60:63], a[228:231], a[60:63], v[60:63]
  ds_read_b64_tr_b16 a[192:193], v13 offset:16384
  v_mfma_f32_16x16x32_bf16 v[88:91], a[232:235], a[60:63], v[88:91]
  v_mfma_f32_16x16x32_bf16 v[116:119], a[236:239], a[60:63], v[116:119]
  ds_read_b64_tr_b16 a[194:195], v13 offset:20480
  v_mfma_f32_16x16x32_bf16 v[144:147], a[240:243], a[60:63], v[144:147]
  s_add_u32 m0, s28, 24576
  s_add_u32 s38, s36, 0
  buffer_load_dwordx4 v7, s[12:15], s38 offen offset:0 sc1 lds
  v_mfma_f32_16x16x32_bf16 v[172:175], a[244:247], a[60:63], v[172:175]
  ds_read_b64_tr_b16 a[196:197], v14 offset:16384
  v_mfma_f32_16x16x32_bf16 v[200:203], a[248:251], a[60:63], v[200:203]
  v_mfma_f32_16x16x32_bf16 v[228:231], a[252:255], a[60:63], v[228:231]
  ds_read_b64_tr_b16 a[198:199], v14 offset:20480
  v_mfma_f32_16x16x32_bf16 v[36:39], a[224:227], a[80:83], v[36:39]
  s_add_u32 s47, s29, 0
  buffer_load_dwordx4 a[60:63], v30, s[8:11], s47 offen offset:0 sc1
  v_mfma_f32_16x16x32_bf16 v[64:67], a[228:231], a[80:83], v[64:67]
  ds_read_b64_tr_b16 a[200:201], v15 offset:16384
  v_mfma_f32_16x16x32_bf16 v[92:95], a[232:235], a[80:83], v[92:95]
  buffer_load_dwordx4 v8, s[12:15], s38 offen offset:1024 sc1 lds
  v_mfma_f32_16x16x32_bf16 v[120:123], a[236:239], a[80:83], v[120:123]
  ds_read_b64_tr_b16 a[202:203], v15 offset:20480
  v_mfma_f32_16x16x32_bf16 v[148:151], a[240:243], a[80:83], v[148:151]
  v_mfma_f32_16x16x32_bf16 v[176:179], a[244:247], a[80:83], v[176:179]
  s_add_u32 s46, s44, 438272
  ds_read_b64_tr_b16 a[204:205], v16 offset:16384
  buffer_store_dwordx4 a[40:43], v30, s[24:27], s46 offen offset:0 sc1
  v_mfma_f32_16x16x32_bf16 v[204:207], a[248:251], a[80:83], v[204:207]
  buffer_load_dwordx4 v9, s[12:15], s38 offen offset:2048 sc1 lds
  v_mfma_f32_16x16x32_bf16 v[232:235], a[252:255], a[80:83], v[232:235]
  ds_read_b64_tr_b16 a[206:207], v16 offset:20480
  v_mfma_f32_16x16x32_bf16 v[40:43], a[224:227], a[84:87], v[40:43]
  buffer_load_dwordx4 a[80:83], v30, s[8:11], s47 offen offset:2048 sc1
  v_mfma_f32_16x16x32_bf16 v[68:71], a[228:231], a[84:87], v[68:71]
  ds_read_b64_tr_b16 a[208:209], v17 offset:16384
  v_mfma_f32_16x16x32_bf16 v[96:99], a[232:235], a[84:87], v[96:99]
  buffer_load_dwordx4 v10, s[12:15], s38 offen offset:3072 sc1 lds
  v_mfma_f32_16x16x32_bf16 v[124:127], a[236:239], a[84:87], v[124:127]
  ds_read_b64_tr_b16 a[210:211], v17 offset:20480
  v_mfma_f32_16x16x32_bf16 v[152:155], a[240:243], a[84:87], v[152:155]
  v_mfma_f32_16x16x32_bf16 v[180:183], a[244:247], a[84:87], v[180:183]
  ds_read_b64_tr_b16 a[212:213], v18 offset:16384
  v_mfma_f32_16x16x32_bf16 v[208:211], a[248:251], a[84:87], v[208:211]
  v_mfma_f32_16x16x32_bf16 v[236:239], a[252:255], a[84:87], v[236:239]
  ds_read_b64_tr_b16 a[214:215], v18 offset:20480
  v_mfma_f32_16x16x32_bf16 v[44:47], a[224:227], a[88:91], v[44:47]
  s_add_u32 s47, s29, 4096
  buffer_load_dwordx4 a[84:87], v30, s[8:11], s47 offen offset:0 sc1
  v_mfma_f32_16x16x32_bf16 v[72:75], a[228:231], a[88:91], v[72:75]
  ds_read_b64_tr_b16 a[216:217], v19 offset:16384
  v_mfma_f32_16x16x32_bf16 v[100:103], a[232:235], a[88:91], v[100:103]
  s_add_u32 m0, s28, 28672
  s_add_u32 s38, s36, 32768
  buffer_load_dwordx4 v7, s[12:15], s38 offen offset:0 sc1 lds
  v_mfma_f32_16x16x32_bf16 v[128:131], a[236:239], a[88:91], v[128:131]
  s_add_u32 s35, s35, 1
  ds_read_b64_tr_b16 a[218:219], v19 offset:20480
  v_mfma_f32_16x16x32_bf16 v[156:159], a[240:243], a[88:91], v[156:159]
  s_and_b32 s48, s35, 14
  v_mfma_f32_16x16x32_bf16 v[184:187], a[244:247], a[88:91], v[184:187]
  s_lshl_b32 s48, s48, 17
  ds_read_b64_tr_b16 a[220:221], v20 offset:16384
  v_mfma_f32_16x16x32_bf16 v[212:215], a[248:251], a[88:91], v[212:215]
  s_add_u32 s36, s30, s48
  buffer_load_dwordx4 v8, s[12:15], s38 offen offset:1024 sc1 lds
  v_mfma_f32_16x16x32_bf16 v[240:243], a[252:255], a[88:91], v[240:243]
  s_waitcnt lgkmcnt(8)
  s_and_b32 s48, s35, 16
  ds_read_b64_tr_b16 a[222:223], v20 offset:20480
  v_mfma_f32_16x16x32_bf16 v[48:51], a[224:227], a[92:95], v[48:51]
  s_lshl_b32 s48, s48, 13
  buffer_load_dwordx4 a[88:91], v30, s[8:11], s47 offen offset:2048 sc1
  v_mfma_f32_16x16x32_bf16 v[76:79], a[228:231], a[92:95], v[76:79]
  s_add_u32 s46, s54, 452608
  s_add_u32 s36, s36, s48
  buffer_store_dwordx4 a[44:47], v30, s[24:27], s46 offen offset:0 sc1
  v_mfma_f32_16x16x32_bf16 v[104:107], a[232:235], a[92:95], v[104:107]
  s_and_b32 s48, s35, 1
  buffer_load_dwordx4 v9, s[12:15], s38 offen offset:2048 sc1 lds
  v_mfma_f32_16x16x32_bf16 v[132:135], a[236:239], a[92:95], v[132:135]
  s_lshl_b32 s48, s48, 16
  v_mfma_f32_16x16x32_bf16 v[160:163], a[240:243], a[92:95], v[160:163]
  s_add_u32 s36, s36, s48
  v_mfma_f32_16x16x32_bf16 v[188:191], a[244:247], a[92:95], v[188:191]
  v_mfma_f32_16x16x32_bf16 v[216:219], a[248:251], a[92:95], v[216:219]
  v_mfma_f32_16x16x32_bf16 v[244:247], a[252:255], a[92:95], v[244:247]
  v_mfma_f32_16x16x32_bf16 v[52:55], a[224:227], a[112:115], v[52:55]
  s_add_u32 s47, s29, 8192
  buffer_load_dwordx4 a[92:95], v30, s[8:11], s47 offen offset:0 sc1
  v_mfma_f32_16x16x32_bf16 v[80:83], a[228:231], a[112:115], v[80:83]
  v_mfma_f32_16x16x32_bf16 v[108:111], a[232:235], a[112:115], v[108:111]
  buffer_load_dwordx4 v10, s[12:15], s38 offen offset:3072 sc1 lds
  v_mfma_f32_16x16x32_bf16 v[136:139], a[236:239], a[112:115], v[136:139]
  v_mfma_f32_16x16x32_bf16 v[164:167], a[240:243], a[112:115], v[164:167]
  v_mfma_f32_16x16x32_bf16 v[192:195], a[244:247], a[112:115], v[192:195]
  v_mfma_f32_16x16x32_bf16 v[220:223], a[248:251], a[112:115], v[220:223]
  v_mfma_f32_16x16x32_bf16 v[248:251], a[252:255], a[112:115], v[248:251]
  buffer_load_dwordx4 a[112:115], v30, s[8:11], s47 offen offset:2048 sc1
  s_add_u32 s29, s29, 26624
  s_waitcnt vmcnt(16) lgkmcnt(0)
  v_mfma_f32_16x16x32_bf16 v[32:35], a[192:195], a[16:19], v[32:35]
  v_mfma_f32_16x16x32_bf16 v[60:63], a[196:199], a[16:19], v[60:63]
  ds_read_b64_tr_b16 a[224:225], v13 offset:0
  v_mfma_f32_16x16x32_bf16 v[88:91], a[200:203], a[16:19], v[88:91]
  v_mfma_f32_16x16x32_bf16 v[116:119], a[204:207], a[16:19], v[116:119]
  ds_read_b64_tr_b16 a[226:227], v13 offset:4096
  v_mfma_f32_16x16x32_bf16 v[144:147], a[208:211], a[16:19], v[144:147]
  s_add_u32 m0, s28, 16384
  s_add_u32 s38, s36, 0
  buffer_load_dwordx4 v7, s[12:15], s38 offen offset:0 sc1 lds
  v_mfma_f32_16x16x32_bf16 v[172:175], a[212:215], a[16:19], v[172:175]
  ds_read_b64_tr_b16 a[228:229], v14 offset:0
  v_mfma_f32_16x16x32_bf16 v[200:203], a[216:219], a[16:19], v[200:203]
  v_mfma_f32_16x16x32_bf16 v[228:231], a[220:223], a[16:19], v[228:231]
  ds_read_b64_tr_b16 a[230:231], v14 offset:4096
  v_mfma_f32_16x16x32_bf16 v[36:39], a[192:195], a[20:23], v[36:39]
  s_add_u32 s47, s29, 0
  buffer_load_dwordx4 a[16:19], v30, s[8:11], s47 offen offset:0 sc1
  v_mfma_f32_16x16x32_bf16 v[64:67], a[196:199], a[20:23], v[64:67]
  ds_read_b64_tr_b16 a[232:233], v15 offset:0
  v_mfma_f32_16x16x32_bf16 v[92:95], a[200:203], a[20:23], v[92:95]
  buffer_load_dwordx4 v8, s[12:15], s38 offen offset:1024 sc1 lds
  v_mfma_f32_16x16x32_bf16 v[120:123], a[204:207], a[20:23], v[120:123]
  ds_read_b64_tr_b16 a[234:235], v15 offset:4096
  v_mfma_f32_16x16x32_bf16 v[148:151], a[208:211], a[20:23], v[148:151]
  v_mfma_f32_16x16x32_bf16 v[176:179], a[212:215], a[20:23], v[176:179]
  s_add_u32 s46, s54, 454656
  ds_read_b64_tr_b16 a[236:237], v16 offset:0
  buffer_store_dwordx4 a[64:67], v30, s[24:27], s46 offen offset:0 sc1
  v_mfma_f32_16x16x32_bf16 v[204:207], a[216:219], a[20:23], v[204:207]
  buffer_load_dwordx4 v9, s[12:15], s38 offen offset:2048 sc1 lds
  v_mfma_f32_16x16x32_bf16 v[232:235], a[220:223], a[20:23], v[232:235]
  ds_read_b64_tr_b16 a[238:239], v16 offset:4096
  v_mfma_f32_16x16x32_bf16 v[40:43], a[192:195], a[24:27], v[40:43]
  buffer_load_dwordx4 a[20:23], v30, s[8:11], s47 offen offset:2048 sc1
  v_mfma_f32_16x16x32_bf16 v[68:71], a[196:199], a[24:27], v[68:71]
  ds_read_b64_tr_b16 a[240:241], v17 offset:0
  v_mfma_f32_16x16x32_bf16 v[96:99], a[200:203], a[24:27], v[96:99]
  buffer_load_dwordx4 v10, s[12:15], s38 offen offset:3072 sc1 lds
  v_mfma_f32_16x16x32_bf16 v[124:127], a[204:207], a[24:27], v[124:127]
  ds_read_b64_tr_b16 a[242:243], v17 offset:4096
  v_mfma_f32_16x16x32_bf16 v[152:155], a[208:211], a[24:27], v[152:155]
  v_mfma_f32_16x16x32_bf16 v[180:183], a[212:215], a[24:27], v[180:183]
  ds_read_b64_tr_b16 a[244:245], v18 offset:0
  v_mfma_f32_16x16x32_bf16 v[208:211], a[216:219], a[24:27], v[208:211]
  v_mfma_f32_16x16x32_bf16 v[236:239], a[220:223], a[24:27], v[236:239]
  ds_read_b64_tr_b16 a[246:247], v18 offset:4096
  v_mfma_f32_16x16x32_bf16 v[44:47], a[192:195], a[28:31], v[44:47]
  s_add_u32 s47, s29, 4096
  buffer_load_dwordx4 a[24:27], v30, s[8:11], s47 offen offset:0 sc1
  v_mfma_f32_16x16x32_bf16 v[72:75], a[196:199], a[28:31], v[72:75]
  ds_read_b64_tr_b16 a[248:249], v19 offset:0
  v_mfma_f32_16x16x32_bf16 v[100:103], a[200:203], a[28:31], v[100:103]
  s_add_u32 m0, s28, 20480
  s_add_u32 s38, s36, 32768
  buffer_load_dwordx4 v7, s[12:15], s38 offen offset:0 sc1 lds
  v_mfma_f32_16x16x32_bf16 v[128:131], a[204:207], a[28:31], v[128:131]
  s_add_u32 s35, s35, 1
  ds_read_b64_tr_b16 a[250:251], v19 offset:4096
  v_mfma_f32_16x16x32_bf16 v[156:159], a[208:211], a[28:31], v[156:159]
  s_and_b32 s48, s35, 14
  v_mfma_f32_16x16x32_bf16 v[184:187], a[212:215], a[28:31], v[184:187]
  s_lshl_b32 s48, s48, 17
  ds_read_b64_tr_b16 a[252:253], v20 offset:0
  v_mfma_f32_16x16x32_bf16 v[212:215], a[216:219], a[28:31], v[212:215]
  s_add_u32 s36, s30, s48
  buffer_load_dwordx4 v8, s[12:15], s38 offen offset:1024 sc1 lds
  v_mfma_f32_16x16x32_bf16 v[240:243], a[220:223], a[28:31], v[240:243]
  s_waitcnt lgkmcnt(8)
  s_and_b32 s48, s35, 16
  ds_read_b64_tr_b16 a[254:255], v20 offset:4096
  v_mfma_f32_16x16x32_bf16 v[48:51], a[192:195], a[48:51], v[48:51]
  s_lshl_b32 s48, s48, 13
  buffer_load_dwordx4 a[28:31], v30, s[8:11], s47 offen offset:2048 sc1
  v_mfma_f32_16x16x32_bf16 v[76:79], a[196:199], a[48:51], v[76:79]
  s_add_u32 s46, s54, 456704
  s_add_u32 s36, s36, s48
  buffer_store_dwordx4 a[68:71], v30, s[24:27], s46 offen offset:0 sc1
  v_mfma_f32_16x16x32_bf16 v[104:107], a[200:203], a[48:51], v[104:107]
  s_and_b32 s48, s35, 1
  buffer_load_dwordx4 v9, s[12:15], s38 offen offset:2048 sc1 lds
  v_mfma_f32_16x16x32_bf16 v[132:135], a[204:207], a[48:51], v[132:135]
  s_lshl_b32 s48, s48, 16
  v_mfma_f32_16x16x32_bf16 v[160:163], a[208:211], a[48:51], v[160:163]
  s_add_u32 s36, s36, s48
  v_mfma_f32_16x16x32_bf16 v[188:191], a[212:215], a[48:51], v[188:191]
  v_mfma_f32_16x16x32_bf16 v[216:219], a[216:219], a[48:51], v[216:219]
  v_mfma_f32_16x16x32_bf16 v[244:247], a[220:223], a[48:51], v[244:247]
  v_mfma_f32_16x16x32_bf16 v[52:55], a[192:195], a[52:55], v[52:55]
  s_add_u32 s47, s29, 8192
  buffer_load_dwordx4 a[48:51], v30, s[8:11], s47 offen offset:0 sc1
  v_mfma_f32_16x16x32_bf16 v[80:83], a[196:199], a[52:55], v[80:83]
  v_mfma_f32_16x16x32_bf16 v[108:111], a[200:203], a[52:55], v[108:111]
  buffer_load_dwordx4 v10, s[12:15], s38 offen offset:3072 sc1 lds
  v_mfma_f32_16x16x32_bf16 v[136:139], a[204:207], a[52:55], v[136:139]
  v_mfma_f32_16x16x32_bf16 v[164:167], a[208:211], a[52:55], v[164:167]
  v_mfma_f32_16x16x32_bf16 v[192:195], a[212:215], a[52:55], v[192:195]
  v_mfma_f32_16x16x32_bf16 v[220:223], a[216:219], a[52:55], v[220:223]
  v_mfma_f32_16x16x32_bf16 v[248:251], a[220:223], a[52:55], v[248:251]
  buffer_load_dwordx4 a[52:55], v30, s[8:11], s47 offen offset:2048 sc1
  s_add_u32 s29, s29, 26624
  s_waitcnt vmcnt(16) lgkmcnt(0)
  v_mfma_f32_16x16x32_bf16 v[32:35], a[224:227], a[60:63], v[32:35]
  v_mfma_f32_16x16x32_bf16 v[60:63], a[228:231], a[60:63], v[60:63]
  ds_read_b64_tr_b16 a[192:193], v13 offset:8192
  v_mfma_f32_16x16x32_bf16 v[88:91], a[232:235], a[60:63], v[88:91]
  v_mfma_f32_16x16x32_bf16 v[116:119], a[236:239], a[60:63], v[116:119]
  ds_read_b64_tr_b16 a[194:195], v13 offset:12288
  v_mfma_f32_16x16x32_bf16 v[144:147], a[240:243], a[60:63], v[144:147]
  s_add_u32 m0, s28, 0
  s_add_u32 s38, s36, 0
  buffer_load_dwordx4 v7, s[12:15], s38 offen offset:0 sc1 lds
  v_mfma_f32_16x16x32_bf16 v[172:175], a[244:247], a[60:63], v[172:175]
  ds_read_b64_tr_b16 a[196:197], v14 offset:8192
  v_mfma_f32_16x16x32_bf16 v[200:203], a[248:251], a[60:63], v[200:203]
  v_mfma_f32_16x16x32_bf16 v[228:231], a[252:255], a[60:63], v[228:231]
  ds_read_b64_tr_b16 a[198:199], v14 offset:12288
  v_mfma_f32_16x16x32_bf16 v[36:39], a[224:227], a[80:83], v[36:39]
  s_add_u32 s47, s29, 0
  buffer_load_dwordx4 a[60:63], v30, s[8:11], s47 offen offset:0 sc1
  v_mfma_f32_16x16x32_bf16 v[64:67], a[228:231], a[80:83], v[64:67]
  ds_read_b64_tr_b16 a[200:201], v15 offset:8192
  v_mfma_f32_16x16x32_bf16 v[92:95], a[232:235], a[80:83], v[92:95]
  buffer_load_dwordx4 v8, s[12:15], s38 offen offset:1024 sc1 lds
  v_mfma_f32_16x16x32_bf16 v[120:123], a[236:239], a[80:83], v[120:123]
  ds_read_b64_tr_b16 a[202:203], v15 offset:12288
  v_mfma_f32_16x16x32_bf16 v[148:151], a[240:243], a[80:83], v[148:151]
  v_mfma_f32_16x16x32_bf16 v[176:179], a[244:247], a[80:83], v[176:179]
  s_add_u32 s46, s54, 458752
  ds_read_b64_tr_b16 a[204:205], v16 offset:8192
  buffer_store_dwordx4 a[72:75], v30, s[24:27], s46 offen offset:0 sc1
  v_mfma_f32_16x16x32_bf16 v[204:207], a[248:251], a[80:83], v[204:207]
  buffer_load_dwordx4 v9, s[12:15], s38 offen offset:2048 sc1 lds
  v_mfma_f32_16x16x32_bf16 v[232:235], a[252:255], a[80:83], v[232:235]
  ds_read_b64_tr_b16 a[206:207], v16 offset:12288
  v_mfma_f32_16x16x32_bf16 v[40:43], a[224:227], a[84:87], v[40:43]
  buffer_load_dwordx4 a[80:83], v30, s[8:11], s47 offen offset:2048 sc1
  v_mfma_f32_16x16x32_bf16 v[68:71], a[228:231], a[84:87], v[68:71]
  ds_read_b64_tr_b16 a[208:209], v17 offset:8192
  v_mfma_f32_16x16x32_bf16 v[96:99], a[232:235], a[84:87], v[96:99]
  buffer_load_dwordx4 v10, s[12:15], s38 offen offset:3072 sc1 lds
  v_mfma_f32_16x16x32_bf16 v[124:127], a[236:239], a[84:87], v[124:127]
  ds_read_b64_tr_b16 a[210:211], v17 offset:12288
  v_mfma_f32_16x16x32_bf16 v[152:155], a[240:243], a[84:87], v[152:155]
  v_mfma_f32_16x16x32_bf16 v[180:183], a[244:247], a[84:87], v[180:183]
  ds_read_b64_tr_b16 a[212:213], v18 offset:8192
  v_mfma_f32_16x16x32_bf16 v[208:211], a[248:251], a[84:87], v[208:211]
  v_mfma_f32_16x16x32_bf16 v[236:239], a[252:255], a[84:87], v[236:239]
  ds_read_b64_tr_b16 a[214:215], v18 offset:12288
  v_mfma_f32_16x16x32_bf16 v[44:47], a[224:227], a[88:91], v[44:47]
  s_add_u32 s47, s29, 4096
  buffer_load_dwordx4 a[84:87], v30, s[8:11], s47 offen offset:0 sc1
  v_mfma_f32_16x16x32_bf16 v[72:75], a[228:231], a[88:91], v[72:75]
  ds_read_b64_tr_b16 a[216:217], v19 offset:8192
  v_mfma_f32_16x16x32_bf16 v[100:103], a[232:235], a[88:91], v[100:103]
  s_add_u32 m0, s28, 4096
  s_add_u32 s38, s36, 32768
  buffer_load_dwordx4 v7, s[12:15], s38 offen offset:0 sc1 lds
  v_mfma_f32_16x16x32_bf16 v[128:131], a[236:239], a[88:91], v[128:131]
  s_add_u32 s35, s35, 1
  ds_read_b64_tr_b16 a[218:219], v19 offset:12288
  v_mfma_f32_16x16x32_bf16 v[156:159], a[240:243], a[88:91], v[156:159]
  s_and_b32 s48, s35, 14
  v_mfma_f32_16x16x32_bf16 v[184:187], a[244:247], a[88:91], v[184:187]
  s_lshl_b32 s48, s48, 17
  ds_read_b64_tr_b16 a[220:221], v20 offset:8192
  v_mfma_f32_16x16x32_bf16 v[212:215], a[248:251], a[88:91], v[212:215]
  s_add_u32 s36, s30, s48
  buffer_load_dwordx4 v8, s[12:15], s38 offen offset:1024 sc1 lds
  v_mfma_f32_16x16x32_bf16 v[240:243], a[252:255], a[88:91], v[240:243]
  s_waitcnt lgkmcnt(8)
  s_and_b32 s48, s35, 16
  ds_read_b64_tr_b16 a[222:223], v20 offset:12288
  v_mfma_f32_16x16x32_bf16 v[48:51], a[224:227], a[92:95], v[48:51]
  s_lshl_b32 s48, s48, 13
  buffer_load_dwordx4 a[88:91], v30, s[8:11], s47 offen offset:2048 sc1
  v_mfma_f32_16x16x32_bf16 v[76:79], a[228:231], a[92:95], v[76:79]
  s_add_u32 s46, s54, 460800
  s_add_u32 s36, s36, s48
  buffer_store_dwordx4 a[76:79], v30, s[24:27], s46 offen offset:0 sc1
  v_mfma_f32_16x16x32_bf16 v[104:107], a[232:235], a[92:95], v[104:107]
  s_and_b32 s48, s35, 1
  buffer_load_dwordx4 v9, s[12:15], s38 offen offset:2048 sc1 lds
  v_mfma_f32_16x16x32_bf16 v[132:135], a[236:239], a[92:95], v[132:135]
  s_lshl_b32 s48, s48, 16
  v_mfma_f32_16x16x32_bf16 v[160:163], a[240:243], a[92:95], v[160:163]
  s_add_u32 s36, s36, s48
  v_mfma_f32_16x16x32_bf16 v[188:191], a[244:247], a[92:95], v[188:191]
  v_mfma_f32_16x16x32_bf16 v[216:219], a[248:251], a[92:95], v[216:219]
  v_mfma_f32_16x16x32_bf16 v[244:247], a[252:255], a[92:95], v[244:247]
  v_mfma_f32_16x16x32_bf16 v[52:55], a[224:227], a[112:115], v[52:55]
  s_add_u32 s47, s29, 8192
  buffer_load_dwordx4 a[92:95], v30, s[8:11], s47 offen offset:0 sc1
  v_mfma_f32_16x16x32_bf16 v[80:83], a[228:231], a[112:115], v[80:83]
  v_mfma_f32_16x16x32_bf16 v[108:111], a[232:235], a[112:115], v[108:111]
  buffer_load_dwordx4 v10, s[12:15], s38 offen offset:3072 sc1 lds
  v_mfma_f32_16x16x32_bf16 v[136:139], a[236:239], a[112:115], v[136:139]
  v_mfma_f32_16x16x32_bf16 v[164:167], a[240:243], a[112:115], v[164:167]
  v_mfma_f32_16x16x32_bf16 v[192:195], a[244:247], a[112:115], v[192:195]
  v_mfma_f32_16x16x32_bf16 v[220:223], a[248:251], a[112:115], v[220:223]
  v_mfma_f32_16x16x32_bf16 v[248:251], a[252:255], a[112:115], v[248:251]
  buffer_load_dwordx4 a[112:115], v30, s[8:11], s47 offen offset:2048 sc1
  s_add_u32 s29, s29, 26624
  s_waitcnt vmcnt(16) lgkmcnt(0)
  v_mfma_f32_16x16x32_bf16 v[32:35], a[192:195], a[16:19], v[32:35]
  v_mfma_f32_16x16x32_bf16 v[60:63], a[196:199], a[16:19], v[60:63]
  ds_read_b64_tr_b16 a[224:225], v13 offset:24576
  v_mfma_f32_16x16x32_bf16 v[88:91], a[200:203], a[16:19], v[88:91]
  v_mfma_f32_16x16x32_bf16 v[116:119], a[204:207], a[16:19], v[116:119]
  ds_read_b64_tr_b16 a[226:227], v13 offset:28672
  v_mfma_f32_16x16x32_bf16 v[144:147], a[208:211], a[16:19], v[144:147]
  s_add_u32 m0, s28, 8192
  s_add_u32 s38, s36, 0
  buffer_load_dwordx4 v7, s[12:15], s38 offen offset:0 sc1 lds
  v_mfma_f32_16x16x32_bf16 v[172:175], a[212:215], a[16:19], v[172:175]
  ds_read_b64_tr_b16 a[228:229], v14 offset:24576
  v_mfma_f32_16x16x32_bf16 v[200:203], a[216:219], a[16:19], v[200:203]
  v_mfma_f32_16x16x32_bf16 v[228:231], a[220:223], a[16:19], v[228:231]
  ds_read_b64_tr_b16 a[230:231], v14 offset:28672
  v_mfma_f32_16x16x32_bf16 v[36:39], a[192:195], a[20:23], v[36:39]
  s_add_u32 s47, s29, 0
  buffer_load_dwordx4 a[16:19], v30, s[8:11], s47 offen offset:0 sc1
  v_mfma_f32_16x16x32_bf16 v[64:67], a[196:199], a[20:23], v[64:67]
  ds_read_b64_tr_b16 a[232:233], v15 offset:24576
  v_mfma_f32_16x16x32_bf16 v[92:95], a[200:203], a[20:23], v[92:95]
  buffer_load_dwordx4 v8, s[12:15], s38 offen offset:1024 sc1 lds
  v_mfma_f32_16x16x32_bf16 v[120:123], a[204:207], a[20:23], v[120:123]
  ds_read_b64_tr_b16 a[234:235], v15 offset:28672
  v_mfma_f32_16x16x32_bf16 v[148:151], a[208:211], a[20:23], v[148:151]
  v_mfma_f32_16x16x32_bf16 v[176:179], a[212:215], a[20:23], v[176:179]
  s_add_u32 s46, s54, 462848
  ds_read_b64_tr_b16 a[236:237], v16 offset:24576
  buffer_store_dwordx4 a[96:99], v30, s[24:27], s46 offen offset:0 sc1
  v_mfma_f32_16x16x32_bf16 v[204:207], a[216:219], a[20:23], v[204:207]
  buffer_load_dwordx4 v9, s[12:15], s38 offen offset:2048 sc1 lds
  v_mfma_f32_16x16x32_bf16 v[232:235], a[220:223], a[20:23], v[232:235]
  ds_read_b64_tr_b16 a[238:239], v16 offset:28672
  v_mfma_f32_16x16x32_bf16 v[40:43], a[192:195], a[24:27], v[40:43]
  buffer_load_dwordx4 a[20:23], v30, s[8:11], s47 offen offset:2048 sc1
  v_mfma_f32_16x16x32_bf16 v[68:71], a[196:199], a[24:27], v[68:71]
  ds_read_b64_tr_b16 a[240:241], v17 offset:24576
  v_mfma_f32_16x16x32_bf16 v[96:99], a[200:203], a[24:27], v[96:99]
  buffer_load_dwordx4 v10, s[12:15], s38 offen offset:3072 sc1 lds
  v_mfma_f32_16x16x32_bf16 v[124:127], a[204:207], a[24:27], v[124:127]
  ds_read_b64_tr_b16 a[242:243], v17 offset:28672
  v_mfma_f32_16x16x32_bf16 v[152:155], a[208:211], a[24:27], v[152:155]
  v_mfma_f32_16x16x32_bf16 v[180:183], a[212:215], a[24:27], v[180:183]
  ds_read_b64_tr_b16 a[244:245], v18 offset:24576
  v_mfma_f32_16x16x32_bf16 v[208:211], a[216:219], a[24:27], v[208:211]
  v_mfma_f32_16x16x32_bf16 v[236:239], a[220:223], a[24:27], v[236:239]
  ds_read_b64_tr_b16 a[246:247], v18 offset:28672
  v_mfma_f32_16x16x32_bf16 v[44:47], a[192:195], a[28:31], v[44:47]
  s_add_u32 s47, s29, 4096
  buffer_load_dwordx4 a[24:27], v30, s[8:11], s47 offen offset:0 sc1
  v_mfma_f32_16x16x32_bf16 v[72:75], a[196:199], a[28:31], v[72:75]
  ds_read_b64_tr_b16 a[248:249], v19 offset:24576
  v_mfma_f32_16x16x32_bf16 v[100:103], a[200:203], a[28:31], v[100:103]
  s_add_u32 m0, s28, 12288
  s_add_u32 s38, s36, 32768
  buffer_load_dwordx4 v7, s[12:15], s38 offen offset:0 sc1 lds
  v_mfma_f32_16x16x32_bf16 v[128:131], a[204:207], a[28:31], v[128:131]
  s_add_u32 s35, s35, 1
  ds_read_b64_tr_b16 a[250:251], v19 offset:28672
  v_mfma_f32_16x16x32_bf16 v[156:159], a[208:211], a[28:31], v[156:159]
  s_and_b32 s48, s35, 14
  v_mfma_f32_16x16x32_bf16 v[184:187], a[212:215], a[28:31], v[184:187]
  s_lshl_b32 s48, s48, 17
  ds_read_b64_tr_b16 a[252:253], v20 offset:24576
  v_mfma_f32_16x16x32_bf16 v[212:215], a[216:219], a[28:31], v[212:215]
  s_add_u32 s36, s30, s48
  buffer_load_dwordx4 v8, s[12:15], s38 offen offset:1024 sc1 lds
  v_mfma_f32_16x16x32_bf16 v[240:243], a[220:223], a[28:31], v[240:243]
  s_waitcnt lgkmcnt(8)
  s_and_b32 s48, s35, 16
  ds_read_b64_tr_b16 a[254:255], v20 offset:28672
  v_mfma_f32_16x16x32_bf16 v[48:51], a[192:195], a[48:51], v[48:51]
  s_lshl_b32 s48, s48, 13
  buffer_load_dwordx4 a[28:31], v30, s[8:11], s47 offen offset:2048 sc1
  v_mfma_f32_16x16x32_bf16 v[76:79], a[196:199], a[48:51], v[76:79]
  s_add_u32 s46, s44, 464896
  s_add_u32 s36, s36, s48
  buffer_store_dwordx4 a[100:103], v30, s[24:27], s46 offen offset:0 sc1
  v_mfma_f32_16x16x32_bf16 v[104:107], a[200:203], a[48:51], v[104:107]
  s_and_b32 s48, s35, 1
  buffer_load_dwordx4 v9, s[12:15], s38 offen offset:2048 sc1 lds
  v_mfma_f32_16x16x32_bf16 v[132:135], a[204:207], a[48:51], v[132:135]
  s_lshl_b32 s48, s48, 16
  v_mfma_f32_16x16x32_bf16 v[160:163], a[208:211], a[48:51], v[160:163]
  s_add_u32 s36, s36, s48
  v_mfma_f32_16x16x32_bf16 v[188:191], a[212:215], a[48:51], v[188:191]
  v_mfma_f32_16x16x32_bf16 v[216:219], a[216:219], a[48:51], v[216:219]
  v_mfma_f32_16x16x32_bf16 v[244:247], a[220:223], a[48:51], v[244:247]
  v_mfma_f32_16x16x32_bf16 v[52:55], a[192:195], a[52:55], v[52:55]
  s_add_u32 s47, s29, 8192
  buffer_load_dwordx4 a[48:51], v30, s[8:11], s47 offen offset:0 sc1
  v_mfma_f32_16x16x32_bf16 v[80:83], a[196:199], a[52:55], v[80:83]
  v_mfma_f32_16x16x32_bf16 v[108:111], a[200:203], a[52:55], v[108:111]
  buffer_load_dwordx4 v10, s[12:15], s38 offen offset:3072 sc1 lds
  v_mfma_f32_16x16x32_bf16 v[136:139], a[204:207], a[52:55], v[136:139]
  v_mfma_f32_16x16x32_bf16 v[164:167], a[208:211], a[52:55], v[164:167]
  v_mfma_f32_16x16x32_bf16 v[192:195], a[212:215], a[52:55], v[192:195]
  v_mfma_f32_16x16x32_bf16 v[220:223], a[216:219], a[52:55], v[220:223]
  v_mfma_f32_16x16x32_bf16 v[248:251], a[220:223], a[52:55], v[248:251]
  buffer_load_dwordx4 a[52:55], v30, s[8:11], s47 offen offset:2048 sc1
  s_add_u32 s29, s29, 26624
  s_waitcnt vmcnt(16) lgkmcnt(0)
  v_mfma_f32_16x16x32_bf16 v[32:35], a[224:227], a[60:63], v[32:35]
  v_mfma_f32_16x16x32_bf16 v[60:63], a[228:231], a[60:63], v[60:63]
  ds_read_b64_tr_b16 a[192:193], v13 offset:16384
  v_mfma_f32_16x16x32_bf16 v[88:91], a[232:235], a[60:63], v[88:91]
  v_mfma_f32_16x16x32_bf16 v[116:119], a[236:239], a[60:63], v[116:119]
  ds_read_b64_tr_b16 a[194:195], v13 offset:20480
  v_mfma_f32_16x16x32_bf16 v[144:147], a[240:243], a[60:63], v[144:147]
  s_add_u32 m0, s28, 24576
  s_add_u32 s38, s36, 0
  buffer_load_dwordx4 v7, s[12:15], s38 offen offset:0 sc1 lds
  v_mfma_f32_16x16x32_bf16 v[172:175], a[244:247], a[60:63], v[172:175]
  ds_read_b64_tr_b16 a[196:197], v14 offset:16384
  v_mfma_f32_16x16x32_bf16 v[200:203], a[248:251], a[60:63], v[200:203]
  v_mfma_f32_16x16x32_bf16 v[228:231], a[252:255], a[60:63], v[228:231]
  ds_read_b64_tr_b16 a[198:199], v14 offset:20480
  v_mfma_f32_16x16x32_bf16 v[36:39], a[224:227], a[80:83], v[36:39]
  s_add_u32 s47, s29, 0
  buffer_load_dwordx4 a[60:63], v30, s[8:11], s47 offen offset:0 sc1
  v_mfma_f32_16x16x32_bf16 v[64:67], a[228:231], a[80:83], v[64:67]
  ds_read_b64_tr_b16 a[200:201], v15 offset:16384
  v_mfma_f32_16x16x32_bf16 v[92:95], a[232:235], a[80:83], v[92:95]
  buffer_load_dwordx4 v8, s[12:15], s38 offen offset:1024 sc1 lds
  v_mfma_f32_16x16x32_bf16 v[120:123], a[236:239], a[80:83], v[120:123]
  ds_read_b64_tr_b16 a[202:203], v15 offset:20480
  v_mfma_f32_16x16x32_bf16 v[148:151], a[240:243], a[80:83], v[148:151]
  v_mfma_f32_16x16x32_bf16 v[176:179], a[244:247], a[80:83], v[176:179]
  ds_read_b64_tr_b16 a[204:205], v16 offset:16384
  v_mfma_f32_16x16x32_bf16 v[204:207], a[248:251], a[80:83], v[204:207]
  buffer_load_dwordx4 v9, s[12:15], s38 offen offset:2048 sc1 lds
  v_mfma_f32_16x16x32_bf16 v[232:235], a[252:255], a[80:83], v[232:235]
  ds_read_b64_tr_b16 a[206:207], v16 offset:20480
  v_mfma_f32_16x16x32_bf16 v[40:43], a[224:227], a[84:87], v[40:43]
  buffer_load_dwordx4 a[80:83], v30, s[8:11], s47 offen offset:2048 sc1
  v_mfma_f32_16x16x32_bf16 v[68:71], a[228:231], a[84:87], v[68:71]
  ds_read_b64_tr_b16 a[208:209], v17 offset:16384
  v_mfma_f32_16x16x32_bf16 v[96:99], a[232:235], a[84:87], v[96:99]
  buffer_load_dwordx4 v10, s[12:15], s38 offen offset:3072 sc1 lds
  v_mfma_f32_16x16x32_bf16 v[124:127], a[236:239], a[84:87], v[124:127]
  ds_read_b64_tr_b16 a[210:211], v17 offset:20480
  v_mfma_f32_16x16x32_bf16 v[152:155], a[240:243], a[84:87], v[152:155]
  v_mfma_f32_16x16x32_bf16 v[180:183], a[244:247], a[84:87], v[180:183]
  ds_read_b64_tr_b16 a[212:213], v18 offset:16384
  v_mfma_f32_16x16x32_bf16 v[208:211], a[248:251], a[84:87], v[208:211]
  v_mfma_f32_16x16x32_bf16 v[236:239], a[252:255], a[84:87], v[236:239]
  ds_read_b64_tr_b16 a[214:215], v18 offset:20480
  v_mfma_f32_16x16x32_bf16 v[44:47], a[224:227], a[88:91], v[44:47]
  s_add_u32 s47, s29, 4096
  buffer_load_dwordx4 a[84:87], v30, s[8:11], s47 offen offset:0 sc1
  v_mfma_f32_16x16x32_bf16 v[72:75], a[228:231], a[88:91], v[72:75]
  ds_read_b64_tr_b16 a[216:217], v19 offset:16384
  v_mfma_f32_16x16x32_bf16 v[100:103], a[232:235], a[88:91], v[100:103]
  s_add_u32 m0, s28, 28672
  s_add_u32 s38, s36, 32768
  buffer_load_dwordx4 v7, s[12:15], s38 offen offset:0 sc1 lds
  v_mfma_f32_16x16x32_bf16 v[128:131], a[236:239], a[88:91], v[128:131]
  s_add_u32 s35, s35, 1
  ds_read_b64_tr_b16 a[218:219], v19 offset:20480
  v_mfma_f32_16x16x32_bf16 v[156:159], a[240:243], a[88:91], v[156:159]
  s_and_b32 s48, s35, 14
  v_mfma_f32_16x16x32_bf16 v[184:187], a[244:247], a[88:91], v[184:187]
  s_lshl_b32 s48, s48, 17
  ds_read_b64_tr_b16 a[220:221], v20 offset:16384
  v_mfma_f32_16x16x32_bf16 v[212:215], a[248:251], a[88:91], v[212:215]
  s_add_u32 s36, s30, s48
  buffer_load_dwordx4 v8, s[12:15], s38 offen offset:1024 sc1 lds
  v_mfma_f32_16x16x32_bf16 v[240:243], a[252:255], a[88:91], v[240:243]
  s_waitcnt lgkmcnt(8)
  s_and_b32 s48, s35, 16
  ds_read_b64_tr_b16 a[222:223], v20 offset:20480
  v_mfma_f32_16x16x32_bf16 v[48:51], a[224:227], a[92:95], v[48:51]
  s_lshl_b32 s48, s48, 13
  buffer_load_dwordx4 a[88:91], v30, s[8:11], s47 offen offset:2048 sc1
  v_mfma_f32_16x16x32_bf16 v[76:79], a[228:231], a[92:95], v[76:79]
  s_add_u32 s36, s36, s48
  v_mfma_f32_16x16x32_bf16 v[104:107], a[232:235], a[92:95], v[104:107]
  s_and_b32 s48, s35, 1
  buffer_load_dwordx4 v9, s[12:15], s38 offen offset:2048 sc1 lds
  v_mfma_f32_16x16x32_bf16 v[132:135], a[236:239], a[92:95], v[132:135]
  s_lshl_b32 s48, s48, 16
  v_mfma_f32_16x16x32_bf16 v[160:163], a[240:243], a[92:95], v[160:163]
  s_add_u32 s36, s36, s48
  v_mfma_f32_16x16x32_bf16 v[188:191], a[244:247], a[92:95], v[188:191]
  v_mfma_f32_16x16x32_bf16 v[216:219], a[248:251], a[92:95], v[216:219]
  v_mfma_f32_16x16x32_bf16 v[244:247], a[252:255], a[92:95], v[244:247]
  v_mfma_f32_16x16x32_bf16 v[52:55], a[224:227], a[112:115], v[52:55]
  s_add_u32 s47, s29, 8192
  buffer_load_dwordx4 a[92:95], v30, s[8:11], s47 offen offset:0 sc1
  v_mfma_f32_16x16x32_bf16 v[80:83], a[228:231], a[112:115], v[80:83]
  v_mfma_f32_16x16x32_bf16 v[108:111], a[232:235], a[112:115], v[108:111]
  buffer_load_dwordx4 v10, s[12:15], s38 offen offset:3072 sc1 lds
  v_mfma_f32_16x16x32_bf16 v[136:139], a[236:239], a[112:115], v[136:139]
  v_mfma_f32_16x16x32_bf16 v[164:167], a[240:243], a[112:115], v[164:167]
  v_mfma_f32_16x16x32_bf16 v[192:195], a[244:247], a[112:115], v[192:195]
  v_mfma_f32_16x16x32_bf16 v[220:223], a[248:251], a[112:115], v[220:223]
  v_mfma_f32_16x16x32_bf16 v[248:251], a[252:255], a[112:115], v[248:251]
  buffer_load_dwordx4 a[112:115], v30, s[8:11], s47 offen offset:2048 sc1
  s_add_u32 s29, s29, 26624
  s_waitcnt vmcnt(14)
  s_barrier
  s_cmp_lg_u32 s3, 0
  s_cbranch_scc1 L2b_sig2
  v_mov_b32 v0, 2
  s_mov_b64 exec, 1
  global_store_dword v12, v0, s[98:99] sc1
  s_mov_b64 exec, -1
L2b_sig2:
  s_mov_b32 s31, 2
L2b_loop:
  s_waitcnt vmcnt(14) lgkmcnt(0)
  v_mfma_f32_16x16x32_bf16 v[32:35], a[192:195], a[16:19], v[32:35]
  v_mfma_f32_16x16x32_bf16 v[60:63], a[196:199], a[16:19], v[60:63]
  ds_read_b64_tr_b16 a[224:225], v13 offset:0
  v_mfma_f32_16x16x32_bf16 v[88:91], a[200:203], a[16:19], v[88:91]
  v_mfma_f32_16x16x32_bf16 v[116:119], a[204:207], a[16:19], v[116:119]
  ds_read_b64_tr_b16 a[226:227], v13 offset:4096
  v_mfma_f32_16x16x32_bf16 v[144:147], a[208:211], a[16:19], v[144:147]
  s_add_u32 m0, s28, 16384
  s_add_u32 s38, s36, 0
  buffer_load_dwordx4 v7, s[12:15], s38 offen offset:0 sc1 lds
  v_mfma_f32_16x16x32_bf16 v[172:175], a[212:215], a[16:19], v[172:175]
  ds_read_b64_tr_b16 a[228:229], v14 offset:0
  v_mfma_f32_16x16x32_bf16 v[200:203], a[216:219], a[16:19], v[200:203]
  v_mfma_f32_16x16x32_bf16 v[228:231], a[220:223], a[16:19], v[228:231]
  ds_read_b64_tr_b16 a[230:231], v14 offset:4096
  v_mfma_f32_16x16x32_bf16 v[36:39], a[192:195], a[20:23], v[36:39]
  s_add_u32 s47, s29, 0
  buffer_load_dwordx4 a[16:19], v30, s[8:11], s47 offen offset:0 sc1
  v_mfma_f32_16x16x32_bf16 v[64:67], a[196:199], a[20:23], v[64:67]
  ds_read_b64_tr_b16 a[232:233], v15 offset:0
  v_mfma_f32_16x16x32_bf16 v[92:95], a[200:203], a[20:23], v[92:95]
  buffer_load_dwordx4 v8, s[12:15], s38 offen offset:1024 sc1 lds
  v_mfma_f32_16x16x32_bf16 v[120:123], a[204:207], a[20:23], v[120:123]
  ds_read_b64_tr_b16 a[234:235], v15 offset:4096
  v_mfma_f32_16x16x32_bf16 v[148:151], a[208:211], a[20:23], v[148:151]
  v_mfma_f32_16x16x32_bf16 v[176:179], a[212:215], a[20:23], v[176:179]
  ds_read_b64_tr_b16 a[236:237], v16 offset:0
  v_mfma_f32_16x16x32_bf16 v[204:207], a[216:219], a[20:23], v[204:207]
  buffer_load_dwordx4 v9, s[12:15], s38 offen offset:2048 sc1 lds
  v_mfma_f32_16x16x32_bf16 v[232:235], a[220:223], a[20:23], v[232:235]
  ds_read_b64_tr_b16 a[238:239], v16 offset:4096
  v_mfma_f32_16x16x32_bf16 v[40:43], a[192:195], a[24:27], v[40:43]
  buffer_load_dwordx4 a[20:23], v30, s[8:11], s47 offen offset:2048 sc1
  v_mfma_f32_16x16x32_bf16 v[68:71], a[196:199], a[24:27], v[68:71]
  ds_read_b64_tr_b16 a[240:241], v17 offset:0
  v_mfma_f32_16x16x32_bf16 v[96:99], a[200:203], a[24:27], v[96:99]
  buffer_load_dwordx4 v10, s[12:15], s38 offen offset:3072 sc1 lds
  v_mfma_f32_16x16x32_bf16 v[124:127], a[204:207], a[24:27], v[124:127]
  ds_read_b64_tr_b16 a[242:243], v17 offset:4096
  v_mfma_f32_16x16x32_bf16 v[152:155], a[208:211], a[24:27], v[152:155]
  v_mfma_f32_16x16x32_bf16 v[180:183], a[212:215], a[24:27], v[180:183]
  ds_read_b64_tr_b16 a[244:245], v18 offset:0
  v_mfma_f32_16x16x32_bf16 v[208:211], a[216:219], a[24:27], v[208:211]
  v_mfma_f32_16x16x32_bf16 v[236:239], a[220:223], a[24:27], v[236:239]
  ds_read_b64_tr_b16 a[246:247], v18 offset:4096
  v_mfma_f32_16x16x32_bf16 v[44:47], a[192:195], a[28:31], v[44:47]
  s_add_u32 s47, s29, 4096
  buffer_load_dwordx4 a[24:27], v30, s[8:11], s47 offen offset:0 sc1
  v_mfma_f32_16x16x32_bf16 v[72:75], a[196:199], a[28:31], v[72:75]
  ds_read_b64_tr_b16 a[248:249], v19 offset:0
  v_mfma_f32_16x16x32_bf16 v[100:103], a[200:203], a[28:31], v[100:103]
  s_add_u32 m0, s28, 20480
  s_add_u32 s38, s36, 32768
  buffer_load_dwordx4 v7, s[12:15], s38 offen offset:0 sc1 lds
  v_mfma_f32_16x16x32_bf16 v[128:131], a[204:207], a[28:31], v[128:131]
  s_add_u32 s35, s35, 1
  ds_read_b64_tr_b16 a[250:251], v19 offset:4096
  v_mfma_f32_16x16x32_bf16 v[156:159], a[208:211], a[28:31], v[156:159]
  s_and_b32 s48, s35, 14
  v_mfma_f32_16x16x32_bf16 v[184:187], a[212:215], a[28:31], v[184:187]
  s_lshl_b32 s48, s48, 17
  ds_read_b64_tr_b16 a[252:253], v20 offset:0
  v_mfma_f32_16x16x32_bf16 v[212:215], a[216:219], a[28:31], v[212:215]
  s_add_u32 s36, s30, s48
  buffer_load_dwordx4 v8, s[12:15], s38 offen offset:1024 sc1 lds
  v_mfma_f32_16x16x32_bf16 v[240:243], a[220:223], a[28:31], v[240:243]
  s_waitcnt lgkmcnt(8)
  s_and_b32 s48, s35, 16
  ds_read_b64_tr_b16 a[254:255], v20 offset:4096
  v_mfma_f32_16x16x32_bf16 v[48:51], a[192:195], a[48:51], v[48:51]
  s_lshl_b32 s48, s48, 13
  buffer_load_dwordx4 a[28:31], v30, s[8:11], s47 offen offset:2048 sc1
  v_mfma_f32_16x16x32_bf16 v[76:79], a[196:199], a[48:51], v[76:79]
  s_add_u32 s36, s36, s48
  v_mfma_f32_16x16x32_bf16 v[104:107], a[200:203], a[48:51], v[104:107]
  s_and_b32 s48, s35, 1
  buffer_load_dwordx4 v9, s[12:15], s38 offen offset:2048 sc1 lds
  v_mfma_f32_16x16x32_bf16 v[132:135], a[204:207], a[48:51], v[132:135]
  s_lshl_b32 s48, s48, 16
  v_mfma_f32_16x16x32_bf16 v[160:163], a[208:211], a[48:51], v[160:163]
  s_add_u32 s36, s36, s48
  v_mfma_f32_16x16x32_bf16 v[188:191], a[212:215], a[48:51], v[188:191]
  v_mfma_f32_16x16x32_bf16 v[216:219], a[216:219], a[48:51], v[216:219]
  v_mfma_f32_16x16x32_bf16 v[244:247], a[220:223], a[48:51], v[244:247]
  v_mfma_f32_16x16x32_bf16 v[52:55], a[192:195], a[52:55], v[52:55]
  s_add_u32 s47, s29, 8192
  buffer_load_dwordx4 a[48:51], v30, s[8:11], s47 offen offset:0 sc1
  v_mfma_f32_16x16x32_bf16 v[80:83], a[196:199], a[52:55], v[80:83]
  v_mfma_f32_16x16x32_bf16 v[108:111], a[200:203], a[52:55], v[108:111]
  buffer_load_dwordx4 v10, s[12:15], s38 offen offset:3072 sc1 lds
  v_mfma_f32_16x16x32_bf16 v[136:139], a[204:207], a[52:55], v[136:139]
  v_mfma_f32_16x16x32_bf16 v[164:167], a[208:211], a[52:55], v[164:167]
  v_mfma_f32_16x16x32_bf16 v[192:195], a[212:215], a[52:55], v[192:195]
  v_mfma_f32_16x16x32_bf16 v[220:223], a[216:219], a[52:55], v[220:223]
  v_mfma_f32_16x16x32_bf16 v[248:251], a[220:223], a[52:55], v[248:251]
  buffer_load_dwordx4 a[52:55], v30, s[8:11], s47 offen offset:2048 sc1
  s_add_u32 s29, s29, 26624
  s_waitcnt vmcnt(14) lgkmcnt(0)
  s_cmp_lg_u32 s31, 3
  s_cbranch_scc1 L2b_p2_go
  s_mov_b32 s49, 524288
L2b_p2_c:
  v_min_u32 v24, v24, v25
  v_min3_u32 v24, v24, v26, v27
  s_nop 0
  v_readfirstlane_b32 s48, v24
  s_sub_u32 s49, s49, 1
  s_cbranch_scc1 L2b_p2_go
  s_cmp_ge_u32 s48, 2
  s_cbranch_scc1 L2b_p2_go
  s_sleep 2
  global_load_dwordx4 v[24:27], v11, s[98:99] sc1
  s_waitcnt vmcnt(0)
  s_branch L2b_p2_c
L2b_p2_go:
  v_mfma_f32_16x16x32_bf16 v[32:35], a[224:227], a[60:63], v[32:35]
  v_mfma_f32_16x16x32_bf16 v[60:63], a[228:231], a[60:63], v[60:63]
  ds_read_b64_tr_b16 a[192:193], v13 offset:8192
  v_mfma_f32_16x16x32_bf16 v[88:91], a[232:235], a[60:63], v[88:91]
  v_mfma_f32_16x16x32_bf16 v[116:119], a[236:239], a[60:63], v[116:119]
  ds_read_b64_tr_b16 a[194:195], v13 offset:12288
  v_mfma_f32_16x16x32_bf16 v[144:147], a[240:243], a[60:63], v[144:147]
  s_add_u32 m0, s28, 0
  s_add_u32 s38, s36, 0
  buffer_load_dwordx4 v7, s[12:15], s38 offen offset:0 sc1 lds
  v_mfma_f32_16x16x32_bf16 v[172:175], a[244:247], a[60:63], v[172:175]
  ds_read_b64_tr_b16 a[196:197], v14 offset:8192
  v_mfma_f32_16x16x32_bf16 v[200:203], a[248:251], a[60:63], v[200:203]
  v_mfma_f32_16x16x32_bf16 v[228:231], a[252:255], a[60:63], v[228:231]
  ds_read_b64_tr_b16 a[198:199], v14 offset:12288
  v_mfma_f32_16x16x32_bf16 v[36:39], a[224:227], a[80:83], v[36:39]
  s_add_u32 s47, s29, 0
  buffer_load_dwordx4 a[60:63], v30, s[8:11], s47 offen offset:0 sc1
  v_mfma_f32_16x16x32_bf16 v[64:67], a[228:231], a[80:83], v[64:67]
  ds_read_b64_tr_b16 a[200:201], v15 offset:8192
  v_mfma_f32_16x16x32_bf16 v[92:95], a[232:235], a[80:83], v[92:95]
  buffer_load_dwordx4 v8, s[12:15], s38 offen offset:1024 sc1 lds
  v_mfma_f32_16x16x32_bf16 v[120:123], a[236:239], a[80:83], v[120:123]
  ds_read_b64_tr_b16 a[202:203], v15 offset:12288
  v_mfma_f32_16x16x32_bf16 v[148:151], a[240:243], a[80:83], v[148:151]
  v_mfma_f32_16x16x32_bf16 v[176:179], a[244:247], a[80:83], v[176:179]
  ds_read_b64_tr_b16 a[204:205], v16 offset:8192
  v_mfma_f32_16x16x32_bf16 v[204:207], a[248:251], a[80:83], v[204:207]
  buffer_load_dwordx4 v9, s[12:15], s38 offen offset:2048 sc1 lds
  v_mfma_f32_16x16x32_bf16 v[232:235], a[252:255], a[80:83], v[232:235]
  ds_read_b64_tr_b16 a[206:207], v16 offset:12288
  v_mfma_f32_16x16x32_bf16 v[40:43], a[224:227], a[84:87], v[40:43]
  buffer_load_dwordx4 a[80:83], v30, s[8:11], s47 offen offset:2048 sc1
  v_mfma_f32_16x16x32_bf16 v[68:71], a[228:231], a[84:87], v[68:71]
  ds_read_b64_tr_b16 a[208:209], v17 offset:8192
  v_mfma_f32_16x16x32_bf16 v[96:99], a[232:235], a[84:87], v[96:99]
  buffer_load_dwordx4 v10, s[12:15], s38 offen offset:3072 sc1 lds
  v_mfma_f32_16x16x32_bf16 v[124:127], a[236:239], a[84:87], v[124:127]
  ds_read_b64_tr_b16 a[210:211], v17 offset:12288
  v_mfma_f32_16x16x32_bf16 v[152:155], a[240:243], a[84:87], v[152:155]
  v_mfma_f32_16x16x32_bf16 v[180:183], a[244:247], a[84:87], v[180:183]
  ds_read_b64_tr_b16 a[212:213], v18 offset:8192
  v_mfma_f32_16x16x32_bf16 v[208:211], a[248:251], a[84:87], v[208:211]
  v_mfma_f32_16x16x32_bf16 v[236:239], a[252:255], a[84:87], v[236:239]
  ds_read_b64_tr_b16 a[214:215], v18 offset:12288
  v_mfma_f32_16x16x32_bf16 v[44:47], a[224:227], a[88:91], v[44:47]
  s_add_u32 s47, s29, 4096
  buffer_load_dwordx4 a[84:87], v30, s[8:11], s47 offen offset:0 sc1
  v_mfma_f32_16x16x32_bf16 v[72:75], a[228:231], a[88:91], v[72:75]
  ds_read_b64_tr_b16 a[216:217], v19 offset:8192
  v_mfma_f32_16x16x32_bf16 v[100:103], a[232:235], a[88:91], v[100:103]
  s_add_u32 m0, s28, 4096
  s_add_u32 s38, s36, 32768
  buffer_load_dwordx4 v7, s[12:15], s38 offen offset:0 sc1 lds
  v_mfma_f32_16x16x32_bf16 v[128:131], a[236:239], a[88:91], v[128:131]
  s_add_u32 s35, s35, 1
  ds_read_b64_tr_b16 a[218:219], v19 offset:12288
  v_mfma_f32_16x16x32_bf16 v[156:159], a[240:243], a[88:91], v[156:159]
  s_and_b32 s48, s35, 14
  v_mfma_f32_16x16x32_bf16 v[184:187], a[244:247], a[88:91], v[184:187]
  s_lshl_b32 s48, s48, 17
  ds_read_b64_tr_b16 a[220:221], v20 offset:8192
  v_mfma_f32_16x16x32_bf16 v[212:215], a[248:251], a[88:91], v[212:215]
  s_add_u32 s36, s30, s48
  buffer_load_dwordx4 v8, s[12:15], s38 offen offset:1024 sc1 lds
  v_mfma_f32_16x16x32_bf16 v[240:243], a[252:255], a[88:91], v[240:243]
  s_waitcnt lgkmcnt(8)
  s_and_b32 s48, s35, 16
  ds_read_b64_tr_b16 a[222:223], v20 offset:12288
  v_mfma_f32_16x16x32_bf16 v[48:51], a[224:227], a[92:95], v[48:51]
  s_lshl_b32 s48, s48, 13
  buffer_load_dwordx4 a[88:91], v30, s[8:11], s47 offen offset:2048 sc1
  v_mfma_f32_16x16x32_bf16 v[76:79], a[228:231], a[92:95], v[76:79]
  s_add_u32 s36, s36, s48
  v_mfma_f32_16x16x32_bf16 v[104:107], a[232:235], a[92:95], v[104:107]
  s_and_b32 s48, s35, 1
  buffer_load_dwordx4 v9, s[12:15], s38 offen offset:2048 sc1 lds
  v_mfma_f32_16x16x32_bf16 v[132:135], a[236:239], a[92:95], v[132:135]
  s_lshl_b32 s48, s48, 16
  v_mfma_f32_16x16x32_bf16 v[160:163], a[240:243], a[92:95], v[160:163]
  s_add_u32 s36, s36, s48
  v_mfma_f32_16x16x32_bf16 v[188:191], a[244:247], a[92:95], v[188:191]
  v_mfma_f32_16x16x32_bf16 v[216:219], a[248:251], a[92:95], v[216:219]
  v_mfma_f32_16x16x32_bf16 v[244:247], a[252:255], a[92:95], v[244:247]
  v_mfma_f32_16x16x32_bf16 v[52:55], a[224:227], a[112:115], v[52:55]
  s_add_u32 s47, s29, 8192
  buffer_load_dwordx4 a[92:95], v30, s[8:11], s47 offen offset:0 sc1
  v_mfma_f32_16x16x32_bf16 v[80:83], a[228:231], a[112:115], v[80:83]
  v_mfma_f32_16x16x32_bf16 v[108:111], a[232:235], a[112:115], v[108:111]
  buffer_load_dwordx4 v10, s[12:15], s38 offen offset:3072 sc1 lds
  v_mfma_f32_16x16x32_bf16 v[136:139], a[236:239], a[112:115], v[136:139]
  v_mfma_f32_16x16x32_bf16 v[164:167], a[240:243], a[112:115], v[164:167]
  v_mfma_f32_16x16x32_bf16 v[192:195], a[244:247], a[112:115], v[192:195]
  v_mfma_f32_16x16x32_bf16 v[220:223], a[248:251], a[112:115], v[220:223]
  v_mfma_f32_16x16x32_bf16 v[248:251], a[252:255], a[112:115], v[248:251]
  buffer_load_dwordx4 a[112:115], v30, s[8:11], s47 offen offset:2048 sc1
  s_add_u32 s29, s29, 26624
  s_waitcnt vmcnt(14) lgkmcnt(0)
  v_mfma_f32_16x16x32_bf16 v[32:35], a[192:195], a[16:19], v[32:35]
  v_mfma_f32_16x16x32_bf16 v[60:63], a[196:199], a[16:19], v[60:63]
  ds_read_b64_tr_b16 a[224:225], v13 offset:24576
  v_mfma_f32_16x16x32_bf16 v[88:91], a[200:203], a[16:19], v[88:91]
  v_mfma_f32_16x16x32_bf16 v[116:119], a[204:207], a[16:19], v[116:119]
  ds_read_b64_tr_b16 a[226:227], v13 offset:28672
  v_mfma_f32_16x16x32_bf16 v[144:147], a[208:211], a[16:19], v[144:147]
  s_add_u32 m0, s28, 8192
  s_add_u32 s38, s36, 0
  buffer_load_dwordx4 v7, s[12:15], s38 offen offset:0 sc1 lds
  v_mfma_f32_16x16x32_bf16 v[172:175], a[212:215], a[16:19], v[172:175]
  ds_read_b64_tr_b16 a[228:229], v14 offset:24576
  v_mfma_f32_16x16x32_bf16 v[200:203], a[216:219], a[16:19], v[200:203]
  v_mfma_f32_16x16x32_bf16 v[228:231], a[220:223], a[16:19], v[228:231]
  ds_read_b64_tr_b16 a[230:231], v14 offset:28672
  v_mfma_f32_16x16x32_bf16 v[36:39], a[192:195], a[20:23], v[36:39]
  s_add_u32 s47, s29, 0
  buffer_load_dwordx4 a[16:19], v30, s[8:11], s47 offen offset:0 sc1
  v_mfma_f32_16x16x32_bf16 v[64:67], a[196:199], a[20:23], v[64:67]
  ds_read_b64_tr_b16 a[232:233], v15 offset:24576
  v_mfma_f32_16x16x32_bf16 v[92:95], a[200:203], a[20:23], v[92:95]
  buffer_load_dwordx4 v8, s[12:15], s38 offen offset:1024 sc1 lds
  v_mfma_f32_16x16x32_bf16 v[120:123], a[204:207], a[20:23], v[120:123]
  ds_read_b64_tr_b16 a[234:235], v15 offset:28672
  v_mfma_f32_16x16x32_bf16 v[148:151], a[208:211], a[20:23], v[148:151]
  v_mfma_f32_16x16x32_bf16 v[176:179], a[212:215], a[20:23], v[176:179]
  ds_read_b64_tr_b16 a[236:237], v16 offset:24576
  v_mfma_f32_16x16x32_bf16 v[204:207], a[216:219], a[20:23], v[204:207]
  buffer_load_dwordx4 v9, s[12:15], s38 offen offset:2048 sc1 lds
  v_mfma_f32_16x16x32_bf16 v[232:235], a[220:223], a[20:23], v[232:235]
  ds_read_b64_tr_b16 a[238:239], v16 offset:28672
  v_mfma_f32_16x16x32_bf16 v[40:43], a[192:195], a[24:27], v[40:43]
  buffer_load_dwordx4 a[20:23], v30, s[8:11], s47 offen offset:2048 sc1
  v_mfma_f32_16x16x32_bf16 v[68:71], a[196:199], a[24:27], v[68:71]
  ds_read_b64_tr_b16 a[240:241], v17 offset:24576
  v_mfma_f32_16x16x32_bf16 v[96:99], a[200:203], a[24:27], v[96:99]
  buffer_load_dwordx4 v10, s[12:15], s38 offen offset:3072 sc1 lds
  v_mfma_f32_16x16x32_bf16 v[124:127], a[204:207], a[24:27], v[124:127]
  ds_read_b64_tr_b16 a[242:243], v17 offset:28672
  v_mfma_f32_16x16x32_bf16 v[152:155], a[208:211], a[24:27], v[152:155]
  v_mfma_f32_16x16x32_bf16 v[180:183], a[212:215], a[24:27], v[180:183]
  ds_read_b64_tr_b16 a[244:245], v18 offset:24576
  v_mfma_f32_16x16x32_bf16 v[208:211], a[216:219], a[24:27], v[208:211]
  v_mfma_f32_16x16x32_bf16 v[236:239], a[220:223], a[24:27], v[236:239]
  ds_read_b64_tr_b16 a[246:247], v18 offset:28672
  v_mfma_f32_16x16x32_bf16 v[44:47], a[192:195], a[28:31], v[44:47]
  s_add_u32 s47, s29, 4096
  buffer_load_dwordx4 a[24:27], v30, s[8:11], s47 offen offset:0 sc1
  v_mfma_f32_16x16x32_bf16 v[72:75], a[196:199], a[28:31], v[72:75]
  ds_read_b64_tr_b16 a[248:249], v19 offset:24576
  v_mfma_f32_16x16x32_bf16 v[100:103], a[200:203], a[28:31], v[100:103]
  s_add_u32 m0, s28, 12288
  s_add_u32 s38, s36, 32768
  buffer_load_dwordx4 v7, s[12:15], s38 offen offset:0 sc1 lds
  v_mfma_f32_16x16x32_bf16 v[128:131], a[204:207], a[28:31], v[128:131]
  s_add_u32 s35, s35, 1
  ds_read_b64_tr_b16 a[250:251], v19 offset:28672
  v_mfma_f32_16x16x32_bf16 v[156:159], a[208:211], a[28:31], v[156:159]
  s_and_b32 s48, s35, 14
  v_mfma_f32_16x16x32_bf16 v[184:187], a[212:215], a[28:31], v[184:187]
  s_lshl_b32 s48, s48, 17
  ds_read_b64_tr_b16 a[252:253], v20 offset:24576
  v_mfma_f32_16x16x32_bf16 v[212:215], a[216:219], a[28:31], v[212:215]
  s_add_u32 s36, s30, s48
  buffer_load_dwordx4 v8, s[12:15], s38 offen offset:1024 sc1 lds
  v_mfma_f32_16x16x32_bf16 v[240:243], a[220:223], a[28:31], v[240:243]
  s_waitcnt lgkmcnt(8)
  s_and_b32 s48, s35, 16
  ds_read_b64_tr_b16 a[254:255], v20 offset:28672
  v_mfma_f32_16x16x32_bf16 v[48:51], a[192:195], a[48:51], v[48:51]
  s_lshl_b32 s48, s48, 13
  buffer_load_dwordx4 a[28:31], v30, s[8:11], s47 offen offset:2048 sc1
  v_mfma_f32_16x16x32_bf16 v[76:79], a[196:199], a[48:51], v[76:79]
  s_add_u32 s36, s36, s48
  v_mfma_f32_16x16x32_bf16 v[104:107], a[200:203], a[48:51], v[104:107]
  s_and_b32 s48, s35, 1
  buffer_load_dwordx4 v9, s[12:15], s38 offen offset:2048 sc1 lds
  v_mfma_f32_16x16x32_bf16 v[132:135], a[204:207], a[48:51], v[132:135]
  s_lshl_b32 s48, s48, 16
  v_mfma_f32_16x16x32_bf16 v[160:163], a[208:211], a[48:51], v[160:163]
  s_add_u32 s36, s36, s48
  v_mfma_f32_16x16x32_bf16 v[188:191], a[212:215], a[48:51], v[188:191]
  v_mfma_f32_16x16x32_bf16 v[216:219], a[216:219], a[48:51], v[216:219]
  v_mfma_f32_16x16x32_bf16 v[244:247], a[220:223], a[48:51], v[244:247]
  v_mfma_f32_16x16x32_bf16 v[52:55], a[192:195], a[52:55], v[52:55]
  s_add_u32 s47, s29, 8192
  buffer_load_dwordx4 a[48:51], v30, s[8:11], s47 offen offset:0 sc1
  v_mfma_f32_16x16x32_bf16 v[80:83], a[196:199], a[52:55], v[80:83]
  v_mfma_f32_16x16x32_bf16 v[108:111], a[200:203], a[52:55], v[108:111]
  buffer_load_dwordx4 v10, s[12:15], s38 offen offset:3072 sc1 lds
  v_mfma_f32_16x16x32_bf16 v[136:139], a[204:207], a[52:55], v[136:139]
  v_mfma_f32_16x16x32_bf16 v[164:167], a[208:211], a[52:55], v[164:167]
  v_mfma_f32_16x16x32_bf16 v[192:195], a[212:215], a[52:55], v[192:195]
  v_mfma_f32_16x16x32_bf16 v[220:223], a[216:219], a[52:55], v[220:223]
  v_mfma_f32_16x16x32_bf16 v[248:251], a[220:223], a[52:55], v[248:251]
  buffer_load_dwordx4 a[52:55], v30, s[8:11], s47 offen offset:2048 sc1
  s_add_u32 s29, s29, 26624
  s_waitcnt vmcnt(14) lgkmcnt(0)
  v_mfma_f32_16x16x32_bf16 v[32:35], a[224:227], a[60:63], v[32:35]
  v_mfma_f32_16x16x32_bf16 v[60:63], a[228:231], a[60:63], v[60:63]
  ds_read_b64_tr_b16 a[192:193], v13 offset:16384
  v_mfma_f32_16x16x32_bf16 v[88:91], a[232:235], a[60:63], v[88:91]
  global_load_dwordx4 v[24:27], v11, s[98:99] sc1
  v_mfma_f32_16x16x32_bf16 v[116:119], a[236:239], a[60:63], v[116:119]
  ds_read_b64_tr_b16 a[194:195], v13 offset:20480
  v_mfma_f32_16x16x32_bf16 v[144:147], a[240:243], a[60:63], v[144:147]
  s_add_u32 m0, s28, 24576
  s_add_u32 s38, s36, 0
  buffer_load_dwordx4 v7, s[12:15], s38 offen offset:0 sc1 lds
  v_mfma_f32_16x16x32_bf16 v[172:175], a[244:247], a[60:63], v[172:175]
  ds_read_b64_tr_b16 a[196:197], v14 offset:16384
  v_mfma_f32_16x16x32_bf16 v[200:203], a[248:251], a[60:63], v[200:203]
  v_mfma_f32_16x16x32_bf16 v[228:231], a[252:255], a[60:63], v[228:231]
  ds_read_b64_tr_b16 a[198:199], v14 offset:20480
  v_mfma_f32_16x16x32_bf16 v[36:39], a[224:227], a[80:83], v[36:39]
  s_add_u32 s47, s29, 0
  buffer_load_dwordx4 a[60:63], v30, s[8:11], s47 offen offset:0 sc1
  v_mfma_f32_16x16x32_bf16 v[64:67], a[228:231], a[80:83], v[64:67]
  ds_read_b64_tr_b16 a[200:201], v15 offset:16384
  v_mfma_f32_16x16x32_bf16 v[92:95], a[232:235], a[80:83], v[92:95]
  buffer_load_dwordx4 v8, s[12:15], s38 offen offset:1024 sc1 lds
  v_mfma_f32_16x16x32_bf16 v[120:123], a[236:239], a[80:83], v[120:123]
  ds_read_b64_tr_b16 a[202:203], v15 offset:20480
  v_mfma_f32_16x16x32_bf16 v[148:151], a[240:243], a[80:83], v[148:151]
  v_mfma_f32_16x16x32_bf16 v[176:179], a[244:247], a[80:83], v[176:179]
  ds_read_b64_tr_b16 a[204:205], v16 offset:16384
  v_mfma_f32_16x16x32_bf16 v[204:207], a[248:251], a[80:83], v[204:207]
  buffer_load_dwordx4 v9, s[12:15], s38 offen offset:2048 sc1 lds
  v_mfma_f32_16x16x32_bf16 v[232:235], a[252:255], a[80:83], v[232:235]
  ds_read_b64_tr_b16 a[206:207], v16 offset:20480
  v_mfma_f32_16x16x32_bf16 v[40:43], a[224:227], a[84:87], v[40:43]
  buffer_load_dwordx4 a[80:83], v30, s[8:11], s47 offen offset:2048 sc1
  v_mfma_f32_16x16x32_bf16 v[68:71], a[228:231], a[84:87], v[68:71]
  ds_read_b64_tr_b16 a[208:209], v17 offset:16384
  v_mfma_f32_16x16x32_bf16 v[96:99], a[232:235], a[84:87], v[96:99]
  buffer_load_dwordx4 v10, s[12:15], s38 offen offset:3072 sc1 lds
  v_mfma_f32_16x16x32_bf16 v[124:127], a[236:239], a[84:87], v[124:127]
  ds_read_b64_tr_b16 a[210:211], v17 offset:20480
  v_mfma_f32_16x16x32_bf16 v[152:155], a[240:243], a[84:87], v[152:155]
  v_mfma_f32_16x16x32_bf16 v[180:183], a[244:247], a[84:87], v[180:183]
  ds_read_b64_tr_b16 a[212:213], v18 offset:16384
  v_mfma_f32_16x16x32_bf16 v[208:211], a[248:251], a[84:87], v[208:211]
  v_mfma_f32_16x16x32_bf16 v[236:239], a[252:255], a[84:87], v[236:239]
  ds_read_b64_tr_b16 a[214:215], v18 offset:20480
  v_mfma_f32_16x16x32_bf16 v[44:47], a[224:227], a[88:91], v[44:47]
  s_add_u32 s47, s29, 4096
  buffer_load_dwordx4 a[84:87], v30, s[8:11], s47 offen offset:0 sc1
  v_mfma_f32_16x16x32_bf16 v[72:75], a[228:231], a[88:91], v[72:75]
  ds_read_b64_tr_b16 a[216:217], v19 offset:16384
  v_mfma_f32_16x16x32_bf16 v[100:103], a[232:235], a[88:91], v[100:103]
  s_add_u32 m0, s28, 28672
  s_add_u32 s38, s36, 32768
  buffer_load_dwordx4 v7, s[12:15], s38 offen offset:0 sc1 lds
  v_mfma_f32_16x16x32_bf16 v[128:131], a[236:239], a[88:91], v[128:131]
  s_add_u32 s35, s35, 1
  ds_read_b64_tr_b16 a[218:219], v19 offset:20480
  v_mfma_f32_16x16x32_bf16 v[156:159], a[240:243], a[88:91], v[156:159]
  s_and_b32 s48, s35, 14
  v_mfma_f32_16x16x32_bf16 v[184:187], a[244:247], a[88:91], v[184:187]
  s_lshl_b32 s48, s48, 17
  ds_read_b64_tr_b16 a[220:221], v20 offset:16384
  v_mfma_f32_16x16x32_bf16 v[212:215], a[248:251], a[88:91], v[212:215]
  s_add_u32 s36, s30, s48
  buffer_load_dwordx4 v8, s[12:15], s38 offen offset:1024 sc1 lds
  v_mfma_f32_16x16x32_bf16 v[240:243], a[252:255], a[88:91], v[240:243]
  s_waitcnt lgkmcnt(8)
  s_and_b32 s48, s35, 16
  ds_read_b64_tr_b16 a[222:223], v20 offset:20480
  v_mfma_f32_16x16x32_bf16 v[48:51], a[224:227], a[92:95], v[48:51]
  s_lshl_b32 s48, s48, 13
  buffer_load_dwordx4 a[88:91], v30, s[8:11], s47 offen offset:2048 sc1
  v_mfma_f32_16x16x32_bf16 v[76:79], a[228:231], a[92:95], v[76:79]
  s_add_u32 s36, s36, s48
  v_mfma_f32_16x16x32_bf16 v[104:107], a[232:235], a[92:95], v[104:107]
  s_and_b32 s48, s35, 1
  buffer_load_dwordx4 v9, s[12:15], s38 offen offset:2048 sc1 lds
  v_mfma_f32_16x16x32_bf16 v[132:135], a[236:239], a[92:95], v[132:135]
  s_lshl_b32 s48, s48, 16
  v_mfma_f32_16x16x32_bf16 v[160:163], a[240:243], a[92:95], v[160:163]
  s_add_u32 s36, s36, s48
  v_mfma_f32_16x16x32_bf16 v[188:191], a[244:247], a[92:95], v[188:191]
  v_mfma_f32_16x16x32_bf16 v[216:219], a[248:251], a[92:95], v[216:219]
  v_mfma_f32_16x16x32_bf16 v[244:247], a[252:255], a[92:95], v[244:247]
  v_mfma_f32_16x16x32_bf16 v[52:55], a[224:227], a[112:115], v[52:55]
  s_add_u32 s47, s29, 8192
  buffer_load_dwordx4 a[92:95], v30, s[8:11], s47 offen offset:0 sc1
  v_mfma_f32_16x16x32_bf16 v[80:83], a[228:231], a[112:115], v[80:83]
  v_mfma_f32_16x16x32_bf16 v[108:111], a[232:235], a[112:115], v[108:111]
  buffer_load_dwordx4 v10, s[12:15], s38 offen offset:3072 sc1 lds
  v_mfma_f32_16x16x32_bf16 v[136:139], a[236:239], a[112:115], v[136:139]
  v_mfma_f32_16x16x32_bf16 v[164:167], a[240:243], a[112:115], v[164:167]
  v_mfma_f32_16x16x32_bf16 v[192:195], a[244:247], a[112:115], v[192:195]
  v_mfma_f32_16x16x32_bf16 v[220:223], a[248:251], a[112:115], v[220:223]
  v_mfma_f32_16x16x32_bf16 v[248:251], a[252:255], a[112:115], v[248:251]
  buffer_load_dwordx4 a[112:115], v30, s[8:11], s47 offen offset:2048 sc1
  s_add_u32 s29, s29, 26624
  s_add_u32 s31, s31, 1
  s_cmp_lt_u32 s31, 7
  s_cbranch_scc1 L2b_loop
  s_waitcnt vmcnt(14) lgkmcnt(0)
  v_mfma_f32_16x16x32_bf16 v[32:35], a[192:195], a[16:19], v[32:35]
  v_mfma_f32_16x16x32_bf16 v[60:63], a[196:199], a[16:19], v[60:63]
  ds_read_b64_tr_b16 a[224:225], v13 offset:0
  v_mfma_f32_16x16x32_bf16 v[88:91], a[200:203], a[16:19], v[88:91]
  v_mfma_f32_16x16x32_bf16 v[116:119], a[204:207], a[16:19], v[116:119]
  ds_read_b64_tr_b16 a[226:227], v13 offset:4096
  v_mfma_f32_16x16x32_bf16 v[144:147], a[208:211], a[16:19], v[144:147]
  v_mfma_f32_16x16x32_bf16 v[172:175], a[212:215], a[16:19], v[172:175]
  ds_read_b64_tr_b16 a[228:229], v14 offset:0
  v_mfma_f32_16x16x32_bf16 v[200:203], a[216:219], a[16:19], v[200:203]
  v_mfma_f32_16x16x32_bf16 v[228:231], a[220:223], a[16:19], v[228:231]
  ds_read_b64_tr_b16 a[230:231], v14 offset:4096
  v_mfma_f32_16x16x32_bf16 v[36:39], a[192:195], a[20:23], v[36:39]
  s_add_u32 s47, s29, 0
  buffer_load_dwordx4 a[16:19], v30, s[8:11], s47 offen offset:0 sc1
  v_mfma_f32_16x16x32_bf16 v[64:67], a[196:199], a[20:23], v[64:67]
  ds_read_b64_tr_b16 a[232:233], v15 offset:0
  v_mfma_f32_16x16x32_bf16 v[92:95], a[200:203], a[20:23], v[92:95]
  v_mfma_f32_16x16x32_bf16 v[120:123], a[204:207], a[20:23], v[120:123]
  ds_read_b64_tr_b16 a[234:235], v15 offset:4096
  v_mfma_f32_16x16x32_bf16 v[148:151], a[208:211], a[20:23], v[148:151]
  v_mfma_f32_16x16x32_bf16 v[176:179], a[212:215], a[20:23], v[176:179]
  ds_read_b64_tr_b16 a[236:237], v16 offset:0
  v_mfma_f32_16x16x32_bf16 v[204:207], a[216:219], a[20:23], v[204:207]
  v_mfma_f32_16x16x32_bf16 v[232:235], a[220:223], a[20:23], v[232:235]
  ds_read_b64_tr_b16 a[238:239], v16 offset:4096
  v_mfma_f32_16x16x32_bf16 v[40:43], a[192:195], a[24:27], v[40:43]
  buffer_load_dwordx4 a[20:23], v30, s[8:11], s47 offen offset:2048 sc1
  v_mfma_f32_16x16x32_bf16 v[68:71], a[196:199], a[24:27], v[68:71]
  ds_read_b64_tr_b16 a[240:241], v17 offset:0
  v_mfma_f32_16x16x32_bf16 v[96:99], a[200:203], a[24:27], v[96:99]
  v_mfma_f32_16x16x32_bf16 v[124:127], a[204:207], a[24:27], v[124:127]
  ds_read_b64_tr_b16 a[242:243], v17 offset:4096
  v_mfma_f32_16x16x32_bf16 v[152:155], a[208:211], a[24:27], v[152:155]
  v_mfma_f32_16x16x32_bf16 v[180:183], a[212:215], a[24:27], v[180:183]
  ds_read_b64_tr_b16 a[244:245], v18 offset:0
  v_mfma_f32_16x16x32_bf16 v[208:211], a[216:219], a[24:27], v[208:211]
  v_mfma_f32_16x16x32_bf16 v[236:239], a[220:223], a[24:27], v[236:239]
  ds_read_b64_tr_b16 a[246:247], v18 offset:4096
  v_mfma_f32_16x16x32_bf16 v[44:47], a[192:195], a[28:31], v[44:47]
  s_add_u32 s47, s29, 4096
  buffer_load_dwordx4 a[24:27], v30, s[8:11], s47 offen offset:0 sc1
  v_mfma_f32_16x16x32_bf16 v[72:75], a[196:199], a[28:31], v[72:75]
  ds_read_b64_tr_b16 a[248:249], v19 offset:0
  v_mfma_f32_16x16x32_bf16 v[100:103], a[200:203], a[28:31], v[100:103]
  v_mfma_f32_16x16x32_bf16 v[128:131], a[204:207], a[28:31], v[128:131]
  ds_read_b64_tr_b16 a[250:251], v19 offset:4096
  v_mfma_f32_16x16x32_bf16 v[156:159], a[208:211], a[28:31], v[156:159]
  v_mfma_f32_16x16x32_bf16 v[184:187], a[212:215], a[28:31], v[184:187]
  ds_read_b64_tr_b16 a[252:253], v20 offset:0
  v_mfma_f32_16x16x32_bf16 v[212:215], a[216:219], a[28:31], v[212:215]
  v_mfma_f32_16x16x32_bf16 v[240:243], a[220:223], a[28:31], v[240:243]
  s_waitcnt lgkmcnt(8)
  ds_read_b64_tr_b16 a[254:255], v20 offset:4096
  v_mfma_f32_16x16x32_bf16 v[48:51], a[192:195], a[48:51], v[48:51]
  buffer_load_dwordx4 a[28:31], v30, s[8:11], s47 offen offset:2048 sc1
  v_mfma_f32_16x16x32_bf16 v[76:79], a[196:199], a[48:51], v[76:79]
  v_mfma_f32_16x16x32_bf16 v[104:107], a[200:203], a[48:51], v[104:107]
  v_mfma_f32_16x16x32_bf16 v[132:135], a[204:207], a[48:51], v[132:135]
  v_mfma_f32_16x16x32_bf16 v[160:163], a[208:211], a[48:51], v[160:163]
  v_mfma_f32_16x16x32_bf16 v[188:191], a[212:215], a[48:51], v[188:191]
  v_mfma_f32_16x16x32_bf16 v[216:219], a[216:219], a[48:51], v[216:219]
  v_mfma_f32_16x16x32_bf16 v[244:247], a[220:223], a[48:51], v[244:247]
  v_mfma_f32_16x16x32_bf16 v[52:55], a[192:195], a[52:55], v[52:55]
  s_add_u32 s47, s29, 8192
  buffer_load_dwordx4 a[48:51], v30, s[8:11], s47 offen offset:0 sc1
  v_mfma_f32_16x16x32_bf16 v[80:83], a[196:199], a[52:55], v[80:83]
  v_mfma_f32_16x16x32_bf16 v[108:111], a[200:203], a[52:55], v[108:111]
  v_mfma_f32_16x16x32_bf16 v[136:139], a[204:207], a[52:55], v[136:139]
  v_mfma_f32_16x16x32_bf16 v[164:167], a[208:211], a[52:55], v[164:167]
  v_mfma_f32_16x16x32_bf16 v[192:195], a[212:215], a[52:55], v[192:195]
  v_mfma_f32_16x16x32_bf16 v[220:223], a[216:219], a[52:55], v[220:223]
  v_mfma_f32_16x16x32_bf16 v[248:251], a[220:223], a[52:55], v[248:251]
  buffer_load_dwordx4 a[52:55], v30, s[8:11], s47 offen offset:2048 sc1
  s_add_u32 s29, s29, 26624
  s_waitcnt vmcnt(6) lgkmcnt(0)
  v_mfma_f32_16x16x32_bf16 v[32:35], a[224:227], a[60:63], v[32:35]
  v_mfma_f32_16x16x32_bf16 v[60:63], a[228:231], a[60:63], v[60:63]
  ds_read_b64_tr_b16 a[192:193], v13 offset:8192
  v_mfma_f32_16x16x32_bf16 v[88:91], a[232:235], a[60:63], v[88:91]
  v_mfma_f32_16x16x32_bf16 v[116:119], a[236:239], a[60:63], v[116:119]
  ds_read_b64_tr_b16 a[194:195], v13 offset:12288
  v_mfma_f32_16x16x32_bf16 v[144:147], a[240:243], a[60:63], v[144:147]
  v_mfma_f32_16x16x32_bf16 v[172:175], a[244:247], a[60:63], v[172:175]
  ds_read_b64_tr_b16 a[196:197], v14 offset:8192
  v_mfma_f32_16x16x32_bf16 v[200:203], a[248:251], a[60:63], v[200:203]
  v_mfma_f32_16x16x32_bf16 v[228:231], a[252:255], a[60:63], v[228:231]
  ds_read_b64_tr_b16 a[198:199], v14 offset:12288
  v_mfma_f32_16x16x32_bf16 v[36:39], a[224:227], a[80:83], v[36:39]
  s_add_u32 s47, s29, 0
  buffer_load_dwordx4 a[60:63], v30, s[8:11], s47 offen offset:0 sc1
  v_mfma_f32_16x16x32_bf16 v[64:67], a[228:231], a[80:83], v[64:67]
  ds_read_b64_tr_b16 a[200:201], v15 offset:8192
  v_mfma_f32_16x16x32_bf16 v[92:95], a[232:235], a[80:83], v[92:95]
  v_mfma_f32_16x16x32_bf16 v[120:123], a[236:239], a[80:83], v[120:123]
  ds_read_b64_tr_b16 a[202:203], v15 offset:12288
  v_mfma_f32_16x16x32_bf16 v[148:151], a[240:243], a[80:83], v[148:151]
  v_mfma_f32_16x16x32_bf16 v[176:179], a[244:247], a[80:83], v[176:179]
  ds_read_b64_tr_b16 a[204:205], v16 offset:8192
  v_mfma_f32_16x16x32_bf16 v[204:207], a[248:251], a[80:83], v[204:207]
  v_mfma_f32_16x16x32_bf16 v[232:235], a[252:255], a[80:83], v[232:235]
  ds_read_b64_tr_b16 a[206:207], v16 offset:12288
  v_mfma_f32_16x16x32_bf16 v[40:43], a[224:227], a[84:87], v[40:43]
  buffer_load_dwordx4 a[80:83], v30, s[8:11], s47 offen offset:2048 sc1
  v_mfma_f32_16x16x32_bf16 v[68:71], a[228:231], a[84:87], v[68:71]
  ds_read_b64_tr_b16 a[208:209], v17 offset:8192
  v_mfma_f32_16x16x32_bf16 v[96:99], a[232:235], a[84:87], v[96:99]
  v_mfma_f32_16x16x32_bf16 v[124:127], a[236:239], a[84:87], v[124:127]
  ds_read_b64_tr_b16 a[210:211], v17 offset:12288
  v_mfma_f32_16x16x32_bf16 v[152:155], a[240:243], a[84:87], v[152:155]
  v_mfma_f32_16x16x32_bf16 v[180:183], a[244:247], a[84:87], v[180:183]
  ds_read_b64_tr_b16 a[212:213], v18 offset:8192
  v_mfma_f32_16x16x32_bf16 v[208:211], a[248:251], a[84:87], v[208:211]
  v_mfma_f32_16x16x32_bf16 v[236:239], a[252:255], a[84:87], v[236:239]
  ds_read_b64_tr_b16 a[214:215], v18 offset:12288
  v_mfma_f32_16x16x32_bf16 v[44:47], a[224:227], a[88:91], v[44:47]
  s_add_u32 s47, s29, 4096
  buffer_load_dwordx4 a[84:87], v30, s[8:11], s47 offen offset:0 sc1
  v_mfma_f32_16x16x32_bf16 v[72:75], a[228:231], a[88:91], v[72:75]
  ds_read_b64_tr_b16 a[216:217], v19 offset:8192
  v_mfma_f32_16x16x32_bf16 v[100:103], a[232:235], a[88:91], v[100:103]
  v_mfma_f32_16x16x32_bf16 v[128:131], a[236:239], a[88:91], v[128:131]
  ds_read_b64_tr_b16 a[218:219], v19 offset:12288
  v_mfma_f32_16x16x32_bf16 v[156:159], a[240:243], a[88:91], v[156:159]
  v_mfma_f32_16x16x32_bf16 v[184:187], a[244:247], a[88:91], v[184:187]
  ds_read_b64_tr_b16 a[220:221], v20 offset:8192
  v_mfma_f32_16x16x32_bf16 v[212:215], a[248:251], a[88:91], v[212:215]
  v_mfma_f32_16x16x32_bf16 v[240:243], a[252:255], a[88:91], v[240:243]
  s_waitcnt lgkmcnt(8)
  ds_read_b64_tr_b16 a[222:223], v20 offset:12288
  v_mfma_f32_16x16x32_bf16 v[48:51], a[224:227], a[92:95], v[48:51]
  buffer_load_dwordx4 a[88:91], v30, s[8:11], s47 offen offset:2048 sc1
  v_mfma_f32_16x16x32_bf16 v[76:79], a[228:231], a[92:95], v[76:79]
  v_mfma_f32_16x16x32_bf16 v[104:107], a[232:235], a[92:95], v[104:107]
  v_mfma_f32_16x16x32_bf16 v[132:135], a[236:239], a[92:95], v[132:135]
  v_mfma_f32_16x16x32_bf16 v[160:163], a[240:243], a[92:95], v[160:163]
  v_mfma_f32_16x16x32_bf16 v[188:191], a[244:247], a[92:95], v[188:191]
  v_mfma_f32_16x16x32_bf16 v[216:219], a[248:251], a[92:95], v[216:219]
  v_mfma_f32_16x16x32_bf16 v[244:247], a[252:255], a[92:95], v[244:247]
  v_mfma_f32_16x16x32_bf16 v[52:55], a[224:227], a[112:115], v[52:55]
  s_add_u32 s47, s29, 8192
  buffer_load_dwordx4 a[92:95], v30, s[8:11], s47 offen offset:0 sc1
  v_mfma_f32_16x16x32_bf16 v[80:83], a[228:231], a[112:115], v[80:83]
  v_mfma_f32_16x16x32_bf16 v[108:111], a[232:235], a[112:115], v[108:111]
  v_mfma_f32_16x16x32_bf16 v[136:139], a[236:239], a[112:115], v[136:139]
  v_mfma_f32_16x16x32_bf16 v[164:167], a[240:243], a[112:115], v[164:167]
  v_mfma_f32_16x16x32_bf16 v[192:195], a[244:247], a[112:115], v[192:195]
  v_mfma_f32_16x16x32_bf16 v[220:223], a[248:251], a[112:115], v[220:223]
  v_mfma_f32_16x16x32_bf16 v[248:251], a[252:255], a[112:115], v[248:251]
  buffer_load_dwordx4 a[112:115], v30, s[8:11], s47 offen offset:2048 sc1
  s_add_u32 s29, s29, 26624
  s_waitcnt vmcnt(6) lgkmcnt(0)
  v_mfma_f32_16x16x32_bf16 v[144:147], a[208:211], a[16:19], v[144:147]
  ds_read_b64_tr_b16 a[240:241], v17 offset:24576
  v_mfma_f32_16x16x32_bf16 v[172:175], a[212:215], a[16:19], v[172:175]
  ds_read_b64_tr_b16 a[242:243], v17 offset:28672
  v_lshl_add_u32 v22, v1, 4, s28
  v_mfma_f32_16x16x32_bf16 v[200:203], a[216:219], a[16:19], v[200:203]
  ds_read_b64_tr_b16 a[244:245], v18 offset:24576
  v_xor_b32 v23, 65536, v22
  v_mfma_f32_16x16x32_bf16 v[228:231], a[220:223], a[16:19], v[228:231]
  ds_read_b64_tr_b16 a[246:247], v18 offset:28672
  v_xor_b32 v28, 98304, v22
  v_mfma_f32_16x16x32_bf16 v[148:151], a[208:211], a[20:23], v[148:151]
  ds_read_b64_tr_b16 a[248:249], v19 offset:24576
  v_mfma_f32_16x16x32_bf16 v[176:179], a[212:215], a[20:23], v[176:179]
  ds_read_b64_tr_b16 a[250:251], v19 offset:28672
  v_mfma_f32_16x16x32_bf16 v[204:207], a[216:219], a[20:23], v[204:207]
  ds_read_b64_tr_b16 a[252:253], v20 offset:24576
  v_mfma_f32_16x16x32_bf16 v[232:235], a[220:223], a[20:23], v[232:235]
  ds_read_b64_tr_b16 a[254:255], v20 offset:28672
  v_mfma_f32_16x16x32_bf16 v[152:155], a[208:211], a[24:27], v[152:155]
  ds_read_b64_tr_b16 a[224:225], v13 offset:24576
  v_mfma_f32_16x16x32_bf16 v[180:183], a[212:215], a[24:27], v[180:183]
  ds_read_b64_tr_b16 a[226:227], v13 offset:28672
  v_mfma_f32_16x16x32_bf16 v[208:211], a[216:219], a[24:27], v[208:211]
  ds_read_b64_tr_b16 a[228:229], v14 offset:24576
  v_mfma_f32_16x16x32_bf16 v[236:239], a[220:223], a[24:27], v[236:239]
  ds_read_b64_tr_b16 a[230:231], v14 offset:28672
  v_mfma_f32_16x16x32_bf16 v[156:159], a[208:211], a[28:31], v[156:159]
  ds_read_b64_tr_b16 a[232:233], v15 offset:24576
  v_mfma_f32_16x16x32_bf16 v[184:187], a[212:215], a[28:31], v[184:187]
  ds_read_b64_tr_b16 a[234:235], v15 offset:28672
  v_mfma_f32_16x16x32_bf16 v[212:215], a[216:219], a[28:31], v[212:215]
  ds_read_b64_tr_b16 a[236:237], v16 offset:24576
  v_mfma_f32_16x16x32_bf16 v[240:243], a[220:223], a[28:31], v[240:243]
  s_waitcnt lgkmcnt(8)
  ds_read_b64_tr_b16 a[238:239], v16 offset:28672
  v_mfma_f32_16x16x32_bf16 v[160:163], a[208:211], a[48:51], v[160:163]
  v_mfma_f32_16x16x32_bf16 v[188:191], a[212:215], a[48:51], v[188:191]
  v_mfma_f32_16x16x32_bf16 v[216:219], a[216:219], a[48:51], v[216:219]
  v_mfma_f32_16x16x32_bf16 v[244:247], a[220:223], a[48:51], v[244:247]
  v_mfma_f32_16x16x32_bf16 v[164:167], a[208:211], a[52:55], v[164:167]
  v_mfma_f32_16x16x32_bf16 v[192:195], a[212:215], a[52:55], v[192:195]
  v_mfma_f32_16x16x32_bf16 v[220:223], a[216:219], a[52:55], v[220:223]
  v_mfma_f32_16x16x32_bf16 v[248:251], a[220:223], a[52:55], v[248:251]
  s_waitcnt vmcnt(0)
  v_mfma_f32_16x16x32_bf16 v[144:147], a[240:243], a[60:63], v[144:147]
  v_mfma_f32_16x16x32_bf16 v[172:175], a[244:247], a[60:63], v[172:175]
  v_mfma_f32_16x16x32_bf16 v[200:203], a[248:251], a[60:63], v[200:203]
  s_waitcnt lgkmcnt(8)
  v_mfma_f32_16x16x32_bf16 v[228:231], a[252:255], a[60:63], v[228:231]
  v_mfma_f32_16x16x32_bf16 v[148:151], a[240:243], a[80:83], v[148:151]
  v_mfma_f32_16x16x32_bf16 v[176:179], a[244:247], a[80:83], v[176:179]
  v_mfma_f32_16x16x32_bf16 v[204:207], a[248:251], a[80:83], v[204:207]
  v_mfma_f32_16x16x32_bf16 v[232:235], a[252:255], a[80:83], v[232:235]
  v_mfma_f32_16x16x32_bf16 v[152:155], a[240:243], a[84:87], v[152:155]
  v_mfma_f32_16x16x32_bf16 v[180:183], a[244:247], a[84:87], v[180:183]
  v_mfma_f32_16x16x32_bf16 v[208:211], a[248:251], a[84:87], v[208:211]
  ds_write_b128 v22, v[144:147] offset:12288
  v_mfma_f32_16x16x32_bf16 v[236:239], a[252:255], a[84:87], v[236:239]
  v_mfma_f32_16x16x32_bf16 v[156:159], a[240:243], a[88:91], v[156:159]
  ds_write_b128 v22, v[172:175] offset:18432
  v_mfma_f32_16x16x32_bf16 v[184:187], a[244:247], a[88:91], v[184:187]
  v_mfma_f32_16x16x32_bf16 v[212:215], a[248:251], a[88:91], v[212:215]
  v_mfma_f32_16x16x32_bf16 v[240:243], a[252:255], a[88:91], v[240:243]
  ds_write_b128 v22, v[200:203] offset:0
  v_mfma_f32_16x16x32_bf16 v[160:163], a[240:243], a[92:95], v[160:163]
  v_mfma_f32_16x16x32_bf16 v[188:191], a[244:247], a[92:95], v[188:191]
  ds_write_b128 v22, v[228:231] offset:6144
  v_mfma_f32_16x16x32_bf16 v[216:219], a[248:251], a[92:95], v[216:219]
  v_mfma_f32_16x16x32_bf16 v[244:247], a[252:255], a[92:95], v[244:247]
  v_mfma_f32_16x16x32_bf16 v[164:167], a[240:243], a[112:115], v[164:167]
  ds_write_b128 v22, v[148:151] offset:13312
  v_mfma_f32_16x16x32_bf16 v[192:195], a[244:247], a[112:115], v[192:195]
  v_mfma_f32_16x16x32_bf16 v[220:223], a[248:251], a[112:115], v[220:223]
  ds_write_b128 v22, v[176:179] offset:19456
  v_mfma_f32_16x16x32_bf16 v[248:251], a[252:255], a[112:115], v[248:251]
  v_mfma_f32_16x16x32_bf16 v[32:35], a[192:195], a[16:19], v[32:35]
  v_mfma_f32_16x16x32_bf16 v[60:63], a[196:199], a[16:19], v[60:63]
  ds_write_b128 v22, v[204:207] offset:1024
  v_mfma_f32_16x16x32_bf16 v[88:91], a[200:203], a[16:19], v[88:91]
  v_mfma_f32_16x16x32_bf16 v[116:119], a[204:207], a[16:19], v[116:119]
  v_mfma_f32_16x16x32_bf16 v[36:39], a[192:195], a[20:23], v[36:39]
  s_waitcnt lgkmcnt(8)
  ds_write_b128 v22, v[232:235] offset:7168
  v_mfma_f32_16x16x32_bf16 v[64:67], a[196:199], a[20:23], v[64:67]
  v_mfma_f32_16x16x32_bf16 v[92:95], a[200:203], a[20:23], v[92:95]
  ds_write_b128 v22, v[152:155] offset:14336
  v_mfma_f32_16x16x32_bf16 v[120:123], a[204:207], a[20:23], v[120:123]
  v_mfma_f32_16x16x32_bf16 v[40:43], a[192:195], a[24:27], v[40:43]
  v_mfma_f32_16x16x32_bf16 v[68:71], a[196:199], a[24:27], v[68:71]
  ds_write_b128 v22, v[180:183] offset:20480
  v_mfma_f32_16x16x32_bf16 v[96:99], a[200:203], a[24:27], v[96:99]
  v_mfma_f32_16x16x32_bf16 v[124:127], a[204:207], a[24:27], v[124:127]
  ds_write_b128 v22, v[208:211] offset:2048
  v_mfma_f32_16x16x32_bf16 v[44:47], a[192:195], a[28:31], v[44:47]
  v_mfma_f32_16x16x32_bf16 v[72:75], a[196:199], a[28:31], v[72:75]
  v_mfma_f32_16x16x32_bf16 v[100:103], a[200:203], a[28:31], v[100:103]
  ds_write_b128 v22, v[236:239] offset:8192
  v_mfma_f32_16x16x32_bf16 v[128:131], a[204:207], a[28:31], v[128:131]
  v_mfma_f32_16x16x32_bf16 v[48:51], a[192:195], a[48:51], v[48:51]
  v_mfma_f32_16x16x32_bf16 v[76:79], a[196:199], a[48:51], v[76:79]
  ds_write_b128 v22, v[156:159] offset:15360
  v_mfma_f32_16x16x32_bf16 v[104:107], a[200:203], a[48:51], v[104:107]
  v_mfma_f32_16x16x32_bf16 v[132:135], a[204:207], a[48:51], v[132:135]
  ds_write_b128 v22, v[184:187] offset:21504
  v_mfma_f32_16x16x32_bf16 v[52:55], a[192:195], a[52:55], v[52:55]
  v_mfma_f32_16x16x32_bf16 v[80:83], a[196:199], a[52:55], v[80:83]
  v_mfma_f32_16x16x32_bf16 v[108:111], a[200:203], a[52:55], v[108:111]
  s_waitcnt lgkmcnt(8)
  ds_write_b128 v22, v[212:215] offset:3072
  v_mfma_f32_16x16x32_bf16 v[136:139], a[204:207], a[52:55], v[136:139]
  v_mfma_f32_16x16x32_bf16 v[32:35], a[224:227], a[60:63], v[32:35]
  ds_write_b128 v22, v[240:243] offset:9216
  v_mfma_f32_16x16x32_bf16 v[60:63], a[228:231], a[60:63], v[60:63]
  v_mfma_f32_16x16x32_bf16 v[88:91], a[232:235], a[60:63], v[88:91]
  v_mfma_f32_16x16x32_bf16 v[116:119], a[236:239], a[60:63], v[116:119]
  ds_write_b128 v22, v[160:163] offset:16384
  v_mfma_f32_16x16x32_bf16 v[36:39], a[224:227], a[80:83], v[36:39]
  v_mfma_f32_16x16x32_bf16 v[64:67], a[228:231], a[80:83], v[64:67]
  ds_write_b128 v22, v[188:191] offset:22528
  v_mfma_f32_16x16x32_bf16 v[92:95], a[232:235], a[80:83], v[92:95]
  v_mfma_f32_16x16x32_bf16 v[120:123], a[236:239], a[80:83], v[120:123]
  v_mfma_f32_16x16x32_bf16 v[40:43], a[224:227], a[84:87], v[40:43]
  ds_write_b128 v22, v[216:219] offset:4096
  v_mfma_f32_16x16x32_bf16 v[68:71], a[228:231], a[84:87], v[68:71]
  v_mfma_f32_16x16x32_bf16 v[96:99], a[232:235], a[84:87], v[96:99]
  v_mfma_f32_16x16x32_bf16 v[124:127], a[236:239], a[84:87], v[124:127]
  ds_write_b128 v22, v[244:247] offset:10240
  v_mfma_f32_16x16x32_bf16 v[44:47], a[224:227], a[88:91], v[44:47]
  v_mfma_f32_16x16x32_bf16 v[72:75], a[228:231], a[88:91], v[72:75]
  ds_write_b128 v22, v[164:167] offset:17408
  v_mfma_f32_16x16x32_bf16 v[100:103], a[232:235], a[88:91], v[100:103]
  v_mfma_f32_16x16x32_bf16 v[128:131], a[236:239], a[88:91], v[128:131]
  v_mfma_f32_16x16x32_bf16 v[48:51], a[224:227], a[92:95], v[48:51]
  s_waitcnt lgkmcnt(8)
  ds_write_b128 v22, v[192:195] offset:23552
  v_mfma_f32_16x16x32_bf16 v[76:79], a[228:231], a[92:95], v[76:79]
  v_mfma_f32_16x16x32_bf16 v[104:107], a[232:235], a[92:95], v[104:107]
  ds_write_b128 v22, v[220:223] offset:5120
  v_mfma_f32_16x16x32_bf16 v[132:135], a[236:239], a[92:95], v[132:135]
  v_mfma_f32_16x16x32_bf16 v[52:55], a[224:227], a[112:115], v[52:55]
  v_mfma_f32_16x16x32_bf16 v[80:83], a[228:231], a[112:115], v[80:83]
  ds_write_b128 v22, v[248:251] offset:11264
  v_mfma_f32_16x16x32_bf16 v[108:111], a[232:235], a[112:115], v[108:111]
  v_mfma_f32_16x16x32_bf16 v[136:139], a[236:239], a[112:115], v[136:139]
  s_waitcnt lgkmcnt(0)
  s_barrier
  ds_read_b128 v[200:203], v23 offset:0
  ds_read_b128 v[204:207], v23 offset:1024
  ds_read_b128 v[208:211], v23 offset:2048
  ds_read_b128 v[212:215], v23 offset:3072
  ds_read_b128 v[216:219], v23 offset:4096
  ds_read_b128 v[220:223], v23 offset:5120
  ds_read_b128 v[228:231], v23 offset:6144
  ds_read_b128 v[232:235], v23 offset:7168
  ds_read_b128 v[236:239], v23 offset:8192
  ds_read_b128 v[240:243], v23 offset:9216
  ds_read_b128 v[244:247], v23 offset:10240
  ds_read_b128 v[248:251], v23 offset:11264
  s_waitcnt lgkmcnt(11)
  v_pk_add_f32 v[88:89], v[88:89], v[200:201]
  v_pk_add_f32 v[90:91], v[90:91], v[202:203]
  ds_write_b128 v23, v[88:91] offset:0
  ds_read_b128 v[144:147], v23 offset:12288
  s_waitcnt lgkmcnt(12)
  v_pk_add_f32 v[92:93], v[92:93], v[204:205]
  v_pk_add_f32 v[94:95], v[94:95], v[206:207]
  ds_write_b128 v23, v[92:95] offset:1024
  ds_read_b128 v[148:151], v23 offset:13312
  s_waitcnt lgkmcnt(13)
  v_pk_add_f32 v[96:97], v[96:97], v[208:209]
  v_pk_add_f32 v[98:99], v[98:99], v[210:211]
  ds_write_b128 v23, v[96:99] offset:2048
  ds_read_b128 v[152:155], v23 offset:14336
  s_waitcnt lgkmcnt(14)
  v_pk_add_f32 v[100:101], v[100:101], v[212:213]
  v_pk_add_f32 v[102:103], v[102:103], v[214:215]
  ds_write_b128 v23, v[100:103] offset:3072
  s_waitcnt lgkmcnt(8)
  ds_read_b128 v[156:159], v23 offset:15360
  v_pk_add_f32 v[104:105], v[104:105], v[216:217]
  v_pk_add_f32 v[106:107], v[106:107], v[218:219]
  ds_write_b128 v23, v[104:107] offset:4096
  ds_read_b128 v[160:163], v23 offset:16384
  v_pk_add_f32 v[108:109], v[108:109], v[220:221]
  v_pk_add_f32 v[110:111], v[110:111], v[222:223]
  ds_write_b128 v23, v[108:111] offset:5120
  ds_read_b128 v[164:167], v23 offset:17408
  v_pk_add_f32 v[116:117], v[116:117], v[228:229]
  v_pk_add_f32 v[118:119], v[118:119], v[230:231]
  ds_write_b128 v23, v[116:119] offset:6144
  ds_read_b128 v[172:175], v23 offset:18432
  v_pk_add_f32 v[120:121], v[120:121], v[232:233]
  v_pk_add_f32 v[122:123], v[122:123], v[234:235]
  s_waitcnt lgkmcnt(8)
  ds_write_b128 v23, v[120:123] offset:7168
  ds_read_b128 v[176:179], v23 offset:19456
  v_pk_add_f32 v[124:125], v[124:125], v[236:237]
  v_pk_add_f32 v[126:127], v[126:127], v[238:239]
  ds_write_b128 v23, v[124:127] offset:8192
  ds_read_b128 v[180:183], v23 offset:20480
  v_pk_add_f32 v[128:129], v[128:129], v[240:241]
  v_pk_add_f32 v[130:131], v[130:131], v[242:243]
  ds_write_b128 v23, v[128:131] offset:9216
  ds_read_b128 v[184:187], v23 offset:21504
  v_pk_add_f32 v[132:133], v[132:133], v[244:245]
  v_pk_add_f32 v[134:135], v[134:135], v[246:247]
  ds_write_b128 v23, v[132:135] offset:10240
  s_waitcnt lgkmcnt(8)
  ds_read_b128 v[188:191], v23 offset:22528
  v_pk_add_f32 v[136:137], v[136:137], v[248:249]
  v_pk_add_f32 v[138:139], v[138:139], v[250:251]
  ds_write_b128 v23, v[136:139] offset:11264
  ds_read_b128 v[192:195], v23 offset:23552
  v_pk_add_f32 v[32:33], v[32:33], v[144:145]
  v_pk_add_f32 v[34:35], v[34:35], v[146:147]
  v_pk_add_f32 v[36:37], v[36:37], v[148:149]
  v_pk_add_f32 v[38:39], v[38:39], v[150:151]
  v_pk_add_f32 v[40:41], v[40:41], v[152:153]
  v_pk_add_f32 v[42:43], v[42:43], v[154:155]
  v_pk_add_f32 v[44:45], v[44:45], v[156:157]
  v_pk_add_f32 v[46:47], v[46:47], v[158:159]
  v_pk_add_f32 v[48:49], v[48:49], v[160:161]
  v_pk_add_f32 v[50:51], v[50:51], v[162:163]
  v_pk_add_f32 v[52:53], v[52:53], v[164:165]
  v_pk_add_f32 v[54:55], v[54:55], v[166:167]
  s_waitcnt lgkmcnt(10)
  v_pk_add_f32 v[60:61], v[60:61], v[172:173]
  v_pk_add_f32 v[62:63], v[62:63], v[174:175]
  s_waitcnt lgkmcnt(8)
  v_pk_add_f32 v[64:65], v[64:65], v[176:177]
  v_pk_add_f32 v[66:67], v[66:67], v[178:179]
  s_waitcnt lgkmcnt(6)
  v_pk_add_f32 v[68:69], v[68:69], v[180:181]
  v_pk_add_f32 v[70:71], v[70:71], v[182:183]
  s_waitcnt lgkmcnt(4)
  v_pk_add_f32 v[72:73], v[72:73], v[184:185]
  v_pk_add_f32 v[74:75], v[74:75], v[186:187]
  s_waitcnt lgkmcnt(2)
  v_pk_add_f32 v[76:77], v[76:77], v[188:189]
  v_pk_add_f32 v[78:79], v[78:79], v[190:191]
  s_waitcnt lgkmcnt(0)
  v_pk_add_f32 v[80:81], v[80:81], v[192:193]
  v_pk_add_f32 v[82:83], v[82:83], v[194:195]
  s_waitcnt lgkmcnt(0)
  s_barrier
  ds_read_b128 v[88:91], v28 offset:0
  ds_read_b128 v[116:119], v28 offset:6144
  ds_read_b128 v[92:95], v28 offset:1024
  ds_read_b128 v[120:123], v28 offset:7168
  ds_read_b128 v[96:99], v28 offset:2048
  ds_read_b128 v[124:127], v28 offset:8192
  ds_read_b128 v[100:103], v28 offset:3072
  ds_read_b128 v[128:131], v28 offset:9216
  ds_read_b128 v[104:107], v28 offset:4096
  ds_read_b128 v[132:135], v28 offset:10240
  ds_read_b128 v[108:111], v28 offset:5120
  ds_read_b128 v[136:139], v28 offset:11264
  s_waitcnt lgkmcnt(11)
  v_pk_add_f32 v[32:33], v[32:33], v[88:89]
  v_pk_add_f32 v[34:35], v[34:35], v[90:91]
  s_waitcnt lgkmcnt(10)
  v_pk_add_f32 v[60:61], v[60:61], v[116:117]
  v_pk_add_f32 v[62:63], v[62:63], v[118:119]
  v_cvt_pk_bf16_f32 v144, v32, v33
  v_cvt_pk_bf16_f32 v145, v34, v35
  v_cvt_pk_bf16_f32 v146, v60, v61
  v_cvt_pk_bf16_f32 v147, v62, v63
  s_mov_b32 s46, 0
  s_nop 0
  v_permlane16_swap_b32 v144, v146
  v_permlane16_swap_b32 v145, v147
  buffer_store_dwordx4 v[144:147], v21, s[16:19], s46 offen offset:0 sc1
  s_waitcnt lgkmcnt(9)
  v_pk_add_f32 v[36:37], v[36:37], v[92:93]
  v_pk_add_f32 v[38:39], v[38:39], v[94:95]
  s_waitcnt lgkmcnt(8)
  v_pk_add_f32 v[64:65], v[64:65], v[120:121]
  v_pk_add_f32 v[66:67], v[66:67], v[122:123]
  v_cvt_pk_bf16_f32 v148, v36, v37
  v_cvt_pk_bf16_f32 v149, v38, v39
  v_cvt_pk_bf16_f32 v150, v64, v65
  v_cvt_pk_bf16_f32 v151, v66, v67
  s_mov_b32 s46, 32768
  s_nop 0
  v_permlane16_swap_b32 v148, v150
  v_permlane16_swap_b32 v149, v151
  buffer_store_dwordx4 v[148:151], v21, s[16:19], s46 offen offset:0 sc1
  s_waitcnt lgkmcnt(7)
  v_pk_add_f32 v[40:41], v[40:41], v[96:97]
  v_pk_add_f32 v[42:43], v[42:43], v[98:99]
  s_waitcnt lgkmcnt(6)
  v_pk_add_f32 v[68:69], v[68:69], v[124:125]
  v_pk_add_f32 v[70:71], v[70:71], v[126:127]
  v_cvt_pk_bf16_f32 v152, v40, v41
  v_cvt_pk_bf16_f32 v153, v42, v43
  v_cvt_pk_bf16_f32 v154, v68, v69
  v_cvt_pk_bf16_f32 v155, v70, v71
  s_mov_b32 s46, 65536
  s_nop 0
  v_permlane16_swap_b32 v152, v154
  v_permlane16_swap_b32 v153, v155
  buffer_store_dwordx4 v[152:155], v21, s[16:19], s46 offen offset:0 sc1
  s_waitcnt lgkmcnt(5)
  v_pk_add_f32 v[44:45], v[44:45], v[100:101]
  v_pk_add_f32 v[46:47], v[46:47], v[102:103]
  s_waitcnt lgkmcnt(4)
  v_pk_add_f32 v[72:73], v[72:73], v[128:129]
  v_pk_add_f32 v[74:75], v[74:75], v[130:131]
  v_cvt_pk_bf16_f32 v156, v44, v45
  v_cvt_pk_bf16_f32 v157, v46, v47
  v_cvt_pk_bf16_f32 v158, v72, v73
  v_cvt_pk_bf16_f32 v159, v74, v75
  s_mov_b32 s46, 98304
  s_nop 0
  v_permlane16_swap_b32 v156, v158
  v_permlane16_swap_b32 v157, v159
  buffer_store_dwordx4 v[156:159], v21, s[16:19], s46 offen offset:0 sc1
  s_waitcnt lgkmcnt(3)
  v_pk_add_f32 v[48:49], v[48:49], v[104:105]
  v_pk_add_f32 v[50:51], v[50:51], v[106:107]
  s_waitcnt lgkmcnt(2)
  v_pk_add_f32 v[76:77], v[76:77], v[132:133]
  v_pk_add_f32 v[78:79], v[78:79], v[134:135]
  v_cvt_pk_bf16_f32 v160, v48, v49
  v_cvt_pk_bf16_f32 v161, v50, v51
  v_cvt_pk_bf16_f32 v162, v76, v77
  v_cvt_pk_bf16_f32 v163, v78, v79
  s_mov_b32 s46, 131072
  s_nop 0
  v_permlane16_swap_b32 v160, v162
  v_permlane16_swap_b32 v161, v163
  buffer_store_dwordx4 v[160:163], v21, s[16:19], s46 offen offset:0 sc1
  s_waitcnt lgkmcnt(1)
  v_pk_add_f32 v[52:53], v[52:53], v[108:109]
  v_pk_add_f32 v[54:55], v[54:55], v[110:111]
  s_waitcnt lgkmcnt(0)
  v_pk_add_f32 v[80:81], v[80:81], v[136:137]
  v_pk_add_f32 v[82:83], v[82:83], v[138:139]
  v_cvt_pk_bf16_f32 v164, v52, v53
  v_cvt_pk_bf16_f32 v165, v54, v55
  v_cvt_pk_bf16_f32 v166, v80, v81
  v_cvt_pk_bf16_f32 v167, v82, v83
  s_mov_b32 s46, 163840
  s_nop 0
  v_permlane16_swap_b32 v164, v166
  v_permlane16_swap_b32 v165, v167
  buffer_store_dwordx4 v[164:167], v21, s[16:19], s46 offen offset:0 sc1
  s_endpgm
L_code_end:
.section .rodata,"a"
.p2align 6
.amdhsa_kernel standalone__mha_block_cached__near_ridge_kernel
  .amdhsa_next_free_vgpr 512
  .amdhsa_next_free_sgpr 102
  .amdhsa_accum_offset 256
  .amdhsa_group_segment_fixed_size 0
  .amdhsa_kernarg_size 64
  .amdhsa_user_sgpr_count 2
  .amdhsa_user_sgpr_kernarg_segment_ptr 1
  .amdhsa_system_sgpr_workgroup_id_x 1
  .amdhsa_float_denorm_mode_32 3
.end_amdhsa_kernel
```
